```python
import torch

def _softmax(x, axis=-1):
    return torch.softmax(x, dim=axis)

def _gelu(x):
    return torch.nn.functional.gelu(x, approximate='tanh')

def _silu(x):
    return torch.nn.functional.silu(x)

def _sigmoid(x):
    return torch.sigmoid(x)

def _layernorm(x, axis=-1, eps=1e-05):
    m = x.mean(dim=axis, keepdim=True)
    v = x.var(dim=axis, keepdim=True, unbiased=False)
    return (x - m) / torch.sqrt(v + eps)

def _scatter_add(tgt, idx, src, axis=0):
    return tgt.clone().index_add_(axis, idx, src)

def _segment_sum(src, seg, n):
    out = torch.zeros((n,) + src.shape[1:], dtype=src.dtype)
    return out.index_add_(0, seg, src)

def _pad(x, pw):
    flat = tuple((v for pair in reversed(pw) for v in pair))
    return torch.nn.functional.pad(x, flat)
kernel_name = 'adaLN_cond__sliding_block_cached__glu_gated_swiglu__prompt'

def setup_inputs():

    _w = lambda a: (lambda t: t.to(torch.bfloat16) if t.is_floating_point() else t)(torch.as_tensor(a))

    def _A_setup():
        B, Sq, D = (1, 2048, 576)
        Hq, Hkv, Sk, Dh = (32, 16, 2048, 128)
        assert Hq % Hkv == 0, (Hq, Hkv)
        return {'x': _w((lambda *s: torch.randn(*s, dtype=torch.bfloat16) * 0.05)(B, Sq, D)), 'k_cache': _w((lambda *s: torch.randn(*s, dtype=torch.bfloat16) * 1.6)(B, Hkv, Sk, Dh)), 'v_cache': _w((lambda *s: torch.randn(*s, dtype=torch.bfloat16) * 0.8)(B, Hkv, Sk, Dh)), 'wq': _w((lambda *s: torch.randn(*s, dtype=torch.bfloat16) * 1.6)(D, Hq * Dh) * D ** (-0.5)), 'wo': _w((lambda *s: torch.randn(*s, dtype=torch.bfloat16) * 0.8)(Hq * Dh, D) * (Hq * Dh) ** (-0.5))}
    _A_in = _A_setup()

    def _B_setup():
        B, S, D, F = (1, 2048, 576, 4608)
        return {'x': _w((lambda *s: torch.randn(*s, dtype=torch.bfloat16) * 0.05)(B, S, D)), 'w1': _w((lambda *s: torch.randn(*s, dtype=torch.bfloat16) * 0.4)(D, F) * (2.0 / D) ** 0.5), 'w3': _w((lambda *s: torch.randn(*s, dtype=torch.bfloat16) * 0.4)(D, F) * (2.0 / D) ** 0.5), 'w2': _w((lambda *s: torch.randn(*s, dtype=torch.bfloat16) * 0.4)(F, D) * (2.0 / F) ** 0.5)}
    _B_in = _B_setup()
    return {'A_x': _A_in['x'], 'A_k_cache': _A_in['k_cache'], 'A_v_cache': _A_in['v_cache'], 'A_wq': _A_in['wq'], 'A_wo': _A_in['wo'], 'B_x': _B_in['x'], 'B_w1': _B_in['w1'], 'B_w3': _B_in['w3'], 'B_w2': _B_in['w2'], 'c': _w((lambda *s: torch.randn(*s, dtype=torch.bfloat16) * 0.1)(1, 576) * 8.0), 'w_mod': _w((lambda *s: torch.randn(*s, dtype=torch.bfloat16) * 0.1)(576, 6 * 576) * 576 ** (-0.5) * 8.0)}

def reference(A_x, A_k_cache, A_v_cache, A_wq, A_wo, B_x, B_w1, B_w3, B_w2, c, w_mod):

    def _A_ref(x, k_cache, v_cache, wq, wo):
        B, Sq, D = x.shape
        Hq, Dh = (32, 128)
        Hkv, Sk = (k_cache.shape[1], k_cache.shape[2])
        W = min(4096, max(256, Sk // 4))
        rep = Hq // Hkv
        q = (lambda x, *d: x.permute(*d))((x @ wq).reshape(B, Sq, Hq, Dh), 0, 2, 1, 3)
        k = (lambda x, n, axis: torch.repeat_interleave(x, n, dim=axis))(k_cache[:, :, Sk - W:, :], rep, axis=1)
        v = (lambda x, n, axis: torch.repeat_interleave(x, n, dim=axis))(v_cache[:, :, Sk - W:, :], rep, axis=1)
        scores = torch.einsum('bhqd,bhkd->bhqk', q, k) * Dh ** (-0.5)
        p = _softmax(scores, axis=-1)
        o = torch.einsum('bhqk,bhkd->bhqd', p, v)
        return (lambda x, *d: x.permute(*d))(o, 0, 2, 1, 3).reshape(B, Sq, Hq * Dh) @ wo

    def _B_ref(x, w1, w3, w2):
        gate = torch.einsum('bsd,df->bsf', x, w1)
        up = torch.einsum('bsd,df->bsf', x, w3)
        h = _silu(gate) * up
        out = torch.einsum('bsf,fd->bsd', h, w2)
        return out
    x = A_x
    mod = (_silu(c) @ w_mod).reshape(c.shape[0], 6, 1, -1)
    sa, ca, ga, sb, cb, gb = (mod[:, 0].clone(), mod[:, 1].clone(), mod[:, 2].clone(), mod[:, 3].clone(), mod[:, 4].clone(), mod[:, 5].clone())
    h = _layernorm(x, axis=-1) * (1 + ca) + sa
    x = x + ga * _A_ref(h, A_k_cache, A_v_cache, A_wq, A_wo)
    h = _layernorm(x, axis=-1) * (1 + cb) + sb
    x = x + gb * _B_ref(h, B_w1, B_w3, B_w2)
    return x
```

```asm
; @launch grid=(256,1,1) block=(256,1,1) lds=163840
.amdgcn_target "amdgcn-amd-amdhsa--gfx950"
.text
.globl adaLN_cond__sliding_block_cached__glu_gated_swiglu__prompt_kernel
.p2align 8
.type adaLN_cond__sliding_block_cached__glu_gated_swiglu__prompt_kernel,@function
adaLN_cond__sliding_block_cached__glu_gated_swiglu__prompt_kernel:
  s_cmp_ge_u32 s2, 0x100
  s_cbranch_scc1 adaLN_cond__sliding_block_cached__glu_gated_swiglu__prompt_kernel_done
  s_load_dwordx2 s[4:5], s[0:1], 0x68
  s_load_dwordx2 s[24:25], s[0:1], 0x50
  s_load_dwordx2 s[28:29], s[0:1], 0x48
  s_load_dwordx2 s[32:33], s[0:1], 0
  s_load_dwordx2 s[36:37], s[0:1], 0x60
  s_load_dwordx2 s[40:41], s[0:1], 24
  s_load_dwordx2 s[44:45], s[0:1], 56
  s_getpc_b64 s[48:49]
adaLN_cond__sliding_block_cached__glu_gated_swiglu__prompt_kernel_pc:
  v_lshlrev_b32 v11, 7, v0
  v_add_u32 v11, 0, v11
  v_min_u32 v11, adaLN_cond__sliding_block_cached__glu_gated_swiglu__prompt_kernel_end-adaLN_cond__sliding_block_cached__glu_gated_swiglu__prompt_kernel_pc-4, v11
  global_load_dword a248, v11, s[48:49]
  v_lshlrev_b32 v11, 7, v0
  v_add_u32 v11, 0x8000, v11
  v_min_u32 v11, adaLN_cond__sliding_block_cached__glu_gated_swiglu__prompt_kernel_end-adaLN_cond__sliding_block_cached__glu_gated_swiglu__prompt_kernel_pc-4, v11
  global_load_dword a249, v11, s[48:49]
  s_and_b32 s50, s2, 15
  s_lshr_b32 s51, s2, 4
  v_lshrrev_b32 v9, 6, v0
  s_nop 0
  v_readfirstlane_b32 s53, v9
  v_and_b32 v1, 63, v0
  s_lshl_b32 s52, s51, 2
  s_add_u32 s52, s52, s53
  s_lshl_b32 s54, s53, 12
  s_mul_i32 s55, s53, 0xc00
  v_lshrrev_b32 v2, 5, v1
  v_bfe_u32 v3, v1, 4, 1
  v_bfe_u32 v4, v1, 2, 2
  v_and_b32 v5, 3, v1
  v_lshrrev_b32 v6, 4, v1
  v_lshlrev_b32 v7, 4, v5
  v_lshlrev_b32 v9, 5, v3
  v_lshlrev_b32 v10, 3, v5
  v_add_u32 v9, v9, v10
  v_lshlrev_b32 v10, 6, v4
  v_add_u32 v8, v9, v10
  v_lshlrev_b32 v9, 9, v2
  v_add_u32 v14, v9, v8
  v_add_u32 v15, 0x10000, v14
  v_lshlrev_b32 v12, 4, v1
  v_bfe_u32 v9, v1, 3, 2
  v_lshlrev_b32 v10, 7, v2
  s_mov_b32 s58, 0x24000
  v_mul_lo_u32 v11, v9, s58
  v_add_u32 v13, v11, v10
  v_and_b32 v9, 7, v1
  v_lshlrev_b32 v9, 4, v9
  v_add_u32 v13, v13, v9
  s_lshl_b32 s56, s51, 8
  v_mov_b32 v9, s56
  v_add_u32 v17, 0, v9
  v_mov_b32 v10, 0x40000000
  v_cmp_eq_u32 vcc, 64, v0
  s_nop 1
  v_cndmask_b32 v16, v10, v9
  v_cndmask_b32 v18, v10, v17
  s_lshl_b32 s59, s53, 3
  s_and_b32 s60, s53, 1
  s_lshl_b32 s61, s53, 5
  v_add_u32 v9, s59, v4
  v_lshlrev_b32 v9, 13, v9
  v_lshlrev_b32 v10, 6, v6
  v_add_u32 v9, v9, v10
  v_add_u32 v9, v9, v7
  v_mov_b32 v22, v9
  v_add_u32 v9, s59, v4
  v_lshlrev_b32 v9, 13, v9
  v_lshlrev_b32 v10, 6, v6
  v_add_u32 v9, v9, v10
  v_add_u32 v9, v9, v7
  v_add_u32 v23, 0x100, v9
  v_add_u32 v9, s59, v4
  v_add_u32 v9, 4, v9
  v_lshlrev_b32 v9, 13, v9
  v_lshlrev_b32 v10, 6, v6
  v_add_u32 v9, v9, v10
  v_add_u32 v9, v9, v7
  v_mov_b32 v24, v9
  v_add_u32 v9, s59, v4
  v_add_u32 v9, 4, v9
  v_lshlrev_b32 v9, 13, v9
  v_lshlrev_b32 v10, 6, v6
  v_add_u32 v9, v9, v10
  v_add_u32 v9, v9, v7
  v_add_u32 v25, 0x100, v9
  v_bfe_u32 v9, v1, 1, 3
  v_add_u32 v9, s59, v9
  v_lshlrev_b32 v9, 8, v9
  v_lshlrev_b32 v10, 5, v6
  v_add_u32 v9, v9, v10
  v_and_b32 v10, 1, v1
  v_xor_b32 v10, s60, v10
  v_lshlrev_b32 v10, 4, v10
  v_add_u32 v9, v9, v10
  v_add_u32 v26, 0, v9
  v_add_u32 v9, s59, v4
  v_lshlrev_b32 v9, 8, v9
  v_lshlrev_b32 v10, 6, v6
  v_add_u32 v9, v9, v10
  v_add_u32 v9, v9, v7
  v_add_u32 v28, 0, v9
  v_bfe_u32 v9, v1, 1, 3
  v_add_u32 v9, s59, v9
  v_lshlrev_b32 v9, 8, v9
  v_lshlrev_b32 v10, 5, v6
  v_add_u32 v9, v9, v10
  v_and_b32 v10, 1, v1
  v_xor_b32 v10, s60, v10
  v_lshlrev_b32 v10, 4, v10
  v_add_u32 v9, v9, v10
  v_add_u32 v27, 0x80, v9
  v_add_u32 v9, s59, v4
  v_lshlrev_b32 v9, 8, v9
  v_lshlrev_b32 v10, 6, v6
  v_add_u32 v9, v9, v10
  v_add_u32 v9, v9, v7
  v_add_u32 v29, 0x400, v9
  v_lshlrev_b32 v9, 2, v2
  v_add_u32 v9, v9, v4
  v_add_u32 v9, s61, v9
  v_lshlrev_b32 v10, 6, v3
  v_add_u32 v10, v10, v7
  s_mov_b32 s58, 0x480
  v_mul_lo_u32 v11, v9, s58
  v_add_u32 v30, v11, v10
  v_lshlrev_b32 v9, 2, v2
  v_add_u32 v9, v9, v4
  v_add_u32 v9, s61, v9
  v_add_u32 v9, 8, v9
  v_lshlrev_b32 v10, 6, v3
  v_add_u32 v10, v10, v7
  s_mov_b32 s58, 0x480
  v_mul_lo_u32 v11, v9, s58
  v_add_u32 v31, v11, v10
  v_lshlrev_b32 v9, 2, v2
  v_add_u32 v9, v9, v4
  v_add_u32 v9, s61, v9
  v_add_u32 v9, 16, v9
  v_lshlrev_b32 v10, 6, v3
  v_add_u32 v10, v10, v7
  s_mov_b32 s58, 0x480
  v_mul_lo_u32 v11, v9, s58
  v_add_u32 v32, v11, v10
  v_lshlrev_b32 v9, 2, v2
  v_add_u32 v9, v9, v4
  v_add_u32 v9, s61, v9
  v_add_u32 v9, 24, v9
  v_lshlrev_b32 v10, 6, v3
  v_add_u32 v10, v10, v7
  s_mov_b32 s58, 0x480
  v_mul_lo_u32 v11, v9, s58
  v_add_u32 v33, v11, v10
  v_lshlrev_b32 v9, 11, v2
  v_lshlrev_b32 v10, 6, v4
  v_add_u32 v9, v9, v10
  v_lshlrev_b32 v10, 5, v3
  v_add_u32 v9, v9, v10
  v_and_b32 v10, 1, v5
  v_lshlrev_b32 v10, 4, v10
  v_add_u32 v9, v9, v10
  v_lshrrev_b32 v10, 1, v5
  v_lshlrev_b32 v10, 3, v10
  v_add_u32 v34, v9, v10
  v_lshlrev_b32 v9, 10, v2
  v_add_u32 v38, v9, v8
  v_bfe_u32 v9, v1, 3, 2
  v_lshlrev_b32 v10, 12, v9
  v_and_b32 v9, 1, v9
  v_xor_b32 v9, v9, v2
  v_lshlrev_b32 v9, 4, v9
  v_add_u32 v10, v10, v9
  v_and_b32 v9, 7, v1
  v_lshlrev_b32 v9, 5, v9
  v_add_u32 v36, v10, v9
  v_add_u32 v35, 0x10000, v34
  v_add_u32 v37, 0x10000, v36
  v_add_u32 v39, 0x10000, v38
  s_lshl_b32 s62, s50, 9
  s_mul_i32 s63, s50, 0x80000
  s_add_u32 s63, s63, 0x60000
  s_mul_i32 s64, s50, 0x48000
  s_mul_i32 s65, s52, 0x9000
  s_mul_i32 s66, s52, 0x90000
  s_mul_i32 s56, s50, 0x2400
  s_add_u32 s66, s66, s56
  v_subrev_u32 v21, 64, v0
  v_lshrrev_b32 v9, 2, v21
  s_mul_i32 s56, s51, 36
  v_add_u32 v9, s56, v9
  v_lshlrev_b32 v9, 13, v9
  v_and_b32 v10, 3, v21
  v_lshlrev_b32 v10, 7, v10
  v_add_u32 v9, v9, v10
  v_mov_b32 v10, 0x40000000
  v_cmp_gt_u32 vcc, 0x90, v21
  s_nop 1
  v_cndmask_b32 v40, v10, v9
  s_mul_i32 s56, s51, 0x4800
  v_lshlrev_b32 v9, 7, v21
  v_add_u32 v9, s56, v9
  v_cndmask_b32 v42, v10, v9
  s_lshl_b32 s56, s51, 13
  v_lshlrev_b32 v9, 7, v21
  v_add_u32 v9, s56, v9
  v_cmp_gt_u32 vcc, 64, v21
  s_nop 1
  v_cndmask_b32 v41, v10, v9
  s_and_b32 s74, s50, 1
  s_lshr_b32 s75, s50, 1
  s_mul_i32 s75, s75, 0x240
  s_mul_i32 s56, s74, 0x140
  s_add_u32 s76, s75, s56
  s_lshl_b32 s77, s76, 1
  s_add_u32 s78, s75, 0x100
  s_lshl_b32 s78, s78, 1
  s_mul_i32 s82, s74, 0x51000
  s_mul_i32 s79, s76, 0x480
  s_add_u32 s80, s79, 0x36000
  s_sub_u32 s80, s80, s82
  s_mul_i32 s56, s74, 0x120
  s_add_u32 s81, s75, s56
  s_mul_i32 s81, s81, 0x480
  s_mov_b32 s83, 0xbfb8aa3b
  s_lshl_b32 s56, s53, 4
  v_lshlrev_b32 v9, 2, v2
  v_add_u32 v9, v9, v4
  v_add_u32 v9, s56, v9
  v_lshlrev_b32 v10, 6, v3
  v_add_u32 v10, v10, v7
  s_mov_b32 s58, 0x2400
  v_mul_lo_u32 v11, v9, s58
  v_add_u32 v19, v11, v10
  v_lshlrev_b32 v9, 2, v2
  v_add_u32 v9, v9, v4
  v_add_u32 v9, s56, v9
  v_add_u32 v9, 8, v9
  v_lshlrev_b32 v10, 6, v3
  v_add_u32 v10, v10, v7
  s_mov_b32 s58, 0x2400
  v_mul_lo_u32 v11, v9, s58
  v_add_u32 v20, v11, v10
  s_mul_i32 s56, s51, 36
  v_add_u32 v9, s56, v21
  s_mov_b32 s58, 0x2400
  v_mul_lo_u32 v9, v9, s58
  v_mov_b32 v10, 0x40000000
  v_cmp_gt_u32 vcc, 36, v21
  s_nop 1
  v_cndmask_b32 v21, v10, v9
  v_and_b32 v240, 7, v0
  v_cmp_gt_u32 s[86:87], 64, v0
  v_lshrrev_b32 v241, 4, v0
  v_lshlrev_b32 v245, 4, v241
  v_bfe_u32 v242, v0, 3, 1
  v_lshlrev_b32 v242, 2, v242
  v_add_u32 v245, v245, v242
  s_lshl_b32 s88, s2, 3
  v_add_u32 v241, s88, v240
  v_mul_u32_u24 v241, 0x240, v241
  v_add_u32 v241, v241, v245
  v_lshlrev_b32 v243, 1, v241
  v_lshlrev_b32 v245, 2, v245
  v_lshrrev_b32 v241, 4, v0
  v_lshlrev_b32 v241, 10, v241
  v_bfe_u32 v242, v0, 3, 1
  v_lshlrev_b32 v242, 9, v242
  v_add_u32 v241, v241, v242
  v_lshlrev_b32 v242, 4, v240
  v_add_u32 v247, v241, v242
  v_lshlrev_b32 v249, 4, v0
  v_lshlrev_b32 v251, 5, v0
  v_mov_b32 v241, 0x40000000
  v_add_u32 v242, 0x400, v243
  v_cndmask_b32 v244, v241, v242, s[86:87]
  v_add_u32 v242, 0x800, v245
  v_cndmask_b32 v246, v241, v242, s[86:87]
  v_add_u32 v242, 0x8000, v247
  v_cndmask_b32 v248, v241, v242, s[86:87]
  v_add_u32 v242, 0x2000, v249
  v_cndmask_b32 v250, v241, v242, s[86:87]
  v_add_u32 v242, 0x4000, v251
  v_cndmask_b32 v252, v241, v242, s[86:87]
  s_mov_b32 s26, 0x3cc000
  s_mov_b32 s27, 0x20000
  s_waitcnt lgkmcnt(0)
  s_mov_b32 s30, 0x480
  s_mov_b32 s31, 0x20000
  s_mov_b32 s34, 0x240000
  s_mov_b32 s35, 0x20000
  s_mov_b32 s38, 0x100
  s_mov_b32 s39, 0x20000
  s_mov_b32 s42, 0x480000
  s_mov_b32 s43, 0x20000
  s_mov_b32 s46, 0x510000
  s_mov_b32 s47, 0x20000
  s_add_u32 s8, s4, 0x8000
  s_addc_u32 s9, s5, 0
  s_mov_b32 s10, 0x2000
  s_mov_b32 s11, 0x20000
  s_mov_b32 s20, s4
  s_mov_b32 s21, s5
  s_mov_b32 s22, 0x3600
  s_mov_b32 s23, 0x20000
  s_add_u32 s16, s4, 0x10000
  s_addc_u32 s17, s5, 0
  s_mov_b32 s18, 0x240000
  s_mov_b32 s19, 0x20000
  s_add_u32 s12, s4, 0x1000000
  s_addc_u32 s13, s5, 0
  s_mov_b32 s14, 0x2400000
  s_mov_b32 s15, 0x20000
  s_lshl_b32 s56, s2, 8
  v_lshlrev_b32 v9, 7, v0
  v_add_u32 v9, s56, v9
  v_mov_b32 v10, 0x40000000
  v_cmp_gt_u32 vcc, 2, v0
  s_nop 1
  v_cndmask_b32 v9, v10, v9
  s_cmp_lt_u32 s2, 32
  s_cselect_b32 s56, 0, 0x40000000
  v_add_u32 v9, s56, v9
  v_mov_b32 v10, 0
  buffer_store_dword v10, v9, s[8:11], 0 offen sc1
  buffer_load_dwordx2 v[64:65], v243, s[32:35], 0 offen
  buffer_load_dwordx2 v[66:67], v243, s[32:35], 0 offen offset:16
  buffer_load_dwordx2 v[68:69], v243, s[32:35], 0 offen offset:512
  buffer_load_dwordx2 v[70:71], v243, s[32:35], 0 offen offset:528
  buffer_load_dwordx2 v[72:73], v244, s[32:35], 0 offen
  buffer_load_dwordx2 v[74:75], v244, s[32:35], 0 offen offset:16
  s_cmp_ge_u32 s2, 54
  s_cbranch_scc1 adaLN_cond__sliding_block_cached__glu_gated_swiglu__prompt_kernel_nomod
  v_and_b32 v76, 7, v0
  v_lshrrev_b32 v77, 3, v0
  v_lshlrev_b32 v78, 1, v77
  buffer_load_ushort v80, v78, s[28:31], 0 offen
  buffer_load_ushort v81, v78, s[28:31], 0 offen offset:64
  buffer_load_ushort v82, v78, s[28:31], 0 offen offset:128
  buffer_load_ushort v83, v78, s[28:31], 0 offen offset:192
  buffer_load_ushort v84, v78, s[28:31], 0 offen offset:256
  buffer_load_ushort v85, v78, s[28:31], 0 offen offset:320
  buffer_load_ushort v86, v78, s[28:31], 0 offen offset:384
  buffer_load_ushort v87, v78, s[28:31], 0 offen offset:448
  buffer_load_ushort v88, v78, s[28:31], 0 offen offset:512
  buffer_load_ushort v89, v78, s[28:31], 0 offen offset:576
  buffer_load_ushort v90, v78, s[28:31], 0 offen offset:640
  buffer_load_ushort v91, v78, s[28:31], 0 offen offset:704
  buffer_load_ushort v92, v78, s[28:31], 0 offen offset:768
  buffer_load_ushort v93, v78, s[28:31], 0 offen offset:832
  buffer_load_ushort v94, v78, s[28:31], 0 offen offset:896
  buffer_load_ushort v95, v78, s[28:31], 0 offen offset:960
  buffer_load_ushort v96, v78, s[28:31], 0 offen offset:1024
  buffer_load_ushort v97, v78, s[28:31], 0 offen offset:1088
  s_mov_b32 s58, 0x1b00
  v_mul_lo_u32 v79, v77, s58
  v_lshlrev_b32 v78, 4, v76
  v_add_u32 v79, v79, v78
  s_lshl_b32 s57, s2, 7
  s_add_u32 s56, s57, 0
  buffer_load_dwordx4 v[100:103], v79, s[24:27], s56 offen
  s_add_u32 s56, s57, 0x36000
  buffer_load_dwordx4 v[104:107], v79, s[24:27], s56 offen
  s_add_u32 s56, s57, 0x6c000
  buffer_load_dwordx4 v[108:111], v79, s[24:27], s56 offen
  s_add_u32 s56, s57, 0xa2000
  buffer_load_dwordx4 v[112:115], v79, s[24:27], s56 offen
  s_add_u32 s56, s57, 0xd8000
  buffer_load_dwordx4 v[116:119], v79, s[24:27], s56 offen
  s_add_u32 s56, s57, 0x10e000
  buffer_load_dwordx4 v[120:123], v79, s[24:27], s56 offen
  s_add_u32 s56, s57, 0x144000
  buffer_load_dwordx4 v[124:127], v79, s[24:27], s56 offen
  s_add_u32 s56, s57, 0x17a000
  buffer_load_dwordx4 v[128:131], v79, s[24:27], s56 offen
  s_add_u32 s56, s57, 0x1b0000
  buffer_load_dwordx4 v[132:135], v79, s[24:27], s56 offen
  s_add_u32 s56, s57, 0x1e6000
  buffer_load_dwordx4 v[136:139], v79, s[24:27], s56 offen
  s_add_u32 s56, s57, 0x21c000
  buffer_load_dwordx4 v[140:143], v79, s[24:27], s56 offen
  s_add_u32 s56, s57, 0x252000
  buffer_load_dwordx4 v[144:147], v79, s[24:27], s56 offen
  s_add_u32 s56, s57, 0x288000
  buffer_load_dwordx4 v[148:151], v79, s[24:27], s56 offen
  s_add_u32 s56, s57, 0x2be000
  buffer_load_dwordx4 v[152:155], v79, s[24:27], s56 offen
  s_add_u32 s56, s57, 0x2f4000
  buffer_load_dwordx4 v[156:159], v79, s[24:27], s56 offen
  s_add_u32 s56, s57, 0x32a000
  buffer_load_dwordx4 v[160:163], v79, s[24:27], s56 offen
  s_add_u32 s56, s57, 0x360000
  buffer_load_dwordx4 v[164:167], v79, s[24:27], s56 offen
  s_add_u32 s56, s57, 0x396000
  buffer_load_dwordx4 v[168:171], v79, s[24:27], s56 offen
  s_waitcnt vmcnt(35)
  v_lshlrev_b32 v80, 16, v80
  v_mul_f32 v79, s83, v80
  v_exp_f32 v79, v79
  s_nop 0
  v_add_f32 v79, 1.0, v79
  v_rcp_f32 v79, v79
  s_nop 0
  v_mul_f32 v80, v80, v79
  s_waitcnt vmcnt(34)
  v_lshlrev_b32 v81, 16, v81
  v_mul_f32 v79, s83, v81
  v_exp_f32 v79, v79
  s_nop 0
  v_add_f32 v79, 1.0, v79
  v_rcp_f32 v79, v79
  s_nop 0
  v_mul_f32 v81, v81, v79
  s_waitcnt vmcnt(33)
  v_lshlrev_b32 v82, 16, v82
  v_mul_f32 v79, s83, v82
  v_exp_f32 v79, v79
  s_nop 0
  v_add_f32 v79, 1.0, v79
  v_rcp_f32 v79, v79
  s_nop 0
  v_mul_f32 v82, v82, v79
  s_waitcnt vmcnt(32)
  v_lshlrev_b32 v83, 16, v83
  v_mul_f32 v79, s83, v83
  v_exp_f32 v79, v79
  s_nop 0
  v_add_f32 v79, 1.0, v79
  v_rcp_f32 v79, v79
  s_nop 0
  v_mul_f32 v83, v83, v79
  s_waitcnt vmcnt(31)
  v_lshlrev_b32 v84, 16, v84
  v_mul_f32 v79, s83, v84
  v_exp_f32 v79, v79
  s_nop 0
  v_add_f32 v79, 1.0, v79
  v_rcp_f32 v79, v79
  s_nop 0
  v_mul_f32 v84, v84, v79
  s_waitcnt vmcnt(30)
  v_lshlrev_b32 v85, 16, v85
  v_mul_f32 v79, s83, v85
  v_exp_f32 v79, v79
  s_nop 0
  v_add_f32 v79, 1.0, v79
  v_rcp_f32 v79, v79
  s_nop 0
  v_mul_f32 v85, v85, v79
  s_waitcnt vmcnt(29)
  v_lshlrev_b32 v86, 16, v86
  v_mul_f32 v79, s83, v86
  v_exp_f32 v79, v79
  s_nop 0
  v_add_f32 v79, 1.0, v79
  v_rcp_f32 v79, v79
  s_nop 0
  v_mul_f32 v86, v86, v79
  s_waitcnt vmcnt(28)
  v_lshlrev_b32 v87, 16, v87
  v_mul_f32 v79, s83, v87
  v_exp_f32 v79, v79
  s_nop 0
  v_add_f32 v79, 1.0, v79
  v_rcp_f32 v79, v79
  s_nop 0
  v_mul_f32 v87, v87, v79
  s_waitcnt vmcnt(27)
  v_lshlrev_b32 v88, 16, v88
  v_mul_f32 v79, s83, v88
  v_exp_f32 v79, v79
  s_nop 0
  v_add_f32 v79, 1.0, v79
  v_rcp_f32 v79, v79
  s_nop 0
  v_mul_f32 v88, v88, v79
  s_waitcnt vmcnt(26)
  v_lshlrev_b32 v89, 16, v89
  v_mul_f32 v79, s83, v89
  v_exp_f32 v79, v79
  s_nop 0
  v_add_f32 v79, 1.0, v79
  v_rcp_f32 v79, v79
  s_nop 0
  v_mul_f32 v89, v89, v79
  s_waitcnt vmcnt(25)
  v_lshlrev_b32 v90, 16, v90
  v_mul_f32 v79, s83, v90
  v_exp_f32 v79, v79
  s_nop 0
  v_add_f32 v79, 1.0, v79
  v_rcp_f32 v79, v79
  s_nop 0
  v_mul_f32 v90, v90, v79
  s_waitcnt vmcnt(24)
  v_lshlrev_b32 v91, 16, v91
  v_mul_f32 v79, s83, v91
  v_exp_f32 v79, v79
  s_nop 0
  v_add_f32 v79, 1.0, v79
  v_rcp_f32 v79, v79
  s_nop 0
  v_mul_f32 v91, v91, v79
  s_waitcnt vmcnt(23)
  v_lshlrev_b32 v92, 16, v92
  v_mul_f32 v79, s83, v92
  v_exp_f32 v79, v79
  s_nop 0
  v_add_f32 v79, 1.0, v79
  v_rcp_f32 v79, v79
  s_nop 0
  v_mul_f32 v92, v92, v79
  s_waitcnt vmcnt(22)
  v_lshlrev_b32 v93, 16, v93
  v_mul_f32 v79, s83, v93
  v_exp_f32 v79, v79
  s_nop 0
  v_add_f32 v79, 1.0, v79
  v_rcp_f32 v79, v79
  s_nop 0
  v_mul_f32 v93, v93, v79
  s_waitcnt vmcnt(21)
  v_lshlrev_b32 v94, 16, v94
  v_mul_f32 v79, s83, v94
  v_exp_f32 v79, v79
  s_nop 0
  v_add_f32 v79, 1.0, v79
  v_rcp_f32 v79, v79
  s_nop 0
  v_mul_f32 v94, v94, v79
  s_waitcnt vmcnt(20)
  v_lshlrev_b32 v95, 16, v95
  v_mul_f32 v79, s83, v95
  v_exp_f32 v79, v79
  s_nop 0
  v_add_f32 v79, 1.0, v79
  v_rcp_f32 v79, v79
  s_nop 0
  v_mul_f32 v95, v95, v79
  s_waitcnt vmcnt(19)
  v_lshlrev_b32 v96, 16, v96
  v_mul_f32 v79, s83, v96
  v_exp_f32 v79, v79
  s_nop 0
  v_add_f32 v79, 1.0, v79
  v_rcp_f32 v79, v79
  s_nop 0
  v_mul_f32 v96, v96, v79
  s_waitcnt vmcnt(18)
  v_lshlrev_b32 v97, 16, v97
  v_mul_f32 v79, s83, v97
  v_exp_f32 v79, v79
  s_nop 0
  v_add_f32 v79, 1.0, v79
  v_rcp_f32 v79, v79
  s_nop 0
  v_mul_f32 v97, v97, v79
  s_waitcnt vmcnt(17)
  v_lshlrev_b32 v180, 16, v100
  v_and_b32 v181, 0xffff0000, v100
  v_mul_f32 v172, v180, v80
  v_mul_f32 v173, v181, v80
  v_lshlrev_b32 v180, 16, v101
  v_and_b32 v181, 0xffff0000, v101
  v_mul_f32 v174, v180, v80
  v_mul_f32 v175, v181, v80
  v_lshlrev_b32 v180, 16, v102
  v_and_b32 v181, 0xffff0000, v102
  v_mul_f32 v176, v180, v80
  v_mul_f32 v177, v181, v80
  v_lshlrev_b32 v180, 16, v103
  v_and_b32 v181, 0xffff0000, v103
  v_mul_f32 v178, v180, v80
  v_mul_f32 v179, v181, v80
  s_waitcnt vmcnt(16)
  v_lshlrev_b32 v180, 16, v104
  v_and_b32 v181, 0xffff0000, v104
  v_fmac_f32 v172, v180, v81
  v_fmac_f32 v173, v181, v81
  v_lshlrev_b32 v180, 16, v105
  v_and_b32 v181, 0xffff0000, v105
  v_fmac_f32 v174, v180, v81
  v_fmac_f32 v175, v181, v81
  v_lshlrev_b32 v180, 16, v106
  v_and_b32 v181, 0xffff0000, v106
  v_fmac_f32 v176, v180, v81
  v_fmac_f32 v177, v181, v81
  v_lshlrev_b32 v180, 16, v107
  v_and_b32 v181, 0xffff0000, v107
  v_fmac_f32 v178, v180, v81
  v_fmac_f32 v179, v181, v81
  s_waitcnt vmcnt(15)
  v_lshlrev_b32 v180, 16, v108
  v_and_b32 v181, 0xffff0000, v108
  v_fmac_f32 v172, v180, v82
  v_fmac_f32 v173, v181, v82
  v_lshlrev_b32 v180, 16, v109
  v_and_b32 v181, 0xffff0000, v109
  v_fmac_f32 v174, v180, v82
  v_fmac_f32 v175, v181, v82
  v_lshlrev_b32 v180, 16, v110
  v_and_b32 v181, 0xffff0000, v110
  v_fmac_f32 v176, v180, v82
  v_fmac_f32 v177, v181, v82
  v_lshlrev_b32 v180, 16, v111
  v_and_b32 v181, 0xffff0000, v111
  v_fmac_f32 v178, v180, v82
  v_fmac_f32 v179, v181, v82
  s_waitcnt vmcnt(14)
  v_lshlrev_b32 v180, 16, v112
  v_and_b32 v181, 0xffff0000, v112
  v_fmac_f32 v172, v180, v83
  v_fmac_f32 v173, v181, v83
  v_lshlrev_b32 v180, 16, v113
  v_and_b32 v181, 0xffff0000, v113
  v_fmac_f32 v174, v180, v83
  v_fmac_f32 v175, v181, v83
  v_lshlrev_b32 v180, 16, v114
  v_and_b32 v181, 0xffff0000, v114
  v_fmac_f32 v176, v180, v83
  v_fmac_f32 v177, v181, v83
  v_lshlrev_b32 v180, 16, v115
  v_and_b32 v181, 0xffff0000, v115
  v_fmac_f32 v178, v180, v83
  v_fmac_f32 v179, v181, v83
  s_waitcnt vmcnt(13)
  v_lshlrev_b32 v180, 16, v116
  v_and_b32 v181, 0xffff0000, v116
  v_fmac_f32 v172, v180, v84
  v_fmac_f32 v173, v181, v84
  v_lshlrev_b32 v180, 16, v117
  v_and_b32 v181, 0xffff0000, v117
  v_fmac_f32 v174, v180, v84
  v_fmac_f32 v175, v181, v84
  v_lshlrev_b32 v180, 16, v118
  v_and_b32 v181, 0xffff0000, v118
  v_fmac_f32 v176, v180, v84
  v_fmac_f32 v177, v181, v84
  v_lshlrev_b32 v180, 16, v119
  v_and_b32 v181, 0xffff0000, v119
  v_fmac_f32 v178, v180, v84
  v_fmac_f32 v179, v181, v84
  s_waitcnt vmcnt(12)
  v_lshlrev_b32 v180, 16, v120
  v_and_b32 v181, 0xffff0000, v120
  v_fmac_f32 v172, v180, v85
  v_fmac_f32 v173, v181, v85
  v_lshlrev_b32 v180, 16, v121
  v_and_b32 v181, 0xffff0000, v121
  v_fmac_f32 v174, v180, v85
  v_fmac_f32 v175, v181, v85
  v_lshlrev_b32 v180, 16, v122
  v_and_b32 v181, 0xffff0000, v122
  v_fmac_f32 v176, v180, v85
  v_fmac_f32 v177, v181, v85
  v_lshlrev_b32 v180, 16, v123
  v_and_b32 v181, 0xffff0000, v123
  v_fmac_f32 v178, v180, v85
  v_fmac_f32 v179, v181, v85
  s_waitcnt vmcnt(11)
  v_lshlrev_b32 v180, 16, v124
  v_and_b32 v181, 0xffff0000, v124
  v_fmac_f32 v172, v180, v86
  v_fmac_f32 v173, v181, v86
  v_lshlrev_b32 v180, 16, v125
  v_and_b32 v181, 0xffff0000, v125
  v_fmac_f32 v174, v180, v86
  v_fmac_f32 v175, v181, v86
  v_lshlrev_b32 v180, 16, v126
  v_and_b32 v181, 0xffff0000, v126
  v_fmac_f32 v176, v180, v86
  v_fmac_f32 v177, v181, v86
  v_lshlrev_b32 v180, 16, v127
  v_and_b32 v181, 0xffff0000, v127
  v_fmac_f32 v178, v180, v86
  v_fmac_f32 v179, v181, v86
  s_waitcnt vmcnt(10)
  v_lshlrev_b32 v180, 16, v128
  v_and_b32 v181, 0xffff0000, v128
  v_fmac_f32 v172, v180, v87
  v_fmac_f32 v173, v181, v87
  v_lshlrev_b32 v180, 16, v129
  v_and_b32 v181, 0xffff0000, v129
  v_fmac_f32 v174, v180, v87
  v_fmac_f32 v175, v181, v87
  v_lshlrev_b32 v180, 16, v130
  v_and_b32 v181, 0xffff0000, v130
  v_fmac_f32 v176, v180, v87
  v_fmac_f32 v177, v181, v87
  v_lshlrev_b32 v180, 16, v131
  v_and_b32 v181, 0xffff0000, v131
  v_fmac_f32 v178, v180, v87
  v_fmac_f32 v179, v181, v87
  s_waitcnt vmcnt(9)
  v_lshlrev_b32 v180, 16, v132
  v_and_b32 v181, 0xffff0000, v132
  v_fmac_f32 v172, v180, v88
  v_fmac_f32 v173, v181, v88
  v_lshlrev_b32 v180, 16, v133
  v_and_b32 v181, 0xffff0000, v133
  v_fmac_f32 v174, v180, v88
  v_fmac_f32 v175, v181, v88
  v_lshlrev_b32 v180, 16, v134
  v_and_b32 v181, 0xffff0000, v134
  v_fmac_f32 v176, v180, v88
  v_fmac_f32 v177, v181, v88
  v_lshlrev_b32 v180, 16, v135
  v_and_b32 v181, 0xffff0000, v135
  v_fmac_f32 v178, v180, v88
  v_fmac_f32 v179, v181, v88
  s_waitcnt vmcnt(8)
  v_lshlrev_b32 v180, 16, v136
  v_and_b32 v181, 0xffff0000, v136
  v_fmac_f32 v172, v180, v89
  v_fmac_f32 v173, v181, v89
  v_lshlrev_b32 v180, 16, v137
  v_and_b32 v181, 0xffff0000, v137
  v_fmac_f32 v174, v180, v89
  v_fmac_f32 v175, v181, v89
  v_lshlrev_b32 v180, 16, v138
  v_and_b32 v181, 0xffff0000, v138
  v_fmac_f32 v176, v180, v89
  v_fmac_f32 v177, v181, v89
  v_lshlrev_b32 v180, 16, v139
  v_and_b32 v181, 0xffff0000, v139
  v_fmac_f32 v178, v180, v89
  v_fmac_f32 v179, v181, v89
  s_waitcnt vmcnt(7)
  v_lshlrev_b32 v180, 16, v140
  v_and_b32 v181, 0xffff0000, v140
  v_fmac_f32 v172, v180, v90
  v_fmac_f32 v173, v181, v90
  v_lshlrev_b32 v180, 16, v141
  v_and_b32 v181, 0xffff0000, v141
  v_fmac_f32 v174, v180, v90
  v_fmac_f32 v175, v181, v90
  v_lshlrev_b32 v180, 16, v142
  v_and_b32 v181, 0xffff0000, v142
  v_fmac_f32 v176, v180, v90
  v_fmac_f32 v177, v181, v90
  v_lshlrev_b32 v180, 16, v143
  v_and_b32 v181, 0xffff0000, v143
  v_fmac_f32 v178, v180, v90
  v_fmac_f32 v179, v181, v90
  s_waitcnt vmcnt(6)
  v_lshlrev_b32 v180, 16, v144
  v_and_b32 v181, 0xffff0000, v144
  v_fmac_f32 v172, v180, v91
  v_fmac_f32 v173, v181, v91
  v_lshlrev_b32 v180, 16, v145
  v_and_b32 v181, 0xffff0000, v145
  v_fmac_f32 v174, v180, v91
  v_fmac_f32 v175, v181, v91
  v_lshlrev_b32 v180, 16, v146
  v_and_b32 v181, 0xffff0000, v146
  v_fmac_f32 v176, v180, v91
  v_fmac_f32 v177, v181, v91
  v_lshlrev_b32 v180, 16, v147
  v_and_b32 v181, 0xffff0000, v147
  v_fmac_f32 v178, v180, v91
  v_fmac_f32 v179, v181, v91
  s_waitcnt vmcnt(5)
  v_lshlrev_b32 v180, 16, v148
  v_and_b32 v181, 0xffff0000, v148
  v_fmac_f32 v172, v180, v92
  v_fmac_f32 v173, v181, v92
  v_lshlrev_b32 v180, 16, v149
  v_and_b32 v181, 0xffff0000, v149
  v_fmac_f32 v174, v180, v92
  v_fmac_f32 v175, v181, v92
  v_lshlrev_b32 v180, 16, v150
  v_and_b32 v181, 0xffff0000, v150
  v_fmac_f32 v176, v180, v92
  v_fmac_f32 v177, v181, v92
  v_lshlrev_b32 v180, 16, v151
  v_and_b32 v181, 0xffff0000, v151
  v_fmac_f32 v178, v180, v92
  v_fmac_f32 v179, v181, v92
  s_waitcnt vmcnt(4)
  v_lshlrev_b32 v180, 16, v152
  v_and_b32 v181, 0xffff0000, v152
  v_fmac_f32 v172, v180, v93
  v_fmac_f32 v173, v181, v93
  v_lshlrev_b32 v180, 16, v153
  v_and_b32 v181, 0xffff0000, v153
  v_fmac_f32 v174, v180, v93
  v_fmac_f32 v175, v181, v93
  v_lshlrev_b32 v180, 16, v154
  v_and_b32 v181, 0xffff0000, v154
  v_fmac_f32 v176, v180, v93
  v_fmac_f32 v177, v181, v93
  v_lshlrev_b32 v180, 16, v155
  v_and_b32 v181, 0xffff0000, v155
  v_fmac_f32 v178, v180, v93
  v_fmac_f32 v179, v181, v93
  s_waitcnt vmcnt(3)
  v_lshlrev_b32 v180, 16, v156
  v_and_b32 v181, 0xffff0000, v156
  v_fmac_f32 v172, v180, v94
  v_fmac_f32 v173, v181, v94
  v_lshlrev_b32 v180, 16, v157
  v_and_b32 v181, 0xffff0000, v157
  v_fmac_f32 v174, v180, v94
  v_fmac_f32 v175, v181, v94
  v_lshlrev_b32 v180, 16, v158
  v_and_b32 v181, 0xffff0000, v158
  v_fmac_f32 v176, v180, v94
  v_fmac_f32 v177, v181, v94
  v_lshlrev_b32 v180, 16, v159
  v_and_b32 v181, 0xffff0000, v159
  v_fmac_f32 v178, v180, v94
  v_fmac_f32 v179, v181, v94
  s_waitcnt vmcnt(2)
  v_lshlrev_b32 v180, 16, v160
  v_and_b32 v181, 0xffff0000, v160
  v_fmac_f32 v172, v180, v95
  v_fmac_f32 v173, v181, v95
  v_lshlrev_b32 v180, 16, v161
  v_and_b32 v181, 0xffff0000, v161
  v_fmac_f32 v174, v180, v95
  v_fmac_f32 v175, v181, v95
  v_lshlrev_b32 v180, 16, v162
  v_and_b32 v181, 0xffff0000, v162
  v_fmac_f32 v176, v180, v95
  v_fmac_f32 v177, v181, v95
  v_lshlrev_b32 v180, 16, v163
  v_and_b32 v181, 0xffff0000, v163
  v_fmac_f32 v178, v180, v95
  v_fmac_f32 v179, v181, v95
  s_waitcnt vmcnt(1)
  v_lshlrev_b32 v180, 16, v164
  v_and_b32 v181, 0xffff0000, v164
  v_fmac_f32 v172, v180, v96
  v_fmac_f32 v173, v181, v96
  v_lshlrev_b32 v180, 16, v165
  v_and_b32 v181, 0xffff0000, v165
  v_fmac_f32 v174, v180, v96
  v_fmac_f32 v175, v181, v96
  v_lshlrev_b32 v180, 16, v166
  v_and_b32 v181, 0xffff0000, v166
  v_fmac_f32 v176, v180, v96
  v_fmac_f32 v177, v181, v96
  v_lshlrev_b32 v180, 16, v167
  v_and_b32 v181, 0xffff0000, v167
  v_fmac_f32 v178, v180, v96
  v_fmac_f32 v179, v181, v96
  s_waitcnt vmcnt(0)
  v_lshlrev_b32 v180, 16, v168
  v_and_b32 v181, 0xffff0000, v168
  v_fmac_f32 v172, v180, v97
  v_fmac_f32 v173, v181, v97
  v_lshlrev_b32 v180, 16, v169
  v_and_b32 v181, 0xffff0000, v169
  v_fmac_f32 v174, v180, v97
  v_fmac_f32 v175, v181, v97
  v_lshlrev_b32 v180, 16, v170
  v_and_b32 v181, 0xffff0000, v170
  v_fmac_f32 v176, v180, v97
  v_fmac_f32 v177, v181, v97
  v_lshlrev_b32 v180, 16, v171
  v_and_b32 v181, 0xffff0000, v171
  v_fmac_f32 v178, v180, v97
  v_fmac_f32 v179, v181, v97
  v_lshlrev_b32 v182, 8, v77
  v_lshlrev_b32 v78, 5, v76
  v_add_u32 v182, v182, v78
  ds_write_b128 v182, v[172:175]
  ds_write_b128 v182, v[176:179] offset:16
  s_waitcnt lgkmcnt(0)
  s_barrier
  v_and_b32 v78, 63, v0
  v_lshlrev_b32 v182, 2, v78
  v_lshrrev_b32 v78, 6, v0
  v_lshlrev_b32 v78, 11, v78
  v_add_u32 v78, v182, v78
  ds_read_b32 v100, v78
  ds_read_b32 v101, v78 offset:256
  ds_read_b32 v102, v78 offset:512
  ds_read_b32 v103, v78 offset:768
  ds_read_b32 v104, v78 offset:1024
  ds_read_b32 v105, v78 offset:1280
  ds_read_b32 v106, v78 offset:1536
  ds_read_b32 v107, v78 offset:1792
  s_waitcnt lgkmcnt(6)
  v_add_f32 v100, v100, v101
  s_waitcnt lgkmcnt(5)
  v_add_f32 v100, v100, v102
  s_waitcnt lgkmcnt(4)
  v_add_f32 v100, v100, v103
  s_waitcnt lgkmcnt(3)
  v_add_f32 v100, v100, v104
  s_waitcnt lgkmcnt(2)
  v_add_f32 v100, v100, v105
  s_waitcnt lgkmcnt(1)
  v_add_f32 v100, v100, v106
  s_waitcnt lgkmcnt(0)
  v_add_f32 v100, v100, v107
  v_lshlrev_b32 v78, 2, v0
  ds_write_b32 v78, v100 offset:8192
  s_waitcnt lgkmcnt(0)
  s_barrier
  ds_read_b32 v100, v182 offset:8192
  ds_read_b32 v101, v182 offset:8448
  ds_read_b32 v102, v182 offset:8704
  ds_read_b32 v103, v182 offset:8960
  s_waitcnt lgkmcnt(2)
  v_add_f32 v100, v100, v101
  s_waitcnt lgkmcnt(0)
  v_add_f32 v102, v102, v103
  v_add_f32 v100, v100, v102
  v_mov_b32 v78, 0x40000000
  v_cmp_gt_u32 vcc, 64, v0
  s_nop 1
  v_cndmask_b32 v182, v78, v182
  s_lshl_b32 s56, s2, 8
  buffer_store_dword v100, v182, s[20:23], s56 offen sc1
  s_waitcnt vmcnt(0)
  s_barrier
  v_mov_b32 v182, 0
  v_cmp_eq_u32 vcc, 64, v0
  s_nop 1
  v_cndmask_b32 v182, v78, v182
  v_mov_b32 v180, 0x80
  v_cndmask_b32 v180, v78, v180
  s_cmp_eq_u32 s53, 1
  s_cbranch_scc0 adaLN_cond__sliding_block_cached__glu_gated_swiglu__prompt_kernel_a0_skip
  v_mov_b32 v181, 1
  s_nop 0
  buffer_atomic_add v181, v182, s[36:39], 0 offen sc0 sc1
  s_waitcnt vmcnt(0)
  v_readfirstlane_b32 s56, v181
  s_nop 3
  s_cmp_eq_u32 s56, 53
  s_cbranch_scc0 adaLN_cond__sliding_block_cached__glu_gated_swiglu__prompt_kernel_a0_skip
  v_mov_b32 v181, 1
  s_nop 0
  buffer_store_dword v181, v180, s[36:39], 0 offen sc1
adaLN_cond__sliding_block_cached__glu_gated_swiglu__prompt_kernel_a0_skip:
adaLN_cond__sliding_block_cached__glu_gated_swiglu__prompt_kernel_nomod:
  s_nop 1
  buffer_load_dword a250, v40, s[40:43], s62 offen
  s_load_dwordx2 s[24:25], s[0:1], 8
  s_load_dwordx2 s[28:29], s[0:1], 16
  s_waitcnt vmcnt(6)
  v_lshlrev_b32 v76, 16, v64
  v_and_b32 v77, 0xffff0000, v64
  v_lshlrev_b32 v78, 16, v65
  v_and_b32 v79, 0xffff0000, v65
  s_waitcnt vmcnt(5)
  v_lshlrev_b32 v80, 16, v66
  v_and_b32 v81, 0xffff0000, v66
  v_lshlrev_b32 v82, 16, v67
  v_and_b32 v83, 0xffff0000, v67
  s_waitcnt vmcnt(4)
  v_lshlrev_b32 v84, 16, v68
  v_and_b32 v85, 0xffff0000, v68
  v_lshlrev_b32 v86, 16, v69
  v_and_b32 v87, 0xffff0000, v69
  s_waitcnt vmcnt(3)
  v_lshlrev_b32 v88, 16, v70
  v_and_b32 v89, 0xffff0000, v70
  v_lshlrev_b32 v90, 16, v71
  v_and_b32 v91, 0xffff0000, v71
  s_waitcnt vmcnt(2)
  v_lshlrev_b32 v92, 16, v72
  v_and_b32 v93, 0xffff0000, v72
  v_lshlrev_b32 v94, 16, v73
  v_and_b32 v95, 0xffff0000, v73
  s_waitcnt vmcnt(1)
  v_lshlrev_b32 v96, 16, v74
  v_and_b32 v97, 0xffff0000, v74
  v_lshlrev_b32 v98, 16, v75
  v_and_b32 v99, 0xffff0000, v75
  v_accvgpr_write_b32 a232, v64
  v_accvgpr_write_b32 a233, v65
  v_accvgpr_write_b32 a234, v66
  v_accvgpr_write_b32 a235, v67
  v_accvgpr_write_b32 a236, v68
  v_accvgpr_write_b32 a237, v69
  v_accvgpr_write_b32 a238, v70
  v_accvgpr_write_b32 a239, v71
  v_accvgpr_write_b32 a240, v72
  v_accvgpr_write_b32 a241, v73
  v_accvgpr_write_b32 a242, v74
  v_accvgpr_write_b32 a243, v75
  v_add_f32 v100, v76, v77
  v_mul_f32 v101, v76, v76
  v_fmac_f32 v101, v77, v77
  v_add_f32 v100, v100, v78
  v_fmac_f32 v101, v78, v78
  v_add_f32 v100, v100, v79
  v_fmac_f32 v101, v79, v79
  v_add_f32 v100, v100, v80
  v_fmac_f32 v101, v80, v80
  v_add_f32 v100, v100, v81
  v_fmac_f32 v101, v81, v81
  v_add_f32 v100, v100, v82
  v_fmac_f32 v101, v82, v82
  v_add_f32 v100, v100, v83
  v_fmac_f32 v101, v83, v83
  v_add_f32 v100, v100, v84
  v_fmac_f32 v101, v84, v84
  v_add_f32 v100, v100, v85
  v_fmac_f32 v101, v85, v85
  v_add_f32 v100, v100, v86
  v_fmac_f32 v101, v86, v86
  v_add_f32 v100, v100, v87
  v_fmac_f32 v101, v87, v87
  v_add_f32 v100, v100, v88
  v_fmac_f32 v101, v88, v88
  v_add_f32 v100, v100, v89
  v_fmac_f32 v101, v89, v89
  v_add_f32 v100, v100, v90
  v_fmac_f32 v101, v90, v90
  v_add_f32 v100, v100, v91
  v_fmac_f32 v101, v91, v91
  v_add_f32 v100, v100, v92
  v_fmac_f32 v101, v92, v92
  v_add_f32 v100, v100, v93
  v_fmac_f32 v101, v93, v93
  v_add_f32 v100, v100, v94
  v_fmac_f32 v101, v94, v94
  v_add_f32 v100, v100, v95
  v_fmac_f32 v101, v95, v95
  v_add_f32 v100, v100, v96
  v_fmac_f32 v101, v96, v96
  v_add_f32 v100, v100, v97
  v_fmac_f32 v101, v97, v97
  v_add_f32 v100, v100, v98
  v_fmac_f32 v101, v98, v98
  v_add_f32 v100, v100, v99
  v_fmac_f32 v101, v99, v99
  s_nop 0
  v_add_f32 v100, v100, v100 row_ror:8 row_mask:0xf bank_mask:0xf
  v_mov_b32 v241, v100
  s_nop 1
  v_permlane16_swap_b32 v100, v241
  v_add_f32 v100, v100, v241
  v_mov_b32 v241, v100
  s_nop 1
  v_permlane32_swap_b32 v100, v241
  v_add_f32 v100, v100, v241
  v_add_f32 v101, v101, v101 row_ror:8 row_mask:0xf bank_mask:0xf
  v_mov_b32 v242, v101
  s_nop 1
  v_permlane16_swap_b32 v101, v242
  v_add_f32 v101, v101, v242
  v_mov_b32 v242, v101
  s_nop 1
  v_permlane32_swap_b32 v101, v242
  v_add_f32 v101, v101, v242
  v_lshrrev_b32 v241, 6, v0
  v_lshlrev_b32 v241, 5, v241
  v_lshlrev_b32 v103, 2, v240
  v_add_u32 v103, 0x20000, v103
  v_add_u32 v102, v241, v103
  ds_write_b32 v102, v100
  ds_write_b32 v102, v101 offset:128
  s_waitcnt lgkmcnt(0)
  s_barrier
  ds_read_b32 v104, v103
  ds_read_b32 v108, v103 offset:128
  ds_read_b32 v105, v103 offset:32
  ds_read_b32 v109, v103 offset:160
  ds_read_b32 v106, v103 offset:64
  ds_read_b32 v110, v103 offset:192
  ds_read_b32 v107, v103 offset:96
  ds_read_b32 v111, v103 offset:224
  s_mov_b32 s89, 0x3ae38e39
  s_mov_b32 s90, 0x3727c5ac
  s_waitcnt lgkmcnt(5)
  v_add_f32 v104, v104, v105
  s_waitcnt lgkmcnt(1)
  v_add_f32 v106, v106, v107
  v_add_f32 v108, v108, v109
  s_waitcnt lgkmcnt(0)
  v_add_f32 v110, v110, v111
  v_add_f32 v104, v104, v106
  v_add_f32 v108, v108, v110
  v_mul_f32 v102, s89, v104
  v_mul_f32 v108, s89, v108
  v_fma_f32 v108, -v102, v102, v108
  v_max_f32 v108, 0, v108
  v_add_f32 v108, s90, v108
  v_rsq_f32 v103, v108
  s_mov_b32 s26, 0x800000
  s_mov_b32 s27, 0x20000
  s_mov_b32 s30, 0x800000
  s_mov_b32 s31, 0x20000
  v_mov_b32 v9, 0x80
  s_cmp_lg_u32 s53, 0
  s_cbranch_scc1 adaLN_cond__sliding_block_cached__glu_gated_swiglu__prompt_kernel_s0_done
  s_mov_b32 s92, 0x200000
adaLN_cond__sliding_block_cached__glu_gated_swiglu__prompt_kernel_s0_poll:
  buffer_load_dword v10, v9, s[36:39], 0 offen sc1
  s_waitcnt vmcnt(0)
  v_readfirstlane_b32 s91, v10
  s_nop 3
  s_cmp_ge_u32 s91, 1
  s_cbranch_scc1 adaLN_cond__sliding_block_cached__glu_gated_swiglu__prompt_kernel_s0_done
  s_sub_u32 s92, s92, 1
  s_cmp_eq_u32 s92, 0
  s_cbranch_scc1 adaLN_cond__sliding_block_cached__glu_gated_swiglu__prompt_kernel_s0_done
  s_sleep 4
  s_branch adaLN_cond__sliding_block_cached__glu_gated_swiglu__prompt_kernel_s0_poll
adaLN_cond__sliding_block_cached__glu_gated_swiglu__prompt_kernel_s0_done:
  s_barrier
  s_mov_b32 s93, 0x900
  buffer_load_dwordx4 v[112:115], v245, s[20:23], s93 offen sc1
  buffer_load_dwordx4 v[116:119], v245, s[20:23], s93 offen offset:32 sc1
  buffer_load_dwordx4 v[120:123], v245, s[20:23], s93 offen offset:1024 sc1
  buffer_load_dwordx4 v[124:127], v245, s[20:23], s93 offen offset:1056 sc1
  buffer_load_dwordx4 v[128:131], v246, s[20:23], s93 offen sc1
  buffer_load_dwordx4 v[132:135], v246, s[20:23], s93 offen offset:32 sc1
  s_mov_b32 s93, 0
  buffer_load_dwordx4 v[136:139], v245, s[20:23], s93 offen sc1
  buffer_load_dwordx4 v[140:143], v245, s[20:23], s93 offen offset:32 sc1
  buffer_load_dwordx4 v[144:147], v245, s[20:23], s93 offen offset:1024 sc1
  buffer_load_dwordx4 v[148:151], v245, s[20:23], s93 offen offset:1056 sc1
  buffer_load_dwordx4 v[152:155], v246, s[20:23], s93 offen sc1
  buffer_load_dwordx4 v[156:159], v246, s[20:23], s93 offen offset:32 sc1
  s_load_dwordx2 s[36:37], s[0:1], 32
  s_load_dwordx2 s[32:33], s[0:1], 48
  s_mov_b32 s94, 0x3e0293ee
  v_sub_f32 v76, v76, v102
  s_waitcnt vmcnt(11)
  v_add_f32 v112, 1.0, v112
  v_mul_f32 v76, v76, v103
  s_waitcnt vmcnt(5)
  v_fma_f32 v76, v76, v112, v136
  v_mul_f32 v76, s94, v76
  v_sub_f32 v77, v77, v102
  v_add_f32 v113, 1.0, v113
  v_mul_f32 v77, v77, v103
  v_fma_f32 v77, v77, v113, v137
  v_mul_f32 v77, s94, v77
  v_sub_f32 v78, v78, v102
  v_add_f32 v114, 1.0, v114
  v_mul_f32 v78, v78, v103
  v_fma_f32 v78, v78, v114, v138
  v_mul_f32 v78, s94, v78
  v_sub_f32 v79, v79, v102
  v_add_f32 v115, 1.0, v115
  v_mul_f32 v79, v79, v103
  v_fma_f32 v79, v79, v115, v139
  v_mul_f32 v79, s94, v79
  v_sub_f32 v80, v80, v102
  v_add_f32 v116, 1.0, v116
  v_mul_f32 v80, v80, v103
  s_waitcnt vmcnt(4)
  v_fma_f32 v80, v80, v116, v140
  v_mul_f32 v80, s94, v80
  v_sub_f32 v81, v81, v102
  v_add_f32 v117, 1.0, v117
  v_mul_f32 v81, v81, v103
  v_fma_f32 v81, v81, v117, v141
  v_mul_f32 v81, s94, v81
  v_sub_f32 v82, v82, v102
  v_add_f32 v118, 1.0, v118
  v_mul_f32 v82, v82, v103
  v_fma_f32 v82, v82, v118, v142
  v_mul_f32 v82, s94, v82
  v_sub_f32 v83, v83, v102
  v_add_f32 v119, 1.0, v119
  v_mul_f32 v83, v83, v103
  v_fma_f32 v83, v83, v119, v143
  v_mul_f32 v83, s94, v83
  v_cvt_pk_bf16_f32 v160, v76, v77
  v_cvt_pk_bf16_f32 v161, v78, v79
  v_cvt_pk_bf16_f32 v162, v80, v81
  v_cvt_pk_bf16_f32 v163, v82, v83
  v_sub_f32 v84, v84, v102
  v_add_f32 v120, 1.0, v120
  v_mul_f32 v84, v84, v103
  s_waitcnt vmcnt(3)
  v_fma_f32 v84, v84, v120, v144
  v_mul_f32 v84, s94, v84
  v_sub_f32 v85, v85, v102
  v_add_f32 v121, 1.0, v121
  v_mul_f32 v85, v85, v103
  v_fma_f32 v85, v85, v121, v145
  v_mul_f32 v85, s94, v85
  v_sub_f32 v86, v86, v102
  v_add_f32 v122, 1.0, v122
  v_mul_f32 v86, v86, v103
  v_fma_f32 v86, v86, v122, v146
  v_mul_f32 v86, s94, v86
  v_sub_f32 v87, v87, v102
  v_add_f32 v123, 1.0, v123
  v_mul_f32 v87, v87, v103
  v_fma_f32 v87, v87, v123, v147
  v_mul_f32 v87, s94, v87
  v_sub_f32 v88, v88, v102
  v_add_f32 v124, 1.0, v124
  v_mul_f32 v88, v88, v103
  s_waitcnt vmcnt(2)
  v_fma_f32 v88, v88, v124, v148
  v_mul_f32 v88, s94, v88
  v_sub_f32 v89, v89, v102
  v_add_f32 v125, 1.0, v125
  v_mul_f32 v89, v89, v103
  v_fma_f32 v89, v89, v125, v149
  v_mul_f32 v89, s94, v89
  v_sub_f32 v90, v90, v102
  v_add_f32 v126, 1.0, v126
  v_mul_f32 v90, v90, v103
  v_fma_f32 v90, v90, v126, v150
  v_mul_f32 v90, s94, v90
  v_sub_f32 v91, v91, v102
  v_add_f32 v127, 1.0, v127
  v_mul_f32 v91, v91, v103
  v_fma_f32 v91, v91, v127, v151
  v_mul_f32 v91, s94, v91
  v_cvt_pk_bf16_f32 v164, v84, v85
  v_cvt_pk_bf16_f32 v165, v86, v87
  v_cvt_pk_bf16_f32 v166, v88, v89
  v_cvt_pk_bf16_f32 v167, v90, v91
  v_sub_f32 v92, v92, v102
  v_add_f32 v128, 1.0, v128
  v_mul_f32 v92, v92, v103
  s_waitcnt vmcnt(1)
  v_fma_f32 v92, v92, v128, v152
  v_mul_f32 v92, s94, v92
  v_sub_f32 v93, v93, v102
  v_add_f32 v129, 1.0, v129
  v_mul_f32 v93, v93, v103
  v_fma_f32 v93, v93, v129, v153
  v_mul_f32 v93, s94, v93
  v_sub_f32 v94, v94, v102
  v_add_f32 v130, 1.0, v130
  v_mul_f32 v94, v94, v103
  v_fma_f32 v94, v94, v130, v154
  v_mul_f32 v94, s94, v94
  v_sub_f32 v95, v95, v102
  v_add_f32 v131, 1.0, v131
  v_mul_f32 v95, v95, v103
  v_fma_f32 v95, v95, v131, v155
  v_mul_f32 v95, s94, v95
  v_sub_f32 v96, v96, v102
  v_add_f32 v132, 1.0, v132
  v_mul_f32 v96, v96, v103
  s_waitcnt vmcnt(0)
  v_fma_f32 v96, v96, v132, v156
  v_mul_f32 v96, s94, v96
  v_sub_f32 v97, v97, v102
  v_add_f32 v133, 1.0, v133
  v_mul_f32 v97, v97, v103
  v_fma_f32 v97, v97, v133, v157
  v_mul_f32 v97, s94, v97
  v_sub_f32 v98, v98, v102
  v_add_f32 v134, 1.0, v134
  v_mul_f32 v98, v98, v103
  v_fma_f32 v98, v98, v134, v158
  v_mul_f32 v98, s94, v98
  v_sub_f32 v99, v99, v102
  v_add_f32 v135, 1.0, v135
  v_mul_f32 v99, v99, v103
  v_fma_f32 v99, v99, v135, v159
  v_mul_f32 v99, s94, v99
  v_cvt_pk_bf16_f32 v168, v92, v93
  v_cvt_pk_bf16_f32 v169, v94, v95
  v_cvt_pk_bf16_f32 v170, v96, v97
  v_cvt_pk_bf16_f32 v171, v98, v99
  s_lshr_b32 s95, s2, 2
  s_mul_i32 s95, s95, 0x9000
  s_and_b32 s96, s2, 3
  s_lshl_b32 s96, s96, 7
  s_add_u32 s95, s95, s96
  buffer_store_dwordx4 v[160:163], v247, s[16:19], s95 offen sc1
  s_add_u32 s88, s95, 0x4000
  buffer_store_dwordx4 v[164:167], v247, s[16:19], s88 offen sc1
  buffer_store_dwordx4 v[168:171], v248, s[16:19], s95 offen sc1
  s_mov_b32 s38, 0x480000
  s_mov_b32 s39, 0x20000
  s_waitcnt lgkmcnt(0)
  s_mov_b32 s34, 0x510000
  s_mov_b32 s35, 0x20000
  s_waitcnt vmcnt(0)
  s_barrier
  v_mov_b32 v10, 1
  buffer_atomic_add v10, v16, s[8:11], 0 offen sc1
  s_add_u32 s67, s62, 0
  s_add_u32 m0, s54, 0
  s_nop 0
  buffer_load_dwordx4 v22, s[40:43], s67 offen lds
  s_add_u32 m0, s54, 0x400
  s_nop 0
  buffer_load_dwordx4 v23, s[40:43], s67 offen lds
  s_add_u32 m0, s54, 0x800
  s_nop 0
  buffer_load_dwordx4 v24, s[40:43], s67 offen lds
  s_add_u32 m0, s54, 0xc00
  s_nop 0
  buffer_load_dwordx4 v25, s[40:43], s67 offen lds
  s_add_u32 s67, s62, 0x40000
  s_add_u32 m0, s54, 0x4000
  s_nop 0
  buffer_load_dwordx4 v22, s[40:43], s67 offen lds
  s_add_u32 m0, s54, 0x4400
  s_nop 0
  buffer_load_dwordx4 v23, s[40:43], s67 offen lds
  s_add_u32 m0, s54, 0x4800
  s_nop 0
  buffer_load_dwordx4 v24, s[40:43], s67 offen lds
  s_add_u32 m0, s54, 0x4c00
  s_nop 0
  buffer_load_dwordx4 v25, s[40:43], s67 offen lds
  s_add_u32 s67, s62, 0x80000
  s_add_u32 m0, s54, 0x8000
  s_nop 0
  buffer_load_dwordx4 v22, s[40:43], s67 offen lds
  s_add_u32 m0, s54, 0x8400
  s_nop 0
  buffer_load_dwordx4 v23, s[40:43], s67 offen lds
  s_add_u32 m0, s54, 0x8800
  s_nop 0
  buffer_load_dwordx4 v24, s[40:43], s67 offen lds
  s_add_u32 m0, s54, 0x8c00
  s_nop 0
  buffer_load_dwordx4 v25, s[40:43], s67 offen lds
  s_cmp_lg_u32 s53, 0
  s_cbranch_scc1 adaLN_cond__sliding_block_cached__glu_gated_swiglu__prompt_kernel_s1_done
  s_mov_b32 s92, 0x200000
adaLN_cond__sliding_block_cached__glu_gated_swiglu__prompt_kernel_s1_poll:
  buffer_load_dword v9, v17, s[8:11], 0 offen sc1
  s_waitcnt vmcnt(0)
  v_readfirstlane_b32 s91, v9
  s_nop 3
  s_cmp_ge_u32 s91, 16
  s_cbranch_scc1 adaLN_cond__sliding_block_cached__glu_gated_swiglu__prompt_kernel_s1_done
  s_sub_u32 s92, s92, 1
  s_cmp_eq_u32 s92, 0
  s_cbranch_scc1 adaLN_cond__sliding_block_cached__glu_gated_swiglu__prompt_kernel_s1_done
  s_sleep 4
  s_branch adaLN_cond__sliding_block_cached__glu_gated_swiglu__prompt_kernel_s1_poll
adaLN_cond__sliding_block_cached__glu_gated_swiglu__prompt_kernel_s1_done:
  s_barrier
  s_add_u32 s69, s65, 0
  buffer_load_dwordx4 a[0:3], v12, s[16:19], s69 offen sc1
  buffer_load_dwordx4 a[4:7], v12, s[16:19], s69 offen offset:1024 sc1
  s_add_u32 s69, s65, 0x800
  buffer_load_dwordx4 a[8:11], v12, s[16:19], s69 offen sc1
  buffer_load_dwordx4 a[12:15], v12, s[16:19], s69 offen offset:1024 sc1
  s_add_u32 s69, s65, 0x1000
  buffer_load_dwordx4 a[16:19], v12, s[16:19], s69 offen sc1
  buffer_load_dwordx4 a[20:23], v12, s[16:19], s69 offen offset:1024 sc1
  s_waitcnt vmcnt(14)
  s_barrier
  ds_read_b64_tr_b16 a[144:145], v34
  s_waitcnt vmcnt(5)
  ds_read_b64_tr_b16 a[146:147], v34 offset:4096
  ds_read_b64_tr_b16 a[148:149], v34 offset:256
  ds_read_b64_tr_b16 a[150:151], v34 offset:4352
  ds_read_b64_tr_b16 a[152:153], v34 offset:512
  ds_read_b64_tr_b16 a[154:155], v34 offset:4608
  ds_read_b64_tr_b16 a[156:157], v34 offset:768
  ds_read_b64_tr_b16 a[158:159], v34 offset:4864
  ds_read_b64_tr_b16 a[160:161], v34 offset:1024
  ds_read_b64_tr_b16 a[162:163], v34 offset:5120
  ds_read_b64_tr_b16 a[164:165], v34 offset:1280
  ds_read_b64_tr_b16 a[166:167], v34 offset:5376
  s_waitcnt lgkmcnt(10)
  v_mfma_f32_32x32x16_bf16 v[64:79], a[144:147], a[0:3], 0
  s_waitcnt lgkmcnt(8)
  ds_read_b64_tr_b16 a[168:169], v34 offset:1536
  s_add_u32 s67, s62, 0xc0000
  ds_read_b64_tr_b16 a[170:171], v34 offset:5632
  s_add_u32 m0, s54, 0xc000
  s_nop 0
  buffer_load_dwordx4 v22, s[40:43], s67 offen lds
  s_add_u32 m0, s54, 0xc400
  v_mov_b32 v224, 0
  v_mfma_f32_32x32x16_bf16 v[80:95], a[148:151], a[0:3], 0
  s_waitcnt lgkmcnt(8)
  ds_read_b64_tr_b16 a[172:173], v34 offset:1792
  ds_read_b64_tr_b16 a[174:175], v34 offset:5888
  buffer_load_dwordx4 v23, s[40:43], s67 offen lds
  s_add_u32 m0, s54, 0xc800
  v_mov_b32 v225, 0
  v_mfma_f32_32x32x16_bf16 v[96:111], a[152:155], a[0:3], 0
  s_waitcnt lgkmcnt(8)
  ds_read_b64_tr_b16 a[144:145], v34 offset:8192
  ds_read_b64_tr_b16 a[146:147], v34 offset:12288
  buffer_load_dwordx4 v24, s[40:43], s67 offen lds
  s_add_u32 m0, s54, 0xcc00
  v_mov_b32 v226, 0
  v_mfma_f32_32x32x16_bf16 v[112:127], a[156:159], a[0:3], 0
  s_waitcnt lgkmcnt(8)
  ds_read_b64_tr_b16 a[148:149], v34 offset:8448
  ds_read_b64_tr_b16 a[150:151], v34 offset:12544
  buffer_load_dwordx4 v25, s[40:43], s67 offen lds
  s_add_u32 s69, s65, 0x1800
  v_mov_b32 v227, 0
  v_mfma_f32_32x32x16_bf16 v[128:143], a[160:163], a[0:3], 0
  s_waitcnt lgkmcnt(8)
  ds_read_b64_tr_b16 a[152:153], v34 offset:8704
  ds_read_b64_tr_b16 a[154:155], v34 offset:12800
  buffer_load_dwordx4 a[24:27], v12, s[16:19], s69 offen sc1
  v_mfma_f32_32x32x16_bf16 v[144:159], a[164:167], a[0:3], 0
  s_waitcnt lgkmcnt(8)
  ds_read_b64_tr_b16 a[156:157], v34 offset:8960
  ds_read_b64_tr_b16 a[158:159], v34 offset:13056
  buffer_load_dwordx4 a[28:31], v12, s[16:19], s69 offen offset:1024 sc1
  s_add_u32 s67, s62, 0x100000
  s_add_u32 m0, s54, 0x10000
  v_mfma_f32_32x32x16_bf16 v[160:175], a[168:171], a[0:3], 0
  s_waitcnt lgkmcnt(8)
  ds_read_b64_tr_b16 a[160:161], v34 offset:9216
  ds_read_b64_tr_b16 a[162:163], v34 offset:13312
  buffer_load_dwordx4 v22, s[40:43], s67 offen lds
  s_add_u32 m0, s54, 0x10400
  v_mfma_f32_32x32x16_bf16 v[176:191], a[172:175], a[0:3], 0
  s_waitcnt lgkmcnt(8)
  ds_read_b64_tr_b16 a[164:165], v34 offset:9472
  s_waitcnt vmcnt(11)
  ds_read_b64_tr_b16 a[166:167], v34 offset:13568
  buffer_load_dwordx4 v23, s[40:43], s67 offen lds
  s_add_u32 m0, s54, 0x10800
  v_mfma_f32_32x32x16_bf16 v[64:79], a[144:147], a[4:7], v[64:79]
  s_waitcnt lgkmcnt(8)
  ds_read_b64_tr_b16 a[168:169], v34 offset:9728
  ds_read_b64_tr_b16 a[170:171], v34 offset:13824
  buffer_load_dwordx4 v24, s[40:43], s67 offen lds
  s_add_u32 m0, s54, 0x10c00
  v_mfma_f32_32x32x16_bf16 v[80:95], a[148:151], a[4:7], v[80:95]
  s_waitcnt lgkmcnt(8)
  ds_read_b64_tr_b16 a[172:173], v34 offset:9984
  ds_read_b64_tr_b16 a[174:175], v34 offset:14080
  s_barrier
  buffer_load_dwordx4 v25, s[40:43], s67 offen lds
  s_add_u32 s69, s65, 0x2000
  v_mfma_f32_32x32x16_bf16 v[96:111], a[152:155], a[4:7], v[96:111]
  s_waitcnt lgkmcnt(8)
  ds_read_b64_tr_b16 a[144:145], v34 offset:16384
  ds_read_b64_tr_b16 a[146:147], v34 offset:20480
  buffer_load_dwordx4 a[32:35], v12, s[16:19], s69 offen sc1
  v_mfma_f32_32x32x16_bf16 v[112:127], a[156:159], a[4:7], v[112:127]
  s_waitcnt lgkmcnt(8)
  ds_read_b64_tr_b16 a[148:149], v34 offset:16640
  ds_read_b64_tr_b16 a[150:151], v34 offset:20736
  buffer_load_dwordx4 a[36:39], v12, s[16:19], s69 offen offset:1024 sc1
  s_add_u32 s67, s62, 0x140000
  s_add_u32 m0, s54, 0x14000
  v_mfma_f32_32x32x16_bf16 v[128:143], a[160:163], a[4:7], v[128:143]
  s_waitcnt lgkmcnt(8)
  ds_read_b64_tr_b16 a[152:153], v34 offset:16896
  ds_read_b64_tr_b16 a[154:155], v34 offset:20992
  buffer_load_dwordx4 v22, s[40:43], s67 offen lds
  s_add_u32 m0, s54, 0x14400
  v_mfma_f32_32x32x16_bf16 v[144:159], a[164:167], a[4:7], v[144:159]
  s_waitcnt lgkmcnt(8)
  ds_read_b64_tr_b16 a[156:157], v34 offset:17152
  ds_read_b64_tr_b16 a[158:159], v34 offset:21248
  buffer_load_dwordx4 v23, s[40:43], s67 offen lds
  s_add_u32 m0, s54, 0x14800
  v_mfma_f32_32x32x16_bf16 v[160:175], a[168:171], a[4:7], v[160:175]
  s_waitcnt lgkmcnt(8)
  ds_read_b64_tr_b16 a[160:161], v34 offset:17408
  ds_read_b64_tr_b16 a[162:163], v34 offset:21504
  buffer_load_dwordx4 v24, s[40:43], s67 offen lds
  s_add_u32 m0, s54, 0x14c00
  v_mfma_f32_32x32x16_bf16 v[176:191], a[172:175], a[4:7], v[176:191]
  s_waitcnt lgkmcnt(8)
  ds_read_b64_tr_b16 a[164:165], v34 offset:17664
  s_waitcnt vmcnt(18)
  ds_read_b64_tr_b16 a[166:167], v34 offset:21760
  buffer_load_dwordx4 v25, s[40:43], s67 offen lds
  s_add_u32 s69, s65, 0x2800
  v_mfma_f32_32x32x16_bf16 v[64:79], a[144:147], a[8:11], v[64:79]
  s_waitcnt lgkmcnt(8)
  ds_read_b64_tr_b16 a[168:169], v34 offset:17920
  ds_read_b64_tr_b16 a[170:171], v34 offset:22016
  buffer_load_dwordx4 a[40:43], v12, s[16:19], s69 offen sc1
  v_mfma_f32_32x32x16_bf16 v[80:95], a[148:151], a[8:11], v[80:95]
  s_waitcnt lgkmcnt(8)
  ds_read_b64_tr_b16 a[172:173], v34 offset:18176
  ds_read_b64_tr_b16 a[174:175], v34 offset:22272
  buffer_load_dwordx4 a[44:47], v12, s[16:19], s69 offen offset:1024 sc1
  s_add_u32 s67, s62, 0x180000
  s_add_u32 m0, s54, 0x18000
  v_mfma_f32_32x32x16_bf16 v[96:111], a[152:155], a[8:11], v[96:111]
  s_waitcnt lgkmcnt(8)
  ds_read_b64_tr_b16 a[144:145], v34 offset:24576
  ds_read_b64_tr_b16 a[146:147], v34 offset:28672
  buffer_load_dwordx4 v22, s[40:43], s67 offen lds
  s_add_u32 m0, s54, 0x18400
  v_mfma_f32_32x32x16_bf16 v[112:127], a[156:159], a[8:11], v[112:127]
  s_waitcnt lgkmcnt(8)
  ds_read_b64_tr_b16 a[148:149], v34 offset:24832
  ds_read_b64_tr_b16 a[150:151], v34 offset:28928
  buffer_load_dwordx4 v23, s[40:43], s67 offen lds
  s_add_u32 m0, s54, 0x18800
  v_mfma_f32_32x32x16_bf16 v[128:143], a[160:163], a[8:11], v[128:143]
  s_waitcnt lgkmcnt(8)
  ds_read_b64_tr_b16 a[152:153], v34 offset:25088
  ds_read_b64_tr_b16 a[154:155], v34 offset:29184
  buffer_load_dwordx4 v24, s[40:43], s67 offen lds
  s_add_u32 m0, s54, 0x18c00
  v_mfma_f32_32x32x16_bf16 v[144:159], a[164:167], a[8:11], v[144:159]
  s_waitcnt lgkmcnt(8)
  ds_read_b64_tr_b16 a[156:157], v34 offset:25344
  ds_read_b64_tr_b16 a[158:159], v34 offset:29440
  buffer_load_dwordx4 v25, s[40:43], s67 offen lds
  s_add_u32 s69, s65, 0x3000
  v_mfma_f32_32x32x16_bf16 v[160:175], a[168:171], a[8:11], v[160:175]
  s_waitcnt lgkmcnt(8)
  ds_read_b64_tr_b16 a[160:161], v34 offset:25600
  ds_read_b64_tr_b16 a[162:163], v34 offset:29696
  buffer_load_dwordx4 a[48:51], v12, s[16:19], s69 offen sc1
  v_mfma_f32_32x32x16_bf16 v[176:191], a[172:175], a[8:11], v[176:191]
  s_waitcnt lgkmcnt(8)
  ds_read_b64_tr_b16 a[164:165], v34 offset:25856
  s_waitcnt vmcnt(25)
  ds_read_b64_tr_b16 a[166:167], v34 offset:29952
  buffer_load_dwordx4 a[52:55], v12, s[16:19], s69 offen offset:1024 sc1
  s_add_u32 s67, s62, 0x1c0000
  s_add_u32 m0, s54, 0x1c000
  v_mfma_f32_32x32x16_bf16 v[64:79], a[144:147], a[12:15], v[64:79]
  s_waitcnt lgkmcnt(8)
  ds_read_b64_tr_b16 a[168:169], v34 offset:26112
  ds_read_b64_tr_b16 a[170:171], v34 offset:30208
  buffer_load_dwordx4 v22, s[40:43], s67 offen lds
  s_add_u32 m0, s54, 0x1c400
  v_mfma_f32_32x32x16_bf16 v[80:95], a[148:151], a[12:15], v[80:95]
  s_waitcnt lgkmcnt(8)
  ds_read_b64_tr_b16 a[172:173], v34 offset:26368
  ds_read_b64_tr_b16 a[174:175], v34 offset:30464
  s_barrier
  buffer_load_dwordx4 v23, s[40:43], s67 offen lds
  s_add_u32 m0, s54, 0x1c800
  v_mfma_f32_32x32x16_bf16 v[96:111], a[152:155], a[12:15], v[96:111]
  s_waitcnt lgkmcnt(8)
  ds_read_b64_tr_b16 a[144:145], v34 offset:32768
  ds_read_b64_tr_b16 a[146:147], v34 offset:36864
  buffer_load_dwordx4 v24, s[40:43], s67 offen lds
  s_add_u32 m0, s54, 0x1cc00
  v_mfma_f32_32x32x16_bf16 v[112:127], a[156:159], a[12:15], v[112:127]
  s_waitcnt lgkmcnt(8)
  ds_read_b64_tr_b16 a[148:149], v34 offset:33024
  ds_read_b64_tr_b16 a[150:151], v34 offset:37120
  buffer_load_dwordx4 v25, s[40:43], s67 offen lds
  s_add_u32 s69, s65, 0x3800
  v_mfma_f32_32x32x16_bf16 v[128:143], a[160:163], a[12:15], v[128:143]
  s_waitcnt lgkmcnt(8)
  ds_read_b64_tr_b16 a[152:153], v34 offset:33280
  ds_read_b64_tr_b16 a[154:155], v34 offset:37376
  buffer_load_dwordx4 a[56:59], v12, s[16:19], s69 offen sc1
  v_mfma_f32_32x32x16_bf16 v[144:159], a[164:167], a[12:15], v[144:159]
  s_waitcnt lgkmcnt(8)
  ds_read_b64_tr_b16 a[156:157], v34 offset:33536
  ds_read_b64_tr_b16 a[158:159], v34 offset:37632
  buffer_load_dwordx4 a[60:63], v12, s[16:19], s69 offen offset:1024 sc1
  s_add_u32 s67, s62, 0x200000
  s_add_u32 m0, s54, 0
  v_mfma_f32_32x32x16_bf16 v[160:175], a[168:171], a[12:15], v[160:175]
  s_waitcnt lgkmcnt(8)
  ds_read_b64_tr_b16 a[160:161], v34 offset:33792
  ds_read_b64_tr_b16 a[162:163], v34 offset:37888
  buffer_load_dwordx4 v22, s[40:43], s67 offen lds
  s_add_u32 m0, s54, 0x400
  v_mfma_f32_32x32x16_bf16 v[176:191], a[172:175], a[12:15], v[176:191]
  s_waitcnt lgkmcnt(8)
  ds_read_b64_tr_b16 a[164:165], v34 offset:34048
  s_waitcnt vmcnt(32)
  ds_read_b64_tr_b16 a[166:167], v34 offset:38144
  buffer_load_dwordx4 v23, s[40:43], s67 offen lds
  s_add_u32 m0, s54, 0x800
  v_mfma_f32_32x32x16_bf16 v[64:79], a[144:147], a[16:19], v[64:79]
  s_waitcnt lgkmcnt(8)
  ds_read_b64_tr_b16 a[168:169], v34 offset:34304
  ds_read_b64_tr_b16 a[170:171], v34 offset:38400
  buffer_load_dwordx4 v24, s[40:43], s67 offen lds
  s_add_u32 m0, s54, 0xc00
  v_mfma_f32_32x32x16_bf16 v[80:95], a[148:151], a[16:19], v[80:95]
  s_waitcnt lgkmcnt(8)
  ds_read_b64_tr_b16 a[172:173], v34 offset:34560
  ds_read_b64_tr_b16 a[174:175], v34 offset:38656
  buffer_load_dwordx4 v25, s[40:43], s67 offen lds
  s_add_u32 s69, s65, 0x4000
  v_mfma_f32_32x32x16_bf16 v[96:111], a[152:155], a[16:19], v[96:111]
  s_waitcnt lgkmcnt(8)
  ds_read_b64_tr_b16 a[144:145], v34 offset:40960
  ds_read_b64_tr_b16 a[146:147], v34 offset:45056
  buffer_load_dwordx4 a[64:67], v12, s[16:19], s69 offen sc1
  v_mfma_f32_32x32x16_bf16 v[112:127], a[156:159], a[16:19], v[112:127]
  s_waitcnt lgkmcnt(8)
  ds_read_b64_tr_b16 a[148:149], v34 offset:41216
  ds_read_b64_tr_b16 a[150:151], v34 offset:45312
  buffer_load_dwordx4 a[68:71], v12, s[16:19], s69 offen offset:1024 sc1
  v_mfma_f32_32x32x16_bf16 v[128:143], a[160:163], a[16:19], v[128:143]
  s_waitcnt lgkmcnt(8)
  ds_read_b64_tr_b16 a[152:153], v34 offset:41472
  ds_read_b64_tr_b16 a[154:155], v34 offset:45568
  v_mfma_f32_32x32x16_bf16 v[144:159], a[164:167], a[16:19], v[144:159]
  s_waitcnt lgkmcnt(8)
  ds_read_b64_tr_b16 a[156:157], v34 offset:41728
  ds_read_b64_tr_b16 a[158:159], v34 offset:45824
  v_mfma_f32_32x32x16_bf16 v[160:175], a[168:171], a[16:19], v[160:175]
  s_waitcnt lgkmcnt(8)
  ds_read_b64_tr_b16 a[160:161], v34 offset:41984
  ds_read_b64_tr_b16 a[162:163], v34 offset:46080
  v_mfma_f32_32x32x16_bf16 v[176:191], a[172:175], a[16:19], v[176:191]
  s_waitcnt lgkmcnt(8)
  ds_read_b64_tr_b16 a[164:165], v34 offset:42240
  s_waitcnt vmcnt(36)
  ds_read_b64_tr_b16 a[166:167], v34 offset:46336
  v_mfma_f32_32x32x16_bf16 v[64:79], a[144:147], a[20:23], v[64:79]
  s_waitcnt lgkmcnt(8)
  ds_read_b64_tr_b16 a[168:169], v34 offset:42496
  ds_read_b64_tr_b16 a[170:171], v34 offset:46592
  buffer_load_dword a251, v41, s[24:27], s63 offen
  v_mfma_f32_32x32x16_bf16 v[80:95], a[148:151], a[20:23], v[80:95]
  s_waitcnt lgkmcnt(8)
  ds_read_b64_tr_b16 a[172:173], v34 offset:42752
  s_waitcnt vmcnt(33)
  ds_read_b64_tr_b16 a[174:175], v34 offset:46848
  s_barrier
  v_mfma_f32_32x32x16_bf16 v[96:111], a[152:155], a[20:23], v[96:111]
  s_waitcnt lgkmcnt(8)
  ds_read_b64_tr_b16 a[144:145], v34 offset:49152
  s_add_u32 s67, s62, 0x240000
  ds_read_b64_tr_b16 a[146:147], v34 offset:53248
  s_add_u32 m0, s54, 0x4000
  s_nop 0
  buffer_load_dwordx4 v22, s[40:43], s67 offen lds
  v_mfma_f32_32x32x16_bf16 v[112:127], a[156:159], a[20:23], v[112:127]
  s_waitcnt lgkmcnt(8)
  ds_read_b64_tr_b16 a[148:149], v34 offset:49408
  ds_read_b64_tr_b16 a[150:151], v34 offset:53504
  v_mfma_f32_32x32x16_bf16 v[128:143], a[160:163], a[20:23], v[128:143]
  s_waitcnt lgkmcnt(8)
  ds_read_b64_tr_b16 a[152:153], v34 offset:49664
  s_add_u32 m0, s54, 0x4400
  ds_read_b64_tr_b16 a[154:155], v34 offset:53760
  buffer_load_dword a252, v41, s[28:31], s63 offen
  v_mfma_f32_32x32x16_bf16 v[144:159], a[164:167], a[20:23], v[144:159]
  s_waitcnt lgkmcnt(8)
  ds_read_b64_tr_b16 a[156:157], v34 offset:49920
  ds_read_b64_tr_b16 a[158:159], v34 offset:54016
  buffer_load_dwordx4 v23, s[40:43], s67 offen lds
  v_mfma_f32_32x32x16_bf16 v[160:175], a[168:171], a[20:23], v[160:175]
  s_waitcnt lgkmcnt(8)
  ds_read_b64_tr_b16 a[160:161], v34 offset:50176
  ds_read_b64_tr_b16 a[162:163], v34 offset:54272
  v_mfma_f32_32x32x16_bf16 v[176:191], a[172:175], a[20:23], v[176:191]
  s_waitcnt lgkmcnt(8)
  ds_read_b64_tr_b16 a[164:165], v34 offset:50432
  s_waitcnt vmcnt(35)
  ds_read_b64_tr_b16 a[166:167], v34 offset:54528
  s_add_u32 m0, s54, 0x4800
  v_mfma_f32_32x32x16_bf16 v[64:79], a[144:147], a[24:27], v[64:79]
  s_waitcnt lgkmcnt(8)
  ds_read_b64_tr_b16 a[168:169], v34 offset:50688
  ds_read_b64_tr_b16 a[170:171], v34 offset:54784
  buffer_load_dwordx4 v24, s[40:43], s67 offen lds
  v_mfma_f32_32x32x16_bf16 v[80:95], a[148:151], a[24:27], v[80:95]
  s_waitcnt lgkmcnt(8)
  ds_read_b64_tr_b16 a[172:173], v34 offset:50944
  ds_read_b64_tr_b16 a[174:175], v34 offset:55040
  v_mfma_f32_32x32x16_bf16 v[96:111], a[152:155], a[24:27], v[96:111]
  s_waitcnt lgkmcnt(8)
  ds_read_b64_tr_b16 a[144:145], v34 offset:57344
  s_add_u32 m0, s54, 0x4c00
  ds_read_b64_tr_b16 a[146:147], v34 offset:61440
  v_mfma_f32_32x32x16_bf16 v[112:127], a[156:159], a[24:27], v[112:127]
  s_waitcnt lgkmcnt(8)
  ds_read_b64_tr_b16 a[148:149], v34 offset:57600
  ds_read_b64_tr_b16 a[150:151], v34 offset:61696
  buffer_load_dwordx4 v25, s[40:43], s67 offen lds
  v_mfma_f32_32x32x16_bf16 v[128:143], a[160:163], a[24:27], v[128:143]
  s_waitcnt lgkmcnt(8)
  ds_read_b64_tr_b16 a[152:153], v34 offset:57856
  ds_read_b64_tr_b16 a[154:155], v34 offset:61952
  v_mfma_f32_32x32x16_bf16 v[144:159], a[164:167], a[24:27], v[144:159]
  s_waitcnt lgkmcnt(8)
  ds_read_b64_tr_b16 a[156:157], v34 offset:58112
  s_add_u32 s69, s65, 0x4800
  ds_read_b64_tr_b16 a[158:159], v34 offset:62208
  v_mfma_f32_32x32x16_bf16 v[160:175], a[168:171], a[24:27], v[160:175]
  s_waitcnt lgkmcnt(8)
  ds_read_b64_tr_b16 a[160:161], v34 offset:58368
  ds_read_b64_tr_b16 a[162:163], v34 offset:62464
  buffer_load_dwordx4 a[72:75], v12, s[16:19], s69 offen sc1
  v_mfma_f32_32x32x16_bf16 v[176:191], a[172:175], a[24:27], v[176:191]
  s_waitcnt lgkmcnt(8)
  ds_read_b64_tr_b16 a[164:165], v34 offset:58624
  s_waitcnt vmcnt(37)
  ds_read_b64_tr_b16 a[166:167], v34 offset:62720
  v_mfma_f32_32x32x16_bf16 v[64:79], a[144:147], a[28:31], v[64:79]
  s_waitcnt lgkmcnt(8)
  ds_read_b64_tr_b16 a[168:169], v34 offset:58880
  ds_read_b64_tr_b16 a[170:171], v34 offset:62976
  v_mfma_f32_32x32x16_bf16 v[80:95], a[148:151], a[28:31], v[80:95]
  s_waitcnt lgkmcnt(8)
  ds_read_b64_tr_b16 a[172:173], v34 offset:59136
  s_waitcnt vmcnt(33)
  ds_read_b64_tr_b16 a[174:175], v34 offset:63232
  s_barrier
  buffer_load_dwordx4 a[76:79], v12, s[16:19], s69 offen offset:1024 sc1
  v_mfma_f32_32x32x16_bf16 v[96:111], a[152:155], a[28:31], v[96:111]
  s_waitcnt lgkmcnt(8)
  ds_read_b64_tr_b16 a[144:145], v35
  ds_read_b64_tr_b16 a[146:147], v35 offset:4096
  v_mfma_f32_32x32x16_bf16 v[112:127], a[156:159], a[28:31], v[112:127]
  s_waitcnt lgkmcnt(8)
  ds_read_b64_tr_b16 a[148:149], v35 offset:256
  s_add_u32 s67, s62, 0x280000
  ds_read_b64_tr_b16 a[150:151], v35 offset:4352
  s_add_u32 m0, s54, 0x8000
  v_mfma_f32_32x32x16_bf16 v[128:143], a[160:163], a[28:31], v[128:143]
  s_waitcnt lgkmcnt(8)
  ds_read_b64_tr_b16 a[152:153], v35 offset:512
  ds_read_b64_tr_b16 a[154:155], v35 offset:4608
  buffer_load_dwordx4 v22, s[40:43], s67 offen lds
  s_add_u32 m0, s54, 0x8400
  v_mfma_f32_32x32x16_bf16 v[144:159], a[164:167], a[28:31], v[144:159]
  s_waitcnt lgkmcnt(8)
  ds_read_b64_tr_b16 a[156:157], v35 offset:768
  ds_read_b64_tr_b16 a[158:159], v35 offset:4864
  buffer_load_dwordx4 v23, s[40:43], s67 offen lds
  s_add_u32 m0, s54, 0x8800
  v_mfma_f32_32x32x16_bf16 v[160:175], a[168:171], a[28:31], v[160:175]
  s_waitcnt lgkmcnt(8)
  ds_read_b64_tr_b16 a[160:161], v35 offset:1024
  ds_read_b64_tr_b16 a[162:163], v35 offset:5120
  buffer_load_dwordx4 v24, s[40:43], s67 offen lds
  s_add_u32 m0, s54, 0x8c00
  v_mfma_f32_32x32x16_bf16 v[176:191], a[172:175], a[28:31], v[176:191]
  s_waitcnt lgkmcnt(8)
  ds_read_b64_tr_b16 a[164:165], v35 offset:1280
  s_waitcnt vmcnt(36)
  ds_read_b64_tr_b16 a[166:167], v35 offset:5376
  buffer_load_dwordx4 v25, s[40:43], s67 offen lds
  s_add_u32 s69, s65, 0x5000
  v_mfma_f32_32x32x16_bf16 v[64:79], a[144:147], a[32:35], v[64:79]
  s_waitcnt lgkmcnt(8)
  ds_read_b64_tr_b16 a[168:169], v35 offset:1536
  ds_read_b64_tr_b16 a[170:171], v35 offset:5632
  buffer_load_dwordx4 a[80:83], v12, s[16:19], s69 offen sc1
  v_mfma_f32_32x32x16_bf16 v[80:95], a[148:151], a[32:35], v[80:95]
  s_waitcnt lgkmcnt(8)
  ds_read_b64_tr_b16 a[172:173], v35 offset:1792
  ds_read_b64_tr_b16 a[174:175], v35 offset:5888
  buffer_load_dwordx4 a[84:87], v12, s[16:19], s69 offen offset:1024 sc1
  v_mfma_f32_32x32x16_bf16 v[96:111], a[152:155], a[32:35], v[96:111]
  s_waitcnt lgkmcnt(8)
  ds_read_b64_tr_b16 a[144:145], v35 offset:8192
  ds_read_b64_tr_b16 a[146:147], v35 offset:12288
  v_mfma_f32_32x32x16_bf16 v[112:127], a[156:159], a[32:35], v[112:127]
  s_waitcnt lgkmcnt(8)
  ds_read_b64_tr_b16 a[148:149], v35 offset:8448
  ds_read_b64_tr_b16 a[150:151], v35 offset:12544
  v_mfma_f32_32x32x16_bf16 v[128:143], a[160:163], a[32:35], v[128:143]
  s_waitcnt lgkmcnt(8)
  ds_read_b64_tr_b16 a[152:153], v35 offset:8704
  ds_read_b64_tr_b16 a[154:155], v35 offset:12800
  v_mfma_f32_32x32x16_bf16 v[144:159], a[164:167], a[32:35], v[144:159]
  s_waitcnt lgkmcnt(8)
  ds_read_b64_tr_b16 a[156:157], v35 offset:8960
  ds_read_b64_tr_b16 a[158:159], v35 offset:13056
  v_mfma_f32_32x32x16_bf16 v[160:175], a[168:171], a[32:35], v[160:175]
  s_waitcnt lgkmcnt(8)
  ds_read_b64_tr_b16 a[160:161], v35 offset:9216
  ds_read_b64_tr_b16 a[162:163], v35 offset:13312
  v_mfma_f32_32x32x16_bf16 v[176:191], a[172:175], a[32:35], v[176:191]
  s_waitcnt lgkmcnt(8)
  ds_read_b64_tr_b16 a[164:165], v35 offset:9472
  s_waitcnt vmcnt(38)
  ds_read_b64_tr_b16 a[166:167], v35 offset:13568
  v_mfma_f32_32x32x16_bf16 v[64:79], a[144:147], a[36:39], v[64:79]
  s_waitcnt lgkmcnt(8)
  ds_read_b64_tr_b16 a[168:169], v35 offset:9728
  ds_read_b64_tr_b16 a[170:171], v35 offset:13824
  v_mfma_f32_32x32x16_bf16 v[80:95], a[148:151], a[36:39], v[80:95]
  s_waitcnt lgkmcnt(8)
  ds_read_b64_tr_b16 a[172:173], v35 offset:9984
  s_waitcnt vmcnt(34)
  ds_read_b64_tr_b16 a[174:175], v35 offset:14080
  s_barrier
  v_mfma_f32_32x32x16_bf16 v[96:111], a[152:155], a[36:39], v[96:111]
  s_waitcnt lgkmcnt(8)
  ds_read_b64_tr_b16 a[144:145], v35 offset:16384
  s_add_u32 s67, s62, 0x2c0000
  ds_read_b64_tr_b16 a[146:147], v35 offset:20480
  s_add_u32 m0, s54, 0xc000
  s_nop 0
  buffer_load_dwordx4 v22, s[40:43], s67 offen lds
  v_mfma_f32_32x32x16_bf16 v[112:127], a[156:159], a[36:39], v[112:127]
  s_waitcnt lgkmcnt(8)
  ds_read_b64_tr_b16 a[148:149], v35 offset:16640
  ds_read_b64_tr_b16 a[150:151], v35 offset:20736
  v_mfma_f32_32x32x16_bf16 v[128:143], a[160:163], a[36:39], v[128:143]
  s_waitcnt lgkmcnt(8)
  ds_read_b64_tr_b16 a[152:153], v35 offset:16896
  s_add_u32 m0, s54, 0xc400
  ds_read_b64_tr_b16 a[154:155], v35 offset:20992
  v_mfma_f32_32x32x16_bf16 v[144:159], a[164:167], a[36:39], v[144:159]
  s_waitcnt lgkmcnt(8)
  ds_read_b64_tr_b16 a[156:157], v35 offset:17152
  ds_read_b64_tr_b16 a[158:159], v35 offset:21248
  buffer_load_dwordx4 v23, s[40:43], s67 offen lds
  v_mfma_f32_32x32x16_bf16 v[160:175], a[168:171], a[36:39], v[160:175]
  s_waitcnt lgkmcnt(8)
  ds_read_b64_tr_b16 a[160:161], v35 offset:17408
  ds_read_b64_tr_b16 a[162:163], v35 offset:21504
  v_mfma_f32_32x32x16_bf16 v[176:191], a[172:175], a[36:39], v[176:191]
  s_waitcnt lgkmcnt(8)
  ds_read_b64_tr_b16 a[164:165], v35 offset:17664
  s_waitcnt vmcnt(35)
  ds_read_b64_tr_b16 a[166:167], v35 offset:21760
  s_add_u32 m0, s54, 0xc800
  v_mfma_f32_32x32x16_bf16 v[64:79], a[144:147], a[40:43], v[64:79]
  s_waitcnt lgkmcnt(8)
  ds_read_b64_tr_b16 a[168:169], v35 offset:17920
  ds_read_b64_tr_b16 a[170:171], v35 offset:22016
  buffer_load_dwordx4 v24, s[40:43], s67 offen lds
  v_mfma_f32_32x32x16_bf16 v[80:95], a[148:151], a[40:43], v[80:95]
  s_waitcnt lgkmcnt(8)
  ds_read_b64_tr_b16 a[172:173], v35 offset:18176
  ds_read_b64_tr_b16 a[174:175], v35 offset:22272
  v_mfma_f32_32x32x16_bf16 v[96:111], a[152:155], a[40:43], v[96:111]
  s_waitcnt lgkmcnt(8)
  ds_read_b64_tr_b16 a[144:145], v35 offset:24576
  s_add_u32 m0, s54, 0xcc00
  ds_read_b64_tr_b16 a[146:147], v35 offset:28672
  v_mfma_f32_32x32x16_bf16 v[112:127], a[156:159], a[40:43], v[112:127]
  s_waitcnt lgkmcnt(8)
  ds_read_b64_tr_b16 a[148:149], v35 offset:24832
  ds_read_b64_tr_b16 a[150:151], v35 offset:28928
  buffer_load_dwordx4 v25, s[40:43], s67 offen lds
  v_mfma_f32_32x32x16_bf16 v[128:143], a[160:163], a[40:43], v[128:143]
  s_waitcnt lgkmcnt(8)
  ds_read_b64_tr_b16 a[152:153], v35 offset:25088
  ds_read_b64_tr_b16 a[154:155], v35 offset:29184
  v_mfma_f32_32x32x16_bf16 v[144:159], a[164:167], a[40:43], v[144:159]
  s_waitcnt lgkmcnt(8)
  ds_read_b64_tr_b16 a[156:157], v35 offset:25344
  s_add_u32 s69, s65, 0x5800
  ds_read_b64_tr_b16 a[158:159], v35 offset:29440
  v_mfma_f32_32x32x16_bf16 v[160:175], a[168:171], a[40:43], v[160:175]
  s_waitcnt lgkmcnt(8)
  ds_read_b64_tr_b16 a[160:161], v35 offset:25600
  ds_read_b64_tr_b16 a[162:163], v35 offset:29696
  buffer_load_dwordx4 a[88:91], v12, s[16:19], s69 offen sc1
  v_mfma_f32_32x32x16_bf16 v[176:191], a[172:175], a[40:43], v[176:191]
  s_waitcnt lgkmcnt(8)
  ds_read_b64_tr_b16 a[164:165], v35 offset:25856
  s_waitcnt vmcnt(37)
  ds_read_b64_tr_b16 a[166:167], v35 offset:29952
  v_mfma_f32_32x32x16_bf16 v[64:79], a[144:147], a[44:47], v[64:79]
  s_waitcnt lgkmcnt(8)
  ds_read_b64_tr_b16 a[168:169], v35 offset:26112
  ds_read_b64_tr_b16 a[170:171], v35 offset:30208
  v_mfma_f32_32x32x16_bf16 v[80:95], a[148:151], a[44:47], v[80:95]
  s_waitcnt lgkmcnt(8)
  ds_read_b64_tr_b16 a[172:173], v35 offset:26368
  s_waitcnt vmcnt(33)
  ds_read_b64_tr_b16 a[174:175], v35 offset:30464
  s_barrier
  buffer_load_dwordx4 a[92:95], v12, s[16:19], s69 offen offset:1024 sc1
  v_mfma_f32_32x32x16_bf16 v[96:111], a[152:155], a[44:47], v[96:111]
  s_waitcnt lgkmcnt(8)
  ds_read_b64_tr_b16 a[144:145], v35 offset:32768
  ds_read_b64_tr_b16 a[146:147], v35 offset:36864
  v_mfma_f32_32x32x16_bf16 v[112:127], a[156:159], a[44:47], v[112:127]
  s_waitcnt lgkmcnt(8)
  ds_read_b64_tr_b16 a[148:149], v35 offset:33024
  s_add_u32 s67, s62, 0x300000
  ds_read_b64_tr_b16 a[150:151], v35 offset:37120
  s_add_u32 m0, s54, 0x10000
  v_mfma_f32_32x32x16_bf16 v[128:143], a[160:163], a[44:47], v[128:143]
  s_waitcnt lgkmcnt(8)
  ds_read_b64_tr_b16 a[152:153], v35 offset:33280
  ds_read_b64_tr_b16 a[154:155], v35 offset:37376
  buffer_load_dwordx4 v22, s[40:43], s67 offen lds
  s_add_u32 m0, s54, 0x10400
  v_mfma_f32_32x32x16_bf16 v[144:159], a[164:167], a[44:47], v[144:159]
  s_waitcnt lgkmcnt(8)
  ds_read_b64_tr_b16 a[156:157], v35 offset:33536
  ds_read_b64_tr_b16 a[158:159], v35 offset:37632
  buffer_load_dwordx4 v23, s[40:43], s67 offen lds
  s_add_u32 m0, s54, 0x10800
  v_mfma_f32_32x32x16_bf16 v[160:175], a[168:171], a[44:47], v[160:175]
  s_waitcnt lgkmcnt(8)
  ds_read_b64_tr_b16 a[160:161], v35 offset:33792
  ds_read_b64_tr_b16 a[162:163], v35 offset:37888
  buffer_load_dwordx4 v24, s[40:43], s67 offen lds
  s_add_u32 m0, s54, 0x10c00
  v_mfma_f32_32x32x16_bf16 v[176:191], a[172:175], a[44:47], v[176:191]
  s_waitcnt lgkmcnt(8)
  ds_read_b64_tr_b16 a[164:165], v35 offset:34048
  s_waitcnt vmcnt(36)
  ds_read_b64_tr_b16 a[166:167], v35 offset:38144
  buffer_load_dwordx4 v25, s[40:43], s67 offen lds
  s_add_u32 s69, s65, 0x6000
  v_mfma_f32_32x32x16_bf16 v[64:79], a[144:147], a[48:51], v[64:79]
  s_waitcnt lgkmcnt(8)
  ds_read_b64_tr_b16 a[168:169], v35 offset:34304
  ds_read_b64_tr_b16 a[170:171], v35 offset:38400
  buffer_load_dwordx4 a[96:99], v12, s[16:19], s69 offen sc1
  v_mfma_f32_32x32x16_bf16 v[80:95], a[148:151], a[48:51], v[80:95]
  s_waitcnt lgkmcnt(8)
  ds_read_b64_tr_b16 a[172:173], v35 offset:34560
  ds_read_b64_tr_b16 a[174:175], v35 offset:38656
  buffer_load_dwordx4 a[100:103], v12, s[16:19], s69 offen offset:1024 sc1
  v_mfma_f32_32x32x16_bf16 v[96:111], a[152:155], a[48:51], v[96:111]
  s_waitcnt lgkmcnt(8)
  ds_read_b64_tr_b16 a[144:145], v35 offset:40960
  ds_read_b64_tr_b16 a[146:147], v35 offset:45056
  v_mfma_f32_32x32x16_bf16 v[112:127], a[156:159], a[48:51], v[112:127]
  s_waitcnt lgkmcnt(8)
  ds_read_b64_tr_b16 a[148:149], v35 offset:41216
  ds_read_b64_tr_b16 a[150:151], v35 offset:45312
  v_mfma_f32_32x32x16_bf16 v[128:143], a[160:163], a[48:51], v[128:143]
  s_waitcnt lgkmcnt(8)
  ds_read_b64_tr_b16 a[152:153], v35 offset:41472
  ds_read_b64_tr_b16 a[154:155], v35 offset:45568
  v_mfma_f32_32x32x16_bf16 v[144:159], a[164:167], a[48:51], v[144:159]
  s_waitcnt lgkmcnt(8)
  ds_read_b64_tr_b16 a[156:157], v35 offset:41728
  ds_read_b64_tr_b16 a[158:159], v35 offset:45824
  v_mfma_f32_32x32x16_bf16 v[160:175], a[168:171], a[48:51], v[160:175]
  s_waitcnt lgkmcnt(8)
  ds_read_b64_tr_b16 a[160:161], v35 offset:41984
  ds_read_b64_tr_b16 a[162:163], v35 offset:46080
  v_mfma_f32_32x32x16_bf16 v[176:191], a[172:175], a[48:51], v[176:191]
  s_waitcnt lgkmcnt(8)
  ds_read_b64_tr_b16 a[164:165], v35 offset:42240
  s_waitcnt vmcnt(38)
  ds_read_b64_tr_b16 a[166:167], v35 offset:46336
  v_mfma_f32_32x32x16_bf16 v[64:79], a[144:147], a[52:55], v[64:79]
  s_waitcnt lgkmcnt(8)
  ds_read_b64_tr_b16 a[168:169], v35 offset:42496
  ds_read_b64_tr_b16 a[170:171], v35 offset:46592
  v_mfma_f32_32x32x16_bf16 v[80:95], a[148:151], a[52:55], v[80:95]
  s_waitcnt lgkmcnt(8)
  ds_read_b64_tr_b16 a[172:173], v35 offset:42752
  s_waitcnt vmcnt(34)
  ds_read_b64_tr_b16 a[174:175], v35 offset:46848
  s_barrier
  v_mfma_f32_32x32x16_bf16 v[96:111], a[152:155], a[52:55], v[96:111]
  s_waitcnt lgkmcnt(8)
  ds_read_b64_tr_b16 a[144:145], v35 offset:49152
  s_add_u32 s67, s62, 0x340000
  ds_read_b64_tr_b16 a[146:147], v35 offset:53248
  s_add_u32 m0, s54, 0x14000
  s_nop 0
  buffer_load_dwordx4 v22, s[40:43], s67 offen lds
  v_mfma_f32_32x32x16_bf16 v[112:127], a[156:159], a[52:55], v[112:127]
  s_waitcnt lgkmcnt(8)
  ds_read_b64_tr_b16 a[148:149], v35 offset:49408
  ds_read_b64_tr_b16 a[150:151], v35 offset:53504
  v_mfma_f32_32x32x16_bf16 v[128:143], a[160:163], a[52:55], v[128:143]
  s_waitcnt lgkmcnt(8)
  ds_read_b64_tr_b16 a[152:153], v35 offset:49664
  s_add_u32 m0, s54, 0x14400
  ds_read_b64_tr_b16 a[154:155], v35 offset:53760
  v_mfma_f32_32x32x16_bf16 v[144:159], a[164:167], a[52:55], v[144:159]
  s_waitcnt lgkmcnt(8)
  ds_read_b64_tr_b16 a[156:157], v35 offset:49920
  ds_read_b64_tr_b16 a[158:159], v35 offset:54016
  buffer_load_dwordx4 v23, s[40:43], s67 offen lds
  v_mfma_f32_32x32x16_bf16 v[160:175], a[168:171], a[52:55], v[160:175]
  s_waitcnt lgkmcnt(8)
  ds_read_b64_tr_b16 a[160:161], v35 offset:50176
  ds_read_b64_tr_b16 a[162:163], v35 offset:54272
  v_mfma_f32_32x32x16_bf16 v[176:191], a[172:175], a[52:55], v[176:191]
  s_waitcnt lgkmcnt(8)
  ds_read_b64_tr_b16 a[164:165], v35 offset:50432
  s_waitcnt vmcnt(35)
  ds_read_b64_tr_b16 a[166:167], v35 offset:54528
  s_add_u32 m0, s54, 0x14800
  v_mfma_f32_32x32x16_bf16 v[64:79], a[144:147], a[56:59], v[64:79]
  s_waitcnt lgkmcnt(8)
  ds_read_b64_tr_b16 a[168:169], v35 offset:50688
  ds_read_b64_tr_b16 a[170:171], v35 offset:54784
  buffer_load_dwordx4 v24, s[40:43], s67 offen lds
  v_mfma_f32_32x32x16_bf16 v[80:95], a[148:151], a[56:59], v[80:95]
  s_waitcnt lgkmcnt(8)
  ds_read_b64_tr_b16 a[172:173], v35 offset:50944
  ds_read_b64_tr_b16 a[174:175], v35 offset:55040
  v_mfma_f32_32x32x16_bf16 v[96:111], a[152:155], a[56:59], v[96:111]
  s_waitcnt lgkmcnt(8)
  ds_read_b64_tr_b16 a[144:145], v35 offset:57344
  s_add_u32 m0, s54, 0x14c00
  ds_read_b64_tr_b16 a[146:147], v35 offset:61440
  v_mfma_f32_32x32x16_bf16 v[112:127], a[156:159], a[56:59], v[112:127]
  s_waitcnt lgkmcnt(8)
  ds_read_b64_tr_b16 a[148:149], v35 offset:57600
  ds_read_b64_tr_b16 a[150:151], v35 offset:61696
  buffer_load_dwordx4 v25, s[40:43], s67 offen lds
  v_mfma_f32_32x32x16_bf16 v[128:143], a[160:163], a[56:59], v[128:143]
  s_waitcnt lgkmcnt(8)
  ds_read_b64_tr_b16 a[152:153], v35 offset:57856
  ds_read_b64_tr_b16 a[154:155], v35 offset:61952
  v_mfma_f32_32x32x16_bf16 v[144:159], a[164:167], a[56:59], v[144:159]
  s_waitcnt lgkmcnt(8)
  ds_read_b64_tr_b16 a[156:157], v35 offset:58112
  s_add_u32 s69, s65, 0x6800
  ds_read_b64_tr_b16 a[158:159], v35 offset:62208
  v_mfma_f32_32x32x16_bf16 v[160:175], a[168:171], a[56:59], v[160:175]
  s_waitcnt lgkmcnt(8)
  ds_read_b64_tr_b16 a[160:161], v35 offset:58368
  ds_read_b64_tr_b16 a[162:163], v35 offset:62464
  buffer_load_dwordx4 a[104:107], v12, s[16:19], s69 offen sc1
  v_mfma_f32_32x32x16_bf16 v[176:191], a[172:175], a[56:59], v[176:191]
  s_waitcnt lgkmcnt(8)
  ds_read_b64_tr_b16 a[164:165], v35 offset:58624
  s_waitcnt vmcnt(37)
  ds_read_b64_tr_b16 a[166:167], v35 offset:62720
  v_mfma_f32_32x32x16_bf16 v[64:79], a[144:147], a[60:63], v[64:79]
  s_waitcnt lgkmcnt(8)
  ds_read_b64_tr_b16 a[168:169], v35 offset:58880
  ds_read_b64_tr_b16 a[170:171], v35 offset:62976
  v_mfma_f32_32x32x16_bf16 v[80:95], a[148:151], a[60:63], v[80:95]
  s_waitcnt lgkmcnt(8)
  ds_read_b64_tr_b16 a[172:173], v35 offset:59136
  s_waitcnt vmcnt(33)
  ds_read_b64_tr_b16 a[174:175], v35 offset:63232
  s_barrier
  buffer_load_dwordx4 a[108:111], v12, s[16:19], s69 offen offset:1024 sc1
  v_mfma_f32_32x32x16_bf16 v[96:111], a[152:155], a[60:63], v[96:111]
  s_waitcnt lgkmcnt(8)
  ds_read_b64_tr_b16 a[144:145], v34
  ds_read_b64_tr_b16 a[146:147], v34 offset:4096
  v_mfma_f32_32x32x16_bf16 v[112:127], a[156:159], a[60:63], v[112:127]
  s_waitcnt lgkmcnt(8)
  ds_read_b64_tr_b16 a[148:149], v34 offset:256
  s_add_u32 s67, s62, 0x380000
  ds_read_b64_tr_b16 a[150:151], v34 offset:4352
  s_add_u32 m0, s54, 0x18000
  v_mfma_f32_32x32x16_bf16 v[128:143], a[160:163], a[60:63], v[128:143]
  s_waitcnt lgkmcnt(8)
  ds_read_b64_tr_b16 a[152:153], v34 offset:512
  ds_read_b64_tr_b16 a[154:155], v34 offset:4608
  buffer_load_dwordx4 v22, s[40:43], s67 offen lds
  s_add_u32 m0, s54, 0x18400
  v_mfma_f32_32x32x16_bf16 v[144:159], a[164:167], a[60:63], v[144:159]
  s_waitcnt lgkmcnt(8)
  ds_read_b64_tr_b16 a[156:157], v34 offset:768
  ds_read_b64_tr_b16 a[158:159], v34 offset:4864
  buffer_load_dwordx4 v23, s[40:43], s67 offen lds
  s_add_u32 m0, s54, 0x18800
  v_mfma_f32_32x32x16_bf16 v[160:175], a[168:171], a[60:63], v[160:175]
  s_waitcnt lgkmcnt(8)
  ds_read_b64_tr_b16 a[160:161], v34 offset:1024
  ds_read_b64_tr_b16 a[162:163], v34 offset:5120
  buffer_load_dwordx4 v24, s[40:43], s67 offen lds
  s_add_u32 m0, s54, 0x18c00
  v_mfma_f32_32x32x16_bf16 v[176:191], a[172:175], a[60:63], v[176:191]
  s_waitcnt lgkmcnt(8)
  ds_read_b64_tr_b16 a[164:165], v34 offset:1280
  s_waitcnt vmcnt(36)
  ds_read_b64_tr_b16 a[166:167], v34 offset:5376
  buffer_load_dwordx4 v25, s[40:43], s67 offen lds
  s_add_u32 s69, s65, 0x7000
  v_mfma_f32_32x32x16_bf16 v[64:79], a[144:147], a[64:67], v[64:79]
  s_waitcnt lgkmcnt(8)
  ds_read_b64_tr_b16 a[168:169], v34 offset:1536
  ds_read_b64_tr_b16 a[170:171], v34 offset:5632
  buffer_load_dwordx4 a[112:115], v12, s[16:19], s69 offen sc1
  v_mfma_f32_32x32x16_bf16 v[80:95], a[148:151], a[64:67], v[80:95]
  s_waitcnt lgkmcnt(8)
  ds_read_b64_tr_b16 a[172:173], v34 offset:1792
  ds_read_b64_tr_b16 a[174:175], v34 offset:5888
  buffer_load_dwordx4 a[116:119], v12, s[16:19], s69 offen offset:1024 sc1
  v_mfma_f32_32x32x16_bf16 v[96:111], a[152:155], a[64:67], v[96:111]
  s_waitcnt lgkmcnt(8)
  ds_read_b64_tr_b16 a[144:145], v34 offset:8192
  ds_read_b64_tr_b16 a[146:147], v34 offset:12288
  v_mfma_f32_32x32x16_bf16 v[112:127], a[156:159], a[64:67], v[112:127]
  s_waitcnt lgkmcnt(8)
  ds_read_b64_tr_b16 a[148:149], v34 offset:8448
  ds_read_b64_tr_b16 a[150:151], v34 offset:12544
  v_mfma_f32_32x32x16_bf16 v[128:143], a[160:163], a[64:67], v[128:143]
  s_waitcnt lgkmcnt(8)
  ds_read_b64_tr_b16 a[152:153], v34 offset:8704
  ds_read_b64_tr_b16 a[154:155], v34 offset:12800
  v_mfma_f32_32x32x16_bf16 v[144:159], a[164:167], a[64:67], v[144:159]
  s_waitcnt lgkmcnt(8)
  ds_read_b64_tr_b16 a[156:157], v34 offset:8960
  ds_read_b64_tr_b16 a[158:159], v34 offset:13056
  v_mfma_f32_32x32x16_bf16 v[160:175], a[168:171], a[64:67], v[160:175]
  s_waitcnt lgkmcnt(8)
  ds_read_b64_tr_b16 a[160:161], v34 offset:9216
  ds_read_b64_tr_b16 a[162:163], v34 offset:13312
  v_mfma_f32_32x32x16_bf16 v[176:191], a[172:175], a[64:67], v[176:191]
  s_waitcnt lgkmcnt(8)
  ds_read_b64_tr_b16 a[164:165], v34 offset:9472
  s_waitcnt vmcnt(38)
  ds_read_b64_tr_b16 a[166:167], v34 offset:13568
  v_mfma_f32_32x32x16_bf16 v[64:79], a[144:147], a[68:71], v[64:79]
  s_waitcnt lgkmcnt(8)
  ds_read_b64_tr_b16 a[168:169], v34 offset:9728
  ds_read_b64_tr_b16 a[170:171], v34 offset:13824
  v_mfma_f32_32x32x16_bf16 v[80:95], a[148:151], a[68:71], v[80:95]
  s_waitcnt lgkmcnt(8)
  ds_read_b64_tr_b16 a[172:173], v34 offset:9984
  s_waitcnt vmcnt(32)
  ds_read_b64_tr_b16 a[174:175], v34 offset:14080
  s_barrier
  v_mfma_f32_32x32x16_bf16 v[96:111], a[152:155], a[68:71], v[96:111]
  s_waitcnt lgkmcnt(8)
  ds_read_b64_tr_b16 a[144:145], v34 offset:16384
  s_add_u32 s67, s62, 0x3c0000
  ds_read_b64_tr_b16 a[146:147], v34 offset:20480
  s_add_u32 m0, s54, 0x1c000
  s_nop 0
  buffer_load_dwordx4 v22, s[40:43], s67 offen lds
  v_mfma_f32_32x32x16_bf16 v[112:127], a[156:159], a[68:71], v[112:127]
  s_waitcnt lgkmcnt(8)
  ds_read_b64_tr_b16 a[148:149], v34 offset:16640
  ds_read_b64_tr_b16 a[150:151], v34 offset:20736
  v_mfma_f32_32x32x16_bf16 v[128:143], a[160:163], a[68:71], v[128:143]
  s_waitcnt lgkmcnt(8)
  ds_read_b64_tr_b16 a[152:153], v34 offset:16896
  s_add_u32 m0, s54, 0x1c400
  ds_read_b64_tr_b16 a[154:155], v34 offset:20992
  v_mfma_f32_32x32x16_bf16 v[144:159], a[164:167], a[68:71], v[144:159]
  s_waitcnt lgkmcnt(8)
  ds_read_b64_tr_b16 a[156:157], v34 offset:17152
  ds_read_b64_tr_b16 a[158:159], v34 offset:21248
  buffer_load_dwordx4 v23, s[40:43], s67 offen lds
  v_mfma_f32_32x32x16_bf16 v[160:175], a[168:171], a[68:71], v[160:175]
  s_waitcnt lgkmcnt(8)
  ds_read_b64_tr_b16 a[160:161], v34 offset:17408
  ds_read_b64_tr_b16 a[162:163], v34 offset:21504
  v_mfma_f32_32x32x16_bf16 v[176:191], a[172:175], a[68:71], v[176:191]
  s_waitcnt lgkmcnt(8)
  ds_read_b64_tr_b16 a[164:165], v34 offset:17664
  s_waitcnt vmcnt(33)
  ds_read_b64_tr_b16 a[166:167], v34 offset:21760
  s_add_u32 m0, s54, 0x1c800
  v_mfma_f32_32x32x16_bf16 v[64:79], a[144:147], a[72:75], v[64:79]
  s_waitcnt lgkmcnt(8)
  ds_read_b64_tr_b16 a[168:169], v34 offset:17920
  ds_read_b64_tr_b16 a[170:171], v34 offset:22016
  buffer_load_dwordx4 v24, s[40:43], s67 offen lds
  v_mfma_f32_32x32x16_bf16 v[80:95], a[148:151], a[72:75], v[80:95]
  s_waitcnt lgkmcnt(8)
  ds_read_b64_tr_b16 a[172:173], v34 offset:18176
  ds_read_b64_tr_b16 a[174:175], v34 offset:22272
  v_mfma_f32_32x32x16_bf16 v[96:111], a[152:155], a[72:75], v[96:111]
  s_waitcnt lgkmcnt(8)
  ds_read_b64_tr_b16 a[144:145], v34 offset:24576
  s_add_u32 m0, s54, 0x1cc00
  ds_read_b64_tr_b16 a[146:147], v34 offset:28672
  v_mfma_f32_32x32x16_bf16 v[112:127], a[156:159], a[72:75], v[112:127]
  s_waitcnt lgkmcnt(8)
  ds_read_b64_tr_b16 a[148:149], v34 offset:24832
  ds_read_b64_tr_b16 a[150:151], v34 offset:28928
  buffer_load_dwordx4 v25, s[40:43], s67 offen lds
  v_mfma_f32_32x32x16_bf16 v[128:143], a[160:163], a[72:75], v[128:143]
  s_waitcnt lgkmcnt(8)
  ds_read_b64_tr_b16 a[152:153], v34 offset:25088
  ds_read_b64_tr_b16 a[154:155], v34 offset:29184
  v_mfma_f32_32x32x16_bf16 v[144:159], a[164:167], a[72:75], v[144:159]
  s_waitcnt lgkmcnt(8)
  ds_read_b64_tr_b16 a[156:157], v34 offset:25344
  s_add_u32 s69, s65, 0x7800
  ds_read_b64_tr_b16 a[158:159], v34 offset:29440
  v_mfma_f32_32x32x16_bf16 v[160:175], a[168:171], a[72:75], v[160:175]
  s_waitcnt lgkmcnt(8)
  ds_read_b64_tr_b16 a[160:161], v34 offset:25600
  ds_read_b64_tr_b16 a[162:163], v34 offset:29696
  buffer_load_dwordx4 a[120:123], v12, s[16:19], s69 offen sc1
  v_mfma_f32_32x32x16_bf16 v[176:191], a[172:175], a[72:75], v[176:191]
  s_waitcnt lgkmcnt(8)
  ds_read_b64_tr_b16 a[164:165], v34 offset:25856
  s_waitcnt vmcnt(35)
  ds_read_b64_tr_b16 a[166:167], v34 offset:29952
  v_mfma_f32_32x32x16_bf16 v[64:79], a[144:147], a[76:79], v[64:79]
  s_waitcnt lgkmcnt(8)
  ds_read_b64_tr_b16 a[168:169], v34 offset:26112
  ds_read_b64_tr_b16 a[170:171], v34 offset:30208
  v_mfma_f32_32x32x16_bf16 v[80:95], a[148:151], a[76:79], v[80:95]
  s_waitcnt lgkmcnt(8)
  ds_read_b64_tr_b16 a[172:173], v34 offset:26368
  s_waitcnt vmcnt(31)
  ds_read_b64_tr_b16 a[174:175], v34 offset:30464
  s_barrier
  buffer_load_dwordx4 a[124:127], v12, s[16:19], s69 offen offset:1024 sc1
  v_mfma_f32_32x32x16_bf16 v[96:111], a[152:155], a[76:79], v[96:111]
  s_waitcnt lgkmcnt(8)
  ds_read_b64_tr_b16 a[144:145], v34 offset:32768
  ds_read_b64_tr_b16 a[146:147], v34 offset:36864
  v_mfma_f32_32x32x16_bf16 v[112:127], a[156:159], a[76:79], v[112:127]
  s_waitcnt lgkmcnt(8)
  ds_read_b64_tr_b16 a[148:149], v34 offset:33024
  s_add_u32 s67, s62, 0x400000
  ds_read_b64_tr_b16 a[150:151], v34 offset:37120
  s_add_u32 m0, s54, 0
  v_mfma_f32_32x32x16_bf16 v[128:143], a[160:163], a[76:79], v[128:143]
  s_waitcnt lgkmcnt(8)
  ds_read_b64_tr_b16 a[152:153], v34 offset:33280
  ds_read_b64_tr_b16 a[154:155], v34 offset:37376
  buffer_load_dwordx4 v22, s[40:43], s67 offen lds
  s_add_u32 m0, s54, 0x400
  v_mfma_f32_32x32x16_bf16 v[144:159], a[164:167], a[76:79], v[144:159]
  s_waitcnt lgkmcnt(8)
  ds_read_b64_tr_b16 a[156:157], v34 offset:33536
  ds_read_b64_tr_b16 a[158:159], v34 offset:37632
  buffer_load_dwordx4 v23, s[40:43], s67 offen lds
  s_add_u32 m0, s54, 0x800
  v_mfma_f32_32x32x16_bf16 v[160:175], a[168:171], a[76:79], v[160:175]
  s_waitcnt lgkmcnt(8)
  ds_read_b64_tr_b16 a[160:161], v34 offset:33792
  ds_read_b64_tr_b16 a[162:163], v34 offset:37888
  buffer_load_dwordx4 v24, s[40:43], s67 offen lds
  s_add_u32 m0, s54, 0xc00
  v_mfma_f32_32x32x16_bf16 v[176:191], a[172:175], a[76:79], v[176:191]
  s_waitcnt lgkmcnt(8)
  ds_read_b64_tr_b16 a[164:165], v34 offset:34048
  s_waitcnt vmcnt(34)
  ds_read_b64_tr_b16 a[166:167], v34 offset:38144
  buffer_load_dwordx4 v25, s[40:43], s67 offen lds
  s_add_u32 s69, s65, 0x8000
  v_mfma_f32_32x32x16_bf16 v[64:79], a[144:147], a[80:83], v[64:79]
  s_waitcnt lgkmcnt(8)
  ds_read_b64_tr_b16 a[168:169], v34 offset:34304
  ds_read_b64_tr_b16 a[170:171], v34 offset:38400
  buffer_load_dwordx4 a[128:131], v12, s[16:19], s69 offen sc1
  v_mfma_f32_32x32x16_bf16 v[80:95], a[148:151], a[80:83], v[80:95]
  s_waitcnt lgkmcnt(8)
  ds_read_b64_tr_b16 a[172:173], v34 offset:34560
  ds_read_b64_tr_b16 a[174:175], v34 offset:38656
  buffer_load_dwordx4 a[132:135], v12, s[16:19], s69 offen offset:1024 sc1
  v_mfma_f32_32x32x16_bf16 v[96:111], a[152:155], a[80:83], v[96:111]
  s_waitcnt lgkmcnt(8)
  ds_read_b64_tr_b16 a[144:145], v34 offset:40960
  ds_read_b64_tr_b16 a[146:147], v34 offset:45056
  v_mfma_f32_32x32x16_bf16 v[112:127], a[156:159], a[80:83], v[112:127]
  s_waitcnt lgkmcnt(8)
  ds_read_b64_tr_b16 a[148:149], v34 offset:41216
  ds_read_b64_tr_b16 a[150:151], v34 offset:45312
  v_mfma_f32_32x32x16_bf16 v[128:143], a[160:163], a[80:83], v[128:143]
  s_waitcnt lgkmcnt(8)
  ds_read_b64_tr_b16 a[152:153], v34 offset:41472
  ds_read_b64_tr_b16 a[154:155], v34 offset:45568
  v_mfma_f32_32x32x16_bf16 v[144:159], a[164:167], a[80:83], v[144:159]
  s_waitcnt lgkmcnt(8)
  ds_read_b64_tr_b16 a[156:157], v34 offset:41728
  ds_read_b64_tr_b16 a[158:159], v34 offset:45824
  v_mfma_f32_32x32x16_bf16 v[160:175], a[168:171], a[80:83], v[160:175]
  s_waitcnt lgkmcnt(8)
  ds_read_b64_tr_b16 a[160:161], v34 offset:41984
  ds_read_b64_tr_b16 a[162:163], v34 offset:46080
  v_mfma_f32_32x32x16_bf16 v[176:191], a[172:175], a[80:83], v[176:191]
  s_waitcnt lgkmcnt(8)
  ds_read_b64_tr_b16 a[164:165], v34 offset:42240
  s_waitcnt vmcnt(36)
  ds_read_b64_tr_b16 a[166:167], v34 offset:46336
  v_mfma_f32_32x32x16_bf16 v[64:79], a[144:147], a[84:87], v[64:79]
  s_waitcnt lgkmcnt(8)
  ds_read_b64_tr_b16 a[168:169], v34 offset:42496
  ds_read_b64_tr_b16 a[170:171], v34 offset:46592
  v_mfma_f32_32x32x16_bf16 v[80:95], a[148:151], a[84:87], v[80:95]
  s_waitcnt lgkmcnt(8)
  ds_read_b64_tr_b16 a[172:173], v34 offset:42752
  s_waitcnt vmcnt(32)
  ds_read_b64_tr_b16 a[174:175], v34 offset:46848
  s_barrier
  v_mfma_f32_32x32x16_bf16 v[96:111], a[152:155], a[84:87], v[96:111]
  s_waitcnt lgkmcnt(8)
  ds_read_b64_tr_b16 a[144:145], v34 offset:49152
  s_add_u32 s67, s62, 0x440000
  ds_read_b64_tr_b16 a[146:147], v34 offset:53248
  s_add_u32 m0, s54, 0x4000
  s_nop 0
  buffer_load_dwordx4 v22, s[40:43], s67 offen lds
  v_mfma_f32_32x32x16_bf16 v[112:127], a[156:159], a[84:87], v[112:127]
  s_waitcnt lgkmcnt(8)
  ds_read_b64_tr_b16 a[148:149], v34 offset:49408
  ds_read_b64_tr_b16 a[150:151], v34 offset:53504
  v_mfma_f32_32x32x16_bf16 v[128:143], a[160:163], a[84:87], v[128:143]
  s_waitcnt lgkmcnt(8)
  ds_read_b64_tr_b16 a[152:153], v34 offset:49664
  s_add_u32 m0, s54, 0x4400
  ds_read_b64_tr_b16 a[154:155], v34 offset:53760
  v_mfma_f32_32x32x16_bf16 v[144:159], a[164:167], a[84:87], v[144:159]
  s_waitcnt lgkmcnt(8)
  ds_read_b64_tr_b16 a[156:157], v34 offset:49920
  ds_read_b64_tr_b16 a[158:159], v34 offset:54016
  buffer_load_dwordx4 v23, s[40:43], s67 offen lds
  v_mfma_f32_32x32x16_bf16 v[160:175], a[168:171], a[84:87], v[160:175]
  s_waitcnt lgkmcnt(8)
  ds_read_b64_tr_b16 a[160:161], v34 offset:50176
  ds_read_b64_tr_b16 a[162:163], v34 offset:54272
  v_mfma_f32_32x32x16_bf16 v[176:191], a[172:175], a[84:87], v[176:191]
  s_waitcnt lgkmcnt(8)
  ds_read_b64_tr_b16 a[164:165], v34 offset:50432
  s_waitcnt vmcnt(33)
  ds_read_b64_tr_b16 a[166:167], v34 offset:54528
  s_add_u32 m0, s54, 0x4800
  v_mfma_f32_32x32x16_bf16 v[64:79], a[144:147], a[88:91], v[64:79]
  s_waitcnt lgkmcnt(8)
  ds_read_b64_tr_b16 a[168:169], v34 offset:50688
  ds_read_b64_tr_b16 a[170:171], v34 offset:54784
  buffer_load_dwordx4 v24, s[40:43], s67 offen lds
  v_mfma_f32_32x32x16_bf16 v[80:95], a[148:151], a[88:91], v[80:95]
  s_waitcnt lgkmcnt(8)
  ds_read_b64_tr_b16 a[172:173], v34 offset:50944
  ds_read_b64_tr_b16 a[174:175], v34 offset:55040
  v_mfma_f32_32x32x16_bf16 v[96:111], a[152:155], a[88:91], v[96:111]
  s_waitcnt lgkmcnt(8)
  ds_read_b64_tr_b16 a[144:145], v34 offset:57344
  s_add_u32 m0, s54, 0x4c00
  ds_read_b64_tr_b16 a[146:147], v34 offset:61440
  v_mfma_f32_32x32x16_bf16 v[112:127], a[156:159], a[88:91], v[112:127]
  s_waitcnt lgkmcnt(8)
  ds_read_b64_tr_b16 a[148:149], v34 offset:57600
  ds_read_b64_tr_b16 a[150:151], v34 offset:61696
  buffer_load_dwordx4 v25, s[40:43], s67 offen lds
  v_mfma_f32_32x32x16_bf16 v[128:143], a[160:163], a[88:91], v[128:143]
  s_waitcnt lgkmcnt(8)
  ds_read_b64_tr_b16 a[152:153], v34 offset:57856
  ds_read_b64_tr_b16 a[154:155], v34 offset:61952
  v_mfma_f32_32x32x16_bf16 v[144:159], a[164:167], a[88:91], v[144:159]
  s_waitcnt lgkmcnt(8)
  ds_read_b64_tr_b16 a[156:157], v34 offset:58112
  s_add_u32 s69, s65, 0x8800
  ds_read_b64_tr_b16 a[158:159], v34 offset:62208
  v_mfma_f32_32x32x16_bf16 v[160:175], a[168:171], a[88:91], v[160:175]
  s_waitcnt lgkmcnt(8)
  ds_read_b64_tr_b16 a[160:161], v34 offset:58368
  ds_read_b64_tr_b16 a[162:163], v34 offset:62464
  buffer_load_dwordx4 a[136:139], v12, s[16:19], s69 offen sc1
  v_mfma_f32_32x32x16_bf16 v[176:191], a[172:175], a[88:91], v[176:191]
  s_waitcnt lgkmcnt(8)
  ds_read_b64_tr_b16 a[164:165], v34 offset:58624
  s_waitcnt vmcnt(35)
  ds_read_b64_tr_b16 a[166:167], v34 offset:62720
  v_mfma_f32_32x32x16_bf16 v[64:79], a[144:147], a[92:95], v[64:79]
  s_waitcnt lgkmcnt(8)
  ds_read_b64_tr_b16 a[168:169], v34 offset:58880
  ds_read_b64_tr_b16 a[170:171], v34 offset:62976
  v_mfma_f32_32x32x16_bf16 v[80:95], a[148:151], a[92:95], v[80:95]
  s_waitcnt lgkmcnt(8)
  ds_read_b64_tr_b16 a[172:173], v34 offset:59136
  s_waitcnt vmcnt(31)
  ds_read_b64_tr_b16 a[174:175], v34 offset:63232
  s_barrier
  buffer_load_dwordx4 a[140:143], v12, s[16:19], s69 offen offset:1024 sc1
  v_mfma_f32_32x32x16_bf16 v[96:111], a[152:155], a[92:95], v[96:111]
  s_waitcnt lgkmcnt(8)
  ds_read_b64_tr_b16 a[144:145], v35
  ds_read_b64_tr_b16 a[146:147], v35 offset:4096
  v_mfma_f32_32x32x16_bf16 v[112:127], a[156:159], a[92:95], v[112:127]
  s_waitcnt lgkmcnt(8)
  ds_read_b64_tr_b16 a[148:149], v35 offset:256
  s_add_u32 s67, s63, 0
  ds_read_b64_tr_b16 a[150:151], v35 offset:4352
  s_add_u32 m0, s54, 0x8000
  v_mfma_f32_32x32x16_bf16 v[128:143], a[160:163], a[92:95], v[128:143]
  s_waitcnt lgkmcnt(8)
  ds_read_b64_tr_b16 a[152:153], v35 offset:512
  ds_read_b64_tr_b16 a[154:155], v35 offset:4608
  buffer_load_dwordx4 v26, s[24:27], s67 offen lds
  s_add_u32 m0, s54, 0x8400
  v_mfma_f32_32x32x16_bf16 v[144:159], a[164:167], a[92:95], v[144:159]
  s_waitcnt lgkmcnt(8)
  ds_read_b64_tr_b16 a[156:157], v35 offset:768
  ds_read_b64_tr_b16 a[158:159], v35 offset:4864
  buffer_load_dwordx4 v27, s[24:27], s67 offen lds
  v_mfma_f32_32x32x16_bf16 v[160:175], a[168:171], a[92:95], v[160:175]
  s_waitcnt lgkmcnt(8)
  ds_read_b64_tr_b16 a[160:161], v35 offset:1024
  ds_read_b64_tr_b16 a[162:163], v35 offset:5120
  v_mfma_f32_32x32x16_bf16 v[176:191], a[172:175], a[92:95], v[176:191]
  s_waitcnt lgkmcnt(8)
  ds_read_b64_tr_b16 a[164:165], v35 offset:1280
  s_waitcnt vmcnt(33)
  ds_read_b64_tr_b16 a[166:167], v35 offset:5376
  v_mfma_f32_32x32x16_bf16 v[64:79], a[144:147], a[96:99], v[64:79]
  s_waitcnt lgkmcnt(8)
  ds_read_b64_tr_b16 a[168:169], v35 offset:1536
  ds_read_b64_tr_b16 a[170:171], v35 offset:5632
  v_mfma_f32_32x32x16_bf16 v[80:95], a[148:151], a[96:99], v[80:95]
  s_waitcnt lgkmcnt(8)
  ds_read_b64_tr_b16 a[172:173], v35 offset:1792
  ds_read_b64_tr_b16 a[174:175], v35 offset:5888
  v_mfma_f32_32x32x16_bf16 v[96:111], a[152:155], a[96:99], v[96:111]
  s_waitcnt lgkmcnt(8)
  ds_read_b64_tr_b16 a[144:145], v35 offset:8192
  ds_read_b64_tr_b16 a[146:147], v35 offset:12288
  v_mfma_f32_32x32x16_bf16 v[112:127], a[156:159], a[96:99], v[112:127]
  s_waitcnt lgkmcnt(8)
  ds_read_b64_tr_b16 a[148:149], v35 offset:8448
  ds_read_b64_tr_b16 a[150:151], v35 offset:12544
  v_mfma_f32_32x32x16_bf16 v[128:143], a[160:163], a[96:99], v[128:143]
  s_waitcnt lgkmcnt(8)
  ds_read_b64_tr_b16 a[152:153], v35 offset:8704
  ds_read_b64_tr_b16 a[154:155], v35 offset:12800
  v_mfma_f32_32x32x16_bf16 v[144:159], a[164:167], a[96:99], v[144:159]
  s_waitcnt lgkmcnt(8)
  ds_read_b64_tr_b16 a[156:157], v35 offset:8960
  ds_read_b64_tr_b16 a[158:159], v35 offset:13056
  v_mfma_f32_32x32x16_bf16 v[160:175], a[168:171], a[96:99], v[160:175]
  s_waitcnt lgkmcnt(8)
  ds_read_b64_tr_b16 a[160:161], v35 offset:9216
  ds_read_b64_tr_b16 a[162:163], v35 offset:13312
  v_mfma_f32_32x32x16_bf16 v[176:191], a[172:175], a[96:99], v[176:191]
  s_waitcnt lgkmcnt(8)
  ds_read_b64_tr_b16 a[164:165], v35 offset:9472
  s_waitcnt vmcnt(32)
  ds_read_b64_tr_b16 a[166:167], v35 offset:13568
  v_mfma_f32_32x32x16_bf16 v[64:79], a[144:147], a[100:103], v[64:79]
  s_waitcnt lgkmcnt(8)
  ds_read_b64_tr_b16 a[168:169], v35 offset:9728
  ds_read_b64_tr_b16 a[170:171], v35 offset:13824
  v_mfma_f32_32x32x16_bf16 v[80:95], a[148:151], a[100:103], v[80:95]
  s_waitcnt lgkmcnt(8)
  ds_read_b64_tr_b16 a[172:173], v35 offset:9984
  s_waitcnt vmcnt(28)
  ds_read_b64_tr_b16 a[174:175], v35 offset:14080
  s_barrier
  v_mfma_f32_32x32x16_bf16 v[96:111], a[152:155], a[100:103], v[96:111]
  s_waitcnt lgkmcnt(8)
  ds_read_b64_tr_b16 a[144:145], v35 offset:16384
  s_add_u32 s67, s63, 0x2000
  ds_read_b64_tr_b16 a[146:147], v35 offset:20480
  s_add_u32 s68, s63, 0
  s_add_u32 m0, s54, 0xc000
  s_nop 0
  buffer_load_dwordx4 v26, s[24:27], s67 offen lds
  v_mfma_f32_32x32x16_bf16 v[112:127], a[156:159], a[100:103], v[112:127]
  s_waitcnt lgkmcnt(8)
  ds_read_b64_tr_b16 a[148:149], v35 offset:16640
  ds_read_b64_tr_b16 a[150:151], v35 offset:20736
  v_mfma_f32_32x32x16_bf16 v[128:143], a[160:163], a[100:103], v[128:143]
  s_waitcnt lgkmcnt(8)
  ds_read_b64_tr_b16 a[152:153], v35 offset:16896
  s_add_u32 m0, s54, 0xc400
  ds_read_b64_tr_b16 a[154:155], v35 offset:20992
  v_mfma_f32_32x32x16_bf16 v[144:159], a[164:167], a[100:103], v[144:159]
  s_waitcnt lgkmcnt(8)
  ds_read_b64_tr_b16 a[156:157], v35 offset:17152
  ds_read_b64_tr_b16 a[158:159], v35 offset:21248
  buffer_load_dwordx4 v27, s[24:27], s67 offen lds
  v_mfma_f32_32x32x16_bf16 v[160:175], a[168:171], a[100:103], v[160:175]
  s_waitcnt lgkmcnt(8)
  ds_read_b64_tr_b16 a[160:161], v35 offset:17408
  ds_read_b64_tr_b16 a[162:163], v35 offset:21504
  v_mfma_f32_32x32x16_bf16 v[176:191], a[172:175], a[100:103], v[176:191]
  s_waitcnt lgkmcnt(8)
  ds_read_b64_tr_b16 a[164:165], v35 offset:17664
  s_waitcnt vmcnt(29)
  ds_read_b64_tr_b16 a[166:167], v35 offset:21760
  s_add_u32 m0, s54, 0xc800
  v_mfma_f32_32x32x16_bf16 v[64:79], a[144:147], a[104:107], v[64:79]
  s_waitcnt lgkmcnt(8)
  ds_read_b64_tr_b16 a[168:169], v35 offset:17920
  ds_read_b64_tr_b16 a[170:171], v35 offset:22016
  buffer_load_dwordx4 v28, s[28:31], s68 offen lds
  v_mfma_f32_32x32x16_bf16 v[80:95], a[148:151], a[104:107], v[80:95]
  s_waitcnt lgkmcnt(8)
  ds_read_b64_tr_b16 a[172:173], v35 offset:18176
  ds_read_b64_tr_b16 a[174:175], v35 offset:22272
  v_mfma_f32_32x32x16_bf16 v[96:111], a[152:155], a[104:107], v[96:111]
  s_waitcnt lgkmcnt(8)
  ds_read_b64_tr_b16 a[144:145], v35 offset:24576
  s_add_u32 m0, s54, 0xcc00
  ds_read_b64_tr_b16 a[146:147], v35 offset:28672
  v_mfma_f32_32x32x16_bf16 v[112:127], a[156:159], a[104:107], v[112:127]
  s_waitcnt lgkmcnt(8)
  ds_read_b64_tr_b16 a[148:149], v35 offset:24832
  ds_read_b64_tr_b16 a[150:151], v35 offset:28928
  buffer_load_dwordx4 v29, s[28:31], s68 offen lds
  v_mfma_f32_32x32x16_bf16 v[128:143], a[160:163], a[104:107], v[128:143]
  s_waitcnt lgkmcnt(8)
  ds_read_b64_tr_b16 a[152:153], v35 offset:25088
  ds_read_b64_tr_b16 a[154:155], v35 offset:29184
  v_mfma_f32_32x32x16_bf16 v[144:159], a[164:167], a[104:107], v[144:159]
  s_waitcnt lgkmcnt(8)
  ds_read_b64_tr_b16 a[156:157], v35 offset:25344
  ds_read_b64_tr_b16 a[158:159], v35 offset:29440
  v_mfma_f32_32x32x16_bf16 v[160:175], a[168:171], a[104:107], v[160:175]
  s_waitcnt lgkmcnt(8)
  ds_read_b64_tr_b16 a[160:161], v35 offset:25600
  ds_read_b64_tr_b16 a[162:163], v35 offset:29696
  v_mfma_f32_32x32x16_bf16 v[176:191], a[172:175], a[104:107], v[176:191]
  s_waitcnt lgkmcnt(8)
  ds_read_b64_tr_b16 a[164:165], v35 offset:25856
  s_waitcnt vmcnt(30)
  ds_read_b64_tr_b16 a[166:167], v35 offset:29952
  v_mfma_f32_32x32x16_bf16 v[64:79], a[144:147], a[108:111], v[64:79]
  s_waitcnt lgkmcnt(8)
  ds_read_b64_tr_b16 a[168:169], v35 offset:26112
  ds_read_b64_tr_b16 a[170:171], v35 offset:30208
  v_mfma_f32_32x32x16_bf16 v[80:95], a[148:151], a[108:111], v[80:95]
  s_waitcnt lgkmcnt(8)
  ds_read_b64_tr_b16 a[172:173], v35 offset:26368
  s_waitcnt vmcnt(26)
  ds_read_b64_tr_b16 a[174:175], v35 offset:30464
  s_barrier
  v_mfma_f32_32x32x16_bf16 v[96:111], a[152:155], a[108:111], v[96:111]
  s_waitcnt lgkmcnt(8)
  ds_read_b64_tr_b16 a[144:145], v35 offset:32768
  s_add_u32 s67, s63, 0x4000
  ds_read_b64_tr_b16 a[146:147], v35 offset:36864
  s_add_u32 s68, s63, 0x2000
  s_add_u32 m0, s54, 0x10000
  s_nop 0
  buffer_load_dwordx4 v26, s[24:27], s67 offen lds
  v_mfma_f32_32x32x16_bf16 v[112:127], a[156:159], a[108:111], v[112:127]
  s_waitcnt lgkmcnt(8)
  ds_read_b64_tr_b16 a[148:149], v35 offset:33024
  ds_read_b64_tr_b16 a[150:151], v35 offset:37120
  v_mfma_f32_32x32x16_bf16 v[128:143], a[160:163], a[108:111], v[128:143]
  s_waitcnt lgkmcnt(8)
  ds_read_b64_tr_b16 a[152:153], v35 offset:33280
  s_add_u32 m0, s54, 0x10400
  ds_read_b64_tr_b16 a[154:155], v35 offset:37376
  v_mfma_f32_32x32x16_bf16 v[144:159], a[164:167], a[108:111], v[144:159]
  s_waitcnt lgkmcnt(8)
  ds_read_b64_tr_b16 a[156:157], v35 offset:33536
  ds_read_b64_tr_b16 a[158:159], v35 offset:37632
  buffer_load_dwordx4 v27, s[24:27], s67 offen lds
  v_mfma_f32_32x32x16_bf16 v[160:175], a[168:171], a[108:111], v[160:175]
  s_waitcnt lgkmcnt(8)
  ds_read_b64_tr_b16 a[160:161], v35 offset:33792
  ds_read_b64_tr_b16 a[162:163], v35 offset:37888
  v_mfma_f32_32x32x16_bf16 v[176:191], a[172:175], a[108:111], v[176:191]
  s_waitcnt lgkmcnt(8)
  ds_read_b64_tr_b16 a[164:165], v35 offset:34048
  s_waitcnt vmcnt(27)
  ds_read_b64_tr_b16 a[166:167], v35 offset:38144
  s_add_u32 m0, s54, 0x10800
  v_mfma_f32_32x32x16_bf16 v[64:79], a[144:147], a[112:115], v[64:79]
  s_waitcnt lgkmcnt(8)
  ds_read_b64_tr_b16 a[168:169], v35 offset:34304
  ds_read_b64_tr_b16 a[170:171], v35 offset:38400
  buffer_load_dwordx4 v28, s[28:31], s68 offen lds
  v_mfma_f32_32x32x16_bf16 v[80:95], a[148:151], a[112:115], v[80:95]
  s_waitcnt lgkmcnt(8)
  ds_read_b64_tr_b16 a[172:173], v35 offset:34560
  ds_read_b64_tr_b16 a[174:175], v35 offset:38656
  v_mfma_f32_32x32x16_bf16 v[96:111], a[152:155], a[112:115], v[96:111]
  s_waitcnt lgkmcnt(8)
  ds_read_b64_tr_b16 a[144:145], v35 offset:40960
  s_add_u32 m0, s54, 0x10c00
  ds_read_b64_tr_b16 a[146:147], v35 offset:45056
  v_mfma_f32_32x32x16_bf16 v[112:127], a[156:159], a[112:115], v[112:127]
  s_waitcnt lgkmcnt(8)
  ds_read_b64_tr_b16 a[148:149], v35 offset:41216
  ds_read_b64_tr_b16 a[150:151], v35 offset:45312
  buffer_load_dwordx4 v29, s[28:31], s68 offen lds
  v_mfma_f32_32x32x16_bf16 v[128:143], a[160:163], a[112:115], v[128:143]
  s_waitcnt lgkmcnt(8)
  ds_read_b64_tr_b16 a[152:153], v35 offset:41472
  ds_read_b64_tr_b16 a[154:155], v35 offset:45568
  v_mfma_f32_32x32x16_bf16 v[144:159], a[164:167], a[112:115], v[144:159]
  s_waitcnt lgkmcnt(8)
  ds_read_b64_tr_b16 a[156:157], v35 offset:41728
  ds_read_b64_tr_b16 a[158:159], v35 offset:45824
  v_mfma_f32_32x32x16_bf16 v[160:175], a[168:171], a[112:115], v[160:175]
  s_waitcnt lgkmcnt(8)
  ds_read_b64_tr_b16 a[160:161], v35 offset:41984
  ds_read_b64_tr_b16 a[162:163], v35 offset:46080
  v_mfma_f32_32x32x16_bf16 v[176:191], a[172:175], a[112:115], v[176:191]
  s_waitcnt lgkmcnt(8)
  ds_read_b64_tr_b16 a[164:165], v35 offset:42240
  s_waitcnt vmcnt(28)
  ds_read_b64_tr_b16 a[166:167], v35 offset:46336
  v_mfma_f32_32x32x16_bf16 v[64:79], a[144:147], a[116:119], v[64:79]
  s_waitcnt lgkmcnt(8)
  ds_read_b64_tr_b16 a[168:169], v35 offset:42496
  ds_read_b64_tr_b16 a[170:171], v35 offset:46592
  v_mfma_f32_32x32x16_bf16 v[80:95], a[148:151], a[116:119], v[80:95]
  s_waitcnt lgkmcnt(8)
  ds_read_b64_tr_b16 a[172:173], v35 offset:42752
  s_waitcnt vmcnt(24)
  ds_read_b64_tr_b16 a[174:175], v35 offset:46848
  s_barrier
  v_mfma_f32_32x32x16_bf16 v[96:111], a[152:155], a[116:119], v[96:111]
  s_waitcnt lgkmcnt(8)
  ds_read_b64_tr_b16 a[144:145], v35 offset:49152
  s_add_u32 s67, s63, 0x6000
  ds_read_b64_tr_b16 a[146:147], v35 offset:53248
  s_add_u32 s68, s63, 0x4000
  s_add_u32 m0, s54, 0x14000
  s_nop 0
  buffer_load_dwordx4 v26, s[24:27], s67 offen lds
  v_mfma_f32_32x32x16_bf16 v[112:127], a[156:159], a[116:119], v[112:127]
  s_waitcnt lgkmcnt(8)
  ds_read_b64_tr_b16 a[148:149], v35 offset:49408
  ds_read_b64_tr_b16 a[150:151], v35 offset:53504
  v_mfma_f32_32x32x16_bf16 v[128:143], a[160:163], a[116:119], v[128:143]
  s_waitcnt lgkmcnt(8)
  ds_read_b64_tr_b16 a[152:153], v35 offset:49664
  s_add_u32 m0, s54, 0x14400
  ds_read_b64_tr_b16 a[154:155], v35 offset:53760
  v_mfma_f32_32x32x16_bf16 v[144:159], a[164:167], a[116:119], v[144:159]
  s_waitcnt lgkmcnt(8)
  ds_read_b64_tr_b16 a[156:157], v35 offset:49920
  ds_read_b64_tr_b16 a[158:159], v35 offset:54016
  buffer_load_dwordx4 v27, s[24:27], s67 offen lds
  v_mfma_f32_32x32x16_bf16 v[160:175], a[168:171], a[116:119], v[160:175]
  s_waitcnt lgkmcnt(8)
  ds_read_b64_tr_b16 a[160:161], v35 offset:50176
  ds_read_b64_tr_b16 a[162:163], v35 offset:54272
  v_mfma_f32_32x32x16_bf16 v[176:191], a[172:175], a[116:119], v[176:191]
  s_waitcnt lgkmcnt(8)
  ds_read_b64_tr_b16 a[164:165], v35 offset:50432
  s_waitcnt vmcnt(25)
  ds_read_b64_tr_b16 a[166:167], v35 offset:54528
  s_add_u32 m0, s54, 0x14800
  v_mfma_f32_32x32x16_bf16 v[64:79], a[144:147], a[120:123], v[64:79]
  s_waitcnt lgkmcnt(8)
  ds_read_b64_tr_b16 a[168:169], v35 offset:50688
  ds_read_b64_tr_b16 a[170:171], v35 offset:54784
  buffer_load_dwordx4 v28, s[28:31], s68 offen lds
  v_mfma_f32_32x32x16_bf16 v[80:95], a[148:151], a[120:123], v[80:95]
  s_waitcnt lgkmcnt(8)
  ds_read_b64_tr_b16 a[172:173], v35 offset:50944
  ds_read_b64_tr_b16 a[174:175], v35 offset:55040
  v_mfma_f32_32x32x16_bf16 v[96:111], a[152:155], a[120:123], v[96:111]
  s_waitcnt lgkmcnt(8)
  ds_read_b64_tr_b16 a[144:145], v35 offset:57344
  s_add_u32 m0, s54, 0x14c00
  ds_read_b64_tr_b16 a[146:147], v35 offset:61440
  v_mfma_f32_32x32x16_bf16 v[112:127], a[156:159], a[120:123], v[112:127]
  s_waitcnt lgkmcnt(8)
  ds_read_b64_tr_b16 a[148:149], v35 offset:57600
  ds_read_b64_tr_b16 a[150:151], v35 offset:61696
  buffer_load_dwordx4 v29, s[28:31], s68 offen lds
  v_mfma_f32_32x32x16_bf16 v[128:143], a[160:163], a[120:123], v[128:143]
  s_waitcnt lgkmcnt(8)
  ds_read_b64_tr_b16 a[152:153], v35 offset:57856
  ds_read_b64_tr_b16 a[154:155], v35 offset:61952
  v_mfma_f32_32x32x16_bf16 v[144:159], a[164:167], a[120:123], v[144:159]
  s_waitcnt lgkmcnt(8)
  ds_read_b64_tr_b16 a[156:157], v35 offset:58112
  ds_read_b64_tr_b16 a[158:159], v35 offset:62208
  v_mfma_f32_32x32x16_bf16 v[160:175], a[168:171], a[120:123], v[160:175]
  s_waitcnt lgkmcnt(8)
  ds_read_b64_tr_b16 a[160:161], v35 offset:58368
  ds_read_b64_tr_b16 a[162:163], v35 offset:62464
  v_mfma_f32_32x32x16_bf16 v[176:191], a[172:175], a[120:123], v[176:191]
  s_waitcnt lgkmcnt(8)
  ds_read_b64_tr_b16 a[164:165], v35 offset:58624
  s_waitcnt vmcnt(26)
  ds_read_b64_tr_b16 a[166:167], v35 offset:62720
  v_mfma_f32_32x32x16_bf16 v[64:79], a[144:147], a[124:127], v[64:79]
  s_waitcnt lgkmcnt(8)
  ds_read_b64_tr_b16 a[168:169], v35 offset:58880
  ds_read_b64_tr_b16 a[170:171], v35 offset:62976
  v_mfma_f32_32x32x16_bf16 v[80:95], a[148:151], a[124:127], v[80:95]
  s_waitcnt lgkmcnt(8)
  ds_read_b64_tr_b16 a[172:173], v35 offset:59136
  s_waitcnt vmcnt(22)
  ds_read_b64_tr_b16 a[174:175], v35 offset:63232
  s_barrier
  v_mfma_f32_32x32x16_bf16 v[96:111], a[152:155], a[124:127], v[96:111]
  s_waitcnt lgkmcnt(8)
  ds_read_b64_tr_b16 a[144:145], v34
  s_add_u32 s67, s63, 0x8000
  ds_read_b64_tr_b16 a[146:147], v34 offset:4096
  s_add_u32 s68, s63, 0x6000
  s_add_u32 m0, s54, 0x18000
  s_nop 0
  buffer_load_dwordx4 v26, s[24:27], s67 offen lds
  v_mfma_f32_32x32x16_bf16 v[112:127], a[156:159], a[124:127], v[112:127]
  s_waitcnt lgkmcnt(8)
  ds_read_b64_tr_b16 a[148:149], v34 offset:256
  ds_read_b64_tr_b16 a[150:151], v34 offset:4352
  v_mfma_f32_32x32x16_bf16 v[128:143], a[160:163], a[124:127], v[128:143]
  s_waitcnt lgkmcnt(8)
  ds_read_b64_tr_b16 a[152:153], v34 offset:512
  s_add_u32 m0, s54, 0x18400
  ds_read_b64_tr_b16 a[154:155], v34 offset:4608
  v_mfma_f32_32x32x16_bf16 v[144:159], a[164:167], a[124:127], v[144:159]
  s_waitcnt lgkmcnt(8)
  ds_read_b64_tr_b16 a[156:157], v34 offset:768
  ds_read_b64_tr_b16 a[158:159], v34 offset:4864
  buffer_load_dwordx4 v27, s[24:27], s67 offen lds
  v_mfma_f32_32x32x16_bf16 v[160:175], a[168:171], a[124:127], v[160:175]
  s_waitcnt lgkmcnt(8)
  ds_read_b64_tr_b16 a[160:161], v34 offset:1024
  ds_read_b64_tr_b16 a[162:163], v34 offset:5120
  v_mfma_f32_32x32x16_bf16 v[176:191], a[172:175], a[124:127], v[176:191]
  s_waitcnt lgkmcnt(8)
  ds_read_b64_tr_b16 a[164:165], v34 offset:1280
  s_waitcnt vmcnt(23)
  ds_read_b64_tr_b16 a[166:167], v34 offset:5376
  s_add_u32 m0, s54, 0x18800
  v_mfma_f32_32x32x16_bf16 v[64:79], a[144:147], a[128:131], v[64:79]
  s_waitcnt lgkmcnt(8)
  ds_read_b64_tr_b16 a[168:169], v34 offset:1536
  ds_read_b64_tr_b16 a[170:171], v34 offset:5632
  buffer_load_dwordx4 v28, s[28:31], s68 offen lds
  v_mfma_f32_32x32x16_bf16 v[80:95], a[148:151], a[128:131], v[80:95]
  s_waitcnt lgkmcnt(8)
  ds_read_b64_tr_b16 a[172:173], v34 offset:1792
  ds_read_b64_tr_b16 a[174:175], v34 offset:5888
  v_mfma_f32_32x32x16_bf16 v[96:111], a[152:155], a[128:131], v[96:111]
  s_waitcnt lgkmcnt(8)
  ds_read_b64_tr_b16 a[144:145], v34 offset:8192
  s_add_u32 m0, s54, 0x18c00
  ds_read_b64_tr_b16 a[146:147], v34 offset:12288
  v_mfma_f32_32x32x16_bf16 v[112:127], a[156:159], a[128:131], v[112:127]
  s_waitcnt lgkmcnt(8)
  ds_read_b64_tr_b16 a[148:149], v34 offset:8448
  ds_read_b64_tr_b16 a[150:151], v34 offset:12544
  buffer_load_dwordx4 v29, s[28:31], s68 offen lds
  v_mfma_f32_32x32x16_bf16 v[128:143], a[160:163], a[128:131], v[128:143]
  s_waitcnt lgkmcnt(8)
  ds_read_b64_tr_b16 a[152:153], v34 offset:8704
  ds_read_b64_tr_b16 a[154:155], v34 offset:12800
  v_mfma_f32_32x32x16_bf16 v[144:159], a[164:167], a[128:131], v[144:159]
  s_waitcnt lgkmcnt(8)
  ds_read_b64_tr_b16 a[156:157], v34 offset:8960
  ds_read_b64_tr_b16 a[158:159], v34 offset:13056
  v_mfma_f32_32x32x16_bf16 v[160:175], a[168:171], a[128:131], v[160:175]
  s_waitcnt lgkmcnt(8)
  ds_read_b64_tr_b16 a[160:161], v34 offset:9216
  ds_read_b64_tr_b16 a[162:163], v34 offset:13312
  v_mfma_f32_32x32x16_bf16 v[176:191], a[172:175], a[128:131], v[176:191]
  s_waitcnt lgkmcnt(8)
  ds_read_b64_tr_b16 a[164:165], v34 offset:9472
  s_waitcnt vmcnt(24)
  ds_read_b64_tr_b16 a[166:167], v34 offset:13568
  v_mfma_f32_32x32x16_bf16 v[64:79], a[144:147], a[132:135], v[64:79]
  s_waitcnt lgkmcnt(8)
  ds_read_b64_tr_b16 a[168:169], v34 offset:9728
  ds_read_b64_tr_b16 a[170:171], v34 offset:13824
  v_mfma_f32_32x32x16_bf16 v[80:95], a[148:151], a[132:135], v[80:95]
  s_waitcnt lgkmcnt(8)
  ds_read_b64_tr_b16 a[172:173], v34 offset:9984
  s_waitcnt vmcnt(20)
  ds_read_b64_tr_b16 a[174:175], v34 offset:14080
  s_barrier
  v_mfma_f32_32x32x16_bf16 v[96:111], a[152:155], a[132:135], v[96:111]
  s_waitcnt lgkmcnt(8)
  ds_read_b64_tr_b16 a[144:145], v34 offset:16384
  s_add_u32 s67, s63, 0xa000
  ds_read_b64_tr_b16 a[146:147], v34 offset:20480
  s_add_u32 s68, s63, 0x8000
  s_add_u32 m0, s54, 0x1c000
  s_nop 0
  buffer_load_dwordx4 v26, s[24:27], s67 offen lds
  v_mfma_f32_32x32x16_bf16 v[112:127], a[156:159], a[132:135], v[112:127]
  s_waitcnt lgkmcnt(8)
  ds_read_b64_tr_b16 a[148:149], v34 offset:16640
  ds_read_b64_tr_b16 a[150:151], v34 offset:20736
  v_mfma_f32_32x32x16_bf16 v[128:143], a[160:163], a[132:135], v[128:143]
  s_waitcnt lgkmcnt(8)
  ds_read_b64_tr_b16 a[152:153], v34 offset:16896
  s_add_u32 m0, s54, 0x1c400
  ds_read_b64_tr_b16 a[154:155], v34 offset:20992
  v_mfma_f32_32x32x16_bf16 v[144:159], a[164:167], a[132:135], v[144:159]
  s_waitcnt lgkmcnt(8)
  ds_read_b64_tr_b16 a[156:157], v34 offset:17152
  ds_read_b64_tr_b16 a[158:159], v34 offset:21248
  buffer_load_dwordx4 v27, s[24:27], s67 offen lds
  v_mfma_f32_32x32x16_bf16 v[160:175], a[168:171], a[132:135], v[160:175]
  s_waitcnt lgkmcnt(8)
  ds_read_b64_tr_b16 a[160:161], v34 offset:17408
  ds_read_b64_tr_b16 a[162:163], v34 offset:21504
  v_mfma_f32_32x32x16_bf16 v[176:191], a[172:175], a[132:135], v[176:191]
  s_waitcnt lgkmcnt(8)
  ds_read_b64_tr_b16 a[164:165], v34 offset:17664
  s_waitcnt vmcnt(21)
  ds_read_b64_tr_b16 a[166:167], v34 offset:21760
  s_add_u32 m0, s54, 0x1c800
  v_mfma_f32_32x32x16_bf16 v[64:79], a[144:147], a[136:139], v[64:79]
  s_waitcnt lgkmcnt(8)
  ds_read_b64_tr_b16 a[168:169], v34 offset:17920
  ds_read_b64_tr_b16 a[170:171], v34 offset:22016
  buffer_load_dwordx4 v28, s[28:31], s68 offen lds
  v_mfma_f32_32x32x16_bf16 v[80:95], a[148:151], a[136:139], v[80:95]
  s_waitcnt lgkmcnt(8)
  ds_read_b64_tr_b16 a[172:173], v34 offset:18176
  ds_read_b64_tr_b16 a[174:175], v34 offset:22272
  v_mfma_f32_32x32x16_bf16 v[96:111], a[152:155], a[136:139], v[96:111]
  s_waitcnt lgkmcnt(8)
  ds_read_b64_tr_b16 a[144:145], v34 offset:24576
  s_add_u32 m0, s54, 0x1cc00
  ds_read_b64_tr_b16 a[146:147], v34 offset:28672
  v_mfma_f32_32x32x16_bf16 v[112:127], a[156:159], a[136:139], v[112:127]
  s_waitcnt lgkmcnt(8)
  ds_read_b64_tr_b16 a[148:149], v34 offset:24832
  ds_read_b64_tr_b16 a[150:151], v34 offset:28928
  buffer_load_dwordx4 v29, s[28:31], s68 offen lds
  v_mfma_f32_32x32x16_bf16 v[128:143], a[160:163], a[136:139], v[128:143]
  s_waitcnt lgkmcnt(8)
  ds_read_b64_tr_b16 a[152:153], v34 offset:25088
  ds_read_b64_tr_b16 a[154:155], v34 offset:29184
  v_mfma_f32_32x32x16_bf16 v[144:159], a[164:167], a[136:139], v[144:159]
  s_waitcnt lgkmcnt(8)
  ds_read_b64_tr_b16 a[156:157], v34 offset:25344
  ds_read_b64_tr_b16 a[158:159], v34 offset:29440
  v_mfma_f32_32x32x16_bf16 v[160:175], a[168:171], a[136:139], v[160:175]
  s_waitcnt lgkmcnt(8)
  ds_read_b64_tr_b16 a[160:161], v34 offset:25600
  ds_read_b64_tr_b16 a[162:163], v34 offset:29696
  v_mfma_f32_32x32x16_bf16 v[176:191], a[172:175], a[136:139], v[176:191]
  s_waitcnt lgkmcnt(8)
  ds_read_b64_tr_b16 a[164:165], v34 offset:25856
  s_waitcnt vmcnt(22)
  ds_read_b64_tr_b16 a[166:167], v34 offset:29952
  s_waitcnt vmcnt(20)
  s_barrier
  v_mfma_f32_32x32x16_bf16 v[64:79], a[144:147], a[140:143], v[64:79]
  s_waitcnt lgkmcnt(8)
  ds_read_b64_tr_b16 a[168:169], v34 offset:26112
  s_add_u32 s67, s63, 0xc000
  ds_read_b64_tr_b16 a[170:171], v34 offset:30208
  s_add_u32 s68, s63, 0xa000
  ds_read_b64_tr_b16 a[172:173], v34 offset:26368
  s_add_u32 m0, s54, 0
  ds_read_b64_tr_b16 a[174:175], v34 offset:30464
  ds_read_b128 a[144:147], v36 offset:32768
  buffer_load_dwordx4 v26, s[24:27], s67 offen lds
  v_mfma_f32_32x32x16_bf16 v[80:95], a[148:151], a[140:143], v[80:95]
  s_waitcnt lgkmcnt(11)
  v_mfma_f32_32x32x16_bf16 v[96:111], a[152:155], a[140:143], v[96:111]
  s_waitcnt lgkmcnt(9)
  ds_read_b128 a[148:151], v36 offset:33024
  s_add_u32 m0, s54, 0x400
  v_mfma_f32_32x32x16_bf16 v[112:127], a[156:159], a[140:143], v[112:127]
  s_waitcnt lgkmcnt(8)
  buffer_load_dwordx4 v27, s[24:27], s67 offen lds
  v_mfma_f32_32x32x16_bf16 v[128:143], a[160:163], a[140:143], v[128:143]
  s_waitcnt lgkmcnt(6)
  ds_read_b128 a[152:155], v36 offset:33280
  v_mfma_f32_32x32x16_bf16 v[144:159], a[164:167], a[140:143], v[144:159]
  s_waitcnt lgkmcnt(5)
  s_add_u32 m0, s54, 0x800
  v_mfma_f32_32x32x16_bf16 v[160:175], a[168:171], a[140:143], v[160:175]
  s_waitcnt lgkmcnt(3)
  ds_read_b128 a[156:159], v36 offset:33536
  buffer_load_dwordx4 v28, s[28:31], s68 offen lds
  v_mfma_f32_32x32x16_bf16 v[176:191], a[172:175], a[140:143], v[176:191]
  s_waitcnt lgkmcnt(3)
  v_cvt_pk_bf16_f32 v64, v64, v65
  v_cvt_pk_bf16_f32 v65, v66, v67
  v_cvt_pk_bf16_f32 v66, v68, v69
  v_cvt_pk_bf16_f32 v67, v70, v71
  v_cvt_pk_bf16_f32 v68, v72, v73
  v_cvt_pk_bf16_f32 v69, v74, v75
  v_cvt_pk_bf16_f32 v70, v76, v77
  v_cvt_pk_bf16_f32 v71, v78, v79
  v_cvt_pk_bf16_f32 v72, v80, v81
  v_cvt_pk_bf16_f32 v73, v82, v83
  v_cvt_pk_bf16_f32 v74, v84, v85
  v_cvt_pk_bf16_f32 v75, v86, v87
  v_cvt_pk_bf16_f32 v76, v88, v89
  v_cvt_pk_bf16_f32 v77, v90, v91
  v_cvt_pk_bf16_f32 v78, v92, v93
  v_cvt_pk_bf16_f32 v79, v94, v95
  v_cvt_pk_bf16_f32 v80, v96, v97
  v_cvt_pk_bf16_f32 v81, v98, v99
  v_cvt_pk_bf16_f32 v82, v100, v101
  v_cvt_pk_bf16_f32 v83, v102, v103
  v_cvt_pk_bf16_f32 v84, v104, v105
  v_cvt_pk_bf16_f32 v85, v106, v107
  v_cvt_pk_bf16_f32 v86, v108, v109
  v_cvt_pk_bf16_f32 v87, v110, v111
  v_cvt_pk_bf16_f32 v88, v112, v113
  v_cvt_pk_bf16_f32 v89, v114, v115
  v_cvt_pk_bf16_f32 v90, v116, v117
  v_cvt_pk_bf16_f32 v91, v118, v119
  v_cvt_pk_bf16_f32 v92, v120, v121
  v_cvt_pk_bf16_f32 v93, v122, v123
  v_cvt_pk_bf16_f32 v94, v124, v125
  v_cvt_pk_bf16_f32 v95, v126, v127
  v_cvt_pk_bf16_f32 v96, v128, v129
  v_cvt_pk_bf16_f32 v97, v130, v131
  v_cvt_pk_bf16_f32 v98, v132, v133
  v_cvt_pk_bf16_f32 v99, v134, v135
  v_cvt_pk_bf16_f32 v100, v136, v137
  v_cvt_pk_bf16_f32 v101, v138, v139
  v_cvt_pk_bf16_f32 v102, v140, v141
  v_cvt_pk_bf16_f32 v103, v142, v143
  v_cvt_pk_bf16_f32 v104, v144, v145
  v_cvt_pk_bf16_f32 v105, v146, v147
  v_cvt_pk_bf16_f32 v106, v148, v149
  v_cvt_pk_bf16_f32 v107, v150, v151
  v_cvt_pk_bf16_f32 v108, v152, v153
  v_cvt_pk_bf16_f32 v109, v154, v155
  v_cvt_pk_bf16_f32 v110, v156, v157
  v_cvt_pk_bf16_f32 v111, v158, v159
  v_cvt_pk_bf16_f32 v112, v160, v161
  v_cvt_pk_bf16_f32 v113, v162, v163
  v_cvt_pk_bf16_f32 v114, v164, v165
  v_cvt_pk_bf16_f32 v115, v166, v167
  v_cvt_pk_bf16_f32 v116, v168, v169
  v_cvt_pk_bf16_f32 v117, v170, v171
  v_cvt_pk_bf16_f32 v118, v172, v173
  v_cvt_pk_bf16_f32 v119, v174, v175
  v_cvt_pk_bf16_f32 v120, v176, v177
  v_cvt_pk_bf16_f32 v121, v178, v179
  v_cvt_pk_bf16_f32 v122, v180, v181
  v_cvt_pk_bf16_f32 v123, v182, v183
  v_cvt_pk_bf16_f32 v124, v184, v185
  v_cvt_pk_bf16_f32 v125, v186, v187
  v_cvt_pk_bf16_f32 v126, v188, v189
  v_cvt_pk_bf16_f32 v127, v190, v191
  v_mfma_f32_32x32x16_bf16 v[128:143], a[144:147], v[64:67], 0
  s_add_u32 m0, s54, 0xc00
  ds_read_b128 a[160:163], v36 offset:33792
  v_mfma_f32_32x32x16_bf16 v[144:159], a[144:147], v[96:99], 0
  s_waitcnt lgkmcnt(3)
  buffer_load_dwordx4 v29, s[28:31], s68 offen lds
  v_mfma_f32_32x32x16_bf16 v[128:143], a[148:151], v[68:71], v[128:143]
  ds_read_b128 a[164:167], v36 offset:34048
  v_mfma_f32_32x32x16_bf16 v[144:159], a[148:151], v[100:103], v[144:159]
  s_waitcnt lgkmcnt(3)
  v_mfma_f32_32x32x16_bf16 v[128:143], a[152:155], v[72:75], v[128:143]
  ds_read_b128 a[168:171], v36 offset:34304
  v_mfma_f32_32x32x16_bf16 v[144:159], a[152:155], v[104:107], v[144:159]
  s_waitcnt lgkmcnt(3)
  v_mfma_f32_32x32x16_bf16 v[128:143], a[156:159], v[76:79], v[128:143]
  ds_read_b128 a[172:175], v36 offset:34560
  v_mfma_f32_32x32x16_bf16 v[144:159], a[156:159], v[108:111], v[144:159]
  s_waitcnt lgkmcnt(3)
  s_waitcnt vmcnt(20)
  s_barrier
  v_mfma_f32_32x32x16_bf16 v[128:143], a[160:163], v[80:83], v[128:143]
  s_add_u32 s67, s63, 0xe000
  ds_read_b128 a[144:147], v36 offset:49152
  s_add_u32 s68, s63, 0xc000
  s_add_u32 m0, s54, 0x4000
  s_nop 0
  buffer_load_dwordx4 v26, s[24:27], s67 offen lds
  v_mfma_f32_32x32x16_bf16 v[144:159], a[160:163], v[112:115], v[144:159]
  s_waitcnt lgkmcnt(3)
  v_mfma_f32_32x32x16_bf16 v[128:143], a[164:167], v[84:87], v[128:143]
  s_add_u32 m0, s54, 0x4400
  ds_read_b128 a[148:151], v36 offset:49408
  v_mfma_f32_32x32x16_bf16 v[144:159], a[164:167], v[116:119], v[144:159]
  s_waitcnt lgkmcnt(3)
  buffer_load_dwordx4 v27, s[24:27], s67 offen lds
  v_mfma_f32_32x32x16_bf16 v[128:143], a[168:171], v[88:91], v[128:143]
  ds_read_b128 a[152:155], v36 offset:49664
  v_mfma_f32_32x32x16_bf16 v[144:159], a[168:171], v[120:123], v[144:159]
  s_waitcnt lgkmcnt(3)
  s_add_u32 m0, s54, 0x4800
  v_mfma_f32_32x32x16_bf16 v[128:143], a[172:175], v[92:95], v[128:143]
  ds_read_b128 a[156:159], v36 offset:49920
  buffer_load_dwordx4 v28, s[28:31], s68 offen lds
  v_mfma_f32_32x32x16_bf16 v[144:159], a[172:175], v[124:127], v[144:159]
  s_waitcnt lgkmcnt(3)
  v_mfma_f32_32x32x16_bf16 v[160:175], a[144:147], v[64:67], 0
  s_add_u32 m0, s54, 0x4c00
  ds_read_b128 a[160:163], v36 offset:50176
  s_nop 4
  v_max3_f32 v228, v128, v129, v130
  v_max3_f32 v228, v228, v131, v132
  v_max3_f32 v228, v228, v133, v134
  v_max3_f32 v228, v228, v135, v136
  v_max3_f32 v228, v228, v137, v138
  v_mfma_f32_32x32x16_bf16 v[176:191], a[144:147], v[96:99], 0
  s_waitcnt lgkmcnt(3)
  buffer_load_dwordx4 v29, s[28:31], s68 offen lds
  v_max3_f32 v228, v228, v139, v140
  v_max3_f32 v228, v228, v141, v142
  v_max_f32 v228, v228, v143
  v_max3_f32 v229, v144, v145, v146
  v_max3_f32 v229, v229, v147, v148
  v_mfma_f32_32x32x16_bf16 v[160:175], a[148:151], v[68:71], v[160:175]
  ds_read_b128 a[164:167], v36 offset:50432
  v_max3_f32 v229, v229, v149, v150
  v_max3_f32 v229, v229, v151, v152
  v_max3_f32 v229, v229, v153, v154
  v_max3_f32 v229, v229, v155, v156
  v_max3_f32 v229, v229, v157, v158
  v_mfma_f32_32x32x16_bf16 v[176:191], a[148:151], v[100:103], v[176:191]
  s_waitcnt lgkmcnt(3)
  v_max_f32 v229, v229, v159
  v_mov_b32 v230, v228
  v_mov_b32 v231, v229
  s_nop 0
  v_permlane32_swap_b32 v228, v230
  v_permlane32_swap_b32 v229, v231
  v_max_f32 v228, v228, v230
  v_mfma_f32_32x32x16_bf16 v[160:175], a[152:155], v[72:75], v[160:175]
  ds_read_b128 a[168:171], v36 offset:50688
  v_max_f32 v229, v229, v231
  v_sub_f32 v192, 0, v228
  v_sub_f32 v208, 0, v229
  v_add_f32 v128, v128, v192
  v_add_f32 v144, v144, v208
  v_mfma_f32_32x32x16_bf16 v[176:191], a[152:155], v[104:107], v[176:191]
  s_waitcnt lgkmcnt(3)
  v_add_f32 v129, v129, v192
  v_add_f32 v145, v145, v208
  v_add_f32 v130, v130, v192
  v_add_f32 v146, v146, v208
  v_add_f32 v131, v131, v192
  v_add_f32 v147, v147, v208
  v_mfma_f32_32x32x16_bf16 v[160:175], a[156:159], v[76:79], v[160:175]
  ds_read_b128 a[172:175], v36 offset:50944
  v_add_f32 v132, v132, v192
  v_add_f32 v148, v148, v208
  v_add_f32 v133, v133, v192
  v_add_f32 v149, v149, v208
  v_add_f32 v134, v134, v192
  v_mfma_f32_32x32x16_bf16 v[176:191], a[156:159], v[108:111], v[176:191]
  s_waitcnt lgkmcnt(3)
  v_add_f32 v150, v150, v208
  v_add_f32 v135, v135, v192
  v_add_f32 v151, v151, v208
  v_add_f32 v136, v136, v192
  v_add_f32 v152, v152, v208
  v_add_f32 v137, v137, v192
  v_mfma_f32_32x32x16_bf16 v[160:175], a[160:163], v[80:83], v[160:175]
  ds_read_b64_tr_b16 a[144:145], v38 offset:51200
  ds_read_b64_tr_b16 a[146:147], v38 offset:55296
  v_add_f32 v153, v153, v208
  v_add_f32 v138, v138, v192
  v_add_f32 v154, v154, v208
  v_mfma_f32_32x32x16_bf16 v[176:191], a[160:163], v[112:115], v[176:191]
  s_waitcnt lgkmcnt(4)
  v_add_f32 v139, v139, v192
  v_add_f32 v155, v155, v208
  v_add_f32 v140, v140, v192
  v_add_f32 v156, v156, v208
  v_add_f32 v141, v141, v192
  v_add_f32 v157, v157, v208
  v_mfma_f32_32x32x16_bf16 v[160:175], a[164:167], v[84:87], v[160:175]
  ds_read_b64_tr_b16 a[148:149], v38 offset:51456
  ds_read_b64_tr_b16 a[150:151], v38 offset:55552
  v_add_f32 v142, v142, v192
  v_add_f32 v158, v158, v208
  v_add_f32 v143, v143, v192
  v_mfma_f32_32x32x16_bf16 v[176:191], a[164:167], v[116:119], v[176:191]
  s_waitcnt lgkmcnt(5)
  v_add_f32 v159, v159, v208
  v_mov_b32 v193, v192
  v_mov_b32 v209, v208
  v_mov_b32 v194, v192
  v_mov_b32 v210, v208
  v_mov_b32 v195, v192
  v_mfma_f32_32x32x16_bf16 v[160:175], a[168:171], v[88:91], v[160:175]
  ds_read_b64_tr_b16 a[152:153], v38 offset:51712
  ds_read_b64_tr_b16 a[154:155], v38 offset:55808
  v_mov_b32 v211, v208
  v_mov_b32 v196, v192
  v_mov_b32 v212, v208
  v_mfma_f32_32x32x16_bf16 v[176:191], a[168:171], v[120:123], v[176:191]
  s_waitcnt lgkmcnt(6)
  v_mov_b32 v197, v192
  v_mov_b32 v213, v208
  v_mov_b32 v198, v192
  v_mov_b32 v214, v208
  v_mov_b32 v199, v192
  v_mov_b32 v215, v208
  v_mfma_f32_32x32x16_bf16 v[160:175], a[172:175], v[92:95], v[160:175]
  ds_read_b64_tr_b16 a[156:157], v38 offset:51968
  ds_read_b64_tr_b16 a[158:159], v38 offset:56064
  v_mov_b32 v200, v192
  v_mov_b32 v216, v208
  v_mov_b32 v201, v192
  v_mfma_f32_32x32x16_bf16 v[176:191], a[172:175], v[124:127], v[176:191]
  s_waitcnt lgkmcnt(6)
  v_mov_b32 v217, v208
  v_mov_b32 v202, v192
  v_mov_b32 v218, v208
  v_mov_b32 v203, v192
  v_mov_b32 v219, v208
  v_mov_b32 v204, v192
  v_mov_b32 v220, v208
  v_mov_b32 v205, v192
  v_mov_b32 v221, v208
  v_mov_b32 v206, v192
  v_mov_b32 v222, v208
  v_mov_b32 v207, v192
  v_mov_b32 v223, v208
  v_exp_f32 v128, v128
  v_exp_f32 v144, v144
  v_exp_f32 v129, v129
  v_exp_f32 v145, v145
  v_add_f32 v224, v224, v128
  v_add_f32 v226, v226, v144
  v_add_f32 v225, v225, v129
  v_add_f32 v227, v227, v145
  v_cvt_pk_bf16_f32 v128, v128, v129
  v_cvt_pk_bf16_f32 v144, v144, v145
  v_exp_f32 v130, v130
  v_exp_f32 v146, v146
  v_exp_f32 v131, v131
  v_exp_f32 v147, v147
  v_add_f32 v224, v224, v130
  v_add_f32 v226, v226, v146
  v_add_f32 v225, v225, v131
  v_add_f32 v227, v227, v147
  v_cvt_pk_bf16_f32 v129, v130, v131
  v_cvt_pk_bf16_f32 v145, v146, v147
  v_exp_f32 v132, v132
  v_exp_f32 v148, v148
  v_exp_f32 v133, v133
  v_exp_f32 v149, v149
  v_add_f32 v224, v224, v132
  v_add_f32 v226, v226, v148
  v_add_f32 v225, v225, v133
  v_add_f32 v227, v227, v149
  v_cvt_pk_bf16_f32 v130, v132, v133
  v_cvt_pk_bf16_f32 v146, v148, v149
  v_exp_f32 v134, v134
  v_exp_f32 v150, v150
  v_exp_f32 v135, v135
  v_exp_f32 v151, v151
  v_add_f32 v224, v224, v134
  v_add_f32 v226, v226, v150
  v_add_f32 v225, v225, v135
  v_add_f32 v227, v227, v151
  v_cvt_pk_bf16_f32 v131, v134, v135
  v_cvt_pk_bf16_f32 v147, v150, v151
  s_nop 0
  v_mfma_f32_32x32x16_bf16 a[0:15], a[144:147], v[128:131], 0
  ds_read_b64_tr_b16 a[160:161], v38 offset:59392
  ds_read_b64_tr_b16 a[162:163], v38 offset:63488
  v_exp_f32 v136, v136
  v_mfma_f32_32x32x16_bf16 a[64:79], a[144:147], v[144:147], 0
  s_waitcnt lgkmcnt(6)
  v_exp_f32 v152, v152
  v_exp_f32 v137, v137
  v_exp_f32 v153, v153
  v_mfma_f32_32x32x16_bf16 a[16:31], a[148:151], v[128:131], 0
  ds_read_b64_tr_b16 a[164:165], v38 offset:59648
  ds_read_b64_tr_b16 a[166:167], v38 offset:63744
  v_add_f32 v224, v224, v136
  v_add_f32 v226, v226, v152
  v_add_f32 v225, v225, v137
  v_mfma_f32_32x32x16_bf16 a[80:95], a[148:151], v[144:147], 0
  s_waitcnt lgkmcnt(6)
  v_add_f32 v227, v227, v153
  v_cvt_pk_bf16_f32 v132, v136, v137
  v_cvt_pk_bf16_f32 v148, v152, v153
  v_exp_f32 v138, v138
  v_mfma_f32_32x32x16_bf16 a[32:47], a[152:155], v[128:131], 0
  ds_read_b64_tr_b16 a[168:169], v38 offset:59904
  ds_read_b64_tr_b16 a[170:171], v38 offset:64000
  v_exp_f32 v154, v154
  v_mfma_f32_32x32x16_bf16 a[96:111], a[152:155], v[144:147], 0
  s_waitcnt lgkmcnt(6)
  v_exp_f32 v139, v139
  v_exp_f32 v155, v155
  v_add_f32 v224, v224, v138
  v_add_f32 v226, v226, v154
  v_mfma_f32_32x32x16_bf16 a[48:63], a[156:159], v[128:131], 0
  ds_read_b64_tr_b16 a[172:173], v38 offset:60160
  ds_read_b64_tr_b16 a[174:175], v38 offset:64256
  v_add_f32 v225, v225, v139
  v_add_f32 v227, v227, v155
  v_cvt_pk_bf16_f32 v133, v138, v139
  v_mfma_f32_32x32x16_bf16 a[112:127], a[156:159], v[144:147], 0
  s_waitcnt lgkmcnt(6)
  v_cvt_pk_bf16_f32 v149, v154, v155
  v_exp_f32 v140, v140
  v_exp_f32 v156, v156
  v_exp_f32 v141, v141
  v_exp_f32 v157, v157
  v_add_f32 v224, v224, v140
  v_add_f32 v226, v226, v156
  v_add_f32 v225, v225, v141
  v_add_f32 v227, v227, v157
  v_cvt_pk_bf16_f32 v134, v140, v141
  v_cvt_pk_bf16_f32 v150, v156, v157
  v_exp_f32 v142, v142
  v_exp_f32 v158, v158
  v_exp_f32 v143, v143
  v_exp_f32 v159, v159
  v_add_f32 v224, v224, v142
  v_add_f32 v226, v226, v158
  v_add_f32 v225, v225, v143
  v_add_f32 v227, v227, v159
  v_cvt_pk_bf16_f32 v135, v142, v143
  v_cvt_pk_bf16_f32 v151, v158, v159
  s_waitcnt vmcnt(20)
  s_barrier
  v_mfma_f32_32x32x16_bf16 a[0:15], a[160:163], v[132:135], a[0:15]
  s_add_u32 s67, s63, 0x10000
  ds_read_b128 a[144:147], v37
  s_add_u32 s68, s63, 0xe000
  v_add_f32 v160, v160, v192
  s_add_u32 m0, s54, 0x8000
  s_nop 0
  buffer_load_dwordx4 v26, s[24:27], s67 offen lds
  v_mfma_f32_32x32x16_bf16 a[64:79], a[160:163], v[148:151], a[64:79]
  s_waitcnt lgkmcnt(5)
  v_add_f32 v176, v176, v208
  v_add_f32 v161, v161, v192
  v_add_f32 v177, v177, v208
  v_add_f32 v162, v162, v192
  v_add_f32 v178, v178, v208
  v_add_f32 v163, v163, v192
  v_mfma_f32_32x32x16_bf16 a[16:31], a[164:167], v[132:135], a[16:31]
  s_add_u32 m0, s54, 0x8400
  ds_read_b128 a[148:151], v37 offset:256
  v_add_f32 v179, v179, v208
  v_add_f32 v164, v164, v192
  v_add_f32 v180, v180, v208
  v_add_f32 v165, v165, v192
  v_add_f32 v181, v181, v208
  v_mfma_f32_32x32x16_bf16 a[80:95], a[164:167], v[148:151], a[80:95]
  s_waitcnt lgkmcnt(4)
  buffer_load_dwordx4 v27, s[24:27], s67 offen lds
  v_add_f32 v166, v166, v192
  v_add_f32 v182, v182, v208
  v_add_f32 v167, v167, v192
  v_add_f32 v183, v183, v208
  v_add_f32 v168, v168, v192
  v_mfma_f32_32x32x16_bf16 a[32:47], a[168:171], v[132:135], a[32:47]
  ds_read_b128 a[152:155], v37 offset:512
  v_add_f32 v184, v184, v208
  v_add_f32 v169, v169, v192
  v_add_f32 v185, v185, v208
  v_add_f32 v170, v170, v192
  v_add_f32 v186, v186, v208
  v_mfma_f32_32x32x16_bf16 a[96:111], a[168:171], v[148:151], a[96:111]
  s_waitcnt lgkmcnt(3)
  v_add_f32 v171, v171, v192
  v_add_f32 v187, v187, v208
  v_add_f32 v172, v172, v192
  v_add_f32 v188, v188, v208
  v_add_f32 v173, v173, v192
  s_add_u32 m0, s54, 0x8800
  v_mfma_f32_32x32x16_bf16 a[48:63], a[172:175], v[132:135], a[48:63]
  ds_read_b128 a[156:159], v37 offset:768
  buffer_load_dwordx4 v28, s[28:31], s68 offen lds
  v_add_f32 v189, v189, v208
  v_add_f32 v174, v174, v192
  v_add_f32 v190, v190, v208
  v_mfma_f32_32x32x16_bf16 a[112:127], a[172:175], v[148:151], a[112:127]
  s_waitcnt lgkmcnt(3)
  v_add_f32 v175, v175, v192
  v_add_f32 v191, v191, v208
  v_exp_f32 v160, v160
  v_exp_f32 v176, v176
  v_mfma_f32_32x32x16_bf16 v[128:143], a[144:147], v[64:67], v[192:207]
  s_add_u32 m0, s54, 0x8c00
  ds_read_b128 a[160:163], v37 offset:1024
  v_exp_f32 v161, v161
  v_exp_f32 v177, v177
  v_add_f32 v224, v224, v160
  v_mfma_f32_32x32x16_bf16 v[144:159], a[144:147], v[96:99], v[208:223]
  s_waitcnt lgkmcnt(3)
  buffer_load_dwordx4 v29, s[28:31], s68 offen lds
  v_add_f32 v226, v226, v176
  v_add_f32 v225, v225, v161
  v_add_f32 v227, v227, v177
  v_cvt_pk_bf16_f32 v160, v160, v161
  v_cvt_pk_bf16_f32 v176, v176, v177
  v_mfma_f32_32x32x16_bf16 v[128:143], a[148:151], v[68:71], v[128:143]
  ds_read_b128 a[164:167], v37 offset:1280
  v_exp_f32 v162, v162
  v_exp_f32 v178, v178
  v_mfma_f32_32x32x16_bf16 v[144:159], a[148:151], v[100:103], v[144:159]
  s_waitcnt lgkmcnt(3)
  v_exp_f32 v163, v163
  v_exp_f32 v179, v179
  v_add_f32 v224, v224, v162
  v_add_f32 v226, v226, v178
  v_mfma_f32_32x32x16_bf16 v[128:143], a[152:155], v[72:75], v[128:143]
  ds_read_b128 a[168:171], v37 offset:1536
  v_add_f32 v225, v225, v163
  v_add_f32 v227, v227, v179
  v_cvt_pk_bf16_f32 v161, v162, v163
  v_cvt_pk_bf16_f32 v177, v178, v179
  v_mfma_f32_32x32x16_bf16 v[144:159], a[152:155], v[104:107], v[144:159]
  s_waitcnt lgkmcnt(3)
  v_exp_f32 v164, v164
  v_exp_f32 v180, v180
  v_exp_f32 v165, v165
  v_mfma_f32_32x32x16_bf16 v[128:143], a[156:159], v[76:79], v[128:143]
  ds_read_b128 a[172:175], v37 offset:1792
  v_exp_f32 v181, v181
  v_add_f32 v224, v224, v164
  v_add_f32 v226, v226, v180
  v_add_f32 v225, v225, v165
  v_mfma_f32_32x32x16_bf16 v[144:159], a[156:159], v[108:111], v[144:159]
  s_waitcnt lgkmcnt(3)
  v_add_f32 v227, v227, v181
  v_cvt_pk_bf16_f32 v162, v164, v165
  v_cvt_pk_bf16_f32 v178, v180, v181
  v_exp_f32 v166, v166
  v_mfma_f32_32x32x16_bf16 v[128:143], a[160:163], v[80:83], v[128:143]
  ds_read_b64_tr_b16 a[144:145], v39 offset:2048
  ds_read_b64_tr_b16 a[146:147], v39 offset:6144
  v_exp_f32 v182, v182
  v_mfma_f32_32x32x16_bf16 v[144:159], a[160:163], v[112:115], v[144:159]
  s_waitcnt lgkmcnt(4)
  v_exp_f32 v167, v167
  v_exp_f32 v183, v183
  v_add_f32 v224, v224, v166
  v_add_f32 v226, v226, v182
  v_mfma_f32_32x32x16_bf16 v[128:143], a[164:167], v[84:87], v[128:143]
  ds_read_b64_tr_b16 a[148:149], v39 offset:2304
  ds_read_b64_tr_b16 a[150:151], v39 offset:6400
  v_add_f32 v225, v225, v167
  v_add_f32 v227, v227, v183
  v_cvt_pk_bf16_f32 v163, v166, v167
  v_mfma_f32_32x32x16_bf16 v[144:159], a[164:167], v[116:119], v[144:159]
  s_waitcnt lgkmcnt(5)
  v_cvt_pk_bf16_f32 v179, v182, v183
  v_exp_f32 v168, v168
  v_exp_f32 v184, v184
  v_mfma_f32_32x32x16_bf16 v[128:143], a[168:171], v[88:91], v[128:143]
  ds_read_b64_tr_b16 a[152:153], v39 offset:2560
  ds_read_b64_tr_b16 a[154:155], v39 offset:6656
  v_exp_f32 v169, v169
  v_mfma_f32_32x32x16_bf16 v[144:159], a[168:171], v[120:123], v[144:159]
  s_waitcnt lgkmcnt(6)
  v_exp_f32 v185, v185
  v_add_f32 v224, v224, v168
  v_add_f32 v226, v226, v184
  v_add_f32 v225, v225, v169
  v_add_f32 v227, v227, v185
  v_mfma_f32_32x32x16_bf16 v[128:143], a[172:175], v[92:95], v[128:143]
  ds_read_b64_tr_b16 a[156:157], v39 offset:2816
  ds_read_b64_tr_b16 a[158:159], v39 offset:6912
  v_cvt_pk_bf16_f32 v164, v168, v169
  v_cvt_pk_bf16_f32 v180, v184, v185
  v_mfma_f32_32x32x16_bf16 v[144:159], a[172:175], v[124:127], v[144:159]
  s_waitcnt lgkmcnt(6)
  v_exp_f32 v170, v170
  v_exp_f32 v186, v186
  v_exp_f32 v171, v171
  v_mfma_f32_32x32x16_bf16 a[0:15], a[144:147], v[160:163], a[0:15]
  ds_read_b64_tr_b16 a[160:161], v39 offset:10240
  ds_read_b64_tr_b16 a[162:163], v39 offset:14336
  v_exp_f32 v187, v187
  v_add_f32 v224, v224, v170
  v_mfma_f32_32x32x16_bf16 a[64:79], a[144:147], v[176:179], a[64:79]
  s_waitcnt lgkmcnt(6)
  v_add_f32 v226, v226, v186
  v_add_f32 v225, v225, v171
  v_add_f32 v227, v227, v187
  v_cvt_pk_bf16_f32 v165, v170, v171
  v_cvt_pk_bf16_f32 v181, v186, v187
  v_mfma_f32_32x32x16_bf16 a[16:31], a[148:151], v[160:163], a[16:31]
  ds_read_b64_tr_b16 a[164:165], v39 offset:10496
  ds_read_b64_tr_b16 a[166:167], v39 offset:14592
  v_exp_f32 v172, v172
  v_mfma_f32_32x32x16_bf16 a[80:95], a[148:151], v[176:179], a[80:95]
  s_waitcnt lgkmcnt(6)
  buffer_load_dword a255, v42, s[36:39], s64 offen
  v_exp_f32 v188, v188
  v_exp_f32 v173, v173
  v_mfma_f32_32x32x16_bf16 a[32:47], a[152:155], v[160:163], a[32:47]
  ds_read_b64_tr_b16 a[168:169], v39 offset:10752
  ds_read_b64_tr_b16 a[170:171], v39 offset:14848
  v_exp_f32 v189, v189
  v_add_f32 v224, v224, v172
  v_mfma_f32_32x32x16_bf16 a[96:111], a[152:155], v[176:179], a[96:111]
  s_waitcnt lgkmcnt(6)
  v_add_f32 v226, v226, v188
  v_add_f32 v225, v225, v173
  v_add_f32 v227, v227, v189
  v_cvt_pk_bf16_f32 v166, v172, v173
  v_cvt_pk_bf16_f32 v182, v188, v189
  v_mfma_f32_32x32x16_bf16 a[48:63], a[156:159], v[160:163], a[48:63]
  ds_read_b64_tr_b16 a[172:173], v39 offset:11008
  ds_read_b64_tr_b16 a[174:175], v39 offset:15104
  v_exp_f32 v174, v174
  v_mfma_f32_32x32x16_bf16 a[112:127], a[156:159], v[176:179], a[112:127]
  s_waitcnt lgkmcnt(6)
  v_exp_f32 v190, v190
  v_exp_f32 v175, v175
  v_exp_f32 v191, v191
  v_add_f32 v224, v224, v174
  v_add_f32 v226, v226, v190
  v_add_f32 v225, v225, v175
  v_add_f32 v227, v227, v191
  v_cvt_pk_bf16_f32 v167, v174, v175
  v_cvt_pk_bf16_f32 v183, v190, v191
  s_waitcnt vmcnt(21)
  s_barrier
  v_mfma_f32_32x32x16_bf16 a[0:15], a[160:163], v[164:167], a[0:15]
  s_add_u32 s67, s63, 0x12000
  ds_read_b128 a[144:147], v37 offset:16384
  s_add_u32 s68, s63, 0x10000
  s_add_u32 m0, s54, 0xc000
  s_nop 0
  buffer_load_dwordx4 v26, s[24:27], s67 offen lds
  v_mfma_f32_32x32x16_bf16 a[64:79], a[160:163], v[180:183], a[64:79]
  s_waitcnt lgkmcnt(5)
  v_exp_f32 v128, v128
  v_exp_f32 v144, v144
  v_exp_f32 v129, v129
  v_mfma_f32_32x32x16_bf16 a[16:31], a[164:167], v[164:167], a[16:31]
  s_add_u32 m0, s54, 0xc400
  ds_read_b128 a[148:151], v37 offset:16640
  v_exp_f32 v145, v145
  v_add_f32 v224, v224, v128
  v_add_f32 v226, v226, v144
  v_add_f32 v225, v225, v129
  v_mfma_f32_32x32x16_bf16 a[80:95], a[164:167], v[180:183], a[80:95]
  s_waitcnt lgkmcnt(4)
  buffer_load_dwordx4 v27, s[24:27], s67 offen lds
  v_add_f32 v227, v227, v145
  v_cvt_pk_bf16_f32 v128, v128, v129
  v_cvt_pk_bf16_f32 v144, v144, v145
  v_exp_f32 v130, v130
  v_mfma_f32_32x32x16_bf16 a[32:47], a[168:171], v[164:167], a[32:47]
  ds_read_b128 a[152:155], v37 offset:16896
  v_exp_f32 v146, v146
  v_exp_f32 v131, v131
  v_mfma_f32_32x32x16_bf16 a[96:111], a[168:171], v[180:183], a[96:111]
  s_waitcnt lgkmcnt(3)
  v_exp_f32 v147, v147
  v_add_f32 v224, v224, v130
  v_add_f32 v226, v226, v146
  v_add_f32 v225, v225, v131
  s_add_u32 m0, s54, 0xc800
  v_mfma_f32_32x32x16_bf16 a[48:63], a[172:175], v[164:167], a[48:63]
  ds_read_b128 a[156:159], v37 offset:17152
  buffer_load_dwordx4 v28, s[28:31], s68 offen lds
  v_add_f32 v227, v227, v147
  v_cvt_pk_bf16_f32 v129, v130, v131
  v_cvt_pk_bf16_f32 v145, v146, v147
  v_mfma_f32_32x32x16_bf16 a[112:127], a[172:175], v[180:183], a[112:127]
  s_waitcnt lgkmcnt(3)
  v_exp_f32 v132, v132
  v_exp_f32 v148, v148
  v_exp_f32 v133, v133
  v_mfma_f32_32x32x16_bf16 v[160:175], a[144:147], v[64:67], v[192:207]
  s_add_u32 m0, s54, 0xcc00
  ds_read_b128 a[160:163], v37 offset:17408
  v_exp_f32 v149, v149
  v_add_f32 v224, v224, v132
  v_add_f32 v226, v226, v148
  v_add_f32 v225, v225, v133
  v_mfma_f32_32x32x16_bf16 v[176:191], a[144:147], v[96:99], v[208:223]
  s_waitcnt lgkmcnt(3)
  buffer_load_dwordx4 v29, s[28:31], s68 offen lds
  v_add_f32 v227, v227, v149
  v_cvt_pk_bf16_f32 v130, v132, v133
  v_cvt_pk_bf16_f32 v146, v148, v149
  v_exp_f32 v134, v134
  v_mfma_f32_32x32x16_bf16 v[160:175], a[148:151], v[68:71], v[160:175]
  ds_read_b128 a[164:167], v37 offset:17664
  v_exp_f32 v150, v150
  v_exp_f32 v135, v135
  v_mfma_f32_32x32x16_bf16 v[176:191], a[148:151], v[100:103], v[176:191]
  s_waitcnt lgkmcnt(3)
  v_exp_f32 v151, v151
  v_add_f32 v224, v224, v134
  v_add_f32 v226, v226, v150
  v_add_f32 v225, v225, v135
  v_add_f32 v227, v227, v151
  v_mfma_f32_32x32x16_bf16 v[160:175], a[152:155], v[72:75], v[160:175]
  ds_read_b128 a[168:171], v37 offset:17920
  v_cvt_pk_bf16_f32 v131, v134, v135
  v_cvt_pk_bf16_f32 v147, v150, v151
  v_exp_f32 v136, v136
  v_mfma_f32_32x32x16_bf16 v[176:191], a[152:155], v[104:107], v[176:191]
  s_waitcnt lgkmcnt(3)
  v_exp_f32 v152, v152
  v_exp_f32 v137, v137
  v_exp_f32 v153, v153
  v_mfma_f32_32x32x16_bf16 v[160:175], a[156:159], v[76:79], v[160:175]
  ds_read_b128 a[172:175], v37 offset:18176
  v_add_f32 v224, v224, v136
  v_add_f32 v226, v226, v152
  v_add_f32 v225, v225, v137
  v_add_f32 v227, v227, v153
  v_cvt_pk_bf16_f32 v132, v136, v137
  v_mfma_f32_32x32x16_bf16 v[176:191], a[156:159], v[108:111], v[176:191]
  s_waitcnt lgkmcnt(3)
  v_cvt_pk_bf16_f32 v148, v152, v153
  v_exp_f32 v138, v138
  v_exp_f32 v154, v154
  v_mfma_f32_32x32x16_bf16 v[160:175], a[160:163], v[80:83], v[160:175]
  ds_read_b64_tr_b16 a[144:145], v39 offset:18432
  ds_read_b64_tr_b16 a[146:147], v39 offset:22528
  v_exp_f32 v139, v139
  v_mfma_f32_32x32x16_bf16 v[176:191], a[160:163], v[112:115], v[176:191]
  s_waitcnt lgkmcnt(4)
  v_exp_f32 v155, v155
  v_add_f32 v224, v224, v138
  v_add_f32 v226, v226, v154
  v_add_f32 v225, v225, v139
  v_add_f32 v227, v227, v155
  v_mfma_f32_32x32x16_bf16 v[160:175], a[164:167], v[84:87], v[160:175]
  ds_read_b64_tr_b16 a[148:149], v39 offset:18688
  ds_read_b64_tr_b16 a[150:151], v39 offset:22784
  v_cvt_pk_bf16_f32 v133, v138, v139
  v_cvt_pk_bf16_f32 v149, v154, v155
  v_mfma_f32_32x32x16_bf16 v[176:191], a[164:167], v[116:119], v[176:191]
  s_waitcnt lgkmcnt(5)
  v_exp_f32 v140, v140
  v_exp_f32 v156, v156
  v_exp_f32 v141, v141
  v_mfma_f32_32x32x16_bf16 v[160:175], a[168:171], v[88:91], v[160:175]
  ds_read_b64_tr_b16 a[152:153], v39 offset:18944
  ds_read_b64_tr_b16 a[154:155], v39 offset:23040
  v_exp_f32 v157, v157
  v_add_f32 v224, v224, v140
  v_mfma_f32_32x32x16_bf16 v[176:191], a[168:171], v[120:123], v[176:191]
  s_waitcnt lgkmcnt(6)
  v_add_f32 v226, v226, v156
  v_add_f32 v225, v225, v141
  v_add_f32 v227, v227, v157
  v_cvt_pk_bf16_f32 v134, v140, v141
  v_cvt_pk_bf16_f32 v150, v156, v157
  v_mfma_f32_32x32x16_bf16 v[160:175], a[172:175], v[92:95], v[160:175]
  ds_read_b64_tr_b16 a[156:157], v39 offset:19200
  ds_read_b64_tr_b16 a[158:159], v39 offset:23296
  v_exp_f32 v142, v142
  v_mfma_f32_32x32x16_bf16 v[176:191], a[172:175], v[124:127], v[176:191]
  s_waitcnt lgkmcnt(6)
  v_exp_f32 v158, v158
  v_exp_f32 v143, v143
  v_exp_f32 v159, v159
  v_mfma_f32_32x32x16_bf16 a[0:15], a[144:147], v[128:131], a[0:15]
  ds_read_b64_tr_b16 a[160:161], v39 offset:26624
  ds_read_b64_tr_b16 a[162:163], v39 offset:30720
  v_add_f32 v224, v224, v142
  v_add_f32 v226, v226, v158
  v_add_f32 v225, v225, v143
  v_mfma_f32_32x32x16_bf16 a[64:79], a[144:147], v[144:147], a[64:79]
  s_waitcnt lgkmcnt(6)
  v_add_f32 v227, v227, v159
  v_cvt_pk_bf16_f32 v135, v142, v143
  v_cvt_pk_bf16_f32 v151, v158, v159
  v_exp_f32 v160, v160
  v_mfma_f32_32x32x16_bf16 a[16:31], a[148:151], v[128:131], a[16:31]
  ds_read_b64_tr_b16 a[164:165], v39 offset:26880
  ds_read_b64_tr_b16 a[166:167], v39 offset:30976
  v_exp_f32 v176, v176
  v_mfma_f32_32x32x16_bf16 a[80:95], a[148:151], v[144:147], a[80:95]
  s_waitcnt lgkmcnt(6)
  v_exp_f32 v161, v161
  v_exp_f32 v177, v177
  v_add_f32 v224, v224, v160
  v_add_f32 v226, v226, v176
  v_mfma_f32_32x32x16_bf16 a[32:47], a[152:155], v[128:131], a[32:47]
  ds_read_b64_tr_b16 a[168:169], v39 offset:27136
  ds_read_b64_tr_b16 a[170:171], v39 offset:31232
  v_add_f32 v225, v225, v161
  v_add_f32 v227, v227, v177
  v_cvt_pk_bf16_f32 v160, v160, v161
  v_mfma_f32_32x32x16_bf16 a[96:111], a[152:155], v[144:147], a[96:111]
  s_waitcnt lgkmcnt(6)
  v_cvt_pk_bf16_f32 v176, v176, v177
  v_exp_f32 v162, v162
  v_exp_f32 v178, v178
  v_mfma_f32_32x32x16_bf16 a[48:63], a[156:159], v[128:131], a[48:63]
  ds_read_b64_tr_b16 a[172:173], v39 offset:27392
  ds_read_b64_tr_b16 a[174:175], v39 offset:31488
  v_exp_f32 v163, v163
  v_mfma_f32_32x32x16_bf16 a[112:127], a[156:159], v[144:147], a[112:127]
  s_waitcnt lgkmcnt(6)
  v_exp_f32 v179, v179
  v_add_f32 v224, v224, v162
  v_add_f32 v226, v226, v178
  s_waitcnt vmcnt(21)
  s_barrier
  v_mfma_f32_32x32x16_bf16 a[0:15], a[160:163], v[132:135], a[0:15]
  s_add_u32 s67, s63, 0x14000
  ds_read_b128 a[144:147], v37 offset:32768
  s_add_u32 s68, s63, 0x12000
  v_add_f32 v225, v225, v163
  s_add_u32 m0, s54, 0x10000
  s_nop 0
  buffer_load_dwordx4 v26, s[24:27], s67 offen lds
  v_mfma_f32_32x32x16_bf16 a[64:79], a[160:163], v[148:151], a[64:79]
  s_waitcnt lgkmcnt(5)
  v_add_f32 v227, v227, v179
  v_cvt_pk_bf16_f32 v161, v162, v163
  v_cvt_pk_bf16_f32 v177, v178, v179
  v_exp_f32 v164, v164
  v_mfma_f32_32x32x16_bf16 a[16:31], a[164:167], v[132:135], a[16:31]
  s_add_u32 m0, s54, 0x10400
  ds_read_b128 a[148:151], v37 offset:33024
  v_exp_f32 v180, v180
  v_exp_f32 v165, v165
  v_mfma_f32_32x32x16_bf16 a[80:95], a[164:167], v[148:151], a[80:95]
  s_waitcnt lgkmcnt(4)
  buffer_load_dwordx4 v27, s[24:27], s67 offen lds
  v_exp_f32 v181, v181
  v_add_f32 v224, v224, v164
  v_add_f32 v226, v226, v180
  v_add_f32 v225, v225, v165
  v_mfma_f32_32x32x16_bf16 a[32:47], a[168:171], v[132:135], a[32:47]
  ds_read_b128 a[152:155], v37 offset:33280
  v_add_f32 v227, v227, v181
  v_cvt_pk_bf16_f32 v162, v164, v165
  v_cvt_pk_bf16_f32 v178, v180, v181
  v_exp_f32 v166, v166
  v_mfma_f32_32x32x16_bf16 a[96:111], a[168:171], v[148:151], a[96:111]
  s_waitcnt lgkmcnt(3)
  v_exp_f32 v182, v182
  v_exp_f32 v167, v167
  s_add_u32 m0, s54, 0x10800
  v_mfma_f32_32x32x16_bf16 a[48:63], a[172:175], v[132:135], a[48:63]
  ds_read_b128 a[156:159], v37 offset:33536
  buffer_load_dwordx4 v28, s[28:31], s68 offen lds
  v_exp_f32 v183, v183
  v_add_f32 v224, v224, v166
  v_mfma_f32_32x32x16_bf16 a[112:127], a[172:175], v[148:151], a[112:127]
  s_waitcnt lgkmcnt(3)
  v_add_f32 v226, v226, v182
  v_add_f32 v225, v225, v167
  v_add_f32 v227, v227, v183
  v_cvt_pk_bf16_f32 v163, v166, v167
  v_cvt_pk_bf16_f32 v179, v182, v183
  v_mfma_f32_32x32x16_bf16 v[128:143], a[144:147], v[64:67], v[192:207]
  s_add_u32 m0, s54, 0x10c00
  ds_read_b128 a[160:163], v37 offset:33792
  v_exp_f32 v168, v168
  v_exp_f32 v184, v184
  v_mfma_f32_32x32x16_bf16 v[144:159], a[144:147], v[96:99], v[208:223]
  s_waitcnt lgkmcnt(3)
  buffer_load_dwordx4 v29, s[28:31], s68 offen lds
  v_exp_f32 v169, v169
  v_exp_f32 v185, v185
  v_add_f32 v224, v224, v168
  v_mfma_f32_32x32x16_bf16 v[128:143], a[148:151], v[68:71], v[128:143]
  ds_read_b128 a[164:167], v37 offset:34048
  v_add_f32 v226, v226, v184
  v_add_f32 v225, v225, v169
  v_add_f32 v227, v227, v185
  v_cvt_pk_bf16_f32 v164, v168, v169
  v_cvt_pk_bf16_f32 v180, v184, v185
  v_mfma_f32_32x32x16_bf16 v[144:159], a[148:151], v[100:103], v[144:159]
  s_waitcnt lgkmcnt(3)
  v_exp_f32 v170, v170
  v_exp_f32 v186, v186
  v_exp_f32 v171, v171
  v_mfma_f32_32x32x16_bf16 v[128:143], a[152:155], v[72:75], v[128:143]
  ds_read_b128 a[168:171], v37 offset:34304
  v_exp_f32 v187, v187
  v_add_f32 v224, v224, v170
  v_add_f32 v226, v226, v186
  v_add_f32 v225, v225, v171
  v_mfma_f32_32x32x16_bf16 v[144:159], a[152:155], v[104:107], v[144:159]
  s_waitcnt lgkmcnt(3)
  v_add_f32 v227, v227, v187
  v_cvt_pk_bf16_f32 v165, v170, v171
  v_cvt_pk_bf16_f32 v181, v186, v187
  v_exp_f32 v172, v172
  v_mfma_f32_32x32x16_bf16 v[128:143], a[156:159], v[76:79], v[128:143]
  ds_read_b128 a[172:175], v37 offset:34560
  v_exp_f32 v188, v188
  v_exp_f32 v173, v173
  v_mfma_f32_32x32x16_bf16 v[144:159], a[156:159], v[108:111], v[144:159]
  s_waitcnt lgkmcnt(3)
  v_exp_f32 v189, v189
  v_add_f32 v224, v224, v172
  v_add_f32 v226, v226, v188
  v_add_f32 v225, v225, v173
  v_add_f32 v227, v227, v189
  v_mfma_f32_32x32x16_bf16 v[128:143], a[160:163], v[80:83], v[128:143]
  ds_read_b64_tr_b16 a[144:145], v39 offset:34816
  ds_read_b64_tr_b16 a[146:147], v39 offset:38912
  v_cvt_pk_bf16_f32 v166, v172, v173
  v_cvt_pk_bf16_f32 v182, v188, v189
  v_mfma_f32_32x32x16_bf16 v[144:159], a[160:163], v[112:115], v[144:159]
  s_waitcnt lgkmcnt(4)
  v_exp_f32 v174, v174
  v_exp_f32 v190, v190
  v_exp_f32 v175, v175
  v_mfma_f32_32x32x16_bf16 v[128:143], a[164:167], v[84:87], v[128:143]
  ds_read_b64_tr_b16 a[148:149], v39 offset:35072
  ds_read_b64_tr_b16 a[150:151], v39 offset:39168
  v_exp_f32 v191, v191
  v_add_f32 v224, v224, v174
  v_mfma_f32_32x32x16_bf16 v[144:159], a[164:167], v[116:119], v[144:159]
  s_waitcnt lgkmcnt(5)
  v_add_f32 v226, v226, v190
  v_add_f32 v225, v225, v175
  v_add_f32 v227, v227, v191
  v_cvt_pk_bf16_f32 v167, v174, v175
  v_cvt_pk_bf16_f32 v183, v190, v191
  v_mfma_f32_32x32x16_bf16 v[128:143], a[168:171], v[88:91], v[128:143]
  ds_read_b64_tr_b16 a[152:153], v39 offset:35328
  ds_read_b64_tr_b16 a[154:155], v39 offset:39424
  v_mfma_f32_32x32x16_bf16 v[144:159], a[168:171], v[120:123], v[144:159]
  s_waitcnt lgkmcnt(6)
  v_mfma_f32_32x32x16_bf16 v[128:143], a[172:175], v[92:95], v[128:143]
  ds_read_b64_tr_b16 a[156:157], v39 offset:35584
  ds_read_b64_tr_b16 a[158:159], v39 offset:39680
  v_mfma_f32_32x32x16_bf16 v[144:159], a[172:175], v[124:127], v[144:159]
  s_waitcnt lgkmcnt(6)
  v_mfma_f32_32x32x16_bf16 a[0:15], a[144:147], v[160:163], a[0:15]
  ds_read_b64_tr_b16 a[160:161], v39 offset:43008
  ds_read_b64_tr_b16 a[162:163], v39 offset:47104
  v_mfma_f32_32x32x16_bf16 a[64:79], a[144:147], v[176:179], a[64:79]
  s_waitcnt lgkmcnt(6)
  s_nop 2
  v_exp_f32 v128, v128
  s_nop 1
  v_exp_f32 v144, v144
  v_exp_f32 v129, v129
  v_mfma_f32_32x32x16_bf16 a[16:31], a[148:151], v[160:163], a[16:31]
  ds_read_b64_tr_b16 a[164:165], v39 offset:43264
  ds_read_b64_tr_b16 a[166:167], v39 offset:47360
  v_exp_f32 v145, v145
  v_add_f32 v224, v224, v128
  v_mfma_f32_32x32x16_bf16 a[80:95], a[148:151], v[176:179], a[80:95]
  s_waitcnt lgkmcnt(6)
  v_add_f32 v226, v226, v144
  v_add_f32 v225, v225, v129
  v_add_f32 v227, v227, v145
  v_cvt_pk_bf16_f32 v128, v128, v129
  v_cvt_pk_bf16_f32 v144, v144, v145
  v_mfma_f32_32x32x16_bf16 a[32:47], a[152:155], v[160:163], a[32:47]
  ds_read_b64_tr_b16 a[168:169], v39 offset:43520
  ds_read_b64_tr_b16 a[170:171], v39 offset:47616
  v_exp_f32 v130, v130
  v_mfma_f32_32x32x16_bf16 a[96:111], a[152:155], v[176:179], a[96:111]
  s_waitcnt lgkmcnt(6)
  v_exp_f32 v146, v146
  v_exp_f32 v131, v131
  v_exp_f32 v147, v147
  v_mfma_f32_32x32x16_bf16 a[48:63], a[156:159], v[160:163], a[48:63]
  ds_read_b64_tr_b16 a[172:173], v39 offset:43776
  ds_read_b64_tr_b16 a[174:175], v39 offset:47872
  v_add_f32 v224, v224, v130
  v_add_f32 v226, v226, v146
  v_add_f32 v225, v225, v131
  v_mfma_f32_32x32x16_bf16 a[112:127], a[156:159], v[176:179], a[112:127]
  s_waitcnt lgkmcnt(6)
  v_add_f32 v227, v227, v147
  v_cvt_pk_bf16_f32 v129, v130, v131
  v_cvt_pk_bf16_f32 v145, v146, v147
  s_waitcnt vmcnt(21)
  s_barrier
  v_mfma_f32_32x32x16_bf16 a[0:15], a[160:163], v[164:167], a[0:15]
  s_add_u32 s67, s63, 0x16000
  ds_read_b128 a[144:147], v37 offset:49152
  s_add_u32 s68, s63, 0x14000
  s_add_u32 m0, s54, 0x14000
  s_nop 0
  buffer_load_dwordx4 v26, s[24:27], s67 offen lds
  v_mfma_f32_32x32x16_bf16 a[64:79], a[160:163], v[180:183], a[64:79]
  s_waitcnt lgkmcnt(5)
  v_exp_f32 v132, v132
  v_exp_f32 v148, v148
  v_exp_f32 v133, v133
  v_mfma_f32_32x32x16_bf16 a[16:31], a[164:167], v[164:167], a[16:31]
  s_add_u32 m0, s54, 0x14400
  ds_read_b128 a[148:151], v37 offset:49408
  v_exp_f32 v149, v149
  v_add_f32 v224, v224, v132
  v_add_f32 v226, v226, v148
  v_add_f32 v225, v225, v133
  v_mfma_f32_32x32x16_bf16 a[80:95], a[164:167], v[180:183], a[80:95]
  s_waitcnt lgkmcnt(4)
  buffer_load_dwordx4 v27, s[24:27], s67 offen lds
  v_add_f32 v227, v227, v149
  v_cvt_pk_bf16_f32 v130, v132, v133
  v_cvt_pk_bf16_f32 v146, v148, v149
  v_exp_f32 v134, v134
  v_mfma_f32_32x32x16_bf16 a[32:47], a[168:171], v[164:167], a[32:47]
  ds_read_b128 a[152:155], v37 offset:49664
  v_exp_f32 v150, v150
  v_exp_f32 v135, v135
  v_mfma_f32_32x32x16_bf16 a[96:111], a[168:171], v[180:183], a[96:111]
  s_waitcnt lgkmcnt(3)
  v_exp_f32 v151, v151
  v_add_f32 v224, v224, v134
  v_add_f32 v226, v226, v150
  v_add_f32 v225, v225, v135
  s_add_u32 m0, s54, 0x14800
  v_mfma_f32_32x32x16_bf16 a[48:63], a[172:175], v[164:167], a[48:63]
  ds_read_b128 a[156:159], v37 offset:49920
  buffer_load_dwordx4 v28, s[28:31], s68 offen lds
  v_add_f32 v227, v227, v151
  v_cvt_pk_bf16_f32 v131, v134, v135
  v_cvt_pk_bf16_f32 v147, v150, v151
  v_mfma_f32_32x32x16_bf16 a[112:127], a[172:175], v[180:183], a[112:127]
  s_waitcnt lgkmcnt(3)
  v_exp_f32 v136, v136
  v_exp_f32 v152, v152
  v_exp_f32 v137, v137
  v_mfma_f32_32x32x16_bf16 v[160:175], a[144:147], v[64:67], v[192:207]
  s_add_u32 m0, s54, 0x14c00
  ds_read_b128 a[160:163], v37 offset:50176
  v_exp_f32 v153, v153
  v_add_f32 v224, v224, v136
  v_add_f32 v226, v226, v152
  v_add_f32 v225, v225, v137
  v_mfma_f32_32x32x16_bf16 v[176:191], a[144:147], v[96:99], v[208:223]
  s_waitcnt lgkmcnt(3)
  buffer_load_dwordx4 v29, s[28:31], s68 offen lds
  v_add_f32 v227, v227, v153
  v_cvt_pk_bf16_f32 v132, v136, v137
  v_cvt_pk_bf16_f32 v148, v152, v153
  v_exp_f32 v138, v138
  v_mfma_f32_32x32x16_bf16 v[160:175], a[148:151], v[68:71], v[160:175]
  ds_read_b128 a[164:167], v37 offset:50432
  v_exp_f32 v154, v154
  v_exp_f32 v139, v139
  v_mfma_f32_32x32x16_bf16 v[176:191], a[148:151], v[100:103], v[176:191]
  s_waitcnt lgkmcnt(3)
  v_exp_f32 v155, v155
  v_add_f32 v224, v224, v138
  v_add_f32 v226, v226, v154
  v_add_f32 v225, v225, v139
  v_add_f32 v227, v227, v155
  v_mfma_f32_32x32x16_bf16 v[160:175], a[152:155], v[72:75], v[160:175]
  ds_read_b128 a[168:171], v37 offset:50688
  v_cvt_pk_bf16_f32 v133, v138, v139
  v_cvt_pk_bf16_f32 v149, v154, v155
  v_exp_f32 v140, v140
  v_mfma_f32_32x32x16_bf16 v[176:191], a[152:155], v[104:107], v[176:191]
  s_waitcnt lgkmcnt(3)
  v_exp_f32 v156, v156
  v_exp_f32 v141, v141
  v_exp_f32 v157, v157
  v_mfma_f32_32x32x16_bf16 v[160:175], a[156:159], v[76:79], v[160:175]
  ds_read_b128 a[172:175], v37 offset:50944
  v_add_f32 v224, v224, v140
  v_add_f32 v226, v226, v156
  v_add_f32 v225, v225, v141
  v_add_f32 v227, v227, v157
  v_cvt_pk_bf16_f32 v134, v140, v141
  v_mfma_f32_32x32x16_bf16 v[176:191], a[156:159], v[108:111], v[176:191]
  s_waitcnt lgkmcnt(3)
  v_cvt_pk_bf16_f32 v150, v156, v157
  v_exp_f32 v142, v142
  v_exp_f32 v158, v158
  v_mfma_f32_32x32x16_bf16 v[160:175], a[160:163], v[80:83], v[160:175]
  ds_read_b64_tr_b16 a[144:145], v39 offset:51200
  ds_read_b64_tr_b16 a[146:147], v39 offset:55296
  v_exp_f32 v143, v143
  v_mfma_f32_32x32x16_bf16 v[176:191], a[160:163], v[112:115], v[176:191]
  s_waitcnt lgkmcnt(4)
  v_exp_f32 v159, v159
  v_add_f32 v224, v224, v142
  v_add_f32 v226, v226, v158
  v_add_f32 v225, v225, v143
  v_add_f32 v227, v227, v159
  v_mfma_f32_32x32x16_bf16 v[160:175], a[164:167], v[84:87], v[160:175]
  ds_read_b64_tr_b16 a[148:149], v39 offset:51456
  ds_read_b64_tr_b16 a[150:151], v39 offset:55552
  v_cvt_pk_bf16_f32 v135, v142, v143
  v_cvt_pk_bf16_f32 v151, v158, v159
  v_mfma_f32_32x32x16_bf16 v[176:191], a[164:167], v[116:119], v[176:191]
  s_waitcnt lgkmcnt(5)
  v_mfma_f32_32x32x16_bf16 v[160:175], a[168:171], v[88:91], v[160:175]
  ds_read_b64_tr_b16 a[152:153], v39 offset:51712
  ds_read_b64_tr_b16 a[154:155], v39 offset:55808
  v_mfma_f32_32x32x16_bf16 v[176:191], a[168:171], v[120:123], v[176:191]
  s_waitcnt lgkmcnt(6)
  v_mfma_f32_32x32x16_bf16 v[160:175], a[172:175], v[92:95], v[160:175]
  ds_read_b64_tr_b16 a[156:157], v39 offset:51968
  ds_read_b64_tr_b16 a[158:159], v39 offset:56064
  v_mfma_f32_32x32x16_bf16 v[176:191], a[172:175], v[124:127], v[176:191]
  s_waitcnt lgkmcnt(6)
  v_mfma_f32_32x32x16_bf16 a[0:15], a[144:147], v[128:131], a[0:15]
  ds_read_b64_tr_b16 a[160:161], v39 offset:59392
  ds_read_b64_tr_b16 a[162:163], v39 offset:63488
  v_mfma_f32_32x32x16_bf16 a[64:79], a[144:147], v[144:147], a[64:79]
  s_waitcnt lgkmcnt(6)
  s_nop 2
  v_exp_f32 v160, v160
  s_nop 1
  v_exp_f32 v176, v176
  v_exp_f32 v161, v161
  v_mfma_f32_32x32x16_bf16 a[16:31], a[148:151], v[128:131], a[16:31]
  ds_read_b64_tr_b16 a[164:165], v39 offset:59648
  ds_read_b64_tr_b16 a[166:167], v39 offset:63744
  v_exp_f32 v177, v177
  v_add_f32 v224, v224, v160
  v_mfma_f32_32x32x16_bf16 a[80:95], a[148:151], v[144:147], a[80:95]
  s_waitcnt lgkmcnt(6)
  v_add_f32 v226, v226, v176
  v_add_f32 v225, v225, v161
  v_add_f32 v227, v227, v177
  v_cvt_pk_bf16_f32 v160, v160, v161
  v_cvt_pk_bf16_f32 v176, v176, v177
  v_mfma_f32_32x32x16_bf16 a[32:47], a[152:155], v[128:131], a[32:47]
  ds_read_b64_tr_b16 a[168:169], v39 offset:59904
  ds_read_b64_tr_b16 a[170:171], v39 offset:64000
  v_exp_f32 v162, v162
  v_mfma_f32_32x32x16_bf16 a[96:111], a[152:155], v[144:147], a[96:111]
  s_waitcnt lgkmcnt(6)
  v_exp_f32 v178, v178
  v_exp_f32 v163, v163
  v_exp_f32 v179, v179
  v_mfma_f32_32x32x16_bf16 a[48:63], a[156:159], v[128:131], a[48:63]
  ds_read_b64_tr_b16 a[172:173], v39 offset:60160
  ds_read_b64_tr_b16 a[174:175], v39 offset:64256
  v_add_f32 v224, v224, v162
  v_add_f32 v226, v226, v178
  v_add_f32 v225, v225, v163
  v_mfma_f32_32x32x16_bf16 a[112:127], a[156:159], v[144:147], a[112:127]
  s_waitcnt lgkmcnt(6)
  v_add_f32 v227, v227, v179
  v_cvt_pk_bf16_f32 v161, v162, v163
  v_cvt_pk_bf16_f32 v177, v178, v179
  s_waitcnt vmcnt(21)
  s_barrier
  v_mfma_f32_32x32x16_bf16 a[0:15], a[160:163], v[132:135], a[0:15]
  s_add_u32 s67, s63, 0x18000
  ds_read_b128 a[144:147], v36
  s_add_u32 s68, s63, 0x16000
  s_add_u32 m0, s54, 0x18000
  s_nop 0
  buffer_load_dwordx4 v26, s[24:27], s67 offen lds
  v_mfma_f32_32x32x16_bf16 a[64:79], a[160:163], v[148:151], a[64:79]
  s_waitcnt lgkmcnt(5)
  v_exp_f32 v164, v164
  v_exp_f32 v180, v180
  v_exp_f32 v165, v165
  v_mfma_f32_32x32x16_bf16 a[16:31], a[164:167], v[132:135], a[16:31]
  s_add_u32 m0, s54, 0x18400
  ds_read_b128 a[148:151], v36 offset:256
  v_exp_f32 v181, v181
  v_add_f32 v224, v224, v164
  v_add_f32 v226, v226, v180
  v_add_f32 v225, v225, v165
  v_mfma_f32_32x32x16_bf16 a[80:95], a[164:167], v[148:151], a[80:95]
  s_waitcnt lgkmcnt(4)
  buffer_load_dwordx4 v27, s[24:27], s67 offen lds
  v_add_f32 v227, v227, v181
  v_cvt_pk_bf16_f32 v162, v164, v165
  v_cvt_pk_bf16_f32 v178, v180, v181
  v_exp_f32 v166, v166
  v_mfma_f32_32x32x16_bf16 a[32:47], a[168:171], v[132:135], a[32:47]
  ds_read_b128 a[152:155], v36 offset:512
  v_exp_f32 v182, v182
  v_exp_f32 v167, v167
  v_mfma_f32_32x32x16_bf16 a[96:111], a[168:171], v[148:151], a[96:111]
  s_waitcnt lgkmcnt(3)
  v_exp_f32 v183, v183
  v_add_f32 v224, v224, v166
  v_add_f32 v226, v226, v182
  v_add_f32 v225, v225, v167
  s_add_u32 m0, s54, 0x18800
  v_mfma_f32_32x32x16_bf16 a[48:63], a[172:175], v[132:135], a[48:63]
  ds_read_b128 a[156:159], v36 offset:768
  buffer_load_dwordx4 v28, s[28:31], s68 offen lds
  v_add_f32 v227, v227, v183
  v_cvt_pk_bf16_f32 v163, v166, v167
  v_cvt_pk_bf16_f32 v179, v182, v183
  v_mfma_f32_32x32x16_bf16 a[112:127], a[172:175], v[148:151], a[112:127]
  s_waitcnt lgkmcnt(3)
  v_exp_f32 v168, v168
  v_exp_f32 v184, v184
  v_exp_f32 v169, v169
  v_mfma_f32_32x32x16_bf16 v[128:143], a[144:147], v[64:67], v[192:207]
  s_add_u32 m0, s54, 0x18c00
  ds_read_b128 a[160:163], v36 offset:1024
  v_exp_f32 v185, v185
  v_add_f32 v224, v224, v168
  v_add_f32 v226, v226, v184
  v_add_f32 v225, v225, v169
  v_mfma_f32_32x32x16_bf16 v[144:159], a[144:147], v[96:99], v[208:223]
  s_waitcnt lgkmcnt(3)
  buffer_load_dwordx4 v29, s[28:31], s68 offen lds
  v_add_f32 v227, v227, v185
  v_cvt_pk_bf16_f32 v164, v168, v169
  v_cvt_pk_bf16_f32 v180, v184, v185
  v_exp_f32 v170, v170
  v_mfma_f32_32x32x16_bf16 v[128:143], a[148:151], v[68:71], v[128:143]
  ds_read_b128 a[164:167], v36 offset:1280
  v_exp_f32 v186, v186
  v_exp_f32 v171, v171
  v_mfma_f32_32x32x16_bf16 v[144:159], a[148:151], v[100:103], v[144:159]
  s_waitcnt lgkmcnt(3)
  v_exp_f32 v187, v187
  v_add_f32 v224, v224, v170
  v_add_f32 v226, v226, v186
  v_add_f32 v225, v225, v171
  v_add_f32 v227, v227, v187
  v_mfma_f32_32x32x16_bf16 v[128:143], a[152:155], v[72:75], v[128:143]
  ds_read_b128 a[168:171], v36 offset:1536
  v_cvt_pk_bf16_f32 v165, v170, v171
  v_cvt_pk_bf16_f32 v181, v186, v187
  v_exp_f32 v172, v172
  v_mfma_f32_32x32x16_bf16 v[144:159], a[152:155], v[104:107], v[144:159]
  s_waitcnt lgkmcnt(3)
  v_exp_f32 v188, v188
  v_exp_f32 v173, v173
  v_exp_f32 v189, v189
  v_mfma_f32_32x32x16_bf16 v[128:143], a[156:159], v[76:79], v[128:143]
  ds_read_b128 a[172:175], v36 offset:1792
  v_add_f32 v224, v224, v172
  v_add_f32 v226, v226, v188
  v_add_f32 v225, v225, v173
  v_add_f32 v227, v227, v189
  v_cvt_pk_bf16_f32 v166, v172, v173
  v_mfma_f32_32x32x16_bf16 v[144:159], a[156:159], v[108:111], v[144:159]
  s_waitcnt lgkmcnt(3)
  v_cvt_pk_bf16_f32 v182, v188, v189
  v_exp_f32 v174, v174
  v_exp_f32 v190, v190
  v_mfma_f32_32x32x16_bf16 v[128:143], a[160:163], v[80:83], v[128:143]
  ds_read_b64_tr_b16 a[144:145], v38 offset:2048
  ds_read_b64_tr_b16 a[146:147], v38 offset:6144
  v_exp_f32 v175, v175
  v_mfma_f32_32x32x16_bf16 v[144:159], a[160:163], v[112:115], v[144:159]
  s_waitcnt lgkmcnt(4)
  v_exp_f32 v191, v191
  v_add_f32 v224, v224, v174
  v_add_f32 v226, v226, v190
  v_add_f32 v225, v225, v175
  v_add_f32 v227, v227, v191
  v_mfma_f32_32x32x16_bf16 v[128:143], a[164:167], v[84:87], v[128:143]
  ds_read_b64_tr_b16 a[148:149], v38 offset:2304
  ds_read_b64_tr_b16 a[150:151], v38 offset:6400
  v_cvt_pk_bf16_f32 v167, v174, v175
  v_cvt_pk_bf16_f32 v183, v190, v191
  v_mfma_f32_32x32x16_bf16 v[144:159], a[164:167], v[116:119], v[144:159]
  s_waitcnt lgkmcnt(5)
  v_mfma_f32_32x32x16_bf16 v[128:143], a[168:171], v[88:91], v[128:143]
  ds_read_b64_tr_b16 a[152:153], v38 offset:2560
  ds_read_b64_tr_b16 a[154:155], v38 offset:6656
  v_mfma_f32_32x32x16_bf16 v[144:159], a[168:171], v[120:123], v[144:159]
  s_waitcnt lgkmcnt(6)
  v_mfma_f32_32x32x16_bf16 v[128:143], a[172:175], v[92:95], v[128:143]
  ds_read_b64_tr_b16 a[156:157], v38 offset:2816
  ds_read_b64_tr_b16 a[158:159], v38 offset:6912
  v_mfma_f32_32x32x16_bf16 v[144:159], a[172:175], v[124:127], v[144:159]
  s_waitcnt lgkmcnt(6)
  v_mfma_f32_32x32x16_bf16 a[0:15], a[144:147], v[160:163], a[0:15]
  ds_read_b64_tr_b16 a[160:161], v38 offset:10240
  ds_read_b64_tr_b16 a[162:163], v38 offset:14336
  v_mfma_f32_32x32x16_bf16 a[64:79], a[144:147], v[176:179], a[64:79]
  s_waitcnt lgkmcnt(6)
  s_nop 2
  v_exp_f32 v128, v128
  s_nop 1
  v_exp_f32 v144, v144
  v_exp_f32 v129, v129
  v_mfma_f32_32x32x16_bf16 a[16:31], a[148:151], v[160:163], a[16:31]
  ds_read_b64_tr_b16 a[164:165], v38 offset:10496
  ds_read_b64_tr_b16 a[166:167], v38 offset:14592
  v_exp_f32 v145, v145
  v_add_f32 v224, v224, v128
  v_mfma_f32_32x32x16_bf16 a[80:95], a[148:151], v[176:179], a[80:95]
  s_waitcnt lgkmcnt(6)
  v_add_f32 v226, v226, v144
  v_add_f32 v225, v225, v129
  v_add_f32 v227, v227, v145
  v_cvt_pk_bf16_f32 v128, v128, v129
  v_cvt_pk_bf16_f32 v144, v144, v145
  v_mfma_f32_32x32x16_bf16 a[32:47], a[152:155], v[160:163], a[32:47]
  ds_read_b64_tr_b16 a[168:169], v38 offset:10752
  ds_read_b64_tr_b16 a[170:171], v38 offset:14848
  v_exp_f32 v130, v130
  v_mfma_f32_32x32x16_bf16 a[96:111], a[152:155], v[176:179], a[96:111]
  s_waitcnt lgkmcnt(6)
  v_exp_f32 v146, v146
  v_exp_f32 v131, v131
  v_exp_f32 v147, v147
  v_mfma_f32_32x32x16_bf16 a[48:63], a[156:159], v[160:163], a[48:63]
  ds_read_b64_tr_b16 a[172:173], v38 offset:11008
  ds_read_b64_tr_b16 a[174:175], v38 offset:15104
  v_add_f32 v224, v224, v130
  v_add_f32 v226, v226, v146
  v_add_f32 v225, v225, v131
  v_mfma_f32_32x32x16_bf16 a[112:127], a[156:159], v[176:179], a[112:127]
  s_waitcnt lgkmcnt(6)
  v_add_f32 v227, v227, v147
  v_cvt_pk_bf16_f32 v129, v130, v131
  v_cvt_pk_bf16_f32 v145, v146, v147
  s_waitcnt vmcnt(21)
  s_barrier
  v_mfma_f32_32x32x16_bf16 a[0:15], a[160:163], v[164:167], a[0:15]
  s_add_u32 s67, s63, 0x1a000
  ds_read_b128 a[144:147], v36 offset:16384
  s_add_u32 s68, s63, 0x18000
  s_add_u32 m0, s54, 0x1c000
  s_nop 0
  buffer_load_dwordx4 v26, s[24:27], s67 offen lds
  v_mfma_f32_32x32x16_bf16 a[64:79], a[160:163], v[180:183], a[64:79]
  s_waitcnt lgkmcnt(5)
  v_exp_f32 v132, v132
  v_exp_f32 v148, v148
  v_exp_f32 v133, v133
  v_mfma_f32_32x32x16_bf16 a[16:31], a[164:167], v[164:167], a[16:31]
  s_add_u32 m0, s54, 0x1c400
  ds_read_b128 a[148:151], v36 offset:16640
  v_exp_f32 v149, v149
  v_add_f32 v224, v224, v132
  v_add_f32 v226, v226, v148
  v_add_f32 v225, v225, v133
  v_mfma_f32_32x32x16_bf16 a[80:95], a[164:167], v[180:183], a[80:95]
  s_waitcnt lgkmcnt(4)
  buffer_load_dwordx4 v27, s[24:27], s67 offen lds
  v_add_f32 v227, v227, v149
  v_cvt_pk_bf16_f32 v130, v132, v133
  v_cvt_pk_bf16_f32 v146, v148, v149
  v_exp_f32 v134, v134
  v_mfma_f32_32x32x16_bf16 a[32:47], a[168:171], v[164:167], a[32:47]
  ds_read_b128 a[152:155], v36 offset:16896
  v_exp_f32 v150, v150
  v_exp_f32 v135, v135
  v_mfma_f32_32x32x16_bf16 a[96:111], a[168:171], v[180:183], a[96:111]
  s_waitcnt lgkmcnt(3)
  v_exp_f32 v151, v151
  v_add_f32 v224, v224, v134
  v_add_f32 v226, v226, v150
  v_add_f32 v225, v225, v135
  s_add_u32 m0, s54, 0x1c800
  v_mfma_f32_32x32x16_bf16 a[48:63], a[172:175], v[164:167], a[48:63]
  ds_read_b128 a[156:159], v36 offset:17152
  buffer_load_dwordx4 v28, s[28:31], s68 offen lds
  v_add_f32 v227, v227, v151
  v_cvt_pk_bf16_f32 v131, v134, v135
  v_cvt_pk_bf16_f32 v147, v150, v151
  v_mfma_f32_32x32x16_bf16 a[112:127], a[172:175], v[180:183], a[112:127]
  s_waitcnt lgkmcnt(3)
  v_exp_f32 v136, v136
  v_exp_f32 v152, v152
  v_exp_f32 v137, v137
  v_mfma_f32_32x32x16_bf16 v[160:175], a[144:147], v[64:67], v[192:207]
  s_add_u32 m0, s54, 0x1cc00
  ds_read_b128 a[160:163], v36 offset:17408
  v_exp_f32 v153, v153
  v_add_f32 v224, v224, v136
  v_add_f32 v226, v226, v152
  v_add_f32 v225, v225, v137
  v_mfma_f32_32x32x16_bf16 v[176:191], a[144:147], v[96:99], v[208:223]
  s_waitcnt lgkmcnt(3)
  buffer_load_dwordx4 v29, s[28:31], s68 offen lds
  v_add_f32 v227, v227, v153
  v_cvt_pk_bf16_f32 v132, v136, v137
  v_cvt_pk_bf16_f32 v148, v152, v153
  v_exp_f32 v138, v138
  v_mfma_f32_32x32x16_bf16 v[160:175], a[148:151], v[68:71], v[160:175]
  ds_read_b128 a[164:167], v36 offset:17664
  v_exp_f32 v154, v154
  v_exp_f32 v139, v139
  v_mfma_f32_32x32x16_bf16 v[176:191], a[148:151], v[100:103], v[176:191]
  s_waitcnt lgkmcnt(3)
  v_exp_f32 v155, v155
  v_add_f32 v224, v224, v138
  v_add_f32 v226, v226, v154
  v_add_f32 v225, v225, v139
  v_add_f32 v227, v227, v155
  v_mfma_f32_32x32x16_bf16 v[160:175], a[152:155], v[72:75], v[160:175]
  ds_read_b128 a[168:171], v36 offset:17920
  v_cvt_pk_bf16_f32 v133, v138, v139
  v_cvt_pk_bf16_f32 v149, v154, v155
  v_exp_f32 v140, v140
  v_mfma_f32_32x32x16_bf16 v[176:191], a[152:155], v[104:107], v[176:191]
  s_waitcnt lgkmcnt(3)
  v_exp_f32 v156, v156
  v_exp_f32 v141, v141
  v_exp_f32 v157, v157
  v_mfma_f32_32x32x16_bf16 v[160:175], a[156:159], v[76:79], v[160:175]
  ds_read_b128 a[172:175], v36 offset:18176
  v_add_f32 v224, v224, v140
  v_add_f32 v226, v226, v156
  v_add_f32 v225, v225, v141
  v_add_f32 v227, v227, v157
  v_cvt_pk_bf16_f32 v134, v140, v141
  v_mfma_f32_32x32x16_bf16 v[176:191], a[156:159], v[108:111], v[176:191]
  s_waitcnt lgkmcnt(3)
  v_cvt_pk_bf16_f32 v150, v156, v157
  v_exp_f32 v142, v142
  v_exp_f32 v158, v158
  v_mfma_f32_32x32x16_bf16 v[160:175], a[160:163], v[80:83], v[160:175]
  ds_read_b64_tr_b16 a[144:145], v38 offset:18432
  ds_read_b64_tr_b16 a[146:147], v38 offset:22528
  v_exp_f32 v143, v143
  v_mfma_f32_32x32x16_bf16 v[176:191], a[160:163], v[112:115], v[176:191]
  s_waitcnt lgkmcnt(4)
  v_exp_f32 v159, v159
  v_add_f32 v224, v224, v142
  v_add_f32 v226, v226, v158
  v_add_f32 v225, v225, v143
  v_add_f32 v227, v227, v159
  v_mfma_f32_32x32x16_bf16 v[160:175], a[164:167], v[84:87], v[160:175]
  ds_read_b64_tr_b16 a[148:149], v38 offset:18688
  ds_read_b64_tr_b16 a[150:151], v38 offset:22784
  v_cvt_pk_bf16_f32 v135, v142, v143
  v_cvt_pk_bf16_f32 v151, v158, v159
  v_mfma_f32_32x32x16_bf16 v[176:191], a[164:167], v[116:119], v[176:191]
  s_waitcnt lgkmcnt(5)
  v_mfma_f32_32x32x16_bf16 v[160:175], a[168:171], v[88:91], v[160:175]
  ds_read_b64_tr_b16 a[152:153], v38 offset:18944
  ds_read_b64_tr_b16 a[154:155], v38 offset:23040
  v_mfma_f32_32x32x16_bf16 v[176:191], a[168:171], v[120:123], v[176:191]
  s_waitcnt lgkmcnt(6)
  v_mfma_f32_32x32x16_bf16 v[160:175], a[172:175], v[92:95], v[160:175]
  ds_read_b64_tr_b16 a[156:157], v38 offset:19200
  ds_read_b64_tr_b16 a[158:159], v38 offset:23296
  v_mfma_f32_32x32x16_bf16 v[176:191], a[172:175], v[124:127], v[176:191]
  s_waitcnt lgkmcnt(6)
  v_mfma_f32_32x32x16_bf16 a[0:15], a[144:147], v[128:131], a[0:15]
  ds_read_b64_tr_b16 a[160:161], v38 offset:26624
  ds_read_b64_tr_b16 a[162:163], v38 offset:30720
  v_mfma_f32_32x32x16_bf16 a[64:79], a[144:147], v[144:147], a[64:79]
  s_waitcnt lgkmcnt(6)
  s_nop 2
  v_exp_f32 v160, v160
  s_nop 1
  v_exp_f32 v176, v176
  v_exp_f32 v161, v161
  v_mfma_f32_32x32x16_bf16 a[16:31], a[148:151], v[128:131], a[16:31]
  ds_read_b64_tr_b16 a[164:165], v38 offset:26880
  ds_read_b64_tr_b16 a[166:167], v38 offset:30976
  v_exp_f32 v177, v177
  v_add_f32 v224, v224, v160
  v_mfma_f32_32x32x16_bf16 a[80:95], a[148:151], v[144:147], a[80:95]
  s_waitcnt lgkmcnt(6)
  v_add_f32 v226, v226, v176
  v_add_f32 v225, v225, v161
  v_add_f32 v227, v227, v177
  v_cvt_pk_bf16_f32 v160, v160, v161
  v_cvt_pk_bf16_f32 v176, v176, v177
  v_mfma_f32_32x32x16_bf16 a[32:47], a[152:155], v[128:131], a[32:47]
  ds_read_b64_tr_b16 a[168:169], v38 offset:27136
  ds_read_b64_tr_b16 a[170:171], v38 offset:31232
  v_exp_f32 v162, v162
  v_mfma_f32_32x32x16_bf16 a[96:111], a[152:155], v[144:147], a[96:111]
  s_waitcnt lgkmcnt(6)
  v_exp_f32 v178, v178
  v_exp_f32 v163, v163
  v_exp_f32 v179, v179
  v_mfma_f32_32x32x16_bf16 a[48:63], a[156:159], v[128:131], a[48:63]
  ds_read_b64_tr_b16 a[172:173], v38 offset:27392
  ds_read_b64_tr_b16 a[174:175], v38 offset:31488
  v_add_f32 v224, v224, v162
  v_add_f32 v226, v226, v178
  v_add_f32 v225, v225, v163
  v_mfma_f32_32x32x16_bf16 a[112:127], a[156:159], v[144:147], a[112:127]
  s_waitcnt lgkmcnt(6)
  v_add_f32 v227, v227, v179
  v_cvt_pk_bf16_f32 v161, v162, v163
  v_cvt_pk_bf16_f32 v177, v178, v179
  s_waitcnt vmcnt(21)
  s_barrier
  v_mfma_f32_32x32x16_bf16 a[0:15], a[160:163], v[132:135], a[0:15]
  s_add_u32 s67, s63, 0x1c000
  ds_read_b128 a[144:147], v36 offset:32768
  s_add_u32 s68, s63, 0x1a000
  s_add_u32 m0, s54, 0
  s_nop 0
  buffer_load_dwordx4 v26, s[24:27], s67 offen lds
  v_mfma_f32_32x32x16_bf16 a[64:79], a[160:163], v[148:151], a[64:79]
  s_waitcnt lgkmcnt(5)
  v_exp_f32 v164, v164
  v_exp_f32 v180, v180
  v_exp_f32 v165, v165
  v_mfma_f32_32x32x16_bf16 a[16:31], a[164:167], v[132:135], a[16:31]
  s_add_u32 m0, s54, 0x400
  ds_read_b128 a[148:151], v36 offset:33024
  v_exp_f32 v181, v181
  v_add_f32 v224, v224, v164
  v_add_f32 v226, v226, v180
  v_add_f32 v225, v225, v165
  v_mfma_f32_32x32x16_bf16 a[80:95], a[164:167], v[148:151], a[80:95]
  s_waitcnt lgkmcnt(4)
  buffer_load_dwordx4 v27, s[24:27], s67 offen lds
  v_add_f32 v227, v227, v181
  v_cvt_pk_bf16_f32 v162, v164, v165
  v_cvt_pk_bf16_f32 v178, v180, v181
  v_exp_f32 v166, v166
  v_mfma_f32_32x32x16_bf16 a[32:47], a[168:171], v[132:135], a[32:47]
  ds_read_b128 a[152:155], v36 offset:33280
  v_exp_f32 v182, v182
  v_exp_f32 v167, v167
  v_mfma_f32_32x32x16_bf16 a[96:111], a[168:171], v[148:151], a[96:111]
  s_waitcnt lgkmcnt(3)
  v_exp_f32 v183, v183
  v_add_f32 v224, v224, v166
  v_add_f32 v226, v226, v182
  v_add_f32 v225, v225, v167
  s_add_u32 m0, s54, 0x800
  v_mfma_f32_32x32x16_bf16 a[48:63], a[172:175], v[132:135], a[48:63]
  ds_read_b128 a[156:159], v36 offset:33536
  buffer_load_dwordx4 v28, s[28:31], s68 offen lds
  v_add_f32 v227, v227, v183
  v_cvt_pk_bf16_f32 v163, v166, v167
  v_cvt_pk_bf16_f32 v179, v182, v183
  v_mfma_f32_32x32x16_bf16 a[112:127], a[172:175], v[148:151], a[112:127]
  s_waitcnt lgkmcnt(3)
  v_exp_f32 v168, v168
  v_exp_f32 v184, v184
  v_exp_f32 v169, v169
  v_mfma_f32_32x32x16_bf16 v[128:143], a[144:147], v[64:67], v[192:207]
  s_add_u32 m0, s54, 0xc00
  ds_read_b128 a[160:163], v36 offset:33792
  v_exp_f32 v185, v185
  v_add_f32 v224, v224, v168
  v_add_f32 v226, v226, v184
  v_add_f32 v225, v225, v169
  v_mfma_f32_32x32x16_bf16 v[144:159], a[144:147], v[96:99], v[208:223]
  s_waitcnt lgkmcnt(3)
  buffer_load_dwordx4 v29, s[28:31], s68 offen lds
  v_add_f32 v227, v227, v185
  v_cvt_pk_bf16_f32 v164, v168, v169
  v_cvt_pk_bf16_f32 v180, v184, v185
  v_exp_f32 v170, v170
  v_mfma_f32_32x32x16_bf16 v[128:143], a[148:151], v[68:71], v[128:143]
  ds_read_b128 a[164:167], v36 offset:34048
  v_exp_f32 v186, v186
  v_exp_f32 v171, v171
  v_mfma_f32_32x32x16_bf16 v[144:159], a[148:151], v[100:103], v[144:159]
  s_waitcnt lgkmcnt(3)
  v_exp_f32 v187, v187
  v_add_f32 v224, v224, v170
  v_add_f32 v226, v226, v186
  v_add_f32 v225, v225, v171
  v_add_f32 v227, v227, v187
  v_mfma_f32_32x32x16_bf16 v[128:143], a[152:155], v[72:75], v[128:143]
  ds_read_b128 a[168:171], v36 offset:34304
  v_cvt_pk_bf16_f32 v165, v170, v171
  v_cvt_pk_bf16_f32 v181, v186, v187
  v_exp_f32 v172, v172
  v_mfma_f32_32x32x16_bf16 v[144:159], a[152:155], v[104:107], v[144:159]
  s_waitcnt lgkmcnt(3)
  v_exp_f32 v188, v188
  v_exp_f32 v173, v173
  v_exp_f32 v189, v189
  v_mfma_f32_32x32x16_bf16 v[128:143], a[156:159], v[76:79], v[128:143]
  ds_read_b128 a[172:175], v36 offset:34560
  v_add_f32 v224, v224, v172
  v_add_f32 v226, v226, v188
  v_add_f32 v225, v225, v173
  v_add_f32 v227, v227, v189
  v_cvt_pk_bf16_f32 v166, v172, v173
  v_mfma_f32_32x32x16_bf16 v[144:159], a[156:159], v[108:111], v[144:159]
  s_waitcnt lgkmcnt(3)
  v_cvt_pk_bf16_f32 v182, v188, v189
  v_exp_f32 v174, v174
  v_exp_f32 v190, v190
  v_mfma_f32_32x32x16_bf16 v[128:143], a[160:163], v[80:83], v[128:143]
  ds_read_b64_tr_b16 a[144:145], v38 offset:34816
  ds_read_b64_tr_b16 a[146:147], v38 offset:38912
  v_exp_f32 v175, v175
  v_mfma_f32_32x32x16_bf16 v[144:159], a[160:163], v[112:115], v[144:159]
  s_waitcnt lgkmcnt(4)
  v_exp_f32 v191, v191
  v_add_f32 v224, v224, v174
  v_add_f32 v226, v226, v190
  v_add_f32 v225, v225, v175
  v_add_f32 v227, v227, v191
  v_mfma_f32_32x32x16_bf16 v[128:143], a[164:167], v[84:87], v[128:143]
  ds_read_b64_tr_b16 a[148:149], v38 offset:35072
  ds_read_b64_tr_b16 a[150:151], v38 offset:39168
  v_cvt_pk_bf16_f32 v167, v174, v175
  v_cvt_pk_bf16_f32 v183, v190, v191
  v_mfma_f32_32x32x16_bf16 v[144:159], a[164:167], v[116:119], v[144:159]
  s_waitcnt lgkmcnt(5)
  v_mfma_f32_32x32x16_bf16 v[128:143], a[168:171], v[88:91], v[128:143]
  ds_read_b64_tr_b16 a[152:153], v38 offset:35328
  ds_read_b64_tr_b16 a[154:155], v38 offset:39424
  v_mfma_f32_32x32x16_bf16 v[144:159], a[168:171], v[120:123], v[144:159]
  s_waitcnt lgkmcnt(6)
  v_mfma_f32_32x32x16_bf16 v[128:143], a[172:175], v[92:95], v[128:143]
  ds_read_b64_tr_b16 a[156:157], v38 offset:35584
  ds_read_b64_tr_b16 a[158:159], v38 offset:39680
  v_mfma_f32_32x32x16_bf16 v[144:159], a[172:175], v[124:127], v[144:159]
  s_waitcnt lgkmcnt(6)
  v_mfma_f32_32x32x16_bf16 a[0:15], a[144:147], v[160:163], a[0:15]
  ds_read_b64_tr_b16 a[160:161], v38 offset:43008
  ds_read_b64_tr_b16 a[162:163], v38 offset:47104
  v_mfma_f32_32x32x16_bf16 a[64:79], a[144:147], v[176:179], a[64:79]
  s_waitcnt lgkmcnt(6)
  s_nop 2
  v_exp_f32 v128, v128
  s_nop 1
  v_exp_f32 v144, v144
  v_exp_f32 v129, v129
  v_mfma_f32_32x32x16_bf16 a[16:31], a[148:151], v[160:163], a[16:31]
  ds_read_b64_tr_b16 a[164:165], v38 offset:43264
  ds_read_b64_tr_b16 a[166:167], v38 offset:47360
  v_exp_f32 v145, v145
  v_add_f32 v224, v224, v128
  v_mfma_f32_32x32x16_bf16 a[80:95], a[148:151], v[176:179], a[80:95]
  s_waitcnt lgkmcnt(6)
  v_add_f32 v226, v226, v144
  v_add_f32 v225, v225, v129
  v_add_f32 v227, v227, v145
  v_cvt_pk_bf16_f32 v128, v128, v129
  v_cvt_pk_bf16_f32 v144, v144, v145
  v_mfma_f32_32x32x16_bf16 a[32:47], a[152:155], v[160:163], a[32:47]
  ds_read_b64_tr_b16 a[168:169], v38 offset:43520
  ds_read_b64_tr_b16 a[170:171], v38 offset:47616
  v_exp_f32 v130, v130
  v_mfma_f32_32x32x16_bf16 a[96:111], a[152:155], v[176:179], a[96:111]
  s_waitcnt lgkmcnt(6)
  v_exp_f32 v146, v146
  v_exp_f32 v131, v131
  v_exp_f32 v147, v147
  v_mfma_f32_32x32x16_bf16 a[48:63], a[156:159], v[160:163], a[48:63]
  ds_read_b64_tr_b16 a[172:173], v38 offset:43776
  ds_read_b64_tr_b16 a[174:175], v38 offset:47872
  v_add_f32 v224, v224, v130
  v_add_f32 v226, v226, v146
  v_add_f32 v225, v225, v131
  v_mfma_f32_32x32x16_bf16 a[112:127], a[156:159], v[176:179], a[112:127]
  s_waitcnt lgkmcnt(6)
  v_add_f32 v227, v227, v147
  v_cvt_pk_bf16_f32 v129, v130, v131
  v_cvt_pk_bf16_f32 v145, v146, v147
  s_waitcnt vmcnt(20)
  s_barrier
  v_mfma_f32_32x32x16_bf16 a[0:15], a[160:163], v[164:167], a[0:15]
  s_add_u32 s67, s63, 0x1e000
  ds_read_b128 a[144:147], v36 offset:49152
  s_add_u32 s68, s63, 0x1c000
  s_add_u32 m0, s54, 0x4000
  s_nop 0
  buffer_load_dwordx4 v26, s[24:27], s67 offen lds
  v_mfma_f32_32x32x16_bf16 a[64:79], a[160:163], v[180:183], a[64:79]
  s_waitcnt lgkmcnt(5)
  v_exp_f32 v132, v132
  v_exp_f32 v148, v148
  v_exp_f32 v133, v133
  v_mfma_f32_32x32x16_bf16 a[16:31], a[164:167], v[164:167], a[16:31]
  s_add_u32 m0, s54, 0x4400
  ds_read_b128 a[148:151], v36 offset:49408
  v_exp_f32 v149, v149
  v_add_f32 v224, v224, v132
  v_add_f32 v226, v226, v148
  v_add_f32 v225, v225, v133
  v_mfma_f32_32x32x16_bf16 a[80:95], a[164:167], v[180:183], a[80:95]
  s_waitcnt lgkmcnt(4)
  buffer_load_dwordx4 v27, s[24:27], s67 offen lds
  v_add_f32 v227, v227, v149
  v_cvt_pk_bf16_f32 v130, v132, v133
  v_cvt_pk_bf16_f32 v146, v148, v149
  v_exp_f32 v134, v134
  v_mfma_f32_32x32x16_bf16 a[32:47], a[168:171], v[164:167], a[32:47]
  ds_read_b128 a[152:155], v36 offset:49664
  v_exp_f32 v150, v150
  v_exp_f32 v135, v135
  v_mfma_f32_32x32x16_bf16 a[96:111], a[168:171], v[180:183], a[96:111]
  s_waitcnt lgkmcnt(3)
  v_exp_f32 v151, v151
  v_add_f32 v224, v224, v134
  v_add_f32 v226, v226, v150
  v_add_f32 v225, v225, v135
  s_add_u32 m0, s54, 0x4800
  v_mfma_f32_32x32x16_bf16 a[48:63], a[172:175], v[164:167], a[48:63]
  ds_read_b128 a[156:159], v36 offset:49920
  buffer_load_dwordx4 v28, s[28:31], s68 offen lds
  v_add_f32 v227, v227, v151
  v_cvt_pk_bf16_f32 v131, v134, v135
  v_cvt_pk_bf16_f32 v147, v150, v151
  v_mfma_f32_32x32x16_bf16 a[112:127], a[172:175], v[180:183], a[112:127]
  s_waitcnt lgkmcnt(3)
  v_exp_f32 v136, v136
  v_exp_f32 v152, v152
  v_exp_f32 v137, v137
  v_mfma_f32_32x32x16_bf16 v[160:175], a[144:147], v[64:67], v[192:207]
  s_add_u32 m0, s54, 0x4c00
  ds_read_b128 a[160:163], v36 offset:50176
  v_exp_f32 v153, v153
  v_add_f32 v224, v224, v136
  v_add_f32 v226, v226, v152
  v_add_f32 v225, v225, v137
  v_mfma_f32_32x32x16_bf16 v[176:191], a[144:147], v[96:99], v[208:223]
  s_waitcnt lgkmcnt(3)
  buffer_load_dwordx4 v29, s[28:31], s68 offen lds
  v_add_f32 v227, v227, v153
  v_cvt_pk_bf16_f32 v132, v136, v137
  v_cvt_pk_bf16_f32 v148, v152, v153
  v_exp_f32 v138, v138
  v_mfma_f32_32x32x16_bf16 v[160:175], a[148:151], v[68:71], v[160:175]
  ds_read_b128 a[164:167], v36 offset:50432
  v_exp_f32 v154, v154
  v_exp_f32 v139, v139
  v_mfma_f32_32x32x16_bf16 v[176:191], a[148:151], v[100:103], v[176:191]
  s_waitcnt lgkmcnt(3)
  v_exp_f32 v155, v155
  v_add_f32 v224, v224, v138
  v_add_f32 v226, v226, v154
  v_add_f32 v225, v225, v139
  v_add_f32 v227, v227, v155
  v_mfma_f32_32x32x16_bf16 v[160:175], a[152:155], v[72:75], v[160:175]
  ds_read_b128 a[168:171], v36 offset:50688
  v_cvt_pk_bf16_f32 v133, v138, v139
  v_cvt_pk_bf16_f32 v149, v154, v155
  v_exp_f32 v140, v140
  v_mfma_f32_32x32x16_bf16 v[176:191], a[152:155], v[104:107], v[176:191]
  s_waitcnt lgkmcnt(3)
  v_exp_f32 v156, v156
  v_exp_f32 v141, v141
  v_exp_f32 v157, v157
  v_mfma_f32_32x32x16_bf16 v[160:175], a[156:159], v[76:79], v[160:175]
  ds_read_b128 a[172:175], v36 offset:50944
  v_add_f32 v224, v224, v140
  v_add_f32 v226, v226, v156
  v_add_f32 v225, v225, v141
  v_add_f32 v227, v227, v157
  v_cvt_pk_bf16_f32 v134, v140, v141
  v_mfma_f32_32x32x16_bf16 v[176:191], a[156:159], v[108:111], v[176:191]
  s_waitcnt lgkmcnt(3)
  v_cvt_pk_bf16_f32 v150, v156, v157
  v_exp_f32 v142, v142
  v_exp_f32 v158, v158
  v_mfma_f32_32x32x16_bf16 v[160:175], a[160:163], v[80:83], v[160:175]
  ds_read_b64_tr_b16 a[144:145], v38 offset:51200
  ds_read_b64_tr_b16 a[146:147], v38 offset:55296
  v_exp_f32 v143, v143
  v_mfma_f32_32x32x16_bf16 v[176:191], a[160:163], v[112:115], v[176:191]
  s_waitcnt lgkmcnt(4)
  v_exp_f32 v159, v159
  v_add_f32 v224, v224, v142
  v_add_f32 v226, v226, v158
  v_add_f32 v225, v225, v143
  v_add_f32 v227, v227, v159
  v_mfma_f32_32x32x16_bf16 v[160:175], a[164:167], v[84:87], v[160:175]
  ds_read_b64_tr_b16 a[148:149], v38 offset:51456
  ds_read_b64_tr_b16 a[150:151], v38 offset:55552
  v_cvt_pk_bf16_f32 v135, v142, v143
  v_cvt_pk_bf16_f32 v151, v158, v159
  v_mfma_f32_32x32x16_bf16 v[176:191], a[164:167], v[116:119], v[176:191]
  s_waitcnt lgkmcnt(5)
  v_mfma_f32_32x32x16_bf16 v[160:175], a[168:171], v[88:91], v[160:175]
  ds_read_b64_tr_b16 a[152:153], v38 offset:51712
  ds_read_b64_tr_b16 a[154:155], v38 offset:55808
  v_mfma_f32_32x32x16_bf16 v[176:191], a[168:171], v[120:123], v[176:191]
  s_waitcnt lgkmcnt(6)
  v_mfma_f32_32x32x16_bf16 v[160:175], a[172:175], v[92:95], v[160:175]
  ds_read_b64_tr_b16 a[156:157], v38 offset:51968
  ds_read_b64_tr_b16 a[158:159], v38 offset:56064
  v_mfma_f32_32x32x16_bf16 v[176:191], a[172:175], v[124:127], v[176:191]
  s_waitcnt lgkmcnt(6)
  v_mfma_f32_32x32x16_bf16 a[0:15], a[144:147], v[128:131], a[0:15]
  ds_read_b64_tr_b16 a[160:161], v38 offset:59392
  ds_read_b64_tr_b16 a[162:163], v38 offset:63488
  v_lshlrev_b32 v11, 7, v0
  v_mfma_f32_32x32x16_bf16 a[64:79], a[144:147], v[144:147], a[64:79]
  s_waitcnt lgkmcnt(6)
  v_add_u32 v11, 0xc000, v11
  s_nop 0
  v_exp_f32 v160, v160
  s_nop 1
  v_exp_f32 v176, v176
  v_mfma_f32_32x32x16_bf16 a[16:31], a[148:151], v[128:131], a[16:31]
  ds_read_b64_tr_b16 a[164:165], v38 offset:59648
  ds_read_b64_tr_b16 a[166:167], v38 offset:63744
  v_min_u32 v11, adaLN_cond__sliding_block_cached__glu_gated_swiglu__prompt_kernel_end-adaLN_cond__sliding_block_cached__glu_gated_swiglu__prompt_kernel_pc-4, v11
  v_exp_f32 v161, v161
  v_mfma_f32_32x32x16_bf16 a[80:95], a[148:151], v[144:147], a[80:95]
  s_waitcnt lgkmcnt(6)
  global_load_dword a248, v11, s[48:49]
  v_exp_f32 v177, v177
  v_add_f32 v224, v224, v160
  v_add_f32 v226, v226, v176
  v_add_f32 v225, v225, v161
  v_mfma_f32_32x32x16_bf16 a[32:47], a[152:155], v[128:131], a[32:47]
  ds_read_b64_tr_b16 a[168:169], v38 offset:59904
  ds_read_b64_tr_b16 a[170:171], v38 offset:64000
  v_add_f32 v227, v227, v177
  v_cvt_pk_bf16_f32 v160, v160, v161
  v_lshlrev_b32 v11, 7, v0
  v_mfma_f32_32x32x16_bf16 a[96:111], a[152:155], v[144:147], a[96:111]
  s_waitcnt lgkmcnt(6)
  v_cvt_pk_bf16_f32 v176, v176, v177
  v_add_u32 v11, 0x14000, v11
  v_exp_f32 v162, v162
  v_exp_f32 v178, v178
  v_mfma_f32_32x32x16_bf16 a[48:63], a[156:159], v[128:131], a[48:63]
  ds_read_b64_tr_b16 a[172:173], v38 offset:60160
  ds_read_b64_tr_b16 a[174:175], v38 offset:64256
  v_min_u32 v11, adaLN_cond__sliding_block_cached__glu_gated_swiglu__prompt_kernel_end-adaLN_cond__sliding_block_cached__glu_gated_swiglu__prompt_kernel_pc-4, v11
  v_exp_f32 v163, v163
  v_mfma_f32_32x32x16_bf16 a[112:127], a[156:159], v[144:147], a[112:127]
  s_waitcnt lgkmcnt(6)
  global_load_dword a249, v11, s[48:49]
  s_waitcnt vmcnt(22)
  v_exp_f32 v179, v179
  v_add_f32 v224, v224, v162
  v_add_f32 v226, v226, v178
  s_barrier
  v_mfma_f32_32x32x16_bf16 a[0:15], a[160:163], v[132:135], a[0:15]
  s_add_u32 s67, s63, 0x20000
  ds_read_b128 a[144:147], v37
  s_add_u32 s68, s63, 0x1e000
  v_add_f32 v225, v225, v163
  s_add_u32 m0, s54, 0x8800
  s_nop 0
  buffer_load_dwordx4 v28, s[28:31], s68 offen lds
  v_mfma_f32_32x32x16_bf16 a[64:79], a[160:163], v[148:151], a[64:79]
  s_waitcnt lgkmcnt(5)
  v_add_f32 v227, v227, v179
  v_cvt_pk_bf16_f32 v161, v162, v163
  v_cvt_pk_bf16_f32 v177, v178, v179
  v_exp_f32 v164, v164
  v_mfma_f32_32x32x16_bf16 a[16:31], a[164:167], v[132:135], a[16:31]
  s_add_u32 m0, s54, 0x8c00
  ds_read_b128 a[148:151], v37 offset:256
  v_exp_f32 v180, v180
  v_exp_f32 v165, v165
  v_mfma_f32_32x32x16_bf16 a[80:95], a[164:167], v[148:151], a[80:95]
  s_waitcnt lgkmcnt(4)
  buffer_load_dwordx4 v29, s[28:31], s68 offen lds
  v_exp_f32 v181, v181
  v_add_f32 v224, v224, v164
  v_add_f32 v226, v226, v180
  v_add_f32 v225, v225, v165
  v_mfma_f32_32x32x16_bf16 a[32:47], a[168:171], v[132:135], a[32:47]
  ds_read_b128 a[152:155], v37 offset:512
  v_add_f32 v227, v227, v181
  v_cvt_pk_bf16_f32 v162, v164, v165
  v_cvt_pk_bf16_f32 v178, v180, v181
  v_exp_f32 v166, v166
  v_mfma_f32_32x32x16_bf16 a[96:111], a[168:171], v[148:151], a[96:111]
  s_waitcnt lgkmcnt(3)
  v_exp_f32 v182, v182
  v_exp_f32 v167, v167
  v_exp_f32 v183, v183
  v_mfma_f32_32x32x16_bf16 a[48:63], a[172:175], v[132:135], a[48:63]
  ds_read_b128 a[156:159], v37 offset:768
  v_add_f32 v224, v224, v166
  v_add_f32 v226, v226, v182
  v_add_f32 v225, v225, v167
  v_add_f32 v227, v227, v183
  v_cvt_pk_bf16_f32 v163, v166, v167
  v_mfma_f32_32x32x16_bf16 a[112:127], a[172:175], v[148:151], a[112:127]
  s_waitcnt lgkmcnt(3)
  v_cvt_pk_bf16_f32 v179, v182, v183
  v_exp_f32 v168, v168
  v_exp_f32 v184, v184
  v_mfma_f32_32x32x16_bf16 v[128:143], a[144:147], v[64:67], v[192:207]
  ds_read_b128 a[160:163], v37 offset:1024
  v_exp_f32 v169, v169
  v_exp_f32 v185, v185
  v_add_f32 v224, v224, v168
  v_mfma_f32_32x32x16_bf16 v[144:159], a[144:147], v[96:99], v[208:223]
  s_waitcnt lgkmcnt(3)
  v_add_f32 v226, v226, v184
  v_add_f32 v225, v225, v169
  v_add_f32 v227, v227, v185
  v_cvt_pk_bf16_f32 v164, v168, v169
  v_cvt_pk_bf16_f32 v180, v184, v185
  v_mfma_f32_32x32x16_bf16 v[128:143], a[148:151], v[68:71], v[128:143]
  ds_read_b128 a[164:167], v37 offset:1280
  v_exp_f32 v170, v170
  v_exp_f32 v186, v186
  v_mfma_f32_32x32x16_bf16 v[144:159], a[148:151], v[100:103], v[144:159]
  s_waitcnt lgkmcnt(3)
  v_exp_f32 v171, v171
  v_exp_f32 v187, v187
  v_add_f32 v224, v224, v170
  v_add_f32 v226, v226, v186
  v_mfma_f32_32x32x16_bf16 v[128:143], a[152:155], v[72:75], v[128:143]
  ds_read_b128 a[168:171], v37 offset:1536
  v_add_f32 v225, v225, v171
  v_add_f32 v227, v227, v187
  v_cvt_pk_bf16_f32 v165, v170, v171
  v_cvt_pk_bf16_f32 v181, v186, v187
  v_mfma_f32_32x32x16_bf16 v[144:159], a[152:155], v[104:107], v[144:159]
  s_waitcnt lgkmcnt(3)
  v_exp_f32 v172, v172
  v_exp_f32 v188, v188
  v_exp_f32 v173, v173
  v_mfma_f32_32x32x16_bf16 v[128:143], a[156:159], v[76:79], v[128:143]
  ds_read_b128 a[172:175], v37 offset:1792
  v_exp_f32 v189, v189
  v_add_f32 v224, v224, v172
  v_add_f32 v226, v226, v188
  v_add_f32 v225, v225, v173
  v_mfma_f32_32x32x16_bf16 v[144:159], a[156:159], v[108:111], v[144:159]
  s_waitcnt lgkmcnt(3)
  v_add_f32 v227, v227, v189
  v_cvt_pk_bf16_f32 v166, v172, v173
  v_cvt_pk_bf16_f32 v182, v188, v189
  v_exp_f32 v174, v174
  v_mfma_f32_32x32x16_bf16 v[128:143], a[160:163], v[80:83], v[128:143]
  ds_read_b64_tr_b16 a[144:145], v39 offset:2048
  ds_read_b64_tr_b16 a[146:147], v39 offset:6144
  v_exp_f32 v190, v190
  v_mfma_f32_32x32x16_bf16 v[144:159], a[160:163], v[112:115], v[144:159]
  s_waitcnt lgkmcnt(4)
  v_exp_f32 v175, v175
  v_exp_f32 v191, v191
  v_add_f32 v224, v224, v174
  v_add_f32 v226, v226, v190
  v_mfma_f32_32x32x16_bf16 v[128:143], a[164:167], v[84:87], v[128:143]
  ds_read_b64_tr_b16 a[148:149], v39 offset:2304
  ds_read_b64_tr_b16 a[150:151], v39 offset:6400
  v_add_f32 v225, v225, v175
  v_add_f32 v227, v227, v191
  v_cvt_pk_bf16_f32 v167, v174, v175
  v_mfma_f32_32x32x16_bf16 v[144:159], a[164:167], v[116:119], v[144:159]
  s_waitcnt lgkmcnt(5)
  v_cvt_pk_bf16_f32 v183, v190, v191
  v_mfma_f32_32x32x16_bf16 v[128:143], a[168:171], v[88:91], v[128:143]
  ds_read_b64_tr_b16 a[152:153], v39 offset:2560
  ds_read_b64_tr_b16 a[154:155], v39 offset:6656
  v_mfma_f32_32x32x16_bf16 v[144:159], a[168:171], v[120:123], v[144:159]
  s_waitcnt lgkmcnt(6)
  v_mfma_f32_32x32x16_bf16 v[128:143], a[172:175], v[92:95], v[128:143]
  ds_read_b64_tr_b16 a[156:157], v39 offset:2816
  ds_read_b64_tr_b16 a[158:159], v39 offset:6912
  v_mfma_f32_32x32x16_bf16 v[144:159], a[172:175], v[124:127], v[144:159]
  s_waitcnt lgkmcnt(6)
  v_mfma_f32_32x32x16_bf16 a[0:15], a[144:147], v[160:163], a[0:15]
  ds_read_b64_tr_b16 a[160:161], v39 offset:10240
  ds_read_b64_tr_b16 a[162:163], v39 offset:14336
  v_mfma_f32_32x32x16_bf16 a[64:79], a[144:147], v[176:179], a[64:79]
  s_waitcnt lgkmcnt(6)
  s_nop 2
  v_exp_f32 v128, v128
  s_nop 1
  v_exp_f32 v144, v144
  v_exp_f32 v129, v129
  v_mfma_f32_32x32x16_bf16 a[16:31], a[148:151], v[160:163], a[16:31]
  ds_read_b64_tr_b16 a[164:165], v39 offset:10496
  ds_read_b64_tr_b16 a[166:167], v39 offset:14592
  v_exp_f32 v145, v145
  v_add_f32 v224, v224, v128
  v_mfma_f32_32x32x16_bf16 a[80:95], a[148:151], v[176:179], a[80:95]
  s_waitcnt lgkmcnt(6)
  v_add_f32 v226, v226, v144
  v_add_f32 v225, v225, v129
  v_add_f32 v227, v227, v145
  v_cvt_pk_bf16_f32 v128, v128, v129
  v_cvt_pk_bf16_f32 v144, v144, v145
  v_mfma_f32_32x32x16_bf16 a[32:47], a[152:155], v[160:163], a[32:47]
  ds_read_b64_tr_b16 a[168:169], v39 offset:10752
  ds_read_b64_tr_b16 a[170:171], v39 offset:14848
  v_exp_f32 v130, v130
  v_mfma_f32_32x32x16_bf16 a[96:111], a[152:155], v[176:179], a[96:111]
  s_waitcnt lgkmcnt(6)
  v_exp_f32 v146, v146
  v_exp_f32 v131, v131
  v_exp_f32 v147, v147
  v_mfma_f32_32x32x16_bf16 a[48:63], a[156:159], v[160:163], a[48:63]
  ds_read_b64_tr_b16 a[172:173], v39 offset:11008
  ds_read_b64_tr_b16 a[174:175], v39 offset:15104
  v_add_f32 v224, v224, v130
  v_add_f32 v226, v226, v146
  v_add_f32 v225, v225, v131
  v_mfma_f32_32x32x16_bf16 a[112:127], a[156:159], v[176:179], a[112:127]
  s_waitcnt lgkmcnt(6)
  v_add_f32 v227, v227, v147
  v_cvt_pk_bf16_f32 v129, v130, v131
  v_cvt_pk_bf16_f32 v145, v146, v147
  s_waitcnt vmcnt(20)
  s_barrier
  v_mfma_f32_32x32x16_bf16 a[0:15], a[160:163], v[164:167], a[0:15]
  s_add_u32 s67, s64, 0
  ds_read_b128 a[144:147], v37 offset:16384
  s_add_u32 m0, s54, 0xc000
  s_nop 0
  buffer_load_dwordx4 v30, s[36:39], s67 offen lds
  v_exp_f32 v132, v132
  v_mfma_f32_32x32x16_bf16 a[64:79], a[160:163], v[180:183], a[64:79]
  s_waitcnt lgkmcnt(5)
  v_exp_f32 v148, v148
  v_exp_f32 v133, v133
  v_exp_f32 v149, v149
  v_mfma_f32_32x32x16_bf16 a[16:31], a[164:167], v[164:167], a[16:31]
  s_add_u32 m0, s54, 0xc400
  ds_read_b128 a[148:151], v37 offset:16640
  v_add_f32 v224, v224, v132
  v_add_f32 v226, v226, v148
  v_add_f32 v225, v225, v133
  v_add_f32 v227, v227, v149
  v_cvt_pk_bf16_f32 v130, v132, v133
  v_mfma_f32_32x32x16_bf16 a[80:95], a[164:167], v[180:183], a[80:95]
  s_waitcnt lgkmcnt(4)
  buffer_load_dwordx4 v31, s[36:39], s67 offen lds
  v_cvt_pk_bf16_f32 v146, v148, v149
  v_exp_f32 v134, v134
  v_exp_f32 v150, v150
  v_mfma_f32_32x32x16_bf16 a[32:47], a[168:171], v[164:167], a[32:47]
  ds_read_b128 a[152:155], v37 offset:16896
  v_exp_f32 v135, v135
  v_exp_f32 v151, v151
  v_add_f32 v224, v224, v134
  v_mfma_f32_32x32x16_bf16 a[96:111], a[168:171], v[180:183], a[96:111]
  s_waitcnt lgkmcnt(3)
  v_add_f32 v226, v226, v150
  v_add_f32 v225, v225, v135
  v_add_f32 v227, v227, v151
  v_cvt_pk_bf16_f32 v131, v134, v135
  v_cvt_pk_bf16_f32 v147, v150, v151
  s_add_u32 m0, s54, 0xc800
  v_mfma_f32_32x32x16_bf16 a[48:63], a[172:175], v[164:167], a[48:63]
  ds_read_b128 a[156:159], v37 offset:17152
  buffer_load_dwordx4 v32, s[36:39], s67 offen lds
  v_exp_f32 v136, v136
  v_mfma_f32_32x32x16_bf16 a[112:127], a[172:175], v[180:183], a[112:127]
  s_waitcnt lgkmcnt(3)
  v_exp_f32 v152, v152
  v_exp_f32 v137, v137
  v_exp_f32 v153, v153
  v_mfma_f32_32x32x16_bf16 v[160:175], a[144:147], v[64:67], v[192:207]
  s_add_u32 m0, s54, 0xcc00
  ds_read_b128 a[160:163], v37 offset:17408
  v_add_f32 v224, v224, v136
  v_add_f32 v226, v226, v152
  v_add_f32 v225, v225, v137
  v_add_f32 v227, v227, v153
  v_cvt_pk_bf16_f32 v132, v136, v137
  v_mfma_f32_32x32x16_bf16 v[176:191], a[144:147], v[96:99], v[208:223]
  s_waitcnt lgkmcnt(3)
  buffer_load_dwordx4 v33, s[36:39], s67 offen lds
  v_cvt_pk_bf16_f32 v148, v152, v153
  v_exp_f32 v138, v138
  v_exp_f32 v154, v154
  v_mfma_f32_32x32x16_bf16 v[160:175], a[148:151], v[68:71], v[160:175]
  ds_read_b128 a[164:167], v37 offset:17664
  v_exp_f32 v139, v139
  v_exp_f32 v155, v155
  v_add_f32 v224, v224, v138
  v_mfma_f32_32x32x16_bf16 v[176:191], a[148:151], v[100:103], v[176:191]
  s_waitcnt lgkmcnt(3)
  v_add_f32 v226, v226, v154
  v_add_f32 v225, v225, v139
  v_add_f32 v227, v227, v155
  v_cvt_pk_bf16_f32 v133, v138, v139
  v_cvt_pk_bf16_f32 v149, v154, v155
  v_mfma_f32_32x32x16_bf16 v[160:175], a[152:155], v[72:75], v[160:175]
  ds_read_b128 a[168:171], v37 offset:17920
  v_exp_f32 v140, v140
  v_exp_f32 v156, v156
  v_mfma_f32_32x32x16_bf16 v[176:191], a[152:155], v[104:107], v[176:191]
  s_waitcnt lgkmcnt(3)
  v_exp_f32 v141, v141
  v_exp_f32 v157, v157
  v_add_f32 v224, v224, v140
  v_add_f32 v226, v226, v156
  v_mfma_f32_32x32x16_bf16 v[160:175], a[156:159], v[76:79], v[160:175]
  ds_read_b128 a[172:175], v37 offset:18176
  v_add_f32 v225, v225, v141
  v_add_f32 v227, v227, v157
  v_cvt_pk_bf16_f32 v134, v140, v141
  v_cvt_pk_bf16_f32 v150, v156, v157
  v_mfma_f32_32x32x16_bf16 v[176:191], a[156:159], v[108:111], v[176:191]
  s_waitcnt lgkmcnt(3)
  v_exp_f32 v142, v142
  v_exp_f32 v158, v158
  v_exp_f32 v143, v143
  v_mfma_f32_32x32x16_bf16 v[160:175], a[160:163], v[80:83], v[160:175]
  ds_read_b64_tr_b16 a[144:145], v39 offset:18432
  ds_read_b64_tr_b16 a[146:147], v39 offset:22528
  v_exp_f32 v159, v159
  v_add_f32 v224, v224, v142
  v_mfma_f32_32x32x16_bf16 v[176:191], a[160:163], v[112:115], v[176:191]
  s_waitcnt lgkmcnt(4)
  v_add_f32 v226, v226, v158
  v_add_f32 v225, v225, v143
  v_add_f32 v227, v227, v159
  v_cvt_pk_bf16_f32 v135, v142, v143
  v_cvt_pk_bf16_f32 v151, v158, v159
  v_mfma_f32_32x32x16_bf16 v[160:175], a[164:167], v[84:87], v[160:175]
  ds_read_b64_tr_b16 a[148:149], v39 offset:18688
  ds_read_b64_tr_b16 a[150:151], v39 offset:22784
  v_mfma_f32_32x32x16_bf16 v[176:191], a[164:167], v[116:119], v[176:191]
  s_waitcnt lgkmcnt(5)
  v_mfma_f32_32x32x16_bf16 v[160:175], a[168:171], v[88:91], v[160:175]
  ds_read_b64_tr_b16 a[152:153], v39 offset:18944
  ds_read_b64_tr_b16 a[154:155], v39 offset:23040
  v_mfma_f32_32x32x16_bf16 v[176:191], a[168:171], v[120:123], v[176:191]
  s_waitcnt lgkmcnt(6)
  v_mfma_f32_32x32x16_bf16 v[160:175], a[172:175], v[92:95], v[160:175]
  ds_read_b64_tr_b16 a[156:157], v39 offset:19200
  ds_read_b64_tr_b16 a[158:159], v39 offset:23296
  v_mfma_f32_32x32x16_bf16 v[176:191], a[172:175], v[124:127], v[176:191]
  s_waitcnt lgkmcnt(6)
  v_mfma_f32_32x32x16_bf16 a[0:15], a[144:147], v[128:131], a[0:15]
  ds_read_b64_tr_b16 a[160:161], v39 offset:26624
  ds_read_b64_tr_b16 a[162:163], v39 offset:30720
  v_mfma_f32_32x32x16_bf16 a[64:79], a[144:147], v[144:147], a[64:79]
  s_waitcnt lgkmcnt(6)
  s_nop 2
  v_exp_f32 v160, v160
  s_nop 1
  v_exp_f32 v176, v176
  v_exp_f32 v161, v161
  v_mfma_f32_32x32x16_bf16 a[16:31], a[148:151], v[128:131], a[16:31]
  ds_read_b64_tr_b16 a[164:165], v39 offset:26880
  ds_read_b64_tr_b16 a[166:167], v39 offset:30976
  v_exp_f32 v177, v177
  v_add_f32 v224, v224, v160
  v_mfma_f32_32x32x16_bf16 a[80:95], a[148:151], v[144:147], a[80:95]
  s_waitcnt lgkmcnt(6)
  v_add_f32 v226, v226, v176
  v_add_f32 v225, v225, v161
  v_add_f32 v227, v227, v177
  v_cvt_pk_bf16_f32 v160, v160, v161
  v_cvt_pk_bf16_f32 v176, v176, v177
  v_mfma_f32_32x32x16_bf16 a[32:47], a[152:155], v[128:131], a[32:47]
  ds_read_b64_tr_b16 a[168:169], v39 offset:27136
  ds_read_b64_tr_b16 a[170:171], v39 offset:31232
  v_exp_f32 v162, v162
  v_mfma_f32_32x32x16_bf16 a[96:111], a[152:155], v[144:147], a[96:111]
  s_waitcnt lgkmcnt(6)
  v_exp_f32 v178, v178
  v_exp_f32 v163, v163
  v_exp_f32 v179, v179
  v_mfma_f32_32x32x16_bf16 a[48:63], a[156:159], v[128:131], a[48:63]
  ds_read_b64_tr_b16 a[172:173], v39 offset:27392
  ds_read_b64_tr_b16 a[174:175], v39 offset:31488
  v_add_f32 v224, v224, v162
  v_add_f32 v226, v226, v178
  v_add_f32 v225, v225, v163
  v_mfma_f32_32x32x16_bf16 a[112:127], a[156:159], v[144:147], a[112:127]
  s_waitcnt lgkmcnt(6)
  v_add_f32 v227, v227, v179
  v_cvt_pk_bf16_f32 v161, v162, v163
  v_cvt_pk_bf16_f32 v177, v178, v179
  s_waitcnt vmcnt(20)
  s_barrier
  v_mfma_f32_32x32x16_bf16 a[0:15], a[160:163], v[132:135], a[0:15]
  s_add_u32 s67, s64, 0x24000
  ds_read_b128 a[144:147], v37 offset:32768
  s_add_u32 m0, s54, 0x10000
  s_nop 0
  buffer_load_dwordx4 v30, s[36:39], s67 offen lds
  v_exp_f32 v164, v164
  v_mfma_f32_32x32x16_bf16 a[64:79], a[160:163], v[148:151], a[64:79]
  s_waitcnt lgkmcnt(5)
  v_exp_f32 v180, v180
  v_exp_f32 v165, v165
  v_exp_f32 v181, v181
  v_mfma_f32_32x32x16_bf16 a[16:31], a[164:167], v[132:135], a[16:31]
  s_add_u32 m0, s54, 0x10400
  ds_read_b128 a[148:151], v37 offset:33024
  v_add_f32 v224, v224, v164
  v_add_f32 v226, v226, v180
  v_add_f32 v225, v225, v165
  v_add_f32 v227, v227, v181
  v_cvt_pk_bf16_f32 v162, v164, v165
  v_mfma_f32_32x32x16_bf16 a[80:95], a[164:167], v[148:151], a[80:95]
  s_waitcnt lgkmcnt(4)
  buffer_load_dwordx4 v31, s[36:39], s67 offen lds
  v_cvt_pk_bf16_f32 v178, v180, v181
  v_exp_f32 v166, v166
  v_exp_f32 v182, v182
  v_mfma_f32_32x32x16_bf16 a[32:47], a[168:171], v[132:135], a[32:47]
  ds_read_b128 a[152:155], v37 offset:33280
  v_exp_f32 v167, v167
  v_exp_f32 v183, v183
  v_add_f32 v224, v224, v166
  v_mfma_f32_32x32x16_bf16 a[96:111], a[168:171], v[148:151], a[96:111]
  s_waitcnt lgkmcnt(3)
  v_add_f32 v226, v226, v182
  v_add_f32 v225, v225, v167
  v_add_f32 v227, v227, v183
  v_cvt_pk_bf16_f32 v163, v166, v167
  v_cvt_pk_bf16_f32 v179, v182, v183
  s_add_u32 m0, s54, 0x10800
  v_mfma_f32_32x32x16_bf16 a[48:63], a[172:175], v[132:135], a[48:63]
  ds_read_b128 a[156:159], v37 offset:33536
  buffer_load_dwordx4 v32, s[36:39], s67 offen lds
  v_exp_f32 v168, v168
  v_mfma_f32_32x32x16_bf16 a[112:127], a[172:175], v[148:151], a[112:127]
  s_waitcnt lgkmcnt(3)
  v_exp_f32 v184, v184
  v_exp_f32 v169, v169
  v_exp_f32 v185, v185
  v_mfma_f32_32x32x16_bf16 v[128:143], a[144:147], v[64:67], v[192:207]
  s_add_u32 m0, s54, 0x10c00
  ds_read_b128 a[160:163], v37 offset:33792
  v_add_f32 v224, v224, v168
  v_add_f32 v226, v226, v184
  v_add_f32 v225, v225, v169
  v_add_f32 v227, v227, v185
  v_cvt_pk_bf16_f32 v164, v168, v169
  v_mfma_f32_32x32x16_bf16 v[144:159], a[144:147], v[96:99], v[208:223]
  s_waitcnt lgkmcnt(3)
  buffer_load_dwordx4 v33, s[36:39], s67 offen lds
  v_cvt_pk_bf16_f32 v180, v184, v185
  v_exp_f32 v170, v170
  v_exp_f32 v186, v186
  v_mfma_f32_32x32x16_bf16 v[128:143], a[148:151], v[68:71], v[128:143]
  ds_read_b128 a[164:167], v37 offset:34048
  v_exp_f32 v171, v171
  v_exp_f32 v187, v187
  v_add_f32 v224, v224, v170
  v_mfma_f32_32x32x16_bf16 v[144:159], a[148:151], v[100:103], v[144:159]
  s_waitcnt lgkmcnt(3)
  v_add_f32 v226, v226, v186
  v_add_f32 v225, v225, v171
  v_add_f32 v227, v227, v187
  v_cvt_pk_bf16_f32 v165, v170, v171
  v_cvt_pk_bf16_f32 v181, v186, v187
  v_mfma_f32_32x32x16_bf16 v[128:143], a[152:155], v[72:75], v[128:143]
  ds_read_b128 a[168:171], v37 offset:34304
  v_exp_f32 v172, v172
  v_exp_f32 v188, v188
  v_mfma_f32_32x32x16_bf16 v[144:159], a[152:155], v[104:107], v[144:159]
  s_waitcnt lgkmcnt(3)
  v_exp_f32 v173, v173
  v_exp_f32 v189, v189
  v_add_f32 v224, v224, v172
  v_add_f32 v226, v226, v188
  v_mfma_f32_32x32x16_bf16 v[128:143], a[156:159], v[76:79], v[128:143]
  ds_read_b128 a[172:175], v37 offset:34560
  v_add_f32 v225, v225, v173
  v_add_f32 v227, v227, v189
  v_cvt_pk_bf16_f32 v166, v172, v173
  v_cvt_pk_bf16_f32 v182, v188, v189
  v_mfma_f32_32x32x16_bf16 v[144:159], a[156:159], v[108:111], v[144:159]
  s_waitcnt lgkmcnt(3)
  v_exp_f32 v174, v174
  v_exp_f32 v190, v190
  v_exp_f32 v175, v175
  v_mfma_f32_32x32x16_bf16 v[128:143], a[160:163], v[80:83], v[128:143]
  ds_read_b64_tr_b16 a[144:145], v39 offset:34816
  ds_read_b64_tr_b16 a[146:147], v39 offset:38912
  v_exp_f32 v191, v191
  v_add_f32 v224, v224, v174
  v_mfma_f32_32x32x16_bf16 v[144:159], a[160:163], v[112:115], v[144:159]
  s_waitcnt lgkmcnt(4)
  v_add_f32 v226, v226, v190
  v_add_f32 v225, v225, v175
  v_add_f32 v227, v227, v191
  v_cvt_pk_bf16_f32 v167, v174, v175
  v_cvt_pk_bf16_f32 v183, v190, v191
  v_mfma_f32_32x32x16_bf16 v[128:143], a[164:167], v[84:87], v[128:143]
  ds_read_b64_tr_b16 a[148:149], v39 offset:35072
  ds_read_b64_tr_b16 a[150:151], v39 offset:39168
  v_mfma_f32_32x32x16_bf16 v[144:159], a[164:167], v[116:119], v[144:159]
  s_waitcnt lgkmcnt(5)
  v_mfma_f32_32x32x16_bf16 v[128:143], a[168:171], v[88:91], v[128:143]
  ds_read_b64_tr_b16 a[152:153], v39 offset:35328
  ds_read_b64_tr_b16 a[154:155], v39 offset:39424
  v_mfma_f32_32x32x16_bf16 v[144:159], a[168:171], v[120:123], v[144:159]
  s_waitcnt lgkmcnt(6)
  v_mfma_f32_32x32x16_bf16 v[128:143], a[172:175], v[92:95], v[128:143]
  ds_read_b64_tr_b16 a[156:157], v39 offset:35584
  ds_read_b64_tr_b16 a[158:159], v39 offset:39680
  v_mfma_f32_32x32x16_bf16 v[144:159], a[172:175], v[124:127], v[144:159]
  s_waitcnt lgkmcnt(6)
  v_mfma_f32_32x32x16_bf16 a[0:15], a[144:147], v[160:163], a[0:15]
  ds_read_b64_tr_b16 a[160:161], v39 offset:43008
  ds_read_b64_tr_b16 a[162:163], v39 offset:47104
  v_mfma_f32_32x32x16_bf16 a[64:79], a[144:147], v[176:179], a[64:79]
  s_waitcnt lgkmcnt(6)
  s_nop 2
  v_exp_f32 v128, v128
  s_nop 1
  v_exp_f32 v144, v144
  v_exp_f32 v129, v129
  v_mfma_f32_32x32x16_bf16 a[16:31], a[148:151], v[160:163], a[16:31]
  ds_read_b64_tr_b16 a[164:165], v39 offset:43264
  ds_read_b64_tr_b16 a[166:167], v39 offset:47360
  v_exp_f32 v145, v145
  v_add_f32 v224, v224, v128
  v_mfma_f32_32x32x16_bf16 a[80:95], a[148:151], v[176:179], a[80:95]
  s_waitcnt lgkmcnt(6)
  v_add_f32 v226, v226, v144
  v_add_f32 v225, v225, v129
  v_add_f32 v227, v227, v145
  v_cvt_pk_bf16_f32 v128, v128, v129
  v_cvt_pk_bf16_f32 v144, v144, v145
  v_mfma_f32_32x32x16_bf16 a[32:47], a[152:155], v[160:163], a[32:47]
  ds_read_b64_tr_b16 a[168:169], v39 offset:43520
  ds_read_b64_tr_b16 a[170:171], v39 offset:47616
  v_exp_f32 v130, v130
  v_mfma_f32_32x32x16_bf16 a[96:111], a[152:155], v[176:179], a[96:111]
  s_waitcnt lgkmcnt(6)
  v_exp_f32 v146, v146
  v_exp_f32 v131, v131
  v_exp_f32 v147, v147
  v_mfma_f32_32x32x16_bf16 a[48:63], a[156:159], v[160:163], a[48:63]
  ds_read_b64_tr_b16 a[172:173], v39 offset:43776
  ds_read_b64_tr_b16 a[174:175], v39 offset:47872
  v_add_f32 v224, v224, v130
  v_add_f32 v226, v226, v146
  v_add_f32 v225, v225, v131
  v_mfma_f32_32x32x16_bf16 a[112:127], a[156:159], v[176:179], a[112:127]
  s_waitcnt lgkmcnt(6)
  v_add_f32 v227, v227, v147
  v_cvt_pk_bf16_f32 v129, v130, v131
  v_cvt_pk_bf16_f32 v145, v146, v147
  s_waitcnt vmcnt(20)
  s_barrier
  v_mfma_f32_32x32x16_bf16 a[0:15], a[160:163], v[164:167], a[0:15]
  s_add_u32 s67, s64, 0x80
  ds_read_b128 a[144:147], v37 offset:49152
  s_add_u32 m0, s54, 0x14000
  s_nop 0
  buffer_load_dwordx4 v30, s[36:39], s67 offen lds
  v_exp_f32 v132, v132
  v_mfma_f32_32x32x16_bf16 a[64:79], a[160:163], v[180:183], a[64:79]
  s_waitcnt lgkmcnt(5)
  v_exp_f32 v148, v148
  v_exp_f32 v133, v133
  v_exp_f32 v149, v149
  v_mfma_f32_32x32x16_bf16 a[16:31], a[164:167], v[164:167], a[16:31]
  s_add_u32 m0, s54, 0x14400
  ds_read_b128 a[148:151], v37 offset:49408
  v_add_f32 v224, v224, v132
  v_add_f32 v226, v226, v148
  v_add_f32 v225, v225, v133
  v_add_f32 v227, v227, v149
  v_cvt_pk_bf16_f32 v130, v132, v133
  v_mfma_f32_32x32x16_bf16 a[80:95], a[164:167], v[180:183], a[80:95]
  s_waitcnt lgkmcnt(4)
  buffer_load_dwordx4 v31, s[36:39], s67 offen lds
  v_cvt_pk_bf16_f32 v146, v148, v149
  v_exp_f32 v134, v134
  v_exp_f32 v150, v150
  v_mfma_f32_32x32x16_bf16 a[32:47], a[168:171], v[164:167], a[32:47]
  ds_read_b128 a[152:155], v37 offset:49664
  v_exp_f32 v135, v135
  v_exp_f32 v151, v151
  v_add_f32 v224, v224, v134
  v_mfma_f32_32x32x16_bf16 a[96:111], a[168:171], v[180:183], a[96:111]
  s_waitcnt lgkmcnt(3)
  v_add_f32 v226, v226, v150
  v_add_f32 v225, v225, v135
  v_add_f32 v227, v227, v151
  v_cvt_pk_bf16_f32 v131, v134, v135
  v_cvt_pk_bf16_f32 v147, v150, v151
  s_add_u32 m0, s54, 0x14800
  v_mfma_f32_32x32x16_bf16 a[48:63], a[172:175], v[164:167], a[48:63]
  ds_read_b128 a[156:159], v37 offset:49920
  buffer_load_dwordx4 v32, s[36:39], s67 offen lds
  v_exp_f32 v136, v136
  v_mfma_f32_32x32x16_bf16 a[112:127], a[172:175], v[180:183], a[112:127]
  s_waitcnt lgkmcnt(3)
  v_exp_f32 v152, v152
  v_exp_f32 v137, v137
  v_exp_f32 v153, v153
  v_mfma_f32_32x32x16_bf16 v[160:175], a[144:147], v[64:67], v[192:207]
  s_add_u32 m0, s54, 0x14c00
  ds_read_b128 a[160:163], v37 offset:50176
  v_add_f32 v224, v224, v136
  v_add_f32 v226, v226, v152
  v_add_f32 v225, v225, v137
  v_add_f32 v227, v227, v153
  v_cvt_pk_bf16_f32 v132, v136, v137
  v_mfma_f32_32x32x16_bf16 v[176:191], a[144:147], v[96:99], v[208:223]
  s_waitcnt lgkmcnt(3)
  buffer_load_dwordx4 v33, s[36:39], s67 offen lds
  v_cvt_pk_bf16_f32 v148, v152, v153
  v_exp_f32 v138, v138
  v_exp_f32 v154, v154
  v_mfma_f32_32x32x16_bf16 v[160:175], a[148:151], v[68:71], v[160:175]
  ds_read_b128 a[164:167], v37 offset:50432
  v_exp_f32 v139, v139
  v_exp_f32 v155, v155
  v_add_f32 v224, v224, v138
  v_mfma_f32_32x32x16_bf16 v[176:191], a[148:151], v[100:103], v[176:191]
  s_waitcnt lgkmcnt(3)
  v_add_f32 v226, v226, v154
  v_add_f32 v225, v225, v139
  v_add_f32 v227, v227, v155
  v_cvt_pk_bf16_f32 v133, v138, v139
  v_cvt_pk_bf16_f32 v149, v154, v155
  v_mfma_f32_32x32x16_bf16 v[160:175], a[152:155], v[72:75], v[160:175]
  ds_read_b128 a[168:171], v37 offset:50688
  v_exp_f32 v140, v140
  v_exp_f32 v156, v156
  v_mfma_f32_32x32x16_bf16 v[176:191], a[152:155], v[104:107], v[176:191]
  s_waitcnt lgkmcnt(3)
  v_exp_f32 v141, v141
  v_exp_f32 v157, v157
  v_add_f32 v224, v224, v140
  v_add_f32 v226, v226, v156
  v_mfma_f32_32x32x16_bf16 v[160:175], a[156:159], v[76:79], v[160:175]
  ds_read_b128 a[172:175], v37 offset:50944
  v_add_f32 v225, v225, v141
  v_add_f32 v227, v227, v157
  v_cvt_pk_bf16_f32 v134, v140, v141
  v_cvt_pk_bf16_f32 v150, v156, v157
  v_mfma_f32_32x32x16_bf16 v[176:191], a[156:159], v[108:111], v[176:191]
  s_waitcnt lgkmcnt(3)
  v_exp_f32 v142, v142
  v_exp_f32 v158, v158
  v_exp_f32 v143, v143
  v_mfma_f32_32x32x16_bf16 v[160:175], a[160:163], v[80:83], v[160:175]
  ds_read_b64_tr_b16 a[144:145], v39 offset:51200
  ds_read_b64_tr_b16 a[146:147], v39 offset:55296
  v_exp_f32 v159, v159
  v_add_f32 v224, v224, v142
  v_mfma_f32_32x32x16_bf16 v[176:191], a[160:163], v[112:115], v[176:191]
  s_waitcnt lgkmcnt(4)
  v_add_f32 v226, v226, v158
  v_add_f32 v225, v225, v143
  v_add_f32 v227, v227, v159
  v_cvt_pk_bf16_f32 v135, v142, v143
  v_cvt_pk_bf16_f32 v151, v158, v159
  v_mfma_f32_32x32x16_bf16 v[160:175], a[164:167], v[84:87], v[160:175]
  ds_read_b64_tr_b16 a[148:149], v39 offset:51456
  ds_read_b64_tr_b16 a[150:151], v39 offset:55552
  v_mfma_f32_32x32x16_bf16 v[176:191], a[164:167], v[116:119], v[176:191]
  s_waitcnt lgkmcnt(5)
  v_mfma_f32_32x32x16_bf16 v[160:175], a[168:171], v[88:91], v[160:175]
  ds_read_b64_tr_b16 a[152:153], v39 offset:51712
  ds_read_b64_tr_b16 a[154:155], v39 offset:55808
  v_mfma_f32_32x32x16_bf16 v[176:191], a[168:171], v[120:123], v[176:191]
  s_waitcnt lgkmcnt(6)
  v_mfma_f32_32x32x16_bf16 v[160:175], a[172:175], v[92:95], v[160:175]
  ds_read_b64_tr_b16 a[156:157], v39 offset:51968
  ds_read_b64_tr_b16 a[158:159], v39 offset:56064
  v_mfma_f32_32x32x16_bf16 v[176:191], a[172:175], v[124:127], v[176:191]
  s_waitcnt lgkmcnt(6)
  v_mfma_f32_32x32x16_bf16 a[0:15], a[144:147], v[128:131], a[0:15]
  ds_read_b64_tr_b16 a[160:161], v39 offset:59392
  ds_read_b64_tr_b16 a[162:163], v39 offset:63488
  v_mfma_f32_32x32x16_bf16 a[64:79], a[144:147], v[144:147], a[64:79]
  s_waitcnt lgkmcnt(6)
  s_nop 2
  v_exp_f32 v160, v160
  s_nop 1
  v_exp_f32 v176, v176
  v_exp_f32 v161, v161
  v_mfma_f32_32x32x16_bf16 a[16:31], a[148:151], v[128:131], a[16:31]
  ds_read_b64_tr_b16 a[164:165], v39 offset:59648
  ds_read_b64_tr_b16 a[166:167], v39 offset:63744
  v_exp_f32 v177, v177
  v_add_f32 v224, v224, v160
  v_mfma_f32_32x32x16_bf16 a[80:95], a[148:151], v[144:147], a[80:95]
  s_waitcnt lgkmcnt(6)
  v_add_f32 v226, v226, v176
  v_add_f32 v225, v225, v161
  v_add_f32 v227, v227, v177
  v_cvt_pk_bf16_f32 v160, v160, v161
  v_cvt_pk_bf16_f32 v176, v176, v177
  v_mfma_f32_32x32x16_bf16 a[32:47], a[152:155], v[128:131], a[32:47]
  ds_read_b64_tr_b16 a[168:169], v39 offset:59904
  ds_read_b64_tr_b16 a[170:171], v39 offset:64000
  v_exp_f32 v162, v162
  v_mfma_f32_32x32x16_bf16 a[96:111], a[152:155], v[144:147], a[96:111]
  s_waitcnt lgkmcnt(6)
  v_exp_f32 v178, v178
  v_exp_f32 v163, v163
  v_exp_f32 v179, v179
  v_mfma_f32_32x32x16_bf16 a[48:63], a[156:159], v[128:131], a[48:63]
  ds_read_b64_tr_b16 a[172:173], v39 offset:60160
  ds_read_b64_tr_b16 a[174:175], v39 offset:64256
  v_add_f32 v224, v224, v162
  v_add_f32 v226, v226, v178
  v_add_f32 v225, v225, v163
  v_mfma_f32_32x32x16_bf16 a[112:127], a[156:159], v[144:147], a[112:127]
  s_waitcnt lgkmcnt(6)
  v_add_f32 v227, v227, v179
  v_cvt_pk_bf16_f32 v161, v162, v163
  v_cvt_pk_bf16_f32 v177, v178, v179
  s_waitcnt vmcnt(20)
  s_barrier
  v_mfma_f32_32x32x16_bf16 a[0:15], a[160:163], v[132:135], a[0:15]
  s_add_u32 s67, s64, 0x24080
  ds_read_b128 a[144:147], v36
  s_add_u32 m0, s54, 0x18000
  s_nop 0
  buffer_load_dwordx4 v30, s[36:39], s67 offen lds
  v_exp_f32 v164, v164
  v_mfma_f32_32x32x16_bf16 a[64:79], a[160:163], v[148:151], a[64:79]
  s_waitcnt lgkmcnt(5)
  v_exp_f32 v180, v180
  v_exp_f32 v165, v165
  v_exp_f32 v181, v181
  v_mfma_f32_32x32x16_bf16 a[16:31], a[164:167], v[132:135], a[16:31]
  s_add_u32 m0, s54, 0x18400
  ds_read_b128 a[148:151], v36 offset:256
  v_add_f32 v224, v224, v164
  v_add_f32 v226, v226, v180
  v_add_f32 v225, v225, v165
  v_add_f32 v227, v227, v181
  v_cvt_pk_bf16_f32 v162, v164, v165
  v_mfma_f32_32x32x16_bf16 a[80:95], a[164:167], v[148:151], a[80:95]
  s_waitcnt lgkmcnt(4)
  buffer_load_dwordx4 v31, s[36:39], s67 offen lds
  v_cvt_pk_bf16_f32 v178, v180, v181
  v_exp_f32 v166, v166
  v_exp_f32 v182, v182
  v_mfma_f32_32x32x16_bf16 a[32:47], a[168:171], v[132:135], a[32:47]
  ds_read_b128 a[152:155], v36 offset:512
  v_exp_f32 v167, v167
  v_exp_f32 v183, v183
  v_add_f32 v224, v224, v166
  v_mfma_f32_32x32x16_bf16 a[96:111], a[168:171], v[148:151], a[96:111]
  s_waitcnt lgkmcnt(3)
  v_add_f32 v226, v226, v182
  v_add_f32 v225, v225, v167
  v_add_f32 v227, v227, v183
  v_cvt_pk_bf16_f32 v163, v166, v167
  v_cvt_pk_bf16_f32 v179, v182, v183
  s_add_u32 m0, s54, 0x18800
  v_mfma_f32_32x32x16_bf16 a[48:63], a[172:175], v[132:135], a[48:63]
  ds_read_b128 a[156:159], v36 offset:768
  buffer_load_dwordx4 v32, s[36:39], s67 offen lds
  v_exp_f32 v168, v168
  v_mfma_f32_32x32x16_bf16 a[112:127], a[172:175], v[148:151], a[112:127]
  s_waitcnt lgkmcnt(3)
  v_exp_f32 v184, v184
  v_exp_f32 v169, v169
  v_exp_f32 v185, v185
  v_mfma_f32_32x32x16_bf16 v[128:143], a[144:147], v[64:67], v[192:207]
  s_add_u32 m0, s54, 0x18c00
  ds_read_b128 a[160:163], v36 offset:1024
  v_add_f32 v224, v224, v168
  v_add_f32 v226, v226, v184
  v_add_f32 v225, v225, v169
  v_add_f32 v227, v227, v185
  v_cvt_pk_bf16_f32 v164, v168, v169
  v_mfma_f32_32x32x16_bf16 v[144:159], a[144:147], v[96:99], v[208:223]
  s_waitcnt lgkmcnt(3)
  buffer_load_dwordx4 v33, s[36:39], s67 offen lds
  v_cvt_pk_bf16_f32 v180, v184, v185
  v_exp_f32 v170, v170
  v_exp_f32 v186, v186
  v_mfma_f32_32x32x16_bf16 v[128:143], a[148:151], v[68:71], v[128:143]
  ds_read_b128 a[164:167], v36 offset:1280
  v_exp_f32 v171, v171
  v_exp_f32 v187, v187
  v_add_f32 v224, v224, v170
  v_mfma_f32_32x32x16_bf16 v[144:159], a[148:151], v[100:103], v[144:159]
  s_waitcnt lgkmcnt(3)
  v_add_f32 v226, v226, v186
  v_add_f32 v225, v225, v171
  v_add_f32 v227, v227, v187
  v_cvt_pk_bf16_f32 v165, v170, v171
  v_cvt_pk_bf16_f32 v181, v186, v187
  v_mfma_f32_32x32x16_bf16 v[128:143], a[152:155], v[72:75], v[128:143]
  ds_read_b128 a[168:171], v36 offset:1536
  v_exp_f32 v172, v172
  v_exp_f32 v188, v188
  v_mfma_f32_32x32x16_bf16 v[144:159], a[152:155], v[104:107], v[144:159]
  s_waitcnt lgkmcnt(3)
  v_exp_f32 v173, v173
  v_exp_f32 v189, v189
  v_add_f32 v224, v224, v172
  v_add_f32 v226, v226, v188
  v_mfma_f32_32x32x16_bf16 v[128:143], a[156:159], v[76:79], v[128:143]
  ds_read_b128 a[172:175], v36 offset:1792
  v_add_f32 v225, v225, v173
  v_add_f32 v227, v227, v189
  v_cvt_pk_bf16_f32 v166, v172, v173
  v_cvt_pk_bf16_f32 v182, v188, v189
  v_mfma_f32_32x32x16_bf16 v[144:159], a[156:159], v[108:111], v[144:159]
  s_waitcnt lgkmcnt(3)
  v_exp_f32 v174, v174
  v_exp_f32 v190, v190
  v_exp_f32 v175, v175
  v_mfma_f32_32x32x16_bf16 v[128:143], a[160:163], v[80:83], v[128:143]
  ds_read_b64_tr_b16 a[144:145], v38 offset:2048
  ds_read_b64_tr_b16 a[146:147], v38 offset:6144
  v_exp_f32 v191, v191
  v_add_f32 v224, v224, v174
  v_mfma_f32_32x32x16_bf16 v[144:159], a[160:163], v[112:115], v[144:159]
  s_waitcnt lgkmcnt(4)
  v_add_f32 v226, v226, v190
  v_add_f32 v225, v225, v175
  v_add_f32 v227, v227, v191
  v_cvt_pk_bf16_f32 v167, v174, v175
  v_cvt_pk_bf16_f32 v183, v190, v191
  v_mfma_f32_32x32x16_bf16 v[128:143], a[164:167], v[84:87], v[128:143]
  ds_read_b64_tr_b16 a[148:149], v38 offset:2304
  ds_read_b64_tr_b16 a[150:151], v38 offset:6400
  v_mfma_f32_32x32x16_bf16 v[144:159], a[164:167], v[116:119], v[144:159]
  s_waitcnt lgkmcnt(5)
  v_mfma_f32_32x32x16_bf16 v[128:143], a[168:171], v[88:91], v[128:143]
  ds_read_b64_tr_b16 a[152:153], v38 offset:2560
  ds_read_b64_tr_b16 a[154:155], v38 offset:6656
  v_mfma_f32_32x32x16_bf16 v[144:159], a[168:171], v[120:123], v[144:159]
  s_waitcnt lgkmcnt(6)
  v_mfma_f32_32x32x16_bf16 v[128:143], a[172:175], v[92:95], v[128:143]
  ds_read_b64_tr_b16 a[156:157], v38 offset:2816
  ds_read_b64_tr_b16 a[158:159], v38 offset:6912
  v_mfma_f32_32x32x16_bf16 v[144:159], a[172:175], v[124:127], v[144:159]
  s_waitcnt lgkmcnt(6)
  v_mfma_f32_32x32x16_bf16 a[0:15], a[144:147], v[160:163], a[0:15]
  ds_read_b64_tr_b16 a[160:161], v38 offset:10240
  ds_read_b64_tr_b16 a[162:163], v38 offset:14336
  v_mfma_f32_32x32x16_bf16 a[64:79], a[144:147], v[176:179], a[64:79]
  s_waitcnt lgkmcnt(6)
  s_nop 2
  v_exp_f32 v128, v128
  s_nop 1
  v_exp_f32 v144, v144
  v_exp_f32 v129, v129
  v_mfma_f32_32x32x16_bf16 a[16:31], a[148:151], v[160:163], a[16:31]
  ds_read_b64_tr_b16 a[164:165], v38 offset:10496
  ds_read_b64_tr_b16 a[166:167], v38 offset:14592
  v_exp_f32 v145, v145
  v_add_f32 v224, v224, v128
  v_mfma_f32_32x32x16_bf16 a[80:95], a[148:151], v[176:179], a[80:95]
  s_waitcnt lgkmcnt(6)
  v_add_f32 v226, v226, v144
  v_add_f32 v225, v225, v129
  v_add_f32 v227, v227, v145
  v_cvt_pk_bf16_f32 v128, v128, v129
  v_cvt_pk_bf16_f32 v144, v144, v145
  v_mfma_f32_32x32x16_bf16 a[32:47], a[152:155], v[160:163], a[32:47]
  ds_read_b64_tr_b16 a[168:169], v38 offset:10752
  ds_read_b64_tr_b16 a[170:171], v38 offset:14848
  v_exp_f32 v130, v130
  v_mfma_f32_32x32x16_bf16 a[96:111], a[152:155], v[176:179], a[96:111]
  s_waitcnt lgkmcnt(6)
  v_exp_f32 v146, v146
  v_exp_f32 v131, v131
  v_exp_f32 v147, v147
  v_mfma_f32_32x32x16_bf16 a[48:63], a[156:159], v[160:163], a[48:63]
  ds_read_b64_tr_b16 a[172:173], v38 offset:11008
  ds_read_b64_tr_b16 a[174:175], v38 offset:15104
  v_add_f32 v224, v224, v130
  v_add_f32 v226, v226, v146
  v_add_f32 v225, v225, v131
  v_mfma_f32_32x32x16_bf16 a[112:127], a[156:159], v[176:179], a[112:127]
  s_waitcnt lgkmcnt(6)
  v_add_f32 v227, v227, v147
  v_cvt_pk_bf16_f32 v129, v130, v131
  v_cvt_pk_bf16_f32 v145, v146, v147
  s_waitcnt vmcnt(20)
  s_barrier
  v_mfma_f32_32x32x16_bf16 a[0:15], a[160:163], v[164:167], a[0:15]
  s_add_u32 s67, s64, 0x100
  ds_read_b128 a[144:147], v36 offset:16384
  s_add_u32 m0, s54, 0x1c000
  s_nop 0
  buffer_load_dwordx4 v30, s[36:39], s67 offen lds
  v_exp_f32 v132, v132
  v_mfma_f32_32x32x16_bf16 a[64:79], a[160:163], v[180:183], a[64:79]
  s_waitcnt lgkmcnt(5)
  v_exp_f32 v148, v148
  v_exp_f32 v133, v133
  v_exp_f32 v149, v149
  v_mfma_f32_32x32x16_bf16 a[16:31], a[164:167], v[164:167], a[16:31]
  s_add_u32 m0, s54, 0x1c400
  ds_read_b128 a[148:151], v36 offset:16640
  v_add_f32 v224, v224, v132
  v_add_f32 v226, v226, v148
  v_add_f32 v225, v225, v133
  v_add_f32 v227, v227, v149
  v_cvt_pk_bf16_f32 v130, v132, v133
  v_mfma_f32_32x32x16_bf16 a[80:95], a[164:167], v[180:183], a[80:95]
  s_waitcnt lgkmcnt(4)
  buffer_load_dwordx4 v31, s[36:39], s67 offen lds
  v_cvt_pk_bf16_f32 v146, v148, v149
  v_exp_f32 v134, v134
  v_exp_f32 v150, v150
  v_mfma_f32_32x32x16_bf16 a[32:47], a[168:171], v[164:167], a[32:47]
  ds_read_b128 a[152:155], v36 offset:16896
  v_exp_f32 v135, v135
  v_exp_f32 v151, v151
  v_add_f32 v224, v224, v134
  v_mfma_f32_32x32x16_bf16 a[96:111], a[168:171], v[180:183], a[96:111]
  s_waitcnt lgkmcnt(3)
  v_add_f32 v226, v226, v150
  v_add_f32 v225, v225, v135
  v_add_f32 v227, v227, v151
  v_cvt_pk_bf16_f32 v131, v134, v135
  v_cvt_pk_bf16_f32 v147, v150, v151
  s_add_u32 m0, s54, 0x1c800
  v_mfma_f32_32x32x16_bf16 a[48:63], a[172:175], v[164:167], a[48:63]
  ds_read_b128 a[156:159], v36 offset:17152
  buffer_load_dwordx4 v32, s[36:39], s67 offen lds
  v_exp_f32 v136, v136
  v_mfma_f32_32x32x16_bf16 a[112:127], a[172:175], v[180:183], a[112:127]
  s_waitcnt lgkmcnt(3)
  v_exp_f32 v152, v152
  v_exp_f32 v137, v137
  v_exp_f32 v153, v153
  v_mfma_f32_32x32x16_bf16 v[160:175], a[144:147], v[64:67], v[192:207]
  s_add_u32 m0, s54, 0x1cc00
  ds_read_b128 a[160:163], v36 offset:17408
  v_add_f32 v224, v224, v136
  v_add_f32 v226, v226, v152
  v_add_f32 v225, v225, v137
  v_add_f32 v227, v227, v153
  v_cvt_pk_bf16_f32 v132, v136, v137
  v_mfma_f32_32x32x16_bf16 v[176:191], a[144:147], v[96:99], v[208:223]
  s_waitcnt lgkmcnt(3)
  buffer_load_dwordx4 v33, s[36:39], s67 offen lds
  v_cvt_pk_bf16_f32 v148, v152, v153
  v_exp_f32 v138, v138
  v_exp_f32 v154, v154
  v_mfma_f32_32x32x16_bf16 v[160:175], a[148:151], v[68:71], v[160:175]
  ds_read_b128 a[164:167], v36 offset:17664
  v_exp_f32 v139, v139
  v_exp_f32 v155, v155
  v_add_f32 v224, v224, v138
  v_mfma_f32_32x32x16_bf16 v[176:191], a[148:151], v[100:103], v[176:191]
  s_waitcnt lgkmcnt(3)
  v_add_f32 v226, v226, v154
  v_add_f32 v225, v225, v139
  v_add_f32 v227, v227, v155
  v_cvt_pk_bf16_f32 v133, v138, v139
  v_cvt_pk_bf16_f32 v149, v154, v155
  v_mfma_f32_32x32x16_bf16 v[160:175], a[152:155], v[72:75], v[160:175]
  ds_read_b128 a[168:171], v36 offset:17920
  v_exp_f32 v140, v140
  v_exp_f32 v156, v156
  v_mfma_f32_32x32x16_bf16 v[176:191], a[152:155], v[104:107], v[176:191]
  s_waitcnt lgkmcnt(3)
  v_exp_f32 v141, v141
  v_exp_f32 v157, v157
  v_add_f32 v224, v224, v140
  v_add_f32 v226, v226, v156
  v_mfma_f32_32x32x16_bf16 v[160:175], a[156:159], v[76:79], v[160:175]
  ds_read_b128 a[172:175], v36 offset:18176
  v_add_f32 v225, v225, v141
  v_add_f32 v227, v227, v157
  v_cvt_pk_bf16_f32 v134, v140, v141
  v_cvt_pk_bf16_f32 v150, v156, v157
  v_mfma_f32_32x32x16_bf16 v[176:191], a[156:159], v[108:111], v[176:191]
  s_waitcnt lgkmcnt(3)
  v_exp_f32 v142, v142
  v_exp_f32 v158, v158
  v_exp_f32 v143, v143
  v_mfma_f32_32x32x16_bf16 v[160:175], a[160:163], v[80:83], v[160:175]
  ds_read_b64_tr_b16 a[144:145], v38 offset:18432
  ds_read_b64_tr_b16 a[146:147], v38 offset:22528
  v_exp_f32 v159, v159
  v_add_f32 v224, v224, v142
  v_mfma_f32_32x32x16_bf16 v[176:191], a[160:163], v[112:115], v[176:191]
  s_waitcnt lgkmcnt(4)
  v_add_f32 v226, v226, v158
  v_add_f32 v225, v225, v143
  v_add_f32 v227, v227, v159
  v_cvt_pk_bf16_f32 v135, v142, v143
  v_cvt_pk_bf16_f32 v151, v158, v159
  v_mfma_f32_32x32x16_bf16 v[160:175], a[164:167], v[84:87], v[160:175]
  ds_read_b64_tr_b16 a[148:149], v38 offset:18688
  ds_read_b64_tr_b16 a[150:151], v38 offset:22784
  v_mfma_f32_32x32x16_bf16 v[176:191], a[164:167], v[116:119], v[176:191]
  s_waitcnt lgkmcnt(5)
  v_mfma_f32_32x32x16_bf16 v[160:175], a[168:171], v[88:91], v[160:175]
  ds_read_b64_tr_b16 a[152:153], v38 offset:18944
  ds_read_b64_tr_b16 a[154:155], v38 offset:23040
  v_mfma_f32_32x32x16_bf16 v[176:191], a[168:171], v[120:123], v[176:191]
  s_waitcnt lgkmcnt(6)
  v_mfma_f32_32x32x16_bf16 v[160:175], a[172:175], v[92:95], v[160:175]
  ds_read_b64_tr_b16 a[156:157], v38 offset:19200
  ds_read_b64_tr_b16 a[158:159], v38 offset:23296
  v_mfma_f32_32x32x16_bf16 v[176:191], a[172:175], v[124:127], v[176:191]
  s_waitcnt lgkmcnt(6)
  v_mfma_f32_32x32x16_bf16 a[0:15], a[144:147], v[128:131], a[0:15]
  ds_read_b64_tr_b16 a[160:161], v38 offset:26624
  ds_read_b64_tr_b16 a[162:163], v38 offset:30720
  v_mfma_f32_32x32x16_bf16 a[64:79], a[144:147], v[144:147], a[64:79]
  s_waitcnt lgkmcnt(6)
  s_nop 2
  v_exp_f32 v160, v160
  s_nop 1
  v_exp_f32 v176, v176
  v_exp_f32 v161, v161
  v_mfma_f32_32x32x16_bf16 a[16:31], a[148:151], v[128:131], a[16:31]
  ds_read_b64_tr_b16 a[164:165], v38 offset:26880
  ds_read_b64_tr_b16 a[166:167], v38 offset:30976
  v_exp_f32 v177, v177
  v_add_f32 v224, v224, v160
  v_mfma_f32_32x32x16_bf16 a[80:95], a[148:151], v[144:147], a[80:95]
  s_waitcnt lgkmcnt(6)
  v_add_f32 v226, v226, v176
  v_add_f32 v225, v225, v161
  v_add_f32 v227, v227, v177
  v_cvt_pk_bf16_f32 v160, v160, v161
  v_cvt_pk_bf16_f32 v176, v176, v177
  v_mfma_f32_32x32x16_bf16 a[32:47], a[152:155], v[128:131], a[32:47]
  ds_read_b64_tr_b16 a[168:169], v38 offset:27136
  ds_read_b64_tr_b16 a[170:171], v38 offset:31232
  v_exp_f32 v162, v162
  v_mfma_f32_32x32x16_bf16 a[96:111], a[152:155], v[144:147], a[96:111]
  s_waitcnt lgkmcnt(6)
  v_exp_f32 v178, v178
  v_exp_f32 v163, v163
  v_exp_f32 v179, v179
  v_mfma_f32_32x32x16_bf16 a[48:63], a[156:159], v[128:131], a[48:63]
  ds_read_b64_tr_b16 a[172:173], v38 offset:27392
  ds_read_b64_tr_b16 a[174:175], v38 offset:31488
  v_add_f32 v224, v224, v162
  v_add_f32 v226, v226, v178
  v_add_f32 v225, v225, v163
  v_mfma_f32_32x32x16_bf16 a[112:127], a[156:159], v[144:147], a[112:127]
  s_waitcnt lgkmcnt(6)
  v_add_f32 v227, v227, v179
  v_cvt_pk_bf16_f32 v161, v162, v163
  v_cvt_pk_bf16_f32 v177, v178, v179
  s_waitcnt vmcnt(20)
  s_barrier
  v_mfma_f32_32x32x16_bf16 a[0:15], a[160:163], v[132:135], a[0:15]
  s_add_u32 s67, s64, 0x24100
  ds_read_b64_tr_b16 a[144:145], v38 offset:34816
  s_add_u32 m0, s54, 0
  ds_read_b64_tr_b16 a[146:147], v38 offset:38912
  buffer_load_dwordx4 v30, s[36:39], s67 offen lds
  v_mfma_f32_32x32x16_bf16 a[64:79], a[160:163], v[148:151], a[64:79]
  s_waitcnt lgkmcnt(6)
  v_exp_f32 v164, v164
  v_exp_f32 v180, v180
  v_exp_f32 v165, v165
  v_mfma_f32_32x32x16_bf16 a[16:31], a[164:167], v[132:135], a[16:31]
  s_add_u32 m0, s54, 0x400
  ds_read_b64_tr_b16 a[148:149], v38 offset:35072
  ds_read_b64_tr_b16 a[150:151], v38 offset:39168
  v_exp_f32 v181, v181
  v_add_f32 v224, v224, v164
  v_mfma_f32_32x32x16_bf16 a[80:95], a[164:167], v[148:151], a[80:95]
  s_waitcnt lgkmcnt(6)
  buffer_load_dwordx4 v31, s[36:39], s67 offen lds
  v_add_f32 v226, v226, v180
  v_add_f32 v225, v225, v165
  v_add_f32 v227, v227, v181
  v_cvt_pk_bf16_f32 v162, v164, v165
  v_cvt_pk_bf16_f32 v178, v180, v181
  v_mfma_f32_32x32x16_bf16 a[32:47], a[168:171], v[132:135], a[32:47]
  ds_read_b64_tr_b16 a[152:153], v38 offset:35328
  ds_read_b64_tr_b16 a[154:155], v38 offset:39424
  v_exp_f32 v166, v166
  v_mfma_f32_32x32x16_bf16 a[96:111], a[168:171], v[148:151], a[96:111]
  s_waitcnt lgkmcnt(6)
  v_exp_f32 v182, v182
  v_exp_f32 v167, v167
  s_add_u32 m0, s54, 0x800
  v_mfma_f32_32x32x16_bf16 a[48:63], a[172:175], v[132:135], a[48:63]
  ds_read_b64_tr_b16 a[156:157], v38 offset:35584
  ds_read_b64_tr_b16 a[158:159], v38 offset:39680
  buffer_load_dwordx4 v32, s[36:39], s67 offen lds
  v_mfma_f32_32x32x16_bf16 a[112:127], a[172:175], v[148:151], a[112:127]
  s_waitcnt lgkmcnt(6)
  v_exp_f32 v183, v183
  v_add_f32 v224, v224, v166
  v_add_f32 v226, v226, v182
  v_add_f32 v225, v225, v167
  v_add_f32 v227, v227, v183
  v_cvt_pk_bf16_f32 v163, v166, v167
  v_cvt_pk_bf16_f32 v179, v182, v183
  s_nop 0
  v_mfma_f32_32x32x16_bf16 a[0:15], a[144:147], v[160:163], a[0:15]
  s_add_u32 m0, s54, 0xc00
  ds_read_b64_tr_b16 a[160:161], v38 offset:43008
  ds_read_b64_tr_b16 a[162:163], v38 offset:47104
  v_exp_f32 v168, v168
  v_mfma_f32_32x32x16_bf16 a[64:79], a[144:147], v[176:179], a[64:79]
  s_waitcnt lgkmcnt(6)
  buffer_load_dwordx4 v33, s[36:39], s67 offen lds
  v_exp_f32 v184, v184
  v_exp_f32 v169, v169
  v_mfma_f32_32x32x16_bf16 a[16:31], a[148:151], v[160:163], a[16:31]
  ds_read_b64_tr_b16 a[164:165], v38 offset:43264
  ds_read_b64_tr_b16 a[166:167], v38 offset:47360
  v_exp_f32 v185, v185
  v_add_f32 v224, v224, v168
  v_mfma_f32_32x32x16_bf16 a[80:95], a[148:151], v[176:179], a[80:95]
  s_waitcnt lgkmcnt(6)
  v_add_f32 v226, v226, v184
  v_add_f32 v225, v225, v169
  v_add_f32 v227, v227, v185
  v_cvt_pk_bf16_f32 v164, v168, v169
  v_cvt_pk_bf16_f32 v180, v184, v185
  v_mfma_f32_32x32x16_bf16 a[32:47], a[152:155], v[160:163], a[32:47]
  ds_read_b64_tr_b16 a[168:169], v38 offset:43520
  ds_read_b64_tr_b16 a[170:171], v38 offset:47616
  v_exp_f32 v170, v170
  v_mfma_f32_32x32x16_bf16 a[96:111], a[152:155], v[176:179], a[96:111]
  s_waitcnt lgkmcnt(6)
  v_exp_f32 v186, v186
  v_exp_f32 v171, v171
  v_exp_f32 v187, v187
  v_mfma_f32_32x32x16_bf16 a[48:63], a[156:159], v[160:163], a[48:63]
  ds_read_b64_tr_b16 a[172:173], v38 offset:43776
  ds_read_b64_tr_b16 a[174:175], v38 offset:47872
  v_add_f32 v224, v224, v170
  v_add_f32 v226, v226, v186
  v_add_f32 v225, v225, v171
  v_mfma_f32_32x32x16_bf16 a[112:127], a[156:159], v[176:179], a[112:127]
  s_waitcnt lgkmcnt(6)
  v_add_f32 v227, v227, v187
  v_cvt_pk_bf16_f32 v165, v170, v171
  v_cvt_pk_bf16_f32 v181, v186, v187
  v_exp_f32 v172, v172
  v_exp_f32 v188, v188
  v_exp_f32 v173, v173
  v_exp_f32 v189, v189
  v_add_f32 v224, v224, v172
  v_add_f32 v226, v226, v188
  v_add_f32 v225, v225, v173
  v_add_f32 v227, v227, v189
  v_cvt_pk_bf16_f32 v166, v172, v173
  v_cvt_pk_bf16_f32 v182, v188, v189
  v_exp_f32 v174, v174
  v_exp_f32 v190, v190
  v_exp_f32 v175, v175
  v_exp_f32 v191, v191
  v_add_f32 v224, v224, v174
  v_add_f32 v226, v226, v190
  v_add_f32 v225, v225, v175
  v_add_f32 v227, v227, v191
  v_cvt_pk_bf16_f32 v167, v174, v175
  v_cvt_pk_bf16_f32 v183, v190, v191
  s_nop 0
  v_mfma_f32_32x32x16_bf16 a[0:15], a[160:163], v[164:167], a[0:15]
  v_add_f32 v224, v224, v225
  v_add_f32 v226, v226, v227
  v_mov_b32 v225, v224
  v_mov_b32 v227, v226
  s_nop 0
  v_permlane32_swap_b32 v224, v225
  v_permlane32_swap_b32 v226, v227
  v_mfma_f32_32x32x16_bf16 a[64:79], a[160:163], v[180:183], a[64:79]
  s_waitcnt lgkmcnt(4)
  v_add_f32 v224, v224, v225
  v_add_f32 v226, v226, v227
  v_add_f32 v229, v224, v226
  s_waitcnt vmcnt(20)
  s_barrier
  v_mfma_f32_32x32x16_bf16 a[16:31], a[164:167], v[164:167], a[16:31]
  s_add_u32 s67, s64, 0x180
  ds_read_b64_tr_b16 a[144:145], v14 offset:49152
  s_add_u32 m0, s54, 0x4000
  ds_read_b64_tr_b16 a[146:147], v14 offset:50176
  buffer_load_dwordx4 v30, s[36:39], s67 offen lds
  v_mfma_f32_32x32x16_bf16 a[80:95], a[164:167], v[180:183], a[80:95]
  s_waitcnt lgkmcnt(4)
  ds_read_b64_tr_b16 a[148:149], v14 offset:49408
  ds_read_b64_tr_b16 a[150:151], v14 offset:50432
  v_mfma_f32_32x32x16_bf16 a[32:47], a[168:171], v[164:167], a[32:47]
  s_add_u32 m0, s54, 0x4400
  ds_read_b64_tr_b16 a[152:153], v14 offset:51200
  ds_read_b64_tr_b16 a[154:155], v14 offset:52224
  v_mfma_f32_32x32x16_bf16 a[96:111], a[168:171], v[180:183], a[96:111]
  s_waitcnt lgkmcnt(6)
  ds_read_b64_tr_b16 a[156:157], v14 offset:51456
  ds_read_b64_tr_b16 a[158:159], v14 offset:52480
  buffer_load_dwordx4 v31, s[36:39], s67 offen lds
  v_mfma_f32_32x32x16_bf16 a[48:63], a[172:175], v[164:167], a[48:63]
  ds_read_b64_tr_b16 a[160:161], v14 offset:53248
  ds_read_b64_tr_b16 a[162:163], v14 offset:54272
  v_mfma_f32_32x32x16_bf16 a[112:127], a[172:175], v[180:183], a[112:127]
  s_waitcnt lgkmcnt(8)
  ds_read_b64_tr_b16 a[164:165], v14 offset:53504
  ds_read_b64_tr_b16 a[166:167], v14 offset:54528
  s_mov_b32 s72, 0x4f800000
  v_cmp_nge_f32 vcc, s72, v229
  s_nop 4
  s_cbranch_vccnz adaLN_cond__sliding_block_cached__glu_gated_swiglu__prompt_kernel_slow
adaLN_cond__sliding_block_cached__glu_gated_swiglu__prompt_kernel_back:
  v_rcp_f32 v224, v224
  v_rcp_f32 v226, v226
  v_accvgpr_read_b32 v228, a0
  v_accvgpr_read_b32 v229, a1
  v_accvgpr_read_b32 v230, a2
  v_accvgpr_read_b32 v231, a3
  v_mul_f32 v228, v228, v224
  v_mul_f32 v229, v229, v224
  v_mul_f32 v230, v230, v224
  v_mul_f32 v231, v231, v224
  v_cvt_pk_bf16_f32 v64, v228, v229
  v_cvt_pk_bf16_f32 v65, v230, v231
  v_accvgpr_read_b32 v228, a4
  v_accvgpr_read_b32 v229, a5
  v_accvgpr_read_b32 v230, a6
  v_accvgpr_read_b32 v231, a7
  v_mul_f32 v228, v228, v224
  v_mul_f32 v229, v229, v224
  v_mul_f32 v230, v230, v224
  v_mul_f32 v231, v231, v224
  v_cvt_pk_bf16_f32 v66, v228, v229
  v_cvt_pk_bf16_f32 v67, v230, v231
  s_nop 1
  v_mfma_f32_32x32x16_bf16 v[128:143], a[144:147], v[64:67], 0
  s_waitcnt lgkmcnt(8)
  ds_read_b64_tr_b16 a[168:169], v14 offset:55296
  s_add_u32 m0, s54, 0x4800
  ds_read_b64_tr_b16 a[170:171], v14 offset:56320
  buffer_load_dwordx4 v32, s[36:39], s67 offen lds
  v_accvgpr_read_b32 v228, a8
  v_mfma_f32_32x32x16_bf16 v[144:159], a[148:151], v[64:67], 0
  s_waitcnt lgkmcnt(8)
  ds_read_b64_tr_b16 a[172:173], v14 offset:55552
  ds_read_b64_tr_b16 a[174:175], v14 offset:56576
  v_accvgpr_read_b32 v229, a9
  v_accvgpr_read_b32 v230, a10
  v_accvgpr_read_b32 v231, a11
  v_mul_f32 v228, v228, v224
  v_mul_f32 v229, v229, v224
  v_mul_f32 v230, v230, v224
  v_mul_f32 v231, v231, v224
  v_cvt_pk_bf16_f32 v68, v228, v229
  v_cvt_pk_bf16_f32 v69, v230, v231
  v_accvgpr_read_b32 v228, a12
  v_accvgpr_read_b32 v229, a13
  v_accvgpr_read_b32 v230, a14
  v_accvgpr_read_b32 v231, a15
  v_mul_f32 v228, v228, v224
  v_mul_f32 v229, v229, v224
  v_mul_f32 v230, v230, v224
  v_mul_f32 v231, v231, v224
  v_cvt_pk_bf16_f32 v70, v228, v229
  v_cvt_pk_bf16_f32 v71, v230, v231
  s_nop 1
  v_mfma_f32_32x32x16_bf16 v[128:143], a[152:155], v[68:71], v[128:143]
  s_waitcnt lgkmcnt(8)
  ds_read_b64_tr_b16 a[144:145], v14 offset:57344
  s_add_u32 m0, s54, 0x4c00
  ds_read_b64_tr_b16 a[146:147], v14 offset:58368
  v_accvgpr_read_b32 v228, a16
  v_accvgpr_read_b32 v229, a17
  v_accvgpr_read_b32 v230, a18
  v_mfma_f32_32x32x16_bf16 v[144:159], a[156:159], v[68:71], v[144:159]
  s_waitcnt lgkmcnt(8)
  ds_read_b64_tr_b16 a[148:149], v14 offset:57600
  ds_read_b64_tr_b16 a[150:151], v14 offset:58624
  buffer_load_dwordx4 v33, s[36:39], s67 offen lds
  v_accvgpr_read_b32 v231, a19
  v_mul_f32 v228, v228, v224
  v_mul_f32 v229, v229, v224
  v_mul_f32 v230, v230, v224
  v_mul_f32 v231, v231, v224
  v_cvt_pk_bf16_f32 v72, v228, v229
  v_cvt_pk_bf16_f32 v73, v230, v231
  v_accvgpr_read_b32 v228, a20
  v_accvgpr_read_b32 v229, a21
  v_accvgpr_read_b32 v230, a22
  v_accvgpr_read_b32 v231, a23
  v_mul_f32 v228, v228, v224
  v_mul_f32 v229, v229, v224
  v_mul_f32 v230, v230, v224
  v_mul_f32 v231, v231, v224
  v_cvt_pk_bf16_f32 v74, v228, v229
  v_cvt_pk_bf16_f32 v75, v230, v231
  s_nop 1
  v_mfma_f32_32x32x16_bf16 v[128:143], a[160:163], v[72:75], v[128:143]
  s_waitcnt lgkmcnt(8)
  ds_read_b64_tr_b16 a[152:153], v14 offset:59392
  ds_read_b64_tr_b16 a[154:155], v14 offset:60416
  v_accvgpr_read_b32 v228, a24
  v_accvgpr_read_b32 v229, a25
  v_accvgpr_read_b32 v230, a26
  v_mfma_f32_32x32x16_bf16 v[144:159], a[164:167], v[72:75], v[144:159]
  s_waitcnt lgkmcnt(8)
  ds_read_b64_tr_b16 a[156:157], v14 offset:59648
  ds_read_b64_tr_b16 a[158:159], v14 offset:60672
  v_accvgpr_read_b32 v231, a27
  v_mul_f32 v228, v228, v224
  v_mul_f32 v229, v229, v224
  v_mul_f32 v230, v230, v224
  v_mul_f32 v231, v231, v224
  v_cvt_pk_bf16_f32 v76, v228, v229
  v_cvt_pk_bf16_f32 v77, v230, v231
  v_accvgpr_read_b32 v228, a28
  v_accvgpr_read_b32 v229, a29
  v_accvgpr_read_b32 v230, a30
  v_accvgpr_read_b32 v231, a31
  v_mul_f32 v228, v228, v224
  v_mul_f32 v229, v229, v224
  v_mul_f32 v230, v230, v224
  v_mul_f32 v231, v231, v224
  v_cvt_pk_bf16_f32 v78, v228, v229
  v_cvt_pk_bf16_f32 v79, v230, v231
  s_nop 1
  v_mfma_f32_32x32x16_bf16 v[128:143], a[168:171], v[76:79], v[128:143]
  s_waitcnt lgkmcnt(8)
  ds_read_b64_tr_b16 a[160:161], v14 offset:61440
  ds_read_b64_tr_b16 a[162:163], v14 offset:62464
  v_accvgpr_read_b32 v228, a32
  v_accvgpr_read_b32 v229, a33
  v_accvgpr_read_b32 v230, a34
  v_mfma_f32_32x32x16_bf16 v[144:159], a[172:175], v[76:79], v[144:159]
  s_waitcnt lgkmcnt(8)
  ds_read_b64_tr_b16 a[164:165], v14 offset:61696
  ds_read_b64_tr_b16 a[166:167], v14 offset:62720
  v_accvgpr_read_b32 v231, a35
  v_mul_f32 v228, v228, v224
  v_mul_f32 v229, v229, v224
  v_mul_f32 v230, v230, v224
  v_mul_f32 v231, v231, v224
  v_cvt_pk_bf16_f32 v80, v228, v229
  v_cvt_pk_bf16_f32 v81, v230, v231
  v_accvgpr_read_b32 v228, a36
  v_accvgpr_read_b32 v229, a37
  v_accvgpr_read_b32 v230, a38
  v_accvgpr_read_b32 v231, a39
  v_mul_f32 v228, v228, v224
  v_mul_f32 v229, v229, v224
  v_mul_f32 v230, v230, v224
  v_mul_f32 v231, v231, v224
  v_cvt_pk_bf16_f32 v82, v228, v229
  v_cvt_pk_bf16_f32 v83, v230, v231
  s_nop 1
  v_mfma_f32_32x32x16_bf16 v[128:143], a[144:147], v[80:83], v[128:143]
  s_waitcnt lgkmcnt(8)
  ds_read_b64_tr_b16 a[168:169], v14 offset:63488
  ds_read_b64_tr_b16 a[170:171], v14 offset:64512
  v_accvgpr_read_b32 v228, a40
  v_accvgpr_read_b32 v229, a41
  v_accvgpr_read_b32 v230, a42
  v_mfma_f32_32x32x16_bf16 v[144:159], a[148:151], v[80:83], v[144:159]
  s_waitcnt lgkmcnt(8)
  ds_read_b64_tr_b16 a[172:173], v14 offset:63744
  s_waitcnt vmcnt(20)
  ds_read_b64_tr_b16 a[174:175], v14 offset:64768
  s_barrier
  v_accvgpr_read_b32 v231, a43
  v_mul_f32 v228, v228, v224
  v_mul_f32 v229, v229, v224
  v_mul_f32 v230, v230, v224
  v_mul_f32 v231, v231, v224
  v_cvt_pk_bf16_f32 v84, v228, v229
  v_cvt_pk_bf16_f32 v85, v230, v231
  v_accvgpr_read_b32 v228, a44
  v_accvgpr_read_b32 v229, a45
  v_accvgpr_read_b32 v230, a46
  v_accvgpr_read_b32 v231, a47
  v_mul_f32 v228, v228, v224
  v_mul_f32 v229, v229, v224
  v_mul_f32 v230, v230, v224
  v_mul_f32 v231, v231, v224
  v_cvt_pk_bf16_f32 v86, v228, v229
  v_cvt_pk_bf16_f32 v87, v230, v231
  s_nop 1
  v_mfma_f32_32x32x16_bf16 v[128:143], a[152:155], v[84:87], v[128:143]
  s_waitcnt lgkmcnt(8)
  ds_read_b64_tr_b16 a[144:145], v15
  s_add_u32 s67, s64, 0x24180
  ds_read_b64_tr_b16 a[146:147], v15 offset:1024
  s_add_u32 m0, s54, 0x8000
  s_nop 0
  buffer_load_dwordx4 v30, s[36:39], s67 offen lds
  v_accvgpr_read_b32 v228, a48
  v_mfma_f32_32x32x16_bf16 v[144:159], a[156:159], v[84:87], v[144:159]
  s_waitcnt lgkmcnt(8)
  ds_read_b64_tr_b16 a[148:149], v15 offset:256
  ds_read_b64_tr_b16 a[150:151], v15 offset:1280
  v_accvgpr_read_b32 v229, a49
  v_accvgpr_read_b32 v230, a50
  v_accvgpr_read_b32 v231, a51
  v_mul_f32 v228, v228, v224
  v_mul_f32 v229, v229, v224
  v_mul_f32 v230, v230, v224
  v_mul_f32 v231, v231, v224
  v_cvt_pk_bf16_f32 v88, v228, v229
  v_cvt_pk_bf16_f32 v89, v230, v231
  v_accvgpr_read_b32 v228, a52
  v_accvgpr_read_b32 v229, a53
  v_accvgpr_read_b32 v230, a54
  v_accvgpr_read_b32 v231, a55
  v_mul_f32 v228, v228, v224
  v_mul_f32 v229, v229, v224
  v_mul_f32 v230, v230, v224
  v_mul_f32 v231, v231, v224
  v_cvt_pk_bf16_f32 v90, v228, v229
  v_cvt_pk_bf16_f32 v91, v230, v231
  s_nop 1
  v_mfma_f32_32x32x16_bf16 v[128:143], a[160:163], v[88:91], v[128:143]
  s_waitcnt lgkmcnt(8)
  ds_read_b64_tr_b16 a[152:153], v15 offset:2048
  s_add_u32 m0, s54, 0x8400
  ds_read_b64_tr_b16 a[154:155], v15 offset:3072
  v_accvgpr_read_b32 v228, a56
  v_accvgpr_read_b32 v229, a57
  v_accvgpr_read_b32 v230, a58
  v_mfma_f32_32x32x16_bf16 v[144:159], a[164:167], v[88:91], v[144:159]
  s_waitcnt lgkmcnt(8)
  ds_read_b64_tr_b16 a[156:157], v15 offset:2304
  ds_read_b64_tr_b16 a[158:159], v15 offset:3328
  buffer_load_dwordx4 v31, s[36:39], s67 offen lds
  v_accvgpr_read_b32 v231, a59
  v_mul_f32 v228, v228, v224
  v_mul_f32 v229, v229, v224
  v_mul_f32 v230, v230, v224
  v_mul_f32 v231, v231, v224
  v_cvt_pk_bf16_f32 v92, v228, v229
  v_cvt_pk_bf16_f32 v93, v230, v231
  v_accvgpr_read_b32 v228, a60
  v_accvgpr_read_b32 v229, a61
  v_accvgpr_read_b32 v230, a62
  v_accvgpr_read_b32 v231, a63
  v_mul_f32 v228, v228, v224
  v_mul_f32 v229, v229, v224
  v_mul_f32 v230, v230, v224
  v_mul_f32 v231, v231, v224
  v_cvt_pk_bf16_f32 v94, v228, v229
  v_cvt_pk_bf16_f32 v95, v230, v231
  s_nop 1
  v_mfma_f32_32x32x16_bf16 v[128:143], a[168:171], v[92:95], v[128:143]
  s_waitcnt lgkmcnt(8)
  ds_read_b64_tr_b16 a[160:161], v15 offset:4096
  ds_read_b64_tr_b16 a[162:163], v15 offset:5120
  v_accvgpr_read_b32 v228, a64
  v_accvgpr_read_b32 v229, a65
  v_accvgpr_read_b32 v230, a66
  v_mfma_f32_32x32x16_bf16 v[144:159], a[172:175], v[92:95], v[144:159]
  s_waitcnt lgkmcnt(8)
  ds_read_b64_tr_b16 a[164:165], v15 offset:4352
  ds_read_b64_tr_b16 a[166:167], v15 offset:5376
  v_accvgpr_read_b32 v231, a67
  v_mul_f32 v228, v228, v226
  v_mul_f32 v229, v229, v226
  v_mul_f32 v230, v230, v226
  v_mul_f32 v231, v231, v226
  v_cvt_pk_bf16_f32 v96, v228, v229
  v_cvt_pk_bf16_f32 v97, v230, v231
  v_accvgpr_read_b32 v228, a68
  v_accvgpr_read_b32 v229, a69
  v_accvgpr_read_b32 v230, a70
  v_accvgpr_read_b32 v231, a71
  v_mul_f32 v228, v228, v226
  v_mul_f32 v229, v229, v226
  v_mul_f32 v230, v230, v226
  v_mul_f32 v231, v231, v226
  v_cvt_pk_bf16_f32 v98, v228, v229
  v_cvt_pk_bf16_f32 v99, v230, v231
  s_nop 1
  v_mfma_f32_32x32x16_bf16 v[128:143], a[144:147], v[96:99], v[128:143]
  s_waitcnt lgkmcnt(8)
  ds_read_b64_tr_b16 a[168:169], v15 offset:6144
  s_add_u32 m0, s54, 0x8800
  ds_read_b64_tr_b16 a[170:171], v15 offset:7168
  buffer_load_dwordx4 v32, s[36:39], s67 offen lds
  v_accvgpr_read_b32 v228, a72
  v_mfma_f32_32x32x16_bf16 v[144:159], a[148:151], v[96:99], v[144:159]
  s_waitcnt lgkmcnt(8)
  ds_read_b64_tr_b16 a[172:173], v15 offset:6400
  ds_read_b64_tr_b16 a[174:175], v15 offset:7424
  v_accvgpr_read_b32 v229, a73
  v_accvgpr_read_b32 v230, a74
  v_accvgpr_read_b32 v231, a75
  v_mul_f32 v228, v228, v226
  v_mul_f32 v229, v229, v226
  v_mul_f32 v230, v230, v226
  v_mul_f32 v231, v231, v226
  v_cvt_pk_bf16_f32 v100, v228, v229
  v_cvt_pk_bf16_f32 v101, v230, v231
  v_accvgpr_read_b32 v228, a76
  v_accvgpr_read_b32 v229, a77
  v_accvgpr_read_b32 v230, a78
  v_accvgpr_read_b32 v231, a79
  v_mul_f32 v228, v228, v226
  v_mul_f32 v229, v229, v226
  v_mul_f32 v230, v230, v226
  v_mul_f32 v231, v231, v226
  v_cvt_pk_bf16_f32 v102, v228, v229
  v_cvt_pk_bf16_f32 v103, v230, v231
  s_nop 1
  v_mfma_f32_32x32x16_bf16 v[128:143], a[152:155], v[100:103], v[128:143]
  s_waitcnt lgkmcnt(8)
  ds_read_b64_tr_b16 a[144:145], v15 offset:8192
  s_add_u32 m0, s54, 0x8c00
  ds_read_b64_tr_b16 a[146:147], v15 offset:9216
  v_accvgpr_read_b32 v228, a80
  v_accvgpr_read_b32 v229, a81
  v_accvgpr_read_b32 v230, a82
  v_mfma_f32_32x32x16_bf16 v[144:159], a[156:159], v[100:103], v[144:159]
  s_waitcnt lgkmcnt(8)
  ds_read_b64_tr_b16 a[148:149], v15 offset:8448
  ds_read_b64_tr_b16 a[150:151], v15 offset:9472
  buffer_load_dwordx4 v33, s[36:39], s67 offen lds
  v_accvgpr_read_b32 v231, a83
  v_mul_f32 v228, v228, v226
  v_mul_f32 v229, v229, v226
  v_mul_f32 v230, v230, v226
  v_mul_f32 v231, v231, v226
  v_cvt_pk_bf16_f32 v104, v228, v229
  v_cvt_pk_bf16_f32 v105, v230, v231
  v_accvgpr_read_b32 v228, a84
  v_accvgpr_read_b32 v229, a85
  v_accvgpr_read_b32 v230, a86
  v_accvgpr_read_b32 v231, a87
  v_mul_f32 v228, v228, v226
  v_mul_f32 v229, v229, v226
  v_mul_f32 v230, v230, v226
  v_mul_f32 v231, v231, v226
  v_cvt_pk_bf16_f32 v106, v228, v229
  v_cvt_pk_bf16_f32 v107, v230, v231
  s_nop 1
  v_mfma_f32_32x32x16_bf16 v[128:143], a[160:163], v[104:107], v[128:143]
  s_waitcnt lgkmcnt(8)
  ds_read_b64_tr_b16 a[152:153], v15 offset:10240
  ds_read_b64_tr_b16 a[154:155], v15 offset:11264
  v_accvgpr_read_b32 v228, a88
  v_accvgpr_read_b32 v229, a89
  v_accvgpr_read_b32 v230, a90
  v_mfma_f32_32x32x16_bf16 v[144:159], a[164:167], v[104:107], v[144:159]
  s_waitcnt lgkmcnt(8)
  ds_read_b64_tr_b16 a[156:157], v15 offset:10496
  ds_read_b64_tr_b16 a[158:159], v15 offset:11520
  v_accvgpr_read_b32 v231, a91
  v_mul_f32 v228, v228, v226
  v_mul_f32 v229, v229, v226
  v_mul_f32 v230, v230, v226
  v_mul_f32 v231, v231, v226
  v_cvt_pk_bf16_f32 v108, v228, v229
  v_cvt_pk_bf16_f32 v109, v230, v231
  v_accvgpr_read_b32 v228, a92
  v_accvgpr_read_b32 v229, a93
  v_accvgpr_read_b32 v230, a94
  v_accvgpr_read_b32 v231, a95
  v_mul_f32 v228, v228, v226
  v_mul_f32 v229, v229, v226
  v_mul_f32 v230, v230, v226
  v_mul_f32 v231, v231, v226
  v_cvt_pk_bf16_f32 v110, v228, v229
  v_cvt_pk_bf16_f32 v111, v230, v231
  s_nop 1
  v_mfma_f32_32x32x16_bf16 v[128:143], a[168:171], v[108:111], v[128:143]
  s_waitcnt lgkmcnt(8)
  ds_read_b64_tr_b16 a[160:161], v15 offset:12288
  ds_read_b64_tr_b16 a[162:163], v15 offset:13312
  v_accvgpr_read_b32 v228, a96
  v_accvgpr_read_b32 v229, a97
  v_accvgpr_read_b32 v230, a98
  v_mfma_f32_32x32x16_bf16 v[144:159], a[172:175], v[108:111], v[144:159]
  s_waitcnt lgkmcnt(8)
  ds_read_b64_tr_b16 a[164:165], v15 offset:12544
  ds_read_b64_tr_b16 a[166:167], v15 offset:13568
  v_accvgpr_read_b32 v231, a99
  v_mul_f32 v228, v228, v226
  v_mul_f32 v229, v229, v226
  v_mul_f32 v230, v230, v226
  v_mul_f32 v231, v231, v226
  v_cvt_pk_bf16_f32 v112, v228, v229
  v_cvt_pk_bf16_f32 v113, v230, v231
  v_accvgpr_read_b32 v228, a100
  v_accvgpr_read_b32 v229, a101
  v_accvgpr_read_b32 v230, a102
  v_accvgpr_read_b32 v231, a103
  v_mul_f32 v228, v228, v226
  v_mul_f32 v229, v229, v226
  v_mul_f32 v230, v230, v226
  v_mul_f32 v231, v231, v226
  v_cvt_pk_bf16_f32 v114, v228, v229
  v_cvt_pk_bf16_f32 v115, v230, v231
  s_nop 1
  v_mfma_f32_32x32x16_bf16 v[128:143], a[144:147], v[112:115], v[128:143]
  s_waitcnt lgkmcnt(8)
  ds_read_b64_tr_b16 a[168:169], v15 offset:14336
  ds_read_b64_tr_b16 a[170:171], v15 offset:15360
  v_accvgpr_read_b32 v228, a104
  v_accvgpr_read_b32 v229, a105
  v_accvgpr_read_b32 v230, a106
  v_mfma_f32_32x32x16_bf16 v[144:159], a[148:151], v[112:115], v[144:159]
  s_waitcnt lgkmcnt(8)
  ds_read_b64_tr_b16 a[172:173], v15 offset:14592
  s_waitcnt vmcnt(20)
  ds_read_b64_tr_b16 a[174:175], v15 offset:15616
  s_barrier
  v_accvgpr_read_b32 v231, a107
  v_mul_f32 v228, v228, v226
  v_mul_f32 v229, v229, v226
  v_mul_f32 v230, v230, v226
  v_mul_f32 v231, v231, v226
  v_cvt_pk_bf16_f32 v116, v228, v229
  v_cvt_pk_bf16_f32 v117, v230, v231
  v_accvgpr_read_b32 v228, a108
  v_accvgpr_read_b32 v229, a109
  v_accvgpr_read_b32 v230, a110
  v_accvgpr_read_b32 v231, a111
  v_mul_f32 v228, v228, v226
  v_mul_f32 v229, v229, v226
  v_mul_f32 v230, v230, v226
  v_mul_f32 v231, v231, v226
  v_cvt_pk_bf16_f32 v118, v228, v229
  v_cvt_pk_bf16_f32 v119, v230, v231
  s_nop 1
  v_mfma_f32_32x32x16_bf16 v[128:143], a[152:155], v[116:119], v[128:143]
  s_waitcnt lgkmcnt(8)
  ds_read_b64_tr_b16 a[144:145], v15 offset:16384
  s_add_u32 s67, s64, 0x200
  ds_read_b64_tr_b16 a[146:147], v15 offset:17408
  s_add_u32 m0, s54, 0xc000
  s_nop 0
  buffer_load_dwordx4 v30, s[36:39], s67 offen lds
  v_accvgpr_read_b32 v228, a112
  v_mfma_f32_32x32x16_bf16 v[144:159], a[156:159], v[116:119], v[144:159]
  s_waitcnt lgkmcnt(8)
  ds_read_b64_tr_b16 a[148:149], v15 offset:16640
  ds_read_b64_tr_b16 a[150:151], v15 offset:17664
  v_accvgpr_read_b32 v229, a113
  v_accvgpr_read_b32 v230, a114
  v_accvgpr_read_b32 v231, a115
  v_mul_f32 v228, v228, v226
  v_mul_f32 v229, v229, v226
  v_mul_f32 v230, v230, v226
  v_mul_f32 v231, v231, v226
  v_cvt_pk_bf16_f32 v120, v228, v229
  v_cvt_pk_bf16_f32 v121, v230, v231
  v_accvgpr_read_b32 v228, a116
  v_accvgpr_read_b32 v229, a117
  v_accvgpr_read_b32 v230, a118
  v_accvgpr_read_b32 v231, a119
  v_mul_f32 v228, v228, v226
  v_mul_f32 v229, v229, v226
  v_mul_f32 v230, v230, v226
  v_mul_f32 v231, v231, v226
  v_cvt_pk_bf16_f32 v122, v228, v229
  v_cvt_pk_bf16_f32 v123, v230, v231
  s_nop 1
  v_mfma_f32_32x32x16_bf16 v[128:143], a[160:163], v[120:123], v[128:143]
  s_waitcnt lgkmcnt(8)
  ds_read_b64_tr_b16 a[152:153], v15 offset:18432
  s_add_u32 m0, s54, 0xc400
  ds_read_b64_tr_b16 a[154:155], v15 offset:19456
  v_accvgpr_read_b32 v228, a120
  v_accvgpr_read_b32 v229, a121
  v_accvgpr_read_b32 v230, a122
  v_mfma_f32_32x32x16_bf16 v[144:159], a[164:167], v[120:123], v[144:159]
  s_waitcnt lgkmcnt(8)
  ds_read_b64_tr_b16 a[156:157], v15 offset:18688
  ds_read_b64_tr_b16 a[158:159], v15 offset:19712
  buffer_load_dwordx4 v31, s[36:39], s67 offen lds
  v_accvgpr_read_b32 v231, a123
  v_mul_f32 v228, v228, v226
  v_mul_f32 v229, v229, v226
  v_mul_f32 v230, v230, v226
  v_mul_f32 v231, v231, v226
  v_cvt_pk_bf16_f32 v124, v228, v229
  v_cvt_pk_bf16_f32 v125, v230, v231
  v_accvgpr_read_b32 v228, a124
  v_accvgpr_read_b32 v229, a125
  v_accvgpr_read_b32 v230, a126
  v_accvgpr_read_b32 v231, a127
  v_mul_f32 v228, v228, v226
  v_mul_f32 v229, v229, v226
  v_mul_f32 v230, v230, v226
  v_mul_f32 v231, v231, v226
  v_cvt_pk_bf16_f32 v126, v228, v229
  v_cvt_pk_bf16_f32 v127, v230, v231
  s_nop 1
  v_mfma_f32_32x32x16_bf16 v[128:143], a[168:171], v[124:127], v[128:143]
  s_waitcnt lgkmcnt(8)
  ds_read_b64_tr_b16 a[160:161], v15 offset:20480
  ds_read_b64_tr_b16 a[162:163], v15 offset:21504
  v_mfma_f32_32x32x16_bf16 v[144:159], a[172:175], v[124:127], v[144:159]
  s_waitcnt lgkmcnt(8)
  ds_read_b64_tr_b16 a[164:165], v15 offset:20736
  s_add_u32 m0, s54, 0xc800
  ds_read_b64_tr_b16 a[166:167], v15 offset:21760
  v_mfma_f32_32x32x16_bf16 v[160:175], a[144:147], v[64:67], 0
  s_waitcnt lgkmcnt(8)
  ds_read_b64_tr_b16 a[168:169], v15 offset:22528
  ds_read_b64_tr_b16 a[170:171], v15 offset:23552
  buffer_load_dwordx4 v32, s[36:39], s67 offen lds
  v_mfma_f32_32x32x16_bf16 v[176:191], a[148:151], v[64:67], 0
  s_waitcnt lgkmcnt(8)
  ds_read_b64_tr_b16 a[172:173], v15 offset:22784
  ds_read_b64_tr_b16 a[174:175], v15 offset:23808
  v_mfma_f32_32x32x16_bf16 v[160:175], a[152:155], v[68:71], v[160:175]
  s_waitcnt lgkmcnt(8)
  ds_read_b64_tr_b16 a[144:145], v15 offset:24576
  s_add_u32 m0, s54, 0xcc00
  ds_read_b64_tr_b16 a[146:147], v15 offset:25600
  v_cvt_pk_bf16_f32 v192, v128, v129
  v_cvt_pk_bf16_f32 v193, v130, v131
  v_cvt_pk_bf16_f32 v194, v132, v133
  v_mfma_f32_32x32x16_bf16 v[176:191], a[156:159], v[68:71], v[176:191]
  s_waitcnt lgkmcnt(8)
  ds_read_b64_tr_b16 a[148:149], v15 offset:24832
  ds_read_b64_tr_b16 a[150:151], v15 offset:25856
  buffer_load_dwordx4 v33, s[36:39], s67 offen lds
  v_cvt_pk_bf16_f32 v195, v134, v135
  v_mfma_f32_32x32x16_bf16 v[160:175], a[160:163], v[72:75], v[160:175]
  s_waitcnt lgkmcnt(8)
  ds_read_b64_tr_b16 a[152:153], v15 offset:26624
  s_add_u32 s57, s66, 0
  ds_read_b64_tr_b16 a[154:155], v15 offset:27648
  buffer_store_dwordx4 v[192:195], v13, s[12:15], s57 offen sc1
  v_mfma_f32_32x32x16_bf16 v[176:191], a[164:167], v[72:75], v[176:191]
  s_waitcnt lgkmcnt(8)
  ds_read_b64_tr_b16 a[156:157], v15 offset:26880
  ds_read_b64_tr_b16 a[158:159], v15 offset:27904
  v_mfma_f32_32x32x16_bf16 v[160:175], a[168:171], v[76:79], v[160:175]
  s_waitcnt lgkmcnt(8)
  ds_read_b64_tr_b16 a[160:161], v15 offset:28672
  ds_read_b64_tr_b16 a[162:163], v15 offset:29696
  v_mfma_f32_32x32x16_bf16 v[176:191], a[172:175], v[76:79], v[176:191]
  s_waitcnt lgkmcnt(8)
  ds_read_b64_tr_b16 a[164:165], v15 offset:28928
  ds_read_b64_tr_b16 a[166:167], v15 offset:29952
  v_mfma_f32_32x32x16_bf16 v[160:175], a[144:147], v[80:83], v[160:175]
  s_waitcnt lgkmcnt(8)
  ds_read_b64_tr_b16 a[168:169], v15 offset:30720
  ds_read_b64_tr_b16 a[170:171], v15 offset:31744
  v_cvt_pk_bf16_f32 v196, v136, v137
  v_cvt_pk_bf16_f32 v197, v138, v139
  v_cvt_pk_bf16_f32 v198, v140, v141
  v_mfma_f32_32x32x16_bf16 v[176:191], a[148:151], v[80:83], v[176:191]
  s_waitcnt lgkmcnt(8)
  ds_read_b64_tr_b16 a[172:173], v15 offset:30976
  s_waitcnt vmcnt(21)
  ds_read_b64_tr_b16 a[174:175], v15 offset:32000
  s_barrier
  v_cvt_pk_bf16_f32 v199, v142, v143
  s_add_u32 s57, s66, 0x100
  v_mfma_f32_32x32x16_bf16 v[160:175], a[152:155], v[84:87], v[160:175]
  s_waitcnt lgkmcnt(8)
  ds_read_b64_tr_b16 a[144:145], v15 offset:32768
  s_add_u32 s67, s64, 0x24200
  ds_read_b64_tr_b16 a[146:147], v15 offset:33792
  s_add_u32 m0, s54, 0x10000
  s_nop 0
  buffer_load_dwordx4 v30, s[36:39], s67 offen lds
  v_mfma_f32_32x32x16_bf16 v[176:191], a[156:159], v[84:87], v[176:191]
  s_waitcnt lgkmcnt(8)
  ds_read_b64_tr_b16 a[148:149], v15 offset:33024
  ds_read_b64_tr_b16 a[150:151], v15 offset:34048
  buffer_store_dwordx4 v[196:199], v13, s[12:15], s57 offen sc1
  v_mfma_f32_32x32x16_bf16 v[160:175], a[160:163], v[88:91], v[160:175]
  s_waitcnt lgkmcnt(8)
  ds_read_b64_tr_b16 a[152:153], v15 offset:34816
  s_add_u32 m0, s54, 0x10400
  ds_read_b64_tr_b16 a[154:155], v15 offset:35840
  v_mfma_f32_32x32x16_bf16 v[176:191], a[164:167], v[88:91], v[176:191]
  s_waitcnt lgkmcnt(8)
  ds_read_b64_tr_b16 a[156:157], v15 offset:35072
  ds_read_b64_tr_b16 a[158:159], v15 offset:36096
  buffer_load_dwordx4 v31, s[36:39], s67 offen lds
  v_mfma_f32_32x32x16_bf16 v[160:175], a[168:171], v[92:95], v[160:175]
  s_waitcnt lgkmcnt(8)
  ds_read_b64_tr_b16 a[160:161], v15 offset:36864
  ds_read_b64_tr_b16 a[162:163], v15 offset:37888
  v_cvt_pk_bf16_f32 v200, v144, v145
  v_cvt_pk_bf16_f32 v201, v146, v147
  v_cvt_pk_bf16_f32 v202, v148, v149
  v_mfma_f32_32x32x16_bf16 v[176:191], a[172:175], v[92:95], v[176:191]
  s_waitcnt lgkmcnt(8)
  ds_read_b64_tr_b16 a[164:165], v15 offset:37120
  s_add_u32 m0, s54, 0x10800
  ds_read_b64_tr_b16 a[166:167], v15 offset:38144
  v_cvt_pk_bf16_f32 v203, v150, v151
  s_add_u32 s57, s66, 0x200
  v_mfma_f32_32x32x16_bf16 v[160:175], a[144:147], v[96:99], v[160:175]
  s_waitcnt lgkmcnt(8)
  ds_read_b64_tr_b16 a[168:169], v15 offset:38912
  ds_read_b64_tr_b16 a[170:171], v15 offset:39936
  buffer_load_dwordx4 v32, s[36:39], s67 offen lds
  v_mfma_f32_32x32x16_bf16 v[176:191], a[148:151], v[96:99], v[176:191]
  s_waitcnt lgkmcnt(8)
  ds_read_b64_tr_b16 a[172:173], v15 offset:39168
  ds_read_b64_tr_b16 a[174:175], v15 offset:40192
  buffer_store_dwordx4 v[200:203], v13, s[12:15], s57 offen sc1
  v_mfma_f32_32x32x16_bf16 v[160:175], a[152:155], v[100:103], v[160:175]
  s_waitcnt lgkmcnt(8)
  ds_read_b64_tr_b16 a[144:145], v15 offset:40960
  s_add_u32 m0, s54, 0x10c00
  ds_read_b64_tr_b16 a[146:147], v15 offset:41984
  v_mfma_f32_32x32x16_bf16 v[176:191], a[156:159], v[100:103], v[176:191]
  s_waitcnt lgkmcnt(8)
  ds_read_b64_tr_b16 a[148:149], v15 offset:41216
  ds_read_b64_tr_b16 a[150:151], v15 offset:42240
  buffer_load_dwordx4 v33, s[36:39], s67 offen lds
  v_mfma_f32_32x32x16_bf16 v[160:175], a[160:163], v[104:107], v[160:175]
  s_waitcnt lgkmcnt(8)
  ds_read_b64_tr_b16 a[152:153], v15 offset:43008
  ds_read_b64_tr_b16 a[154:155], v15 offset:44032
  v_cvt_pk_bf16_f32 v204, v152, v153
  v_cvt_pk_bf16_f32 v205, v154, v155
  v_cvt_pk_bf16_f32 v206, v156, v157
  v_mfma_f32_32x32x16_bf16 v[176:191], a[164:167], v[104:107], v[176:191]
  s_waitcnt lgkmcnt(8)
  ds_read_b64_tr_b16 a[156:157], v15 offset:43264
  ds_read_b64_tr_b16 a[158:159], v15 offset:44288
  v_cvt_pk_bf16_f32 v207, v158, v159
  s_add_u32 s57, s66, 0x300
  v_mfma_f32_32x32x16_bf16 v[160:175], a[168:171], v[108:111], v[160:175]
  s_waitcnt lgkmcnt(8)
  ds_read_b64_tr_b16 a[160:161], v15 offset:45056
  ds_read_b64_tr_b16 a[162:163], v15 offset:46080
  buffer_store_dwordx4 v[204:207], v13, s[12:15], s57 offen sc1
  v_mfma_f32_32x32x16_bf16 v[176:191], a[172:175], v[108:111], v[176:191]
  s_waitcnt lgkmcnt(8)
  ds_read_b64_tr_b16 a[164:165], v15 offset:45312
  ds_read_b64_tr_b16 a[166:167], v15 offset:46336
  v_mfma_f32_32x32x16_bf16 v[160:175], a[144:147], v[112:115], v[160:175]
  s_waitcnt lgkmcnt(8)
  ds_read_b64_tr_b16 a[168:169], v15 offset:47104
  ds_read_b64_tr_b16 a[170:171], v15 offset:48128
  v_mfma_f32_32x32x16_bf16 v[176:191], a[148:151], v[112:115], v[176:191]
  s_waitcnt lgkmcnt(8)
  ds_read_b64_tr_b16 a[172:173], v15 offset:47360
  s_waitcnt vmcnt(24)
  ds_read_b64_tr_b16 a[174:175], v15 offset:48384
  s_barrier
  v_mfma_f32_32x32x16_bf16 v[160:175], a[152:155], v[116:119], v[160:175]
  s_waitcnt lgkmcnt(8)
  ds_read_b64_tr_b16 a[144:145], v15 offset:49152
  s_add_u32 s67, s64, 0x280
  ds_read_b64_tr_b16 a[146:147], v15 offset:50176
  s_add_u32 m0, s54, 0x14000
  s_nop 0
  buffer_load_dwordx4 v30, s[36:39], s67 offen lds
  v_mfma_f32_32x32x16_bf16 v[176:191], a[156:159], v[116:119], v[176:191]
  s_waitcnt lgkmcnt(8)
  ds_read_b64_tr_b16 a[148:149], v15 offset:49408
  ds_read_b64_tr_b16 a[150:151], v15 offset:50432
  v_mfma_f32_32x32x16_bf16 v[160:175], a[160:163], v[120:123], v[160:175]
  s_waitcnt lgkmcnt(8)
  ds_read_b64_tr_b16 a[152:153], v15 offset:51200
  s_add_u32 m0, s54, 0x14400
  ds_read_b64_tr_b16 a[154:155], v15 offset:52224
  v_mfma_f32_32x32x16_bf16 v[176:191], a[164:167], v[120:123], v[176:191]
  s_waitcnt lgkmcnt(8)
  ds_read_b64_tr_b16 a[156:157], v15 offset:51456
  ds_read_b64_tr_b16 a[158:159], v15 offset:52480
  buffer_load_dwordx4 v31, s[36:39], s67 offen lds
  v_mfma_f32_32x32x16_bf16 v[160:175], a[168:171], v[124:127], v[160:175]
  s_waitcnt lgkmcnt(8)
  ds_read_b64_tr_b16 a[160:161], v15 offset:53248
  ds_read_b64_tr_b16 a[162:163], v15 offset:54272
  v_mfma_f32_32x32x16_bf16 v[176:191], a[172:175], v[124:127], v[176:191]
  s_waitcnt lgkmcnt(8)
  ds_read_b64_tr_b16 a[164:165], v15 offset:53504
  s_add_u32 m0, s54, 0x14800
  ds_read_b64_tr_b16 a[166:167], v15 offset:54528
  v_mfma_f32_32x32x16_bf16 v[128:143], a[144:147], v[64:67], 0
  s_waitcnt lgkmcnt(8)
  ds_read_b64_tr_b16 a[168:169], v15 offset:55296
  ds_read_b64_tr_b16 a[170:171], v15 offset:56320
  buffer_load_dwordx4 v32, s[36:39], s67 offen lds
  v_mfma_f32_32x32x16_bf16 v[144:159], a[148:151], v[64:67], 0
  s_waitcnt lgkmcnt(8)
  ds_read_b64_tr_b16 a[172:173], v15 offset:55552
  s_add_u32 s84, s77, 0
  ds_read_b64_tr_b16 a[174:175], v15 offset:56576
  buffer_load_dword a253, v21, s[32:35], s84 offen
  v_mfma_f32_32x32x16_bf16 v[128:143], a[152:155], v[68:71], v[128:143]
  s_waitcnt lgkmcnt(8)
  ds_read_b64_tr_b16 a[144:145], v15 offset:57344
  s_add_u32 m0, s54, 0x14c00
  ds_read_b64_tr_b16 a[146:147], v15 offset:58368
  v_cvt_pk_bf16_f32 v192, v160, v161
  v_cvt_pk_bf16_f32 v193, v162, v163
  v_cvt_pk_bf16_f32 v194, v164, v165
  v_mfma_f32_32x32x16_bf16 v[144:159], a[156:159], v[68:71], v[144:159]
  s_waitcnt lgkmcnt(8)
  ds_read_b64_tr_b16 a[148:149], v15 offset:57600
  ds_read_b64_tr_b16 a[150:151], v15 offset:58624
  buffer_load_dwordx4 v33, s[36:39], s67 offen lds
  buffer_load_dword a254, v21, s[44:47], s84 offen
  v_mfma_f32_32x32x16_bf16 v[128:143], a[160:163], v[72:75], v[128:143]
  s_waitcnt lgkmcnt(8)
  ds_read_b64_tr_b16 a[152:153], v15 offset:59392
  ds_read_b64_tr_b16 a[154:155], v15 offset:60416
  v_cvt_pk_bf16_f32 v195, v166, v167
  s_add_u32 s57, s66, 0x400
  v_mfma_f32_32x32x16_bf16 v[144:159], a[164:167], v[72:75], v[144:159]
  s_waitcnt lgkmcnt(8)
  ds_read_b64_tr_b16 a[156:157], v15 offset:59648
  ds_read_b64_tr_b16 a[158:159], v15 offset:60672
  buffer_store_dwordx4 v[192:195], v13, s[12:15], s57 offen sc1
  v_mfma_f32_32x32x16_bf16 v[128:143], a[168:171], v[76:79], v[128:143]
  s_waitcnt lgkmcnt(8)
  ds_read_b64_tr_b16 a[160:161], v15 offset:61440
  ds_read_b64_tr_b16 a[162:163], v15 offset:62464
  v_mfma_f32_32x32x16_bf16 v[144:159], a[172:175], v[76:79], v[144:159]
  s_waitcnt lgkmcnt(8)
  ds_read_b64_tr_b16 a[164:165], v15 offset:61696
  ds_read_b64_tr_b16 a[166:167], v15 offset:62720
  v_mfma_f32_32x32x16_bf16 v[128:143], a[144:147], v[80:83], v[128:143]
  s_waitcnt lgkmcnt(8)
  ds_read_b64_tr_b16 a[168:169], v15 offset:63488
  ds_read_b64_tr_b16 a[170:171], v15 offset:64512
  v_cvt_pk_bf16_f32 v196, v168, v169
  v_cvt_pk_bf16_f32 v197, v170, v171
  v_cvt_pk_bf16_f32 v198, v172, v173
  v_mfma_f32_32x32x16_bf16 v[144:159], a[148:151], v[80:83], v[144:159]
  s_waitcnt lgkmcnt(8)
  ds_read_b64_tr_b16 a[172:173], v15 offset:63744
  s_waitcnt vmcnt(27)
  ds_read_b64_tr_b16 a[174:175], v15 offset:64768
  s_barrier
  v_cvt_pk_bf16_f32 v199, v174, v175
  s_add_u32 s57, s66, 0x500
  v_mfma_f32_32x32x16_bf16 v[128:143], a[152:155], v[84:87], v[128:143]
  s_waitcnt lgkmcnt(8)
  ds_read_b64_tr_b16 a[144:145], v14
  s_add_u32 s67, s64, 0x24280
  ds_read_b64_tr_b16 a[146:147], v14 offset:1024
  s_add_u32 m0, s54, 0x18000
  s_nop 0
  buffer_load_dwordx4 v30, s[36:39], s67 offen lds
  v_mfma_f32_32x32x16_bf16 v[144:159], a[156:159], v[84:87], v[144:159]
  s_waitcnt lgkmcnt(8)
  ds_read_b64_tr_b16 a[148:149], v14 offset:256
  ds_read_b64_tr_b16 a[150:151], v14 offset:1280
  buffer_store_dwordx4 v[196:199], v13, s[12:15], s57 offen sc1
  v_mfma_f32_32x32x16_bf16 v[128:143], a[160:163], v[88:91], v[128:143]
  s_waitcnt lgkmcnt(8)
  ds_read_b64_tr_b16 a[152:153], v14 offset:2048
  s_add_u32 m0, s54, 0x18400
  ds_read_b64_tr_b16 a[154:155], v14 offset:3072
  v_mfma_f32_32x32x16_bf16 v[144:159], a[164:167], v[88:91], v[144:159]
  s_waitcnt lgkmcnt(8)
  ds_read_b64_tr_b16 a[156:157], v14 offset:2304
  ds_read_b64_tr_b16 a[158:159], v14 offset:3328
  buffer_load_dwordx4 v31, s[36:39], s67 offen lds
  v_mfma_f32_32x32x16_bf16 v[128:143], a[168:171], v[92:95], v[128:143]
  s_waitcnt lgkmcnt(8)
  ds_read_b64_tr_b16 a[160:161], v14 offset:4096
  ds_read_b64_tr_b16 a[162:163], v14 offset:5120
  v_cvt_pk_bf16_f32 v200, v176, v177
  v_cvt_pk_bf16_f32 v201, v178, v179
  v_cvt_pk_bf16_f32 v202, v180, v181
  v_mfma_f32_32x32x16_bf16 v[144:159], a[172:175], v[92:95], v[144:159]
  s_waitcnt lgkmcnt(8)
  ds_read_b64_tr_b16 a[164:165], v14 offset:4352
  s_add_u32 m0, s54, 0x18800
  ds_read_b64_tr_b16 a[166:167], v14 offset:5376
  v_cvt_pk_bf16_f32 v203, v182, v183
  s_add_u32 s57, s66, 0x600
  v_mfma_f32_32x32x16_bf16 v[128:143], a[144:147], v[96:99], v[128:143]
  s_waitcnt lgkmcnt(8)
  ds_read_b64_tr_b16 a[168:169], v14 offset:6144
  ds_read_b64_tr_b16 a[170:171], v14 offset:7168
  buffer_load_dwordx4 v32, s[36:39], s67 offen lds
  v_mfma_f32_32x32x16_bf16 v[144:159], a[148:151], v[96:99], v[144:159]
  s_waitcnt lgkmcnt(8)
  ds_read_b64_tr_b16 a[172:173], v14 offset:6400
  ds_read_b64_tr_b16 a[174:175], v14 offset:7424
  buffer_store_dwordx4 v[200:203], v13, s[12:15], s57 offen sc1
  v_mfma_f32_32x32x16_bf16 v[128:143], a[152:155], v[100:103], v[128:143]
  s_waitcnt lgkmcnt(8)
  ds_read_b64_tr_b16 a[144:145], v14 offset:8192
  s_add_u32 m0, s54, 0x18c00
  ds_read_b64_tr_b16 a[146:147], v14 offset:9216
  v_mfma_f32_32x32x16_bf16 v[144:159], a[156:159], v[100:103], v[144:159]
  s_waitcnt lgkmcnt(8)
  ds_read_b64_tr_b16 a[148:149], v14 offset:8448
  ds_read_b64_tr_b16 a[150:151], v14 offset:9472
  buffer_load_dwordx4 v33, s[36:39], s67 offen lds
  v_mfma_f32_32x32x16_bf16 v[128:143], a[160:163], v[104:107], v[128:143]
  s_waitcnt lgkmcnt(8)
  ds_read_b64_tr_b16 a[152:153], v14 offset:10240
  ds_read_b64_tr_b16 a[154:155], v14 offset:11264
  v_cvt_pk_bf16_f32 v204, v184, v185
  v_cvt_pk_bf16_f32 v205, v186, v187
  v_cvt_pk_bf16_f32 v206, v188, v189
  v_mfma_f32_32x32x16_bf16 v[144:159], a[164:167], v[104:107], v[144:159]
  s_waitcnt lgkmcnt(8)
  ds_read_b64_tr_b16 a[156:157], v14 offset:10496
  ds_read_b64_tr_b16 a[158:159], v14 offset:11520
  v_cvt_pk_bf16_f32 v207, v190, v191
  s_add_u32 s57, s66, 0x700
  v_mfma_f32_32x32x16_bf16 v[128:143], a[168:171], v[108:111], v[128:143]
  s_waitcnt lgkmcnt(8)
  ds_read_b64_tr_b16 a[160:161], v14 offset:12288
  ds_read_b64_tr_b16 a[162:163], v14 offset:13312
  buffer_store_dwordx4 v[204:207], v13, s[12:15], s57 offen sc1
  v_mfma_f32_32x32x16_bf16 v[144:159], a[172:175], v[108:111], v[144:159]
  s_waitcnt lgkmcnt(8)
  ds_read_b64_tr_b16 a[164:165], v14 offset:12544
  ds_read_b64_tr_b16 a[166:167], v14 offset:13568
  v_mfma_f32_32x32x16_bf16 v[128:143], a[144:147], v[112:115], v[128:143]
  s_waitcnt lgkmcnt(8)
  ds_read_b64_tr_b16 a[168:169], v14 offset:14336
  ds_read_b64_tr_b16 a[170:171], v14 offset:15360
  v_mfma_f32_32x32x16_bf16 v[144:159], a[148:151], v[112:115], v[144:159]
  s_waitcnt lgkmcnt(8)
  ds_read_b64_tr_b16 a[172:173], v14 offset:14592
  s_waitcnt vmcnt(30)
  ds_read_b64_tr_b16 a[174:175], v14 offset:15616
  s_barrier
  v_mfma_f32_32x32x16_bf16 v[128:143], a[152:155], v[116:119], v[128:143]
  s_waitcnt lgkmcnt(8)
  ds_read_b64_tr_b16 a[144:145], v14 offset:16384
  s_add_u32 s67, s64, 0x300
  ds_read_b64_tr_b16 a[146:147], v14 offset:17408
  s_add_u32 m0, s54, 0x1c000
  s_nop 0
  buffer_load_dwordx4 v30, s[36:39], s67 offen lds
  v_mfma_f32_32x32x16_bf16 v[144:159], a[156:159], v[116:119], v[144:159]
  s_waitcnt lgkmcnt(8)
  ds_read_b64_tr_b16 a[148:149], v14 offset:16640
  ds_read_b64_tr_b16 a[150:151], v14 offset:17664
  v_mfma_f32_32x32x16_bf16 v[128:143], a[160:163], v[120:123], v[128:143]
  s_waitcnt lgkmcnt(8)
  ds_read_b64_tr_b16 a[152:153], v14 offset:18432
  s_add_u32 m0, s54, 0x1c400
  ds_read_b64_tr_b16 a[154:155], v14 offset:19456
  v_mfma_f32_32x32x16_bf16 v[144:159], a[164:167], v[120:123], v[144:159]
  s_waitcnt lgkmcnt(8)
  ds_read_b64_tr_b16 a[156:157], v14 offset:18688
  ds_read_b64_tr_b16 a[158:159], v14 offset:19712
  buffer_load_dwordx4 v31, s[36:39], s67 offen lds
  v_mfma_f32_32x32x16_bf16 v[128:143], a[168:171], v[124:127], v[128:143]
  s_waitcnt lgkmcnt(8)
  ds_read_b64_tr_b16 a[160:161], v14 offset:20480
  ds_read_b64_tr_b16 a[162:163], v14 offset:21504
  v_mfma_f32_32x32x16_bf16 v[144:159], a[172:175], v[124:127], v[144:159]
  s_waitcnt lgkmcnt(8)
  ds_read_b64_tr_b16 a[164:165], v14 offset:20736
  s_add_u32 m0, s54, 0x1c800
  ds_read_b64_tr_b16 a[166:167], v14 offset:21760
  v_mfma_f32_32x32x16_bf16 v[160:175], a[144:147], v[64:67], 0
  s_waitcnt lgkmcnt(8)
  ds_read_b64_tr_b16 a[168:169], v14 offset:22528
  ds_read_b64_tr_b16 a[170:171], v14 offset:23552
  buffer_load_dwordx4 v32, s[36:39], s67 offen lds
  v_mfma_f32_32x32x16_bf16 v[176:191], a[148:151], v[64:67], 0
  s_waitcnt lgkmcnt(8)
  ds_read_b64_tr_b16 a[172:173], v14 offset:22784
  ds_read_b64_tr_b16 a[174:175], v14 offset:23808
  v_mfma_f32_32x32x16_bf16 v[160:175], a[152:155], v[68:71], v[160:175]
  s_waitcnt lgkmcnt(8)
  ds_read_b64_tr_b16 a[144:145], v14 offset:24576
  s_add_u32 m0, s54, 0x1cc00
  ds_read_b64_tr_b16 a[146:147], v14 offset:25600
  v_cvt_pk_bf16_f32 v192, v128, v129
  v_cvt_pk_bf16_f32 v193, v130, v131
  v_cvt_pk_bf16_f32 v194, v132, v133
  v_mfma_f32_32x32x16_bf16 v[176:191], a[156:159], v[68:71], v[176:191]
  s_waitcnt lgkmcnt(8)
  ds_read_b64_tr_b16 a[148:149], v14 offset:24832
  ds_read_b64_tr_b16 a[150:151], v14 offset:25856
  buffer_load_dwordx4 v33, s[36:39], s67 offen lds
  v_cvt_pk_bf16_f32 v195, v134, v135
  v_mfma_f32_32x32x16_bf16 v[160:175], a[160:163], v[72:75], v[160:175]
  s_waitcnt lgkmcnt(8)
  ds_read_b64_tr_b16 a[152:153], v14 offset:26624
  s_add_u32 s57, s66, 0x800
  ds_read_b64_tr_b16 a[154:155], v14 offset:27648
  buffer_store_dwordx4 v[192:195], v13, s[12:15], s57 offen sc1
  v_mfma_f32_32x32x16_bf16 v[176:191], a[164:167], v[72:75], v[176:191]
  s_waitcnt lgkmcnt(8)
  ds_read_b64_tr_b16 a[156:157], v14 offset:26880
  ds_read_b64_tr_b16 a[158:159], v14 offset:27904
  v_mfma_f32_32x32x16_bf16 v[160:175], a[168:171], v[76:79], v[160:175]
  s_waitcnt lgkmcnt(8)
  ds_read_b64_tr_b16 a[160:161], v14 offset:28672
  ds_read_b64_tr_b16 a[162:163], v14 offset:29696
  v_mfma_f32_32x32x16_bf16 v[176:191], a[172:175], v[76:79], v[176:191]
  s_waitcnt lgkmcnt(8)
  ds_read_b64_tr_b16 a[164:165], v14 offset:28928
  ds_read_b64_tr_b16 a[166:167], v14 offset:29952
  v_mfma_f32_32x32x16_bf16 v[160:175], a[144:147], v[80:83], v[160:175]
  s_waitcnt lgkmcnt(8)
  ds_read_b64_tr_b16 a[168:169], v14 offset:30720
  ds_read_b64_tr_b16 a[170:171], v14 offset:31744
  v_cvt_pk_bf16_f32 v196, v136, v137
  v_cvt_pk_bf16_f32 v197, v138, v139
  v_cvt_pk_bf16_f32 v198, v140, v141
  v_mfma_f32_32x32x16_bf16 v[176:191], a[148:151], v[80:83], v[176:191]
  s_waitcnt lgkmcnt(8)
  ds_read_b64_tr_b16 a[172:173], v14 offset:30976
  s_waitcnt vmcnt(31)
  ds_read_b64_tr_b16 a[174:175], v14 offset:32000
  s_barrier
  v_cvt_pk_bf16_f32 v199, v142, v143
  s_add_u32 s57, s66, 0x900
  v_mfma_f32_32x32x16_bf16 v[160:175], a[152:155], v[84:87], v[160:175]
  s_waitcnt lgkmcnt(8)
  ds_read_b64_tr_b16 a[144:145], v14 offset:32768
  s_add_u32 s67, s64, 0x24300
  ds_read_b64_tr_b16 a[146:147], v14 offset:33792
  s_add_u32 m0, s54, 0
  s_nop 0
  buffer_load_dwordx4 v30, s[36:39], s67 offen lds
  v_mfma_f32_32x32x16_bf16 v[176:191], a[156:159], v[84:87], v[176:191]
  s_waitcnt lgkmcnt(8)
  ds_read_b64_tr_b16 a[148:149], v14 offset:33024
  ds_read_b64_tr_b16 a[150:151], v14 offset:34048
  buffer_store_dwordx4 v[196:199], v13, s[12:15], s57 offen sc1
  v_mfma_f32_32x32x16_bf16 v[160:175], a[160:163], v[88:91], v[160:175]
  s_waitcnt lgkmcnt(8)
  ds_read_b64_tr_b16 a[152:153], v14 offset:34816
  s_add_u32 m0, s54, 0x400
  ds_read_b64_tr_b16 a[154:155], v14 offset:35840
  v_mfma_f32_32x32x16_bf16 v[176:191], a[164:167], v[88:91], v[176:191]
  s_waitcnt lgkmcnt(8)
  ds_read_b64_tr_b16 a[156:157], v14 offset:35072
  ds_read_b64_tr_b16 a[158:159], v14 offset:36096
  buffer_load_dwordx4 v31, s[36:39], s67 offen lds
  v_mfma_f32_32x32x16_bf16 v[160:175], a[168:171], v[92:95], v[160:175]
  s_waitcnt lgkmcnt(8)
  ds_read_b64_tr_b16 a[160:161], v14 offset:36864
  ds_read_b64_tr_b16 a[162:163], v14 offset:37888
  v_cvt_pk_bf16_f32 v200, v144, v145
  v_cvt_pk_bf16_f32 v201, v146, v147
  v_cvt_pk_bf16_f32 v202, v148, v149
  v_mfma_f32_32x32x16_bf16 v[176:191], a[172:175], v[92:95], v[176:191]
  s_waitcnt lgkmcnt(8)
  ds_read_b64_tr_b16 a[164:165], v14 offset:37120
  s_add_u32 m0, s54, 0x800
  ds_read_b64_tr_b16 a[166:167], v14 offset:38144
  v_cvt_pk_bf16_f32 v203, v150, v151
  s_add_u32 s57, s66, 0xa00
  v_mfma_f32_32x32x16_bf16 v[160:175], a[144:147], v[96:99], v[160:175]
  s_waitcnt lgkmcnt(8)
  ds_read_b64_tr_b16 a[168:169], v14 offset:38912
  ds_read_b64_tr_b16 a[170:171], v14 offset:39936
  buffer_load_dwordx4 v32, s[36:39], s67 offen lds
  v_mfma_f32_32x32x16_bf16 v[176:191], a[148:151], v[96:99], v[176:191]
  s_waitcnt lgkmcnt(8)
  ds_read_b64_tr_b16 a[172:173], v14 offset:39168
  ds_read_b64_tr_b16 a[174:175], v14 offset:40192
  buffer_store_dwordx4 v[200:203], v13, s[12:15], s57 offen sc1
  v_mfma_f32_32x32x16_bf16 v[160:175], a[152:155], v[100:103], v[160:175]
  s_waitcnt lgkmcnt(8)
  ds_read_b64_tr_b16 a[144:145], v14 offset:40960
  s_add_u32 m0, s54, 0xc00
  ds_read_b64_tr_b16 a[146:147], v14 offset:41984
  v_mfma_f32_32x32x16_bf16 v[176:191], a[156:159], v[100:103], v[176:191]
  s_waitcnt lgkmcnt(8)
  ds_read_b64_tr_b16 a[148:149], v14 offset:41216
  ds_read_b64_tr_b16 a[150:151], v14 offset:42240
  buffer_load_dwordx4 v33, s[36:39], s67 offen lds
  v_mfma_f32_32x32x16_bf16 v[160:175], a[160:163], v[104:107], v[160:175]
  s_waitcnt lgkmcnt(8)
  ds_read_b64_tr_b16 a[152:153], v14 offset:43008
  ds_read_b64_tr_b16 a[154:155], v14 offset:44032
  v_cvt_pk_bf16_f32 v204, v152, v153
  v_cvt_pk_bf16_f32 v205, v154, v155
  v_cvt_pk_bf16_f32 v206, v156, v157
  v_mfma_f32_32x32x16_bf16 v[176:191], a[164:167], v[104:107], v[176:191]
  s_waitcnt lgkmcnt(8)
  ds_read_b64_tr_b16 a[156:157], v14 offset:43264
  ds_read_b64_tr_b16 a[158:159], v14 offset:44288
  v_cvt_pk_bf16_f32 v207, v158, v159
  s_add_u32 s57, s66, 0xb00
  v_mfma_f32_32x32x16_bf16 v[160:175], a[168:171], v[108:111], v[160:175]
  s_waitcnt lgkmcnt(8)
  ds_read_b64_tr_b16 a[160:161], v14 offset:45056
  ds_read_b64_tr_b16 a[162:163], v14 offset:46080
  buffer_store_dwordx4 v[204:207], v13, s[12:15], s57 offen sc1
  v_mfma_f32_32x32x16_bf16 v[176:191], a[172:175], v[108:111], v[176:191]
  s_waitcnt lgkmcnt(8)
  ds_read_b64_tr_b16 a[164:165], v14 offset:45312
  ds_read_b64_tr_b16 a[166:167], v14 offset:46336
  v_mfma_f32_32x32x16_bf16 v[160:175], a[144:147], v[112:115], v[160:175]
  s_waitcnt lgkmcnt(8)
  ds_read_b64_tr_b16 a[168:169], v14 offset:47104
  ds_read_b64_tr_b16 a[170:171], v14 offset:48128
  v_mfma_f32_32x32x16_bf16 v[176:191], a[148:151], v[112:115], v[176:191]
  s_waitcnt lgkmcnt(8)
  ds_read_b64_tr_b16 a[172:173], v14 offset:47360
  s_waitcnt vmcnt(34)
  ds_read_b64_tr_b16 a[174:175], v14 offset:48384
  s_barrier
  v_mfma_f32_32x32x16_bf16 v[160:175], a[152:155], v[116:119], v[160:175]
  s_waitcnt lgkmcnt(8)
  ds_read_b64_tr_b16 a[144:145], v14 offset:49152
  s_add_u32 s67, s64, 0x380
  ds_read_b64_tr_b16 a[146:147], v14 offset:50176
  s_add_u32 m0, s54, 0x4000
  s_nop 0
  buffer_load_dwordx4 v30, s[36:39], s67 offen lds
  v_mfma_f32_32x32x16_bf16 v[176:191], a[156:159], v[116:119], v[176:191]
  s_waitcnt lgkmcnt(8)
  ds_read_b64_tr_b16 a[148:149], v14 offset:49408
  ds_read_b64_tr_b16 a[150:151], v14 offset:50432
  v_mfma_f32_32x32x16_bf16 v[160:175], a[160:163], v[120:123], v[160:175]
  s_waitcnt lgkmcnt(8)
  ds_read_b64_tr_b16 a[152:153], v14 offset:51200
  s_add_u32 m0, s54, 0x4400
  ds_read_b64_tr_b16 a[154:155], v14 offset:52224
  v_mfma_f32_32x32x16_bf16 v[176:191], a[164:167], v[120:123], v[176:191]
  s_waitcnt lgkmcnt(8)
  ds_read_b64_tr_b16 a[156:157], v14 offset:51456
  ds_read_b64_tr_b16 a[158:159], v14 offset:52480
  buffer_load_dwordx4 v31, s[36:39], s67 offen lds
  v_mfma_f32_32x32x16_bf16 v[160:175], a[168:171], v[124:127], v[160:175]
  s_waitcnt lgkmcnt(8)
  ds_read_b64_tr_b16 a[160:161], v14 offset:53248
  ds_read_b64_tr_b16 a[162:163], v14 offset:54272
  v_mfma_f32_32x32x16_bf16 v[176:191], a[172:175], v[124:127], v[176:191]
  s_waitcnt lgkmcnt(8)
  ds_read_b64_tr_b16 a[164:165], v14 offset:53504
  s_add_u32 m0, s54, 0x4800
  ds_read_b64_tr_b16 a[166:167], v14 offset:54528
  v_mfma_f32_32x32x16_bf16 v[128:143], a[144:147], v[64:67], 0
  s_waitcnt lgkmcnt(8)
  ds_read_b64_tr_b16 a[168:169], v14 offset:55296
  ds_read_b64_tr_b16 a[170:171], v14 offset:56320
  buffer_load_dwordx4 v32, s[36:39], s67 offen lds
  v_mfma_f32_32x32x16_bf16 v[144:159], a[148:151], v[64:67], 0
  s_waitcnt lgkmcnt(8)
  ds_read_b64_tr_b16 a[172:173], v14 offset:55552
  ds_read_b64_tr_b16 a[174:175], v14 offset:56576
  v_mfma_f32_32x32x16_bf16 v[128:143], a[152:155], v[68:71], v[128:143]
  s_waitcnt lgkmcnt(8)
  ds_read_b64_tr_b16 a[144:145], v14 offset:57344
  s_add_u32 m0, s54, 0x4c00
  ds_read_b64_tr_b16 a[146:147], v14 offset:58368
  v_cvt_pk_bf16_f32 v192, v160, v161
  v_cvt_pk_bf16_f32 v193, v162, v163
  v_cvt_pk_bf16_f32 v194, v164, v165
  v_mfma_f32_32x32x16_bf16 v[144:159], a[156:159], v[68:71], v[144:159]
  s_waitcnt lgkmcnt(8)
  ds_read_b64_tr_b16 a[148:149], v14 offset:57600
  ds_read_b64_tr_b16 a[150:151], v14 offset:58624
  buffer_load_dwordx4 v33, s[36:39], s67 offen lds
  v_cvt_pk_bf16_f32 v195, v166, v167
  v_mfma_f32_32x32x16_bf16 v[128:143], a[160:163], v[72:75], v[128:143]
  s_waitcnt lgkmcnt(8)
  ds_read_b64_tr_b16 a[152:153], v14 offset:59392
  s_add_u32 s57, s66, 0xc00
  ds_read_b64_tr_b16 a[154:155], v14 offset:60416
  buffer_store_dwordx4 v[192:195], v13, s[12:15], s57 offen sc1
  v_mfma_f32_32x32x16_bf16 v[144:159], a[164:167], v[72:75], v[144:159]
  s_waitcnt lgkmcnt(8)
  ds_read_b64_tr_b16 a[156:157], v14 offset:59648
  ds_read_b64_tr_b16 a[158:159], v14 offset:60672
  v_mfma_f32_32x32x16_bf16 v[128:143], a[168:171], v[76:79], v[128:143]
  s_waitcnt lgkmcnt(8)
  ds_read_b64_tr_b16 a[160:161], v14 offset:61440
  ds_read_b64_tr_b16 a[162:163], v14 offset:62464
  v_mfma_f32_32x32x16_bf16 v[144:159], a[172:175], v[76:79], v[144:159]
  s_waitcnt lgkmcnt(8)
  ds_read_b64_tr_b16 a[164:165], v14 offset:61696
  ds_read_b64_tr_b16 a[166:167], v14 offset:62720
  v_mfma_f32_32x32x16_bf16 v[128:143], a[144:147], v[80:83], v[128:143]
  s_waitcnt lgkmcnt(8)
  ds_read_b64_tr_b16 a[168:169], v14 offset:63488
  ds_read_b64_tr_b16 a[170:171], v14 offset:64512
  v_cvt_pk_bf16_f32 v196, v168, v169
  v_cvt_pk_bf16_f32 v197, v170, v171
  v_cvt_pk_bf16_f32 v198, v172, v173
  v_mfma_f32_32x32x16_bf16 v[144:159], a[148:151], v[80:83], v[144:159]
  s_waitcnt lgkmcnt(8)
  ds_read_b64_tr_b16 a[172:173], v14 offset:63744
  s_waitcnt vmcnt(32)
  ds_read_b64_tr_b16 a[174:175], v14 offset:64768
  s_barrier
  v_cvt_pk_bf16_f32 v199, v174, v175
  s_add_u32 s57, s66, 0xd00
  v_mfma_f32_32x32x16_bf16 v[128:143], a[152:155], v[84:87], v[128:143]
  s_waitcnt lgkmcnt(8)
  ds_read_b64_tr_b16 a[144:145], v15
  s_add_u32 s67, s64, 0x24380
  ds_read_b64_tr_b16 a[146:147], v15 offset:1024
  s_add_u32 m0, s54, 0x8000
  s_nop 0
  buffer_load_dwordx4 v30, s[36:39], s67 offen lds
  v_mfma_f32_32x32x16_bf16 v[144:159], a[156:159], v[84:87], v[144:159]
  s_waitcnt lgkmcnt(8)
  ds_read_b64_tr_b16 a[148:149], v15 offset:256
  ds_read_b64_tr_b16 a[150:151], v15 offset:1280
  buffer_store_dwordx4 v[196:199], v13, s[12:15], s57 offen sc1
  v_mfma_f32_32x32x16_bf16 v[128:143], a[160:163], v[88:91], v[128:143]
  s_waitcnt lgkmcnt(8)
  ds_read_b64_tr_b16 a[152:153], v15 offset:2048
  s_add_u32 m0, s54, 0x8400
  ds_read_b64_tr_b16 a[154:155], v15 offset:3072
  v_mfma_f32_32x32x16_bf16 v[144:159], a[164:167], v[88:91], v[144:159]
  s_waitcnt lgkmcnt(8)
  ds_read_b64_tr_b16 a[156:157], v15 offset:2304
  ds_read_b64_tr_b16 a[158:159], v15 offset:3328
  buffer_load_dwordx4 v31, s[36:39], s67 offen lds
  v_mfma_f32_32x32x16_bf16 v[128:143], a[168:171], v[92:95], v[128:143]
  s_waitcnt lgkmcnt(8)
  ds_read_b64_tr_b16 a[160:161], v15 offset:4096
  ds_read_b64_tr_b16 a[162:163], v15 offset:5120
  v_cvt_pk_bf16_f32 v200, v176, v177
  v_cvt_pk_bf16_f32 v201, v178, v179
  v_cvt_pk_bf16_f32 v202, v180, v181
  v_mfma_f32_32x32x16_bf16 v[144:159], a[172:175], v[92:95], v[144:159]
  s_waitcnt lgkmcnt(8)
  ds_read_b64_tr_b16 a[164:165], v15 offset:4352
  s_add_u32 m0, s54, 0x8800
  ds_read_b64_tr_b16 a[166:167], v15 offset:5376
  v_cvt_pk_bf16_f32 v203, v182, v183
  s_add_u32 s57, s66, 0xe00
  v_mfma_f32_32x32x16_bf16 v[128:143], a[144:147], v[96:99], v[128:143]
  s_waitcnt lgkmcnt(8)
  ds_read_b64_tr_b16 a[168:169], v15 offset:6144
  ds_read_b64_tr_b16 a[170:171], v15 offset:7168
  buffer_load_dwordx4 v32, s[36:39], s67 offen lds
  v_mfma_f32_32x32x16_bf16 v[144:159], a[148:151], v[96:99], v[144:159]
  s_waitcnt lgkmcnt(8)
  ds_read_b64_tr_b16 a[172:173], v15 offset:6400
  ds_read_b64_tr_b16 a[174:175], v15 offset:7424
  buffer_store_dwordx4 v[200:203], v13, s[12:15], s57 offen sc1
  v_mfma_f32_32x32x16_bf16 v[128:143], a[152:155], v[100:103], v[128:143]
  s_waitcnt lgkmcnt(8)
  ds_read_b64_tr_b16 a[144:145], v15 offset:8192
  s_add_u32 m0, s54, 0x8c00
  ds_read_b64_tr_b16 a[146:147], v15 offset:9216
  v_mfma_f32_32x32x16_bf16 v[144:159], a[156:159], v[100:103], v[144:159]
  s_waitcnt lgkmcnt(8)
  ds_read_b64_tr_b16 a[148:149], v15 offset:8448
  ds_read_b64_tr_b16 a[150:151], v15 offset:9472
  buffer_load_dwordx4 v33, s[36:39], s67 offen lds
  v_mfma_f32_32x32x16_bf16 v[128:143], a[160:163], v[104:107], v[128:143]
  s_waitcnt lgkmcnt(8)
  ds_read_b64_tr_b16 a[152:153], v15 offset:10240
  ds_read_b64_tr_b16 a[154:155], v15 offset:11264
  v_cvt_pk_bf16_f32 v204, v184, v185
  v_cvt_pk_bf16_f32 v205, v186, v187
  v_cvt_pk_bf16_f32 v206, v188, v189
  v_mfma_f32_32x32x16_bf16 v[144:159], a[164:167], v[104:107], v[144:159]
  s_waitcnt lgkmcnt(8)
  ds_read_b64_tr_b16 a[156:157], v15 offset:10496
  ds_read_b64_tr_b16 a[158:159], v15 offset:11520
  v_cvt_pk_bf16_f32 v207, v190, v191
  s_add_u32 s57, s66, 0xf00
  v_mfma_f32_32x32x16_bf16 v[128:143], a[168:171], v[108:111], v[128:143]
  s_waitcnt lgkmcnt(8)
  ds_read_b64_tr_b16 a[160:161], v15 offset:12288
  ds_read_b64_tr_b16 a[162:163], v15 offset:13312
  buffer_store_dwordx4 v[204:207], v13, s[12:15], s57 offen sc1
  v_mfma_f32_32x32x16_bf16 v[144:159], a[172:175], v[108:111], v[144:159]
  s_waitcnt lgkmcnt(8)
  ds_read_b64_tr_b16 a[164:165], v15 offset:12544
  ds_read_b64_tr_b16 a[166:167], v15 offset:13568
  v_mfma_f32_32x32x16_bf16 v[128:143], a[144:147], v[112:115], v[128:143]
  s_waitcnt lgkmcnt(8)
  ds_read_b64_tr_b16 a[168:169], v15 offset:14336
  ds_read_b64_tr_b16 a[170:171], v15 offset:15360
  v_mfma_f32_32x32x16_bf16 v[144:159], a[148:151], v[112:115], v[144:159]
  s_waitcnt lgkmcnt(8)
  ds_read_b64_tr_b16 a[172:173], v15 offset:14592
  s_waitcnt vmcnt(33)
  ds_read_b64_tr_b16 a[174:175], v15 offset:15616
  s_barrier
  v_mfma_f32_32x32x16_bf16 v[128:143], a[152:155], v[116:119], v[128:143]
  s_waitcnt lgkmcnt(8)
  ds_read_b64_tr_b16 a[144:145], v15 offset:16384
  s_add_u32 s67, s64, 0x400
  ds_read_b64_tr_b16 a[146:147], v15 offset:17408
  s_add_u32 m0, s54, 0xc000
  s_nop 0
  buffer_load_dwordx4 v30, s[36:39], s67 offen lds
  v_mfma_f32_32x32x16_bf16 v[144:159], a[156:159], v[116:119], v[144:159]
  s_waitcnt lgkmcnt(8)
  ds_read_b64_tr_b16 a[148:149], v15 offset:16640
  ds_read_b64_tr_b16 a[150:151], v15 offset:17664
  v_mfma_f32_32x32x16_bf16 v[128:143], a[160:163], v[120:123], v[128:143]
  s_waitcnt lgkmcnt(8)
  ds_read_b64_tr_b16 a[152:153], v15 offset:18432
  s_add_u32 m0, s54, 0xc400
  ds_read_b64_tr_b16 a[154:155], v15 offset:19456
  v_mfma_f32_32x32x16_bf16 v[144:159], a[164:167], v[120:123], v[144:159]
  s_waitcnt lgkmcnt(8)
  ds_read_b64_tr_b16 a[156:157], v15 offset:18688
  ds_read_b64_tr_b16 a[158:159], v15 offset:19712
  buffer_load_dwordx4 v31, s[36:39], s67 offen lds
  v_mfma_f32_32x32x16_bf16 v[128:143], a[168:171], v[124:127], v[128:143]
  s_waitcnt lgkmcnt(8)
  ds_read_b64_tr_b16 a[160:161], v15 offset:20480
  ds_read_b64_tr_b16 a[162:163], v15 offset:21504
  v_mfma_f32_32x32x16_bf16 v[144:159], a[172:175], v[124:127], v[144:159]
  s_waitcnt lgkmcnt(8)
  ds_read_b64_tr_b16 a[164:165], v15 offset:20736
  s_add_u32 m0, s54, 0xc800
  ds_read_b64_tr_b16 a[166:167], v15 offset:21760
  v_mfma_f32_32x32x16_bf16 v[160:175], a[144:147], v[64:67], 0
  s_waitcnt lgkmcnt(8)
  ds_read_b64_tr_b16 a[168:169], v15 offset:22528
  ds_read_b64_tr_b16 a[170:171], v15 offset:23552
  buffer_load_dwordx4 v32, s[36:39], s67 offen lds
  v_mfma_f32_32x32x16_bf16 v[176:191], a[148:151], v[64:67], 0
  s_waitcnt lgkmcnt(8)
  ds_read_b64_tr_b16 a[172:173], v15 offset:22784
  ds_read_b64_tr_b16 a[174:175], v15 offset:23808
  v_mfma_f32_32x32x16_bf16 v[160:175], a[152:155], v[68:71], v[160:175]
  s_waitcnt lgkmcnt(8)
  ds_read_b64_tr_b16 a[144:145], v15 offset:24576
  s_add_u32 m0, s54, 0xcc00
  ds_read_b64_tr_b16 a[146:147], v15 offset:25600
  v_cvt_pk_bf16_f32 v192, v128, v129
  v_cvt_pk_bf16_f32 v193, v130, v131
  v_cvt_pk_bf16_f32 v194, v132, v133
  v_mfma_f32_32x32x16_bf16 v[176:191], a[156:159], v[68:71], v[176:191]
  s_waitcnt lgkmcnt(8)
  ds_read_b64_tr_b16 a[148:149], v15 offset:24832
  ds_read_b64_tr_b16 a[150:151], v15 offset:25856
  buffer_load_dwordx4 v33, s[36:39], s67 offen lds
  v_cvt_pk_bf16_f32 v195, v134, v135
  v_mfma_f32_32x32x16_bf16 v[160:175], a[160:163], v[72:75], v[160:175]
  s_waitcnt lgkmcnt(8)
  ds_read_b64_tr_b16 a[152:153], v15 offset:26624
  s_add_u32 s57, s66, 0x1000
  ds_read_b64_tr_b16 a[154:155], v15 offset:27648
  buffer_store_dwordx4 v[192:195], v13, s[12:15], s57 offen sc1
  v_mfma_f32_32x32x16_bf16 v[176:191], a[164:167], v[72:75], v[176:191]
  s_waitcnt lgkmcnt(8)
  ds_read_b64_tr_b16 a[156:157], v15 offset:26880
  ds_read_b64_tr_b16 a[158:159], v15 offset:27904
  v_mfma_f32_32x32x16_bf16 v[160:175], a[168:171], v[76:79], v[160:175]
  s_waitcnt lgkmcnt(8)
  ds_read_b64_tr_b16 a[160:161], v15 offset:28672
  ds_read_b64_tr_b16 a[162:163], v15 offset:29696
  v_mfma_f32_32x32x16_bf16 v[176:191], a[172:175], v[76:79], v[176:191]
  s_waitcnt lgkmcnt(8)
  ds_read_b64_tr_b16 a[164:165], v15 offset:28928
  ds_read_b64_tr_b16 a[166:167], v15 offset:29952
  v_mfma_f32_32x32x16_bf16 v[160:175], a[144:147], v[80:83], v[160:175]
  s_waitcnt lgkmcnt(8)
  ds_read_b64_tr_b16 a[168:169], v15 offset:30720
  ds_read_b64_tr_b16 a[170:171], v15 offset:31744
  v_cvt_pk_bf16_f32 v196, v136, v137
  v_cvt_pk_bf16_f32 v197, v138, v139
  v_cvt_pk_bf16_f32 v198, v140, v141
  v_mfma_f32_32x32x16_bf16 v[176:191], a[148:151], v[80:83], v[176:191]
  s_waitcnt lgkmcnt(8)
  ds_read_b64_tr_b16 a[172:173], v15 offset:30976
  s_waitcnt vmcnt(30)
  ds_read_b64_tr_b16 a[174:175], v15 offset:32000
  s_barrier
  v_cvt_pk_bf16_f32 v199, v142, v143
  s_add_u32 s57, s66, 0x1100
  v_mfma_f32_32x32x16_bf16 v[160:175], a[152:155], v[84:87], v[160:175]
  s_waitcnt lgkmcnt(8)
  ds_read_b64_tr_b16 a[144:145], v15 offset:32768
  s_add_u32 s67, s64, 0x24400
  ds_read_b64_tr_b16 a[146:147], v15 offset:33792
  s_add_u32 m0, s54, 0x10000
  s_nop 0
  buffer_load_dwordx4 v30, s[36:39], s67 offen lds
  v_mfma_f32_32x32x16_bf16 v[176:191], a[156:159], v[84:87], v[176:191]
  s_waitcnt lgkmcnt(8)
  ds_read_b64_tr_b16 a[148:149], v15 offset:33024
  ds_read_b64_tr_b16 a[150:151], v15 offset:34048
  buffer_store_dwordx4 v[196:199], v13, s[12:15], s57 offen sc1
  v_mfma_f32_32x32x16_bf16 v[160:175], a[160:163], v[88:91], v[160:175]
  s_waitcnt lgkmcnt(8)
  ds_read_b64_tr_b16 a[152:153], v15 offset:34816
  s_add_u32 m0, s54, 0x10400
  ds_read_b64_tr_b16 a[154:155], v15 offset:35840
  v_mfma_f32_32x32x16_bf16 v[176:191], a[164:167], v[88:91], v[176:191]
  s_waitcnt lgkmcnt(8)
  ds_read_b64_tr_b16 a[156:157], v15 offset:35072
  ds_read_b64_tr_b16 a[158:159], v15 offset:36096
  buffer_load_dwordx4 v31, s[36:39], s67 offen lds
  v_mfma_f32_32x32x16_bf16 v[160:175], a[168:171], v[92:95], v[160:175]
  s_waitcnt lgkmcnt(8)
  ds_read_b64_tr_b16 a[160:161], v15 offset:36864
  ds_read_b64_tr_b16 a[162:163], v15 offset:37888
  v_cvt_pk_bf16_f32 v200, v144, v145
  v_cvt_pk_bf16_f32 v201, v146, v147
  v_cvt_pk_bf16_f32 v202, v148, v149
  v_mfma_f32_32x32x16_bf16 v[176:191], a[172:175], v[92:95], v[176:191]
  s_waitcnt lgkmcnt(8)
  ds_read_b64_tr_b16 a[164:165], v15 offset:37120
  s_add_u32 m0, s54, 0x10800
  ds_read_b64_tr_b16 a[166:167], v15 offset:38144
  v_cvt_pk_bf16_f32 v203, v150, v151
  s_add_u32 s57, s66, 0x1200
  v_mfma_f32_32x32x16_bf16 v[160:175], a[144:147], v[96:99], v[160:175]
  s_waitcnt lgkmcnt(8)
  ds_read_b64_tr_b16 a[168:169], v15 offset:38912
  ds_read_b64_tr_b16 a[170:171], v15 offset:39936
  buffer_load_dwordx4 v32, s[36:39], s67 offen lds
  v_mfma_f32_32x32x16_bf16 v[176:191], a[148:151], v[96:99], v[176:191]
  s_waitcnt lgkmcnt(8)
  ds_read_b64_tr_b16 a[172:173], v15 offset:39168
  ds_read_b64_tr_b16 a[174:175], v15 offset:40192
  buffer_store_dwordx4 v[200:203], v13, s[12:15], s57 offen sc1
  v_mfma_f32_32x32x16_bf16 v[160:175], a[152:155], v[100:103], v[160:175]
  s_waitcnt lgkmcnt(8)
  ds_read_b64_tr_b16 a[144:145], v15 offset:40960
  s_add_u32 m0, s54, 0x10c00
  ds_read_b64_tr_b16 a[146:147], v15 offset:41984
  v_mfma_f32_32x32x16_bf16 v[176:191], a[156:159], v[100:103], v[176:191]
  s_waitcnt lgkmcnt(8)
  ds_read_b64_tr_b16 a[148:149], v15 offset:41216
  ds_read_b64_tr_b16 a[150:151], v15 offset:42240
  buffer_load_dwordx4 v33, s[36:39], s67 offen lds
  v_mfma_f32_32x32x16_bf16 v[160:175], a[160:163], v[104:107], v[160:175]
  s_waitcnt lgkmcnt(8)
  ds_read_b64_tr_b16 a[152:153], v15 offset:43008
  ds_read_b64_tr_b16 a[154:155], v15 offset:44032
  v_cvt_pk_bf16_f32 v204, v152, v153
  v_cvt_pk_bf16_f32 v205, v154, v155
  v_cvt_pk_bf16_f32 v206, v156, v157
  v_mfma_f32_32x32x16_bf16 v[176:191], a[164:167], v[104:107], v[176:191]
  s_waitcnt lgkmcnt(8)
  ds_read_b64_tr_b16 a[156:157], v15 offset:43264
  ds_read_b64_tr_b16 a[158:159], v15 offset:44288
  v_cvt_pk_bf16_f32 v207, v158, v159
  s_add_u32 s57, s66, 0x1300
  v_mfma_f32_32x32x16_bf16 v[160:175], a[168:171], v[108:111], v[160:175]
  s_waitcnt lgkmcnt(8)
  ds_read_b64_tr_b16 a[160:161], v15 offset:45056
  ds_read_b64_tr_b16 a[162:163], v15 offset:46080
  buffer_store_dwordx4 v[204:207], v13, s[12:15], s57 offen sc1
  v_mfma_f32_32x32x16_bf16 v[176:191], a[172:175], v[108:111], v[176:191]
  s_waitcnt lgkmcnt(8)
  ds_read_b64_tr_b16 a[164:165], v15 offset:45312
  ds_read_b64_tr_b16 a[166:167], v15 offset:46336
  v_mfma_f32_32x32x16_bf16 v[160:175], a[144:147], v[112:115], v[160:175]
  s_waitcnt lgkmcnt(8)
  ds_read_b64_tr_b16 a[168:169], v15 offset:47104
  ds_read_b64_tr_b16 a[170:171], v15 offset:48128
  v_mfma_f32_32x32x16_bf16 v[176:191], a[148:151], v[112:115], v[176:191]
  s_waitcnt lgkmcnt(8)
  ds_read_b64_tr_b16 a[172:173], v15 offset:47360
  s_waitcnt vmcnt(32)
  ds_read_b64_tr_b16 a[174:175], v15 offset:48384
  s_barrier
  v_mfma_f32_32x32x16_bf16 v[160:175], a[152:155], v[116:119], v[160:175]
  s_waitcnt lgkmcnt(8)
  ds_read_b64_tr_b16 a[144:145], v15 offset:49152
  s_add_u32 s67, s77, 0
  ds_read_b64_tr_b16 a[146:147], v15 offset:50176
  s_add_u32 m0, s54, 0x14000
  s_nop 0
  buffer_load_dwordx4 v19, s[32:35], s67 offen lds
  v_mfma_f32_32x32x16_bf16 v[176:191], a[156:159], v[116:119], v[176:191]
  s_waitcnt lgkmcnt(8)
  ds_read_b64_tr_b16 a[148:149], v15 offset:49408
  ds_read_b64_tr_b16 a[150:151], v15 offset:50432
  v_mfma_f32_32x32x16_bf16 v[160:175], a[160:163], v[120:123], v[160:175]
  s_waitcnt lgkmcnt(8)
  ds_read_b64_tr_b16 a[152:153], v15 offset:51200
  s_add_u32 m0, s54, 0x14400
  ds_read_b64_tr_b16 a[154:155], v15 offset:52224
  v_mfma_f32_32x32x16_bf16 v[176:191], a[164:167], v[120:123], v[176:191]
  s_waitcnt lgkmcnt(8)
  ds_read_b64_tr_b16 a[156:157], v15 offset:51456
  ds_read_b64_tr_b16 a[158:159], v15 offset:52480
  buffer_load_dwordx4 v19, s[44:47], s67 offen lds
  v_mfma_f32_32x32x16_bf16 v[160:175], a[168:171], v[124:127], v[160:175]
  s_waitcnt lgkmcnt(8)
  ds_read_b64_tr_b16 a[160:161], v15 offset:53248
  ds_read_b64_tr_b16 a[162:163], v15 offset:54272
  v_mfma_f32_32x32x16_bf16 v[176:191], a[172:175], v[124:127], v[176:191]
  s_waitcnt lgkmcnt(8)
  ds_read_b64_tr_b16 a[164:165], v15 offset:53504
  s_add_u32 m0, s54, 0x14800
  ds_read_b64_tr_b16 a[166:167], v15 offset:54528
  v_mfma_f32_32x32x16_bf16 v[128:143], a[144:147], v[64:67], 0
  s_waitcnt lgkmcnt(8)
  ds_read_b64_tr_b16 a[168:169], v15 offset:55296
  ds_read_b64_tr_b16 a[170:171], v15 offset:56320
  buffer_load_dwordx4 v20, s[32:35], s67 offen lds
  v_mfma_f32_32x32x16_bf16 v[144:159], a[148:151], v[64:67], 0
  s_waitcnt lgkmcnt(8)
  ds_read_b64_tr_b16 a[172:173], v15 offset:55552
  ds_read_b64_tr_b16 a[174:175], v15 offset:56576
  v_mfma_f32_32x32x16_bf16 v[128:143], a[152:155], v[68:71], v[128:143]
  s_waitcnt lgkmcnt(8)
  ds_read_b64_tr_b16 a[144:145], v15 offset:57344
  s_add_u32 m0, s54, 0x14c00
  ds_read_b64_tr_b16 a[146:147], v15 offset:58368
  v_cvt_pk_bf16_f32 v192, v160, v161
  v_cvt_pk_bf16_f32 v193, v162, v163
  v_cvt_pk_bf16_f32 v194, v164, v165
  v_mfma_f32_32x32x16_bf16 v[144:159], a[156:159], v[68:71], v[144:159]
  s_waitcnt lgkmcnt(8)
  ds_read_b64_tr_b16 a[148:149], v15 offset:57600
  ds_read_b64_tr_b16 a[150:151], v15 offset:58624
  buffer_load_dwordx4 v20, s[44:47], s67 offen lds
  v_cvt_pk_bf16_f32 v195, v166, v167
  v_mfma_f32_32x32x16_bf16 v[128:143], a[160:163], v[72:75], v[128:143]
  s_waitcnt lgkmcnt(8)
  ds_read_b64_tr_b16 a[152:153], v15 offset:59392
  s_add_u32 s57, s66, 0x1400
  ds_read_b64_tr_b16 a[154:155], v15 offset:60416
  buffer_store_dwordx4 v[192:195], v13, s[12:15], s57 offen sc1
  v_mfma_f32_32x32x16_bf16 v[144:159], a[164:167], v[72:75], v[144:159]
  s_waitcnt lgkmcnt(8)
  ds_read_b64_tr_b16 a[156:157], v15 offset:59648
  ds_read_b64_tr_b16 a[158:159], v15 offset:60672
  v_mfma_f32_32x32x16_bf16 v[128:143], a[168:171], v[76:79], v[128:143]
  s_waitcnt lgkmcnt(8)
  ds_read_b64_tr_b16 a[160:161], v15 offset:61440
  ds_read_b64_tr_b16 a[162:163], v15 offset:62464
  v_mfma_f32_32x32x16_bf16 v[144:159], a[172:175], v[76:79], v[144:159]
  s_waitcnt lgkmcnt(8)
  ds_read_b64_tr_b16 a[164:165], v15 offset:61696
  s_waitcnt vmcnt(17)
  ds_read_b64_tr_b16 a[166:167], v15 offset:62720
  s_barrier
  v_mov_b32 v57, 1
  buffer_atomic_add v57, v16, s[8:11], 0 offen offset:128 sc1
  v_mfma_f32_32x32x16_bf16 v[128:143], a[144:147], v[80:83], v[128:143]
  s_waitcnt lgkmcnt(8)
  ds_read_b64_tr_b16 a[168:169], v15 offset:63488
  ds_read_b64_tr_b16 a[170:171], v15 offset:64512
  v_cvt_pk_bf16_f32 v196, v168, v169
  v_cvt_pk_bf16_f32 v197, v170, v171
  v_cvt_pk_bf16_f32 v198, v172, v173
  v_mfma_f32_32x32x16_bf16 v[144:159], a[148:151], v[80:83], v[144:159]
  s_waitcnt lgkmcnt(8)
  ds_read_b64_tr_b16 a[172:173], v15 offset:63744
  ds_read_b64_tr_b16 a[174:175], v15 offset:64768
  s_barrier
  v_cvt_pk_bf16_f32 v199, v174, v175
  s_add_u32 s57, s66, 0x1500
  v_mfma_f32_32x32x16_bf16 v[128:143], a[152:155], v[84:87], v[128:143]
  s_waitcnt lgkmcnt(8)
  ds_read_b64_tr_b16 a[144:145], v14
  s_add_u32 s67, s77, 0x90000
  ds_read_b64_tr_b16 a[146:147], v14 offset:1024
  s_add_u32 m0, s54, 0x18000
  s_nop 0
  buffer_load_dwordx4 v19, s[32:35], s67 offen lds
  v_mfma_f32_32x32x16_bf16 v[144:159], a[156:159], v[84:87], v[144:159]
  s_waitcnt lgkmcnt(8)
  ds_read_b64_tr_b16 a[148:149], v14 offset:256
  ds_read_b64_tr_b16 a[150:151], v14 offset:1280
  buffer_store_dwordx4 v[196:199], v13, s[12:15], s57 offen sc1
  v_mfma_f32_32x32x16_bf16 v[128:143], a[160:163], v[88:91], v[128:143]
  s_waitcnt lgkmcnt(8)
  ds_read_b64_tr_b16 a[152:153], v14 offset:2048
  s_add_u32 m0, s54, 0x18400
  ds_read_b64_tr_b16 a[154:155], v14 offset:3072
  v_mfma_f32_32x32x16_bf16 v[144:159], a[164:167], v[88:91], v[144:159]
  s_waitcnt lgkmcnt(8)
  ds_read_b64_tr_b16 a[156:157], v14 offset:2304
  ds_read_b64_tr_b16 a[158:159], v14 offset:3328
  buffer_load_dwordx4 v19, s[44:47], s67 offen lds
  v_mfma_f32_32x32x16_bf16 v[128:143], a[168:171], v[92:95], v[128:143]
  s_waitcnt lgkmcnt(8)
  ds_read_b64_tr_b16 a[160:161], v14 offset:4096
  ds_read_b64_tr_b16 a[162:163], v14 offset:5120
  v_cvt_pk_bf16_f32 v200, v176, v177
  v_cvt_pk_bf16_f32 v201, v178, v179
  v_cvt_pk_bf16_f32 v202, v180, v181
  v_mfma_f32_32x32x16_bf16 v[144:159], a[172:175], v[92:95], v[144:159]
  s_waitcnt lgkmcnt(8)
  ds_read_b64_tr_b16 a[164:165], v14 offset:4352
  s_add_u32 m0, s54, 0x18800
  ds_read_b64_tr_b16 a[166:167], v14 offset:5376
  v_cvt_pk_bf16_f32 v203, v182, v183
  s_add_u32 s57, s66, 0x1600
  v_mfma_f32_32x32x16_bf16 v[128:143], a[144:147], v[96:99], v[128:143]
  s_waitcnt lgkmcnt(8)
  ds_read_b64_tr_b16 a[168:169], v14 offset:6144
  ds_read_b64_tr_b16 a[170:171], v14 offset:7168
  buffer_load_dwordx4 v20, s[32:35], s67 offen lds
  v_mfma_f32_32x32x16_bf16 v[144:159], a[148:151], v[96:99], v[144:159]
  s_waitcnt lgkmcnt(8)
  ds_read_b64_tr_b16 a[172:173], v14 offset:6400
  ds_read_b64_tr_b16 a[174:175], v14 offset:7424
  buffer_store_dwordx4 v[200:203], v13, s[12:15], s57 offen sc1
  v_mfma_f32_32x32x16_bf16 v[128:143], a[152:155], v[100:103], v[128:143]
  s_waitcnt lgkmcnt(8)
  ds_read_b64_tr_b16 a[144:145], v14 offset:8192
  s_add_u32 m0, s54, 0x18c00
  ds_read_b64_tr_b16 a[146:147], v14 offset:9216
  v_mfma_f32_32x32x16_bf16 v[144:159], a[156:159], v[100:103], v[144:159]
  s_waitcnt lgkmcnt(8)
  ds_read_b64_tr_b16 a[148:149], v14 offset:8448
  ds_read_b64_tr_b16 a[150:151], v14 offset:9472
  buffer_load_dwordx4 v20, s[44:47], s67 offen lds
  v_mfma_f32_32x32x16_bf16 v[128:143], a[160:163], v[104:107], v[128:143]
  s_waitcnt lgkmcnt(8)
  ds_read_b64_tr_b16 a[152:153], v14 offset:10240
  ds_read_b64_tr_b16 a[154:155], v14 offset:11264
  v_cvt_pk_bf16_f32 v204, v184, v185
  v_cvt_pk_bf16_f32 v205, v186, v187
  v_cvt_pk_bf16_f32 v206, v188, v189
  v_mfma_f32_32x32x16_bf16 v[144:159], a[164:167], v[104:107], v[144:159]
  s_waitcnt lgkmcnt(8)
  ds_read_b64_tr_b16 a[156:157], v14 offset:10496
  ds_read_b64_tr_b16 a[158:159], v14 offset:11520
  v_cvt_pk_bf16_f32 v207, v190, v191
  s_add_u32 s57, s66, 0x1700
  v_mfma_f32_32x32x16_bf16 v[128:143], a[168:171], v[108:111], v[128:143]
  s_waitcnt lgkmcnt(8)
  ds_read_b64_tr_b16 a[160:161], v14 offset:12288
  ds_read_b64_tr_b16 a[162:163], v14 offset:13312
  buffer_store_dwordx4 v[204:207], v13, s[12:15], s57 offen sc1
  v_mfma_f32_32x32x16_bf16 v[144:159], a[172:175], v[108:111], v[144:159]
  s_waitcnt lgkmcnt(8)
  ds_read_b64_tr_b16 a[164:165], v14 offset:12544
  ds_read_b64_tr_b16 a[166:167], v14 offset:13568
  v_mfma_f32_32x32x16_bf16 v[128:143], a[144:147], v[112:115], v[128:143]
  s_waitcnt lgkmcnt(8)
  ds_read_b64_tr_b16 a[168:169], v14 offset:14336
  ds_read_b64_tr_b16 a[170:171], v14 offset:15360
  v_mfma_f32_32x32x16_bf16 v[144:159], a[148:151], v[112:115], v[144:159]
  s_waitcnt lgkmcnt(8)
  ds_read_b64_tr_b16 a[172:173], v14 offset:14592
  ds_read_b64_tr_b16 a[174:175], v14 offset:15616
  s_barrier
  v_mfma_f32_32x32x16_bf16 v[128:143], a[152:155], v[116:119], v[128:143]
  s_waitcnt lgkmcnt(8)
  ds_read_b64_tr_b16 a[144:145], v14 offset:16384
  s_add_u32 s67, s77, 0x120000
  ds_read_b64_tr_b16 a[146:147], v14 offset:17408
  s_add_u32 m0, s54, 0x1c000
  s_nop 0
  buffer_load_dwordx4 v19, s[32:35], s67 offen lds
  v_mfma_f32_32x32x16_bf16 v[144:159], a[156:159], v[116:119], v[144:159]
  s_waitcnt lgkmcnt(8)
  ds_read_b64_tr_b16 a[148:149], v14 offset:16640
  ds_read_b64_tr_b16 a[150:151], v14 offset:17664
  v_mfma_f32_32x32x16_bf16 v[128:143], a[160:163], v[120:123], v[128:143]
  s_waitcnt lgkmcnt(8)
  ds_read_b64_tr_b16 a[152:153], v14 offset:18432
  s_add_u32 m0, s54, 0x1c400
  ds_read_b64_tr_b16 a[154:155], v14 offset:19456
  v_mfma_f32_32x32x16_bf16 v[144:159], a[164:167], v[120:123], v[144:159]
  s_waitcnt lgkmcnt(8)
  ds_read_b64_tr_b16 a[156:157], v14 offset:18688
  ds_read_b64_tr_b16 a[158:159], v14 offset:19712
  buffer_load_dwordx4 v19, s[44:47], s67 offen lds
  v_mfma_f32_32x32x16_bf16 v[128:143], a[168:171], v[124:127], v[128:143]
  s_waitcnt lgkmcnt(8)
  ds_read_b64_tr_b16 a[160:161], v14 offset:20480
  ds_read_b64_tr_b16 a[162:163], v14 offset:21504
  v_mfma_f32_32x32x16_bf16 v[144:159], a[172:175], v[124:127], v[144:159]
  s_waitcnt lgkmcnt(8)
  ds_read_b64_tr_b16 a[164:165], v14 offset:20736
  s_add_u32 m0, s54, 0x1c800
  ds_read_b64_tr_b16 a[166:167], v14 offset:21760
  v_mfma_f32_32x32x16_bf16 v[160:175], a[144:147], v[64:67], 0
  s_waitcnt lgkmcnt(8)
  ds_read_b64_tr_b16 a[168:169], v14 offset:22528
  ds_read_b64_tr_b16 a[170:171], v14 offset:23552
  buffer_load_dwordx4 v20, s[32:35], s67 offen lds
  v_mfma_f32_32x32x16_bf16 v[176:191], a[148:151], v[64:67], 0
  s_waitcnt lgkmcnt(8)
  ds_read_b64_tr_b16 a[172:173], v14 offset:22784
  ds_read_b64_tr_b16 a[174:175], v14 offset:23808
  v_mfma_f32_32x32x16_bf16 v[160:175], a[152:155], v[68:71], v[160:175]
  s_waitcnt lgkmcnt(8)
  ds_read_b64_tr_b16 a[144:145], v14 offset:24576
  s_add_u32 m0, s54, 0x1cc00
  ds_read_b64_tr_b16 a[146:147], v14 offset:25600
  v_cvt_pk_bf16_f32 v192, v128, v129
  v_cvt_pk_bf16_f32 v193, v130, v131
  v_cvt_pk_bf16_f32 v194, v132, v133
  v_mfma_f32_32x32x16_bf16 v[176:191], a[156:159], v[68:71], v[176:191]
  s_waitcnt lgkmcnt(8)
  ds_read_b64_tr_b16 a[148:149], v14 offset:24832
  ds_read_b64_tr_b16 a[150:151], v14 offset:25856
  buffer_load_dwordx4 v20, s[44:47], s67 offen lds
  v_cvt_pk_bf16_f32 v195, v134, v135
  v_mfma_f32_32x32x16_bf16 v[160:175], a[160:163], v[72:75], v[160:175]
  s_waitcnt lgkmcnt(8)
  ds_read_b64_tr_b16 a[152:153], v14 offset:26624
  s_add_u32 s57, s66, 0x1800
  ds_read_b64_tr_b16 a[154:155], v14 offset:27648
  buffer_store_dwordx4 v[192:195], v13, s[12:15], s57 offen sc1
  v_mfma_f32_32x32x16_bf16 v[176:191], a[164:167], v[72:75], v[176:191]
  s_waitcnt lgkmcnt(8)
  ds_read_b64_tr_b16 a[156:157], v14 offset:26880
  ds_read_b64_tr_b16 a[158:159], v14 offset:27904
  v_mfma_f32_32x32x16_bf16 v[160:175], a[168:171], v[76:79], v[160:175]
  s_waitcnt lgkmcnt(8)
  ds_read_b64_tr_b16 a[160:161], v14 offset:28672
  ds_read_b64_tr_b16 a[162:163], v14 offset:29696
  v_mfma_f32_32x32x16_bf16 v[176:191], a[172:175], v[76:79], v[176:191]
  s_waitcnt lgkmcnt(8)
  ds_read_b64_tr_b16 a[164:165], v14 offset:28928
  ds_read_b64_tr_b16 a[166:167], v14 offset:29952
  v_mfma_f32_32x32x16_bf16 v[160:175], a[144:147], v[80:83], v[160:175]
  s_waitcnt lgkmcnt(8)
  ds_read_b64_tr_b16 a[168:169], v14 offset:30720
  ds_read_b64_tr_b16 a[170:171], v14 offset:31744
  v_cvt_pk_bf16_f32 v196, v136, v137
  v_cvt_pk_bf16_f32 v197, v138, v139
  v_cvt_pk_bf16_f32 v198, v140, v141
  v_mfma_f32_32x32x16_bf16 v[176:191], a[148:151], v[80:83], v[176:191]
  s_waitcnt lgkmcnt(8)
  ds_read_b64_tr_b16 a[172:173], v14 offset:30976
  ds_read_b64_tr_b16 a[174:175], v14 offset:32000
  s_barrier
  v_cvt_pk_bf16_f32 v199, v142, v143
  s_add_u32 s57, s66, 0x1900
  v_mfma_f32_32x32x16_bf16 v[160:175], a[152:155], v[84:87], v[160:175]
  s_waitcnt lgkmcnt(8)
  ds_read_b64_tr_b16 a[144:145], v14 offset:32768
  s_add_u32 s67, s77, 0x1b0000
  ds_read_b64_tr_b16 a[146:147], v14 offset:33792
  s_add_u32 m0, s54, 0
  s_nop 0
  buffer_load_dwordx4 v19, s[32:35], s67 offen lds
  v_mfma_f32_32x32x16_bf16 v[176:191], a[156:159], v[84:87], v[176:191]
  s_waitcnt lgkmcnt(8)
  ds_read_b64_tr_b16 a[148:149], v14 offset:33024
  ds_read_b64_tr_b16 a[150:151], v14 offset:34048
  buffer_store_dwordx4 v[196:199], v13, s[12:15], s57 offen sc1
  v_mfma_f32_32x32x16_bf16 v[160:175], a[160:163], v[88:91], v[160:175]
  s_waitcnt lgkmcnt(8)
  ds_read_b64_tr_b16 a[152:153], v14 offset:34816
  s_add_u32 m0, s54, 0x400
  ds_read_b64_tr_b16 a[154:155], v14 offset:35840
  v_mfma_f32_32x32x16_bf16 v[176:191], a[164:167], v[88:91], v[176:191]
  s_waitcnt lgkmcnt(8)
  ds_read_b64_tr_b16 a[156:157], v14 offset:35072
  ds_read_b64_tr_b16 a[158:159], v14 offset:36096
  buffer_load_dwordx4 v19, s[44:47], s67 offen lds
  v_mfma_f32_32x32x16_bf16 v[160:175], a[168:171], v[92:95], v[160:175]
  s_waitcnt lgkmcnt(8)
  ds_read_b64_tr_b16 a[160:161], v14 offset:36864
  ds_read_b64_tr_b16 a[162:163], v14 offset:37888
  v_cvt_pk_bf16_f32 v200, v144, v145
  v_cvt_pk_bf16_f32 v201, v146, v147
  v_cvt_pk_bf16_f32 v202, v148, v149
  v_mfma_f32_32x32x16_bf16 v[176:191], a[172:175], v[92:95], v[176:191]
  s_waitcnt lgkmcnt(8)
  ds_read_b64_tr_b16 a[164:165], v14 offset:37120
  s_add_u32 m0, s54, 0x800
  ds_read_b64_tr_b16 a[166:167], v14 offset:38144
  v_cvt_pk_bf16_f32 v203, v150, v151
  s_add_u32 s57, s66, 0x1a00
  v_mfma_f32_32x32x16_bf16 v[160:175], a[144:147], v[96:99], v[160:175]
  s_waitcnt lgkmcnt(8)
  ds_read_b64_tr_b16 a[168:169], v14 offset:38912
  ds_read_b64_tr_b16 a[170:171], v14 offset:39936
  buffer_load_dwordx4 v20, s[32:35], s67 offen lds
  v_mfma_f32_32x32x16_bf16 v[176:191], a[148:151], v[96:99], v[176:191]
  s_waitcnt lgkmcnt(8)
  ds_read_b64_tr_b16 a[172:173], v14 offset:39168
  ds_read_b64_tr_b16 a[174:175], v14 offset:40192
  buffer_store_dwordx4 v[200:203], v13, s[12:15], s57 offen sc1
  v_mfma_f32_32x32x16_bf16 v[160:175], a[152:155], v[100:103], v[160:175]
  s_waitcnt lgkmcnt(8)
  ds_read_b64_tr_b16 a[144:145], v14 offset:40960
  s_add_u32 m0, s54, 0xc00
  ds_read_b64_tr_b16 a[146:147], v14 offset:41984
  v_mfma_f32_32x32x16_bf16 v[176:191], a[156:159], v[100:103], v[176:191]
  s_waitcnt lgkmcnt(8)
  ds_read_b64_tr_b16 a[148:149], v14 offset:41216
  ds_read_b64_tr_b16 a[150:151], v14 offset:42240
  buffer_load_dwordx4 v20, s[44:47], s67 offen lds
  v_mfma_f32_32x32x16_bf16 v[160:175], a[160:163], v[104:107], v[160:175]
  s_waitcnt lgkmcnt(8)
  ds_read_b64_tr_b16 a[152:153], v14 offset:43008
  ds_read_b64_tr_b16 a[154:155], v14 offset:44032
  v_cvt_pk_bf16_f32 v204, v152, v153
  v_cvt_pk_bf16_f32 v205, v154, v155
  v_cvt_pk_bf16_f32 v206, v156, v157
  v_mfma_f32_32x32x16_bf16 v[176:191], a[164:167], v[104:107], v[176:191]
  s_waitcnt lgkmcnt(8)
  ds_read_b64_tr_b16 a[156:157], v14 offset:43264
  ds_read_b64_tr_b16 a[158:159], v14 offset:44288
  v_cvt_pk_bf16_f32 v207, v158, v159
  s_add_u32 s57, s66, 0x1b00
  v_mfma_f32_32x32x16_bf16 v[160:175], a[168:171], v[108:111], v[160:175]
  s_waitcnt lgkmcnt(8)
  ds_read_b64_tr_b16 a[160:161], v14 offset:45056
  ds_read_b64_tr_b16 a[162:163], v14 offset:46080
  buffer_store_dwordx4 v[204:207], v13, s[12:15], s57 offen sc1
  v_mfma_f32_32x32x16_bf16 v[176:191], a[172:175], v[108:111], v[176:191]
  s_waitcnt lgkmcnt(8)
  ds_read_b64_tr_b16 a[164:165], v14 offset:45312
  ds_read_b64_tr_b16 a[166:167], v14 offset:46336
  v_mfma_f32_32x32x16_bf16 v[160:175], a[144:147], v[112:115], v[160:175]
  s_waitcnt lgkmcnt(8)
  ds_read_b64_tr_b16 a[168:169], v14 offset:47104
  ds_read_b64_tr_b16 a[170:171], v14 offset:48128
  v_mfma_f32_32x32x16_bf16 v[176:191], a[148:151], v[112:115], v[176:191]
  s_waitcnt lgkmcnt(8)
  ds_read_b64_tr_b16 a[172:173], v14 offset:47360
  s_waitcnt vmcnt(33)
  ds_read_b64_tr_b16 a[174:175], v14 offset:48384
  s_barrier
  v_mfma_f32_32x32x16_bf16 v[160:175], a[152:155], v[116:119], v[160:175]
  s_waitcnt lgkmcnt(8)
  ds_read_b64_tr_b16 a[144:145], v14 offset:49152
  s_add_u32 s67, s77, 0x240000
  ds_read_b64_tr_b16 a[146:147], v14 offset:50176
  s_add_u32 m0, s54, 0x4000
  s_nop 0
  buffer_load_dwordx4 v19, s[32:35], s67 offen lds
  v_mfma_f32_32x32x16_bf16 v[176:191], a[156:159], v[116:119], v[176:191]
  s_waitcnt lgkmcnt(8)
  ds_read_b64_tr_b16 a[148:149], v14 offset:49408
  ds_read_b64_tr_b16 a[150:151], v14 offset:50432
  v_mfma_f32_32x32x16_bf16 v[160:175], a[160:163], v[120:123], v[160:175]
  s_waitcnt lgkmcnt(8)
  ds_read_b64_tr_b16 a[152:153], v14 offset:51200
  s_add_u32 m0, s54, 0x4400
  ds_read_b64_tr_b16 a[154:155], v14 offset:52224
  v_mfma_f32_32x32x16_bf16 v[176:191], a[164:167], v[120:123], v[176:191]
  s_waitcnt lgkmcnt(8)
  ds_read_b64_tr_b16 a[156:157], v14 offset:51456
  ds_read_b64_tr_b16 a[158:159], v14 offset:52480
  buffer_load_dwordx4 v19, s[44:47], s67 offen lds
  v_mfma_f32_32x32x16_bf16 v[160:175], a[168:171], v[124:127], v[160:175]
  s_waitcnt lgkmcnt(8)
  ds_read_b64_tr_b16 a[160:161], v14 offset:53248
  ds_read_b64_tr_b16 a[162:163], v14 offset:54272
  v_mfma_f32_32x32x16_bf16 v[176:191], a[172:175], v[124:127], v[176:191]
  s_waitcnt lgkmcnt(8)
  ds_read_b64_tr_b16 a[164:165], v14 offset:53504
  s_add_u32 m0, s54, 0x4800
  ds_read_b64_tr_b16 a[166:167], v14 offset:54528
  v_mfma_f32_32x32x16_bf16 v[128:143], a[144:147], v[64:67], 0
  s_waitcnt lgkmcnt(8)
  ds_read_b64_tr_b16 a[168:169], v14 offset:55296
  ds_read_b64_tr_b16 a[170:171], v14 offset:56320
  buffer_load_dwordx4 v20, s[32:35], s67 offen lds
  v_mfma_f32_32x32x16_bf16 v[144:159], a[148:151], v[64:67], 0
  s_waitcnt lgkmcnt(8)
  ds_read_b64_tr_b16 a[172:173], v14 offset:55552
  ds_read_b64_tr_b16 a[174:175], v14 offset:56576
  v_mfma_f32_32x32x16_bf16 v[128:143], a[152:155], v[68:71], v[128:143]
  s_waitcnt lgkmcnt(8)
  ds_read_b64_tr_b16 a[144:145], v14 offset:57344
  s_add_u32 m0, s54, 0x4c00
  ds_read_b64_tr_b16 a[146:147], v14 offset:58368
  v_cvt_pk_bf16_f32 v192, v160, v161
  v_cvt_pk_bf16_f32 v193, v162, v163
  v_cvt_pk_bf16_f32 v194, v164, v165
  v_mfma_f32_32x32x16_bf16 v[144:159], a[156:159], v[68:71], v[144:159]
  s_waitcnt lgkmcnt(8)
  ds_read_b64_tr_b16 a[148:149], v14 offset:57600
  ds_read_b64_tr_b16 a[150:151], v14 offset:58624
  buffer_load_dwordx4 v20, s[44:47], s67 offen lds
  v_cvt_pk_bf16_f32 v195, v166, v167
  v_mfma_f32_32x32x16_bf16 v[128:143], a[160:163], v[72:75], v[128:143]
  s_waitcnt lgkmcnt(8)
  ds_read_b64_tr_b16 a[152:153], v14 offset:59392
  s_add_u32 s57, s66, 0x1c00
  ds_read_b64_tr_b16 a[154:155], v14 offset:60416
  buffer_store_dwordx4 v[192:195], v13, s[12:15], s57 offen sc1
  v_mfma_f32_32x32x16_bf16 v[144:159], a[164:167], v[72:75], v[144:159]
  s_waitcnt lgkmcnt(8)
  ds_read_b64_tr_b16 a[156:157], v14 offset:59648
  ds_read_b64_tr_b16 a[158:159], v14 offset:60672
  buffer_load_dword v57, v17, s[8:11], 0 offen offset:128 sc1
  v_mfma_f32_32x32x16_bf16 v[128:143], a[168:171], v[76:79], v[128:143]
  s_waitcnt lgkmcnt(8)
  ds_read_b64_tr_b16 a[160:161], v14 offset:61440
  ds_read_b64_tr_b16 a[162:163], v14 offset:62464
  v_mfma_f32_32x32x16_bf16 v[144:159], a[172:175], v[76:79], v[144:159]
  s_waitcnt lgkmcnt(8)
  ds_read_b64_tr_b16 a[164:165], v14 offset:61696
  ds_read_b64_tr_b16 a[166:167], v14 offset:62720
  v_mfma_f32_32x32x16_bf16 v[128:143], a[144:147], v[80:83], v[128:143]
  s_waitcnt lgkmcnt(8)
  ds_read_b64_tr_b16 a[168:169], v14 offset:63488
  ds_read_b64_tr_b16 a[170:171], v14 offset:64512
  v_cvt_pk_bf16_f32 v196, v168, v169
  v_cvt_pk_bf16_f32 v197, v170, v171
  v_cvt_pk_bf16_f32 v198, v172, v173
  v_mfma_f32_32x32x16_bf16 v[144:159], a[148:151], v[80:83], v[144:159]
  s_waitcnt lgkmcnt(8)
  ds_read_b64_tr_b16 a[172:173], v14 offset:63744
  s_waitcnt vmcnt(32)
  ds_read_b64_tr_b16 a[174:175], v14 offset:64768
  s_barrier
  v_cvt_pk_bf16_f32 v199, v174, v175
  s_add_u32 s57, s66, 0x1d00
  v_mfma_f32_32x32x16_bf16 v[128:143], a[152:155], v[84:87], v[128:143]
  s_waitcnt lgkmcnt(8)
  ds_read_b64_tr_b16 a[144:145], v15
  s_add_u32 s67, s77, 0x2d0000
  ds_read_b64_tr_b16 a[146:147], v15 offset:1024
  s_add_u32 m0, s54, 0x8000
  s_nop 0
  buffer_load_dwordx4 v19, s[32:35], s67 offen lds
  v_mfma_f32_32x32x16_bf16 v[144:159], a[156:159], v[84:87], v[144:159]
  s_waitcnt lgkmcnt(8)
  ds_read_b64_tr_b16 a[148:149], v15 offset:256
  ds_read_b64_tr_b16 a[150:151], v15 offset:1280
  buffer_store_dwordx4 v[196:199], v13, s[12:15], s57 offen sc1
  v_mfma_f32_32x32x16_bf16 v[128:143], a[160:163], v[88:91], v[128:143]
  s_waitcnt lgkmcnt(8)
  ds_read_b64_tr_b16 a[152:153], v15 offset:2048
  s_add_u32 m0, s54, 0x8400
  ds_read_b64_tr_b16 a[154:155], v15 offset:3072
  v_mfma_f32_32x32x16_bf16 v[144:159], a[164:167], v[88:91], v[144:159]
  s_waitcnt lgkmcnt(8)
  ds_read_b64_tr_b16 a[156:157], v15 offset:2304
  ds_read_b64_tr_b16 a[158:159], v15 offset:3328
  buffer_load_dwordx4 v19, s[44:47], s67 offen lds
  v_mfma_f32_32x32x16_bf16 v[128:143], a[168:171], v[92:95], v[128:143]
  s_waitcnt lgkmcnt(8)
  ds_read_b64_tr_b16 a[160:161], v15 offset:4096
  ds_read_b64_tr_b16 a[162:163], v15 offset:5120
  v_cvt_pk_bf16_f32 v200, v176, v177
  v_cvt_pk_bf16_f32 v201, v178, v179
  v_cvt_pk_bf16_f32 v202, v180, v181
  v_mfma_f32_32x32x16_bf16 v[144:159], a[172:175], v[92:95], v[144:159]
  s_waitcnt lgkmcnt(8)
  ds_read_b64_tr_b16 a[164:165], v15 offset:4352
  s_add_u32 m0, s54, 0x8800
  ds_read_b64_tr_b16 a[166:167], v15 offset:5376
  v_cvt_pk_bf16_f32 v203, v182, v183
  s_add_u32 s57, s66, 0x1e00
  v_mfma_f32_32x32x16_bf16 v[128:143], a[144:147], v[96:99], v[128:143]
  s_waitcnt lgkmcnt(8)
  ds_read_b64_tr_b16 a[168:169], v15 offset:6144
  ds_read_b64_tr_b16 a[170:171], v15 offset:7168
  buffer_load_dwordx4 v20, s[32:35], s67 offen lds
  v_mfma_f32_32x32x16_bf16 v[144:159], a[148:151], v[96:99], v[144:159]
  s_waitcnt lgkmcnt(8)
  ds_read_b64_tr_b16 a[172:173], v15 offset:6400
  ds_read_b64_tr_b16 a[174:175], v15 offset:7424
  buffer_store_dwordx4 v[200:203], v13, s[12:15], s57 offen sc1
  v_mfma_f32_32x32x16_bf16 v[128:143], a[152:155], v[100:103], v[128:143]
  s_waitcnt lgkmcnt(8)
  ds_read_b64_tr_b16 a[144:145], v15 offset:8192
  s_add_u32 m0, s54, 0x8c00
  ds_read_b64_tr_b16 a[146:147], v15 offset:9216
  v_mfma_f32_32x32x16_bf16 v[144:159], a[156:159], v[100:103], v[144:159]
  s_waitcnt lgkmcnt(8)
  ds_read_b64_tr_b16 a[148:149], v15 offset:8448
  ds_read_b64_tr_b16 a[150:151], v15 offset:9472
  buffer_load_dwordx4 v20, s[44:47], s67 offen lds
  v_mfma_f32_32x32x16_bf16 v[128:143], a[160:163], v[104:107], v[128:143]
  s_waitcnt lgkmcnt(8)
  ds_read_b64_tr_b16 a[152:153], v15 offset:10240
  ds_read_b64_tr_b16 a[154:155], v15 offset:11264
  v_cvt_pk_bf16_f32 v204, v184, v185
  v_cvt_pk_bf16_f32 v205, v186, v187
  v_cvt_pk_bf16_f32 v206, v188, v189
  v_mfma_f32_32x32x16_bf16 v[144:159], a[164:167], v[104:107], v[144:159]
  s_waitcnt lgkmcnt(8)
  ds_read_b64_tr_b16 a[156:157], v15 offset:10496
  ds_read_b64_tr_b16 a[158:159], v15 offset:11520
  v_cvt_pk_bf16_f32 v207, v190, v191
  s_add_u32 s57, s66, 0x1f00
  v_mfma_f32_32x32x16_bf16 v[128:143], a[168:171], v[108:111], v[128:143]
  s_waitcnt lgkmcnt(8)
  ds_read_b64_tr_b16 a[160:161], v15 offset:12288
  ds_read_b64_tr_b16 a[162:163], v15 offset:13312
  buffer_store_dwordx4 v[204:207], v13, s[12:15], s57 offen sc1
  v_mfma_f32_32x32x16_bf16 v[144:159], a[172:175], v[108:111], v[144:159]
  s_waitcnt lgkmcnt(8)
  ds_read_b64_tr_b16 a[164:165], v15 offset:12544
  ds_read_b64_tr_b16 a[166:167], v15 offset:13568
  v_mfma_f32_32x32x16_bf16 v[128:143], a[144:147], v[112:115], v[128:143]
  s_waitcnt lgkmcnt(8)
  ds_read_b64_tr_b16 a[168:169], v15 offset:14336
  ds_read_b64_tr_b16 a[170:171], v15 offset:15360
  v_mfma_f32_32x32x16_bf16 v[144:159], a[148:151], v[112:115], v[144:159]
  s_waitcnt lgkmcnt(8)
  ds_read_b64_tr_b16 a[172:173], v15 offset:14592
  ds_read_b64_tr_b16 a[174:175], v15 offset:15616
  v_mfma_f32_32x32x16_bf16 v[128:143], a[152:155], v[116:119], v[128:143]
  s_waitcnt lgkmcnt(8)
  v_mfma_f32_32x32x16_bf16 v[144:159], a[156:159], v[116:119], v[144:159]
  s_waitcnt lgkmcnt(6)
  v_mfma_f32_32x32x16_bf16 v[128:143], a[160:163], v[120:123], v[128:143]
  s_waitcnt lgkmcnt(4)
  v_mfma_f32_32x32x16_bf16 v[144:159], a[164:167], v[120:123], v[144:159]
  s_waitcnt lgkmcnt(2)
  v_mfma_f32_32x32x16_bf16 v[128:143], a[168:171], v[124:127], v[128:143]
  s_waitcnt lgkmcnt(0)
  v_mfma_f32_32x32x16_bf16 v[144:159], a[172:175], v[124:127], v[144:159]
  s_waitcnt vmcnt(7)
  v_readfirstlane_b32 s85, v57
  s_nop 3
  s_cmp_ge_u32 s85, 16
  s_cbranch_scc1 adaLN_cond__sliding_block_cached__glu_gated_swiglu__prompt_kernel_e1_ok
  s_mov_b32 s72, 0x200000
adaLN_cond__sliding_block_cached__glu_gated_swiglu__prompt_kernel_e1_spin:
  buffer_load_dword v57, v17, s[8:11], 0 offen offset:128 sc1
  s_waitcnt vmcnt(0)
  v_readfirstlane_b32 s85, v57
  s_nop 3
  s_cmp_ge_u32 s85, 16
  s_cbranch_scc1 adaLN_cond__sliding_block_cached__glu_gated_swiglu__prompt_kernel_e1_ok
  s_sub_u32 s72, s72, 1
  s_cmp_eq_u32 s72, 0
  s_cbranch_scc1 adaLN_cond__sliding_block_cached__glu_gated_swiglu__prompt_kernel_e1_ok
  s_sleep 4
  s_branch adaLN_cond__sliding_block_cached__glu_gated_swiglu__prompt_kernel_e1_spin
adaLN_cond__sliding_block_cached__glu_gated_swiglu__prompt_kernel_e1_ok:
  s_nop 7
  v_cvt_pk_bf16_f32 v192, v128, v129
  v_cvt_pk_bf16_f32 v193, v130, v131
  v_cvt_pk_bf16_f32 v194, v132, v133
  v_cvt_pk_bf16_f32 v195, v134, v135
  s_add_u32 s57, s66, 0x2000
  buffer_store_dwordx4 v[192:195], v13, s[12:15], s57 offen sc1
  v_cvt_pk_bf16_f32 v196, v136, v137
  v_cvt_pk_bf16_f32 v197, v138, v139
  v_cvt_pk_bf16_f32 v198, v140, v141
  v_cvt_pk_bf16_f32 v199, v142, v143
  s_add_u32 s57, s66, 0x2100
  buffer_store_dwordx4 v[196:199], v13, s[12:15], s57 offen sc1
  v_cvt_pk_bf16_f32 v200, v144, v145
  v_cvt_pk_bf16_f32 v201, v146, v147
  v_cvt_pk_bf16_f32 v202, v148, v149
  v_cvt_pk_bf16_f32 v203, v150, v151
  s_add_u32 s57, s66, 0x2200
  buffer_store_dwordx4 v[200:203], v13, s[12:15], s57 offen sc1
  v_cvt_pk_bf16_f32 v204, v152, v153
  v_cvt_pk_bf16_f32 v205, v154, v155
  v_cvt_pk_bf16_f32 v206, v156, v157
  v_cvt_pk_bf16_f32 v207, v158, v159
  s_add_u32 s57, s66, 0x2300
  buffer_store_dwordx4 v[204:207], v13, s[12:15], s57 offen sc1
  s_load_dwordx2 s[24:25], s[0:1], 64
  v_and_b32 v31, 7, v0
  v_cmp_gt_u32 s[86:87], 64, v0
  v_lshrrev_b32 v32, 4, v0
  v_lshlrev_b32 v36, 4, v32
  v_bfe_u32 v33, v0, 3, 1
  v_lshlrev_b32 v33, 2, v33
  v_add_u32 v36, v36, v33
  s_lshl_b32 s88, s2, 3
  v_add_u32 v32, s88, v31
  v_mul_u32_u24 v32, 0x240, v32
  v_add_u32 v32, v32, v36
  v_lshlrev_b32 v34, 1, v32
  v_lshlrev_b32 v36, 2, v36
  v_lshrrev_b32 v32, 4, v0
  v_lshlrev_b32 v32, 10, v32
  v_bfe_u32 v33, v0, 3, 1
  v_lshlrev_b32 v33, 9, v33
  v_add_u32 v32, v32, v33
  v_lshlrev_b32 v33, 4, v31
  v_add_u32 v38, v32, v33
  v_lshlrev_b32 v40, 4, v0
  v_lshlrev_b32 v42, 5, v0
  v_mov_b32 v32, 0x40000000
  v_add_u32 v33, 0x400, v34
  v_cndmask_b32 v35, v32, v33, s[86:87]
  v_add_u32 v33, 0x800, v36
  v_cndmask_b32 v37, v32, v33, s[86:87]
  v_add_u32 v33, 0x8000, v38
  v_cndmask_b32 v39, v32, v33, s[86:87]
  v_add_u32 v33, 0x2000, v40
  v_cndmask_b32 v41, v32, v33, s[86:87]
  v_add_u32 v33, 0x4000, v42
  v_cndmask_b32 v43, v32, v33, s[86:87]
  v_and_b32 v32, 31, v0
  v_bfe_u32 v33, v32, 2, 2
  v_add_u32 v33, 1, v33
  v_bfe_u32 v33, v33, 1, 1
  v_mul_u32_u24 v33, 12, v33
  v_xor_b32 v33, v33, v32
  v_bfe_u32 v32, v0, 5, 1
  v_lshlrev_b32 v32, 3, v32
  v_sub_u32 v33, v33, v32
  v_mov_b32 v9, 0
  v_cmp_eq_u32 vcc, 0, v33
  v_mov_b32 v32, 0x3f80
  s_nop 0
  v_cndmask_b32 v9, v9, v32
  v_cmp_eq_u32 vcc, 1, v33
  v_mov_b32 v32, 0x3f800000
  s_nop 0
  v_cndmask_b32 v9, v9, v32
  v_accvgpr_write_b32 a176, v9
  v_mov_b32 v9, 0
  v_cmp_eq_u32 vcc, 2, v33
  v_mov_b32 v32, 0x3f80
  s_nop 0
  v_cndmask_b32 v9, v9, v32
  v_cmp_eq_u32 vcc, 3, v33
  v_mov_b32 v32, 0x3f800000
  s_nop 0
  v_cndmask_b32 v9, v9, v32
  v_accvgpr_write_b32 a177, v9
  v_mov_b32 v9, 0
  v_cmp_eq_u32 vcc, 4, v33
  v_mov_b32 v32, 0x3f80
  s_nop 0
  v_cndmask_b32 v9, v9, v32
  v_cmp_eq_u32 vcc, 5, v33
  v_mov_b32 v32, 0x3f800000
  s_nop 0
  v_cndmask_b32 v9, v9, v32
  v_accvgpr_write_b32 a178, v9
  v_mov_b32 v9, 0
  v_cmp_eq_u32 vcc, 6, v33
  v_mov_b32 v32, 0x3f80
  s_nop 0
  v_cndmask_b32 v9, v9, v32
  v_cmp_eq_u32 vcc, 7, v33
  v_mov_b32 v32, 0x3f800000
  s_nop 0
  v_cndmask_b32 v9, v9, v32
  v_accvgpr_write_b32 a179, v9
  s_mul_i32 s56, s53, 24
  v_lshlrev_b32 v9, 2, v2
  v_add_u32 v9, v9, v4
  v_add_u32 v9, s56, v9
  v_lshlrev_b32 v10, 6, v3
  v_add_u32 v10, v10, v7
  s_mov_b32 s58, 0x480
  v_mul_lo_u32 v11, v9, s58
  v_add_u32 v22, v11, v10
  v_cmp_gt_u32 vcc, 64, v9
  v_mov_b32 v10, s82
  s_nop 0
  v_cndmask_b32 v10, 0, v10
  v_add_u32 v25, v22, v10
  s_mul_i32 s56, s53, 24
  v_lshlrev_b32 v9, 2, v2
  v_add_u32 v9, v9, v4
  v_add_u32 v9, s56, v9
  v_add_u32 v9, 8, v9
  v_lshlrev_b32 v10, 6, v3
  v_add_u32 v10, v10, v7
  s_mov_b32 s58, 0x480
  v_mul_lo_u32 v11, v9, s58
  v_add_u32 v23, v11, v10
  v_cmp_gt_u32 vcc, 64, v9
  v_mov_b32 v10, s82
  s_nop 0
  v_cndmask_b32 v10, 0, v10
  v_add_u32 v26, v23, v10
  s_mul_i32 s56, s53, 24
  v_lshlrev_b32 v9, 2, v2
  v_add_u32 v9, v9, v4
  v_add_u32 v9, s56, v9
  v_add_u32 v9, 16, v9
  v_lshlrev_b32 v10, 6, v3
  v_add_u32 v10, v10, v7
  s_mov_b32 s58, 0x480
  v_mul_lo_u32 v11, v9, s58
  v_add_u32 v24, v11, v10
  v_cmp_gt_u32 vcc, 64, v9
  v_mov_b32 v10, s82
  s_nop 0
  v_cndmask_b32 v10, 0, v10
  v_add_u32 v27, v24, v10
  s_lshl_b32 s56, s74, 8
  v_add_u32 v28, s56, v14
  v_add_u32 v29, s56, v15
  v_subrev_u32 v11, 64, v0
  s_mul_i32 s56, s51, 0x5100
  v_lshlrev_b32 v9, 7, v11
  v_add_u32 v9, s56, v9
  v_mov_b32 v10, 0x40000000
  v_cmp_gt_u32 vcc, 0xa2, v11
  s_nop 1
  v_cndmask_b32 v30, v10, v9
  s_mov_b32 s26, 0x510000
  s_mov_b32 s27, 0x20000
  s_waitcnt lgkmcnt(0)
  s_mul_i32 s91, s2, 0x24000
  s_lshl_b32 s93, s53, 10
  s_add_u32 s93, s93, s91
  s_mov_b32 s92, 0x1200
  buffer_load_dwordx4 a[12:15], v36, s[20:23], s92 offen sc1
  buffer_load_dwordx4 a[16:19], v36, s[20:23], s92 offen offset:32 sc1
  buffer_load_dwordx4 a[20:23], v36, s[20:23], s92 offen offset:1024 sc1
  buffer_load_dwordx4 a[24:27], v36, s[20:23], s92 offen offset:1056 sc1
  buffer_load_dwordx4 a[28:31], v37, s[20:23], s92 offen sc1
  buffer_load_dwordx4 a[32:35], v37, s[20:23], s92 offen offset:32 sc1
  s_mov_b32 s92, 0x2400
  buffer_load_dwordx4 a[36:39], v36, s[20:23], s92 offen sc1
  buffer_load_dwordx4 a[40:43], v36, s[20:23], s92 offen offset:32 sc1
  buffer_load_dwordx4 a[44:47], v36, s[20:23], s92 offen offset:1024 sc1
  buffer_load_dwordx4 a[48:51], v36, s[20:23], s92 offen offset:1056 sc1
  buffer_load_dwordx4 a[52:55], v37, s[20:23], s92 offen sc1
  buffer_load_dwordx4 a[56:59], v37, s[20:23], s92 offen offset:32 sc1
  s_mov_b32 s92, 0x1b00
  buffer_load_dwordx4 a[60:63], v36, s[20:23], s92 offen sc1
  buffer_load_dwordx4 a[64:67], v36, s[20:23], s92 offen offset:32 sc1
  buffer_load_dwordx4 a[68:71], v36, s[20:23], s92 offen offset:1024 sc1
  buffer_load_dwordx4 a[72:75], v36, s[20:23], s92 offen offset:1056 sc1
  buffer_load_dwordx4 a[76:79], v37, s[20:23], s92 offen sc1
  buffer_load_dwordx4 a[80:83], v37, s[20:23], s92 offen offset:32 sc1
  s_waitcnt vmcnt(18)
  s_barrier
  v_mov_b32 v10, 1
  buffer_atomic_add v10, v16, s[8:11], 0 offen sc1
  s_cmp_lg_u32 s53, 0
  s_cbranch_scc0 adaLN_cond__sliding_block_cached__glu_gated_swiglu__prompt_kernel_l1
  s_add_u32 s69, s93, 0
  buffer_load_dwordx4 v[56:59], v12, s[12:15], s69 offen sc1
  s_add_u32 s69, s93, 9216
  buffer_load_dwordx4 v[60:63], v12, s[12:15], s69 offen sc1
  s_add_u32 s69, s93, 18432
  buffer_load_dwordx4 v[64:67], v12, s[12:15], s69 offen sc1
  s_add_u32 s69, s93, 27648
  buffer_load_dwordx4 v[68:71], v12, s[12:15], s69 offen sc1
  s_add_u32 s69, s93, 36864
  buffer_load_dwordx4 v[72:75], v12, s[12:15], s69 offen sc1
  s_add_u32 s69, s93, 46080
  buffer_load_dwordx4 v[76:79], v12, s[12:15], s69 offen sc1
  s_add_u32 s69, s93, 55296
  buffer_load_dwordx4 v[80:83], v12, s[12:15], s69 offen sc1
  s_add_u32 s69, s93, 64512
  buffer_load_dwordx4 v[84:87], v12, s[12:15], s69 offen sc1
  s_add_u32 s69, s93, 73728
  buffer_load_dwordx4 v[88:91], v12, s[12:15], s69 offen sc1
  s_add_u32 s69, s93, 82944
  buffer_load_dwordx4 v[92:95], v12, s[12:15], s69 offen sc1
  s_add_u32 s69, s93, 92160
  buffer_load_dwordx4 v[96:99], v12, s[12:15], s69 offen sc1
  s_add_u32 s69, s93, 101376
  buffer_load_dwordx4 v[100:103], v12, s[12:15], s69 offen sc1
  s_add_u32 s69, s93, 110592
  buffer_load_dwordx4 v[104:107], v12, s[12:15], s69 offen sc1
  s_add_u32 s69, s93, 119808
  buffer_load_dwordx4 v[108:111], v12, s[12:15], s69 offen sc1
  s_add_u32 s69, s93, 129024
  buffer_load_dwordx4 v[112:115], v12, s[12:15], s69 offen sc1
  s_add_u32 s69, s93, 138240
  buffer_load_dwordx4 v[116:119], v12, s[12:15], s69 offen sc1
adaLN_cond__sliding_block_cached__glu_gated_swiglu__prompt_kernel_l1:
  s_cmp_lg_u32 s53, 0
  s_cbranch_scc1 adaLN_cond__sliding_block_cached__glu_gated_swiglu__prompt_kernel_s2_done
  s_mov_b32 s90, 0x200000
adaLN_cond__sliding_block_cached__glu_gated_swiglu__prompt_kernel_s2_poll:
  buffer_load_dword v9, v17, s[8:11], 0 offen sc1
  s_waitcnt vmcnt(0)
  v_readfirstlane_b32 s89, v9
  s_nop 3
  s_cmp_ge_u32 s89, 32
  s_cbranch_scc1 adaLN_cond__sliding_block_cached__glu_gated_swiglu__prompt_kernel_s2_done
  s_sub_u32 s90, s90, 1
  s_cmp_eq_u32 s90, 0
  s_cbranch_scc1 adaLN_cond__sliding_block_cached__glu_gated_swiglu__prompt_kernel_s2_done
  s_sleep 4
  s_branch adaLN_cond__sliding_block_cached__glu_gated_swiglu__prompt_kernel_s2_poll
adaLN_cond__sliding_block_cached__glu_gated_swiglu__prompt_kernel_s2_done:
  s_barrier
  s_cmp_eq_u32 s53, 0
  s_cbranch_scc0 adaLN_cond__sliding_block_cached__glu_gated_swiglu__prompt_kernel_l1b
  s_add_u32 s69, s93, 0
  buffer_load_dwordx4 v[56:59], v12, s[12:15], s69 offen sc1
  s_add_u32 s69, s93, 9216
  buffer_load_dwordx4 v[60:63], v12, s[12:15], s69 offen sc1
  s_add_u32 s69, s93, 18432
  buffer_load_dwordx4 v[64:67], v12, s[12:15], s69 offen sc1
  s_add_u32 s69, s93, 27648
  buffer_load_dwordx4 v[68:71], v12, s[12:15], s69 offen sc1
  s_add_u32 s69, s93, 36864
  buffer_load_dwordx4 v[72:75], v12, s[12:15], s69 offen sc1
  s_add_u32 s69, s93, 46080
  buffer_load_dwordx4 v[76:79], v12, s[12:15], s69 offen sc1
  s_add_u32 s69, s93, 55296
  buffer_load_dwordx4 v[80:83], v12, s[12:15], s69 offen sc1
  s_add_u32 s69, s93, 64512
  buffer_load_dwordx4 v[84:87], v12, s[12:15], s69 offen sc1
  s_add_u32 s69, s93, 73728
  buffer_load_dwordx4 v[88:91], v12, s[12:15], s69 offen sc1
  s_add_u32 s69, s93, 82944
  buffer_load_dwordx4 v[92:95], v12, s[12:15], s69 offen sc1
  s_add_u32 s69, s93, 92160
  buffer_load_dwordx4 v[96:99], v12, s[12:15], s69 offen sc1
  s_add_u32 s69, s93, 101376
  buffer_load_dwordx4 v[100:103], v12, s[12:15], s69 offen sc1
  s_add_u32 s69, s93, 110592
  buffer_load_dwordx4 v[104:107], v12, s[12:15], s69 offen sc1
  s_add_u32 s69, s93, 119808
  buffer_load_dwordx4 v[108:111], v12, s[12:15], s69 offen sc1
  s_add_u32 s69, s93, 129024
  buffer_load_dwordx4 v[112:115], v12, s[12:15], s69 offen sc1
  s_add_u32 s69, s93, 138240
  buffer_load_dwordx4 v[116:119], v12, s[12:15], s69 offen sc1
adaLN_cond__sliding_block_cached__glu_gated_swiglu__prompt_kernel_l1b:
  s_add_u32 s94, s91, 0
  buffer_load_dwordx4 v[184:187], v41, s[12:15], s94 offen sc1
  s_add_u32 s94, s91, 0x2400
  buffer_load_dwordx4 v[188:191], v41, s[12:15], s94 offen sc1
  s_add_u32 s94, s91, 0x4800
  buffer_load_dwordx4 v[192:195], v41, s[12:15], s94 offen sc1
  s_add_u32 s94, s91, 0x6c00
  buffer_load_dwordx4 v[196:199], v41, s[12:15], s94 offen sc1
  s_add_u32 s94, s91, 0x9000
  buffer_load_dwordx4 v[200:203], v41, s[12:15], s94 offen sc1
  s_add_u32 s94, s91, 0xb400
  buffer_load_dwordx4 v[204:207], v41, s[12:15], s94 offen sc1
  s_add_u32 s94, s91, 0xd800
  buffer_load_dwordx4 v[208:211], v41, s[12:15], s94 offen sc1
  s_add_u32 s94, s91, 0xfc00
  buffer_load_dwordx4 v[212:215], v41, s[12:15], s94 offen sc1
  s_add_u32 s94, s91, 0x12000
  buffer_load_dwordx4 v[216:219], v41, s[12:15], s94 offen sc1
  s_add_u32 s94, s91, 0x14400
  buffer_load_dwordx4 v[220:223], v41, s[12:15], s94 offen sc1
  s_add_u32 s94, s91, 0x16800
  buffer_load_dwordx4 v[224:227], v41, s[12:15], s94 offen sc1
  s_add_u32 s94, s91, 0x18c00
  buffer_load_dwordx4 v[228:231], v41, s[12:15], s94 offen sc1
  s_add_u32 s94, s91, 0x1b000
  buffer_load_dwordx4 v[232:235], v41, s[12:15], s94 offen sc1
  s_add_u32 s94, s91, 0x1d400
  buffer_load_dwordx4 v[236:239], v41, s[12:15], s94 offen sc1
  s_add_u32 s94, s91, 0x1f800
  buffer_load_dwordx4 v[240:243], v41, s[12:15], s94 offen sc1
  s_add_u32 s94, s91, 0x21c00
  buffer_load_dwordx4 v[244:247], v41, s[12:15], s94 offen sc1
  s_add_u32 s95, s91, 0x1000
  buffer_load_dwordx4 v[120:123], v40, s[12:15], s95 offen sc1
  s_add_u32 s95, s91, 0x3400
  buffer_load_dwordx4 v[124:127], v40, s[12:15], s95 offen sc1
  s_add_u32 s95, s91, 0x5800
  buffer_load_dwordx4 v[128:131], v40, s[12:15], s95 offen sc1
  s_add_u32 s95, s91, 0x7c00
  buffer_load_dwordx4 v[132:135], v40, s[12:15], s95 offen sc1
  s_add_u32 s95, s91, 0xa000
  buffer_load_dwordx4 v[136:139], v40, s[12:15], s95 offen sc1
  s_add_u32 s95, s91, 0xc400
  buffer_load_dwordx4 v[140:143], v40, s[12:15], s95 offen sc1
  s_add_u32 s95, s91, 0xe800
  buffer_load_dwordx4 v[144:147], v40, s[12:15], s95 offen sc1
  s_add_u32 s95, s91, 0x10c00
  buffer_load_dwordx4 v[148:151], v40, s[12:15], s95 offen sc1
  s_add_u32 s95, s91, 0x13000
  buffer_load_dwordx4 v[152:155], v40, s[12:15], s95 offen sc1
  s_add_u32 s95, s91, 0x15400
  buffer_load_dwordx4 v[156:159], v40, s[12:15], s95 offen sc1
  s_add_u32 s95, s91, 0x17800
  buffer_load_dwordx4 v[160:163], v40, s[12:15], s95 offen sc1
  s_add_u32 s95, s91, 0x19c00
  buffer_load_dwordx4 v[164:167], v40, s[12:15], s95 offen sc1
  s_add_u32 s95, s91, 0x1c000
  buffer_load_dwordx4 v[168:171], v40, s[12:15], s95 offen sc1
  s_add_u32 s95, s91, 0x1e400
  buffer_load_dwordx4 v[172:175], v40, s[12:15], s95 offen sc1
  s_add_u32 s95, s91, 0x20800
  buffer_load_dwordx4 v[176:179], v40, s[12:15], s95 offen sc1
  s_add_u32 s95, s91, 0x22c00
  buffer_load_dwordx4 v[180:183], v40, s[12:15], s95 offen sc1
  s_waitcnt vmcnt(47)
  v_mfma_f32_32x32x16_bf16 a[96:111], a[176:179], v[56:59], 0
  s_waitcnt vmcnt(46)
  v_mfma_f32_32x32x16_bf16 a[96:111], a[176:179], v[60:63], a[96:111]
  s_waitcnt vmcnt(45)
  v_mfma_f32_32x32x16_bf16 a[96:111], a[176:179], v[64:67], a[96:111]
  s_waitcnt vmcnt(44)
  v_mfma_f32_32x32x16_bf16 a[96:111], a[176:179], v[68:71], a[96:111]
  s_waitcnt vmcnt(43)
  v_mfma_f32_32x32x16_bf16 a[96:111], a[176:179], v[72:75], a[96:111]
  s_waitcnt vmcnt(42)
  v_mfma_f32_32x32x16_bf16 a[96:111], a[176:179], v[76:79], a[96:111]
  s_waitcnt vmcnt(41)
  v_mfma_f32_32x32x16_bf16 a[96:111], a[176:179], v[80:83], a[96:111]
  s_waitcnt vmcnt(40)
  v_mfma_f32_32x32x16_bf16 a[96:111], a[176:179], v[84:87], a[96:111]
  s_waitcnt vmcnt(39)
  v_mfma_f32_32x32x16_bf16 a[96:111], a[176:179], v[88:91], a[96:111]
  s_waitcnt vmcnt(38)
  v_mfma_f32_32x32x16_bf16 a[96:111], a[176:179], v[92:95], a[96:111]
  s_waitcnt vmcnt(37)
  v_mfma_f32_32x32x16_bf16 a[96:111], a[176:179], v[96:99], a[96:111]
  s_waitcnt vmcnt(36)
  v_mfma_f32_32x32x16_bf16 a[96:111], a[176:179], v[100:103], a[96:111]
  s_waitcnt vmcnt(35)
  v_mfma_f32_32x32x16_bf16 a[96:111], a[176:179], v[104:107], a[96:111]
  s_waitcnt vmcnt(34)
  v_mfma_f32_32x32x16_bf16 a[96:111], a[176:179], v[108:111], a[96:111]
  s_waitcnt vmcnt(33)
  v_mfma_f32_32x32x16_bf16 a[96:111], a[176:179], v[112:115], a[96:111]
  s_waitcnt vmcnt(32)
  v_mfma_f32_32x32x16_bf16 a[96:111], a[176:179], v[116:119], a[96:111]
  s_waitcnt vmcnt(31)
  v_mfma_f32_32x32x16_bf16 a[128:143], a[176:179], v[184:187], 0
  s_waitcnt vmcnt(30)
  v_mfma_f32_32x32x16_bf16 a[128:143], a[176:179], v[188:191], a[128:143]
  s_waitcnt vmcnt(29)
  v_mfma_f32_32x32x16_bf16 a[128:143], a[176:179], v[192:195], a[128:143]
  s_waitcnt vmcnt(28)
  v_mfma_f32_32x32x16_bf16 a[128:143], a[176:179], v[196:199], a[128:143]
  s_waitcnt vmcnt(27)
  v_mfma_f32_32x32x16_bf16 a[128:143], a[176:179], v[200:203], a[128:143]
  s_waitcnt vmcnt(26)
  v_mfma_f32_32x32x16_bf16 a[128:143], a[176:179], v[204:207], a[128:143]
  s_waitcnt vmcnt(25)
  v_mfma_f32_32x32x16_bf16 a[128:143], a[176:179], v[208:211], a[128:143]
  s_waitcnt vmcnt(24)
  v_mfma_f32_32x32x16_bf16 a[128:143], a[176:179], v[212:215], a[128:143]
  s_waitcnt vmcnt(23)
  v_mfma_f32_32x32x16_bf16 a[128:143], a[176:179], v[216:219], a[128:143]
  s_waitcnt vmcnt(22)
  v_mfma_f32_32x32x16_bf16 a[128:143], a[176:179], v[220:223], a[128:143]
  s_waitcnt vmcnt(21)
  v_mfma_f32_32x32x16_bf16 a[128:143], a[176:179], v[224:227], a[128:143]
  s_waitcnt vmcnt(20)
  v_mfma_f32_32x32x16_bf16 a[128:143], a[176:179], v[228:231], a[128:143]
  s_waitcnt vmcnt(19)
  v_mfma_f32_32x32x16_bf16 a[128:143], a[176:179], v[232:235], a[128:143]
  s_waitcnt vmcnt(18)
  v_mfma_f32_32x32x16_bf16 a[128:143], a[176:179], v[236:239], a[128:143]
  s_waitcnt vmcnt(17)
  v_mfma_f32_32x32x16_bf16 a[128:143], a[176:179], v[240:243], a[128:143]
  s_waitcnt vmcnt(16)
  v_mfma_f32_32x32x16_bf16 a[128:143], a[176:179], v[244:247], a[128:143]
  v_accvgpr_read_b32 v57, a232
  v_accvgpr_read_b32 v59, a233
  v_accvgpr_read_b32 v61, a234
  v_accvgpr_read_b32 v63, a235
  v_accvgpr_read_b32 v64, a12
  v_accvgpr_read_b32 v65, a13
  v_accvgpr_read_b32 v66, a14
  v_accvgpr_read_b32 v67, a15
  v_accvgpr_read_b32 v68, a16
  v_accvgpr_read_b32 v69, a17
  v_accvgpr_read_b32 v70, a18
  v_accvgpr_read_b32 v71, a19
  v_lshlrev_b32 v56, 16, v57
  v_and_b32 v57, 0xffff0000, v57
  v_lshlrev_b32 v58, 16, v59
  v_and_b32 v59, 0xffff0000, v59
  v_lshlrev_b32 v60, 16, v61
  v_and_b32 v61, 0xffff0000, v61
  v_lshlrev_b32 v62, 16, v63
  v_and_b32 v63, 0xffff0000, v63
  v_accvgpr_read_b32 v72, a96
  v_accvgpr_read_b32 v73, a97
  v_accvgpr_read_b32 v74, a98
  v_accvgpr_read_b32 v75, a99
  v_accvgpr_read_b32 v76, a100
  v_accvgpr_read_b32 v77, a101
  v_accvgpr_read_b32 v78, a102
  v_accvgpr_read_b32 v79, a103
  v_fmac_f32 v56, v64, v72
  v_fmac_f32 v57, v65, v73
  v_fmac_f32 v58, v66, v74
  v_fmac_f32 v59, v67, v75
  v_fmac_f32 v60, v68, v76
  v_fmac_f32 v61, v69, v77
  v_fmac_f32 v62, v70, v78
  v_fmac_f32 v63, v71, v79
  v_accvgpr_write_b32 a208, v56
  v_accvgpr_write_b32 a209, v57
  v_accvgpr_write_b32 a210, v58
  v_accvgpr_write_b32 a211, v59
  v_accvgpr_write_b32 a212, v60
  v_accvgpr_write_b32 a213, v61
  v_accvgpr_write_b32 a214, v62
  v_accvgpr_write_b32 a215, v63
  v_accvgpr_read_b32 v80, a36
  v_accvgpr_read_b32 v81, a37
  v_accvgpr_read_b32 v82, a38
  v_accvgpr_read_b32 v83, a39
  v_accvgpr_read_b32 v84, a40
  v_accvgpr_read_b32 v85, a41
  v_accvgpr_read_b32 v86, a42
  v_accvgpr_read_b32 v87, a43
  v_accvgpr_read_b32 v88, a44
  v_accvgpr_read_b32 v89, a45
  v_accvgpr_read_b32 v90, a46
  v_accvgpr_read_b32 v91, a47
  v_accvgpr_read_b32 v92, a48
  v_accvgpr_read_b32 v93, a49
  v_accvgpr_read_b32 v94, a50
  v_accvgpr_read_b32 v95, a51
  v_accvgpr_read_b32 v96, a52
  v_accvgpr_read_b32 v97, a53
  v_accvgpr_read_b32 v98, a54
  v_accvgpr_read_b32 v99, a55
  v_accvgpr_read_b32 v100, a56
  v_accvgpr_read_b32 v101, a57
  v_accvgpr_read_b32 v102, a58
  v_accvgpr_read_b32 v103, a59
  v_accvgpr_read_b32 v185, a240
  v_accvgpr_read_b32 v187, a241
  v_accvgpr_read_b32 v189, a242
  v_accvgpr_read_b32 v191, a243
  v_accvgpr_read_b32 v192, a28
  v_accvgpr_read_b32 v193, a29
  v_accvgpr_read_b32 v194, a30
  v_accvgpr_read_b32 v195, a31
  v_accvgpr_read_b32 v196, a32
  v_accvgpr_read_b32 v197, a33
  v_accvgpr_read_b32 v198, a34
  v_accvgpr_read_b32 v199, a35
  v_lshlrev_b32 v184, 16, v185
  v_and_b32 v185, 0xffff0000, v185
  v_lshlrev_b32 v186, 16, v187
  v_and_b32 v187, 0xffff0000, v187
  v_lshlrev_b32 v188, 16, v189
  v_and_b32 v189, 0xffff0000, v189
  v_lshlrev_b32 v190, 16, v191
  v_and_b32 v191, 0xffff0000, v191
  v_accvgpr_read_b32 v200, a128
  v_accvgpr_read_b32 v201, a129
  v_accvgpr_read_b32 v202, a130
  v_accvgpr_read_b32 v203, a131
  v_accvgpr_read_b32 v204, a132
  v_accvgpr_read_b32 v205, a133
  v_accvgpr_read_b32 v206, a134
  v_accvgpr_read_b32 v207, a135
  v_fmac_f32 v184, v192, v200
  v_fmac_f32 v185, v193, v201
  v_fmac_f32 v186, v194, v202
  v_fmac_f32 v187, v195, v203
  v_fmac_f32 v188, v196, v204
  v_fmac_f32 v189, v197, v205
  v_fmac_f32 v190, v198, v206
  v_fmac_f32 v191, v199, v207
  v_accvgpr_write_b32 a224, v184
  v_accvgpr_write_b32 a225, v185
  v_accvgpr_write_b32 a226, v186
  v_accvgpr_write_b32 a227, v187
  v_accvgpr_write_b32 a228, v188
  v_accvgpr_write_b32 a229, v189
  v_accvgpr_write_b32 a230, v190
  v_accvgpr_write_b32 a231, v191
  v_accvgpr_read_b32 v200, a60
  v_accvgpr_read_b32 v201, a61
  v_accvgpr_read_b32 v202, a62
  v_accvgpr_read_b32 v203, a63
  v_accvgpr_read_b32 v204, a64
  v_accvgpr_read_b32 v205, a65
  v_accvgpr_read_b32 v206, a66
  v_accvgpr_read_b32 v207, a67
  v_accvgpr_read_b32 v208, a68
  v_accvgpr_read_b32 v209, a69
  v_accvgpr_read_b32 v210, a70
  v_accvgpr_read_b32 v211, a71
  v_accvgpr_read_b32 v212, a72
  v_accvgpr_read_b32 v213, a73
  v_accvgpr_read_b32 v214, a74
  v_accvgpr_read_b32 v215, a75
  v_accvgpr_read_b32 v216, a76
  v_accvgpr_read_b32 v217, a77
  v_accvgpr_read_b32 v218, a78
  v_accvgpr_read_b32 v219, a79
  v_accvgpr_read_b32 v220, a80
  v_accvgpr_read_b32 v221, a81
  v_accvgpr_read_b32 v222, a82
  v_accvgpr_read_b32 v223, a83
  s_waitcnt vmcnt(15)
  v_mfma_f32_32x32x16_bf16 a[112:127], a[176:179], v[120:123], 0
  s_waitcnt vmcnt(14)
  v_mfma_f32_32x32x16_bf16 a[112:127], a[176:179], v[124:127], a[112:127]
  s_waitcnt vmcnt(13)
  v_mfma_f32_32x32x16_bf16 a[112:127], a[176:179], v[128:131], a[112:127]
  s_waitcnt vmcnt(12)
  v_mfma_f32_32x32x16_bf16 a[112:127], a[176:179], v[132:135], a[112:127]
  s_waitcnt vmcnt(11)
  v_mfma_f32_32x32x16_bf16 a[112:127], a[176:179], v[136:139], a[112:127]
  s_waitcnt vmcnt(10)
  v_mfma_f32_32x32x16_bf16 a[112:127], a[176:179], v[140:143], a[112:127]
  s_waitcnt vmcnt(9)
  v_mfma_f32_32x32x16_bf16 a[112:127], a[176:179], v[144:147], a[112:127]
  s_waitcnt vmcnt(8)
  v_mfma_f32_32x32x16_bf16 a[112:127], a[176:179], v[148:151], a[112:127]
  s_waitcnt vmcnt(7)
  v_mfma_f32_32x32x16_bf16 a[112:127], a[176:179], v[152:155], a[112:127]
  s_waitcnt vmcnt(6)
  v_mfma_f32_32x32x16_bf16 a[112:127], a[176:179], v[156:159], a[112:127]
  s_waitcnt vmcnt(5)
  v_mfma_f32_32x32x16_bf16 a[112:127], a[176:179], v[160:163], a[112:127]
  s_waitcnt vmcnt(4)
  v_mfma_f32_32x32x16_bf16 a[112:127], a[176:179], v[164:167], a[112:127]
  s_waitcnt vmcnt(3)
  v_mfma_f32_32x32x16_bf16 a[112:127], a[176:179], v[168:171], a[112:127]
  s_waitcnt vmcnt(2)
  v_mfma_f32_32x32x16_bf16 a[112:127], a[176:179], v[172:175], a[112:127]
  s_waitcnt vmcnt(1)
  v_mfma_f32_32x32x16_bf16 a[112:127], a[176:179], v[176:179], a[112:127]
  s_waitcnt vmcnt(0)
  v_mfma_f32_32x32x16_bf16 a[112:127], a[176:179], v[180:183], a[112:127]
  v_accvgpr_read_b32 v121, a236
  v_accvgpr_read_b32 v123, a237
  v_accvgpr_read_b32 v125, a238
  v_accvgpr_read_b32 v127, a239
  v_accvgpr_read_b32 v128, a20
  v_accvgpr_read_b32 v129, a21
  v_accvgpr_read_b32 v130, a22
  v_accvgpr_read_b32 v131, a23
  v_accvgpr_read_b32 v132, a24
  v_accvgpr_read_b32 v133, a25
  v_accvgpr_read_b32 v134, a26
  v_accvgpr_read_b32 v135, a27
  v_lshlrev_b32 v120, 16, v121
  v_and_b32 v121, 0xffff0000, v121
  v_lshlrev_b32 v122, 16, v123
  v_and_b32 v123, 0xffff0000, v123
  v_lshlrev_b32 v124, 16, v125
  v_and_b32 v125, 0xffff0000, v125
  v_lshlrev_b32 v126, 16, v127
  v_and_b32 v127, 0xffff0000, v127
  v_accvgpr_read_b32 v136, a112
  v_accvgpr_read_b32 v137, a113
  v_accvgpr_read_b32 v138, a114
  v_accvgpr_read_b32 v139, a115
  v_accvgpr_read_b32 v140, a116
  v_accvgpr_read_b32 v141, a117
  v_accvgpr_read_b32 v142, a118
  v_accvgpr_read_b32 v143, a119
  v_fmac_f32 v120, v128, v136
  v_fmac_f32 v121, v129, v137
  v_fmac_f32 v122, v130, v138
  v_fmac_f32 v123, v131, v139
  v_fmac_f32 v124, v132, v140
  v_fmac_f32 v125, v133, v141
  v_fmac_f32 v126, v134, v142
  v_fmac_f32 v127, v135, v143
  v_accvgpr_write_b32 a216, v120
  v_accvgpr_write_b32 a217, v121
  v_accvgpr_write_b32 a218, v122
  v_accvgpr_write_b32 a219, v123
  v_accvgpr_write_b32 a220, v124
  v_accvgpr_write_b32 a221, v125
  v_accvgpr_write_b32 a222, v126
  v_accvgpr_write_b32 a223, v127
  v_add_f32 v144, v56, v57
  v_mul_f32 v145, v56, v56
  v_fmac_f32 v145, v57, v57
  v_add_f32 v144, v144, v58
  v_fmac_f32 v145, v58, v58
  v_add_f32 v144, v144, v59
  v_fmac_f32 v145, v59, v59
  v_add_f32 v144, v144, v60
  v_fmac_f32 v145, v60, v60
  v_add_f32 v144, v144, v61
  v_fmac_f32 v145, v61, v61
  v_add_f32 v144, v144, v62
  v_fmac_f32 v145, v62, v62
  v_add_f32 v144, v144, v63
  v_fmac_f32 v145, v63, v63
  v_add_f32 v144, v144, v120
  v_fmac_f32 v145, v120, v120
  v_add_f32 v144, v144, v121
  v_fmac_f32 v145, v121, v121
  v_add_f32 v144, v144, v122
  v_fmac_f32 v145, v122, v122
  v_add_f32 v144, v144, v123
  v_fmac_f32 v145, v123, v123
  v_add_f32 v144, v144, v124
  v_fmac_f32 v145, v124, v124
  v_add_f32 v144, v144, v125
  v_fmac_f32 v145, v125, v125
  v_add_f32 v144, v144, v126
  v_fmac_f32 v145, v126, v126
  v_add_f32 v144, v144, v127
  v_fmac_f32 v145, v127, v127
  v_add_f32 v144, v144, v184
  v_fmac_f32 v145, v184, v184
  v_add_f32 v144, v144, v185
  v_fmac_f32 v145, v185, v185
  v_add_f32 v144, v144, v186
  v_fmac_f32 v145, v186, v186
  v_add_f32 v144, v144, v187
  v_fmac_f32 v145, v187, v187
  v_add_f32 v144, v144, v188
  v_fmac_f32 v145, v188, v188
  v_add_f32 v144, v144, v189
  v_fmac_f32 v145, v189, v189
  v_add_f32 v144, v144, v190
  v_fmac_f32 v145, v190, v190
  v_add_f32 v144, v144, v191
  v_fmac_f32 v145, v191, v191
  s_nop 0
  v_add_f32 v144, v144, v144 row_ror:8 row_mask:0xf bank_mask:0xf
  v_mov_b32 v32, v144
  s_nop 1
  v_permlane16_swap_b32 v144, v32
  v_add_f32 v144, v144, v32
  v_mov_b32 v32, v144
  s_nop 1
  v_permlane32_swap_b32 v144, v32
  v_add_f32 v144, v144, v32
  v_add_f32 v145, v145, v145 row_ror:8 row_mask:0xf bank_mask:0xf
  v_mov_b32 v33, v145
  s_nop 1
  v_permlane16_swap_b32 v145, v33
  v_add_f32 v145, v145, v33
  v_mov_b32 v33, v145
  s_nop 1
  v_permlane32_swap_b32 v145, v33
  v_add_f32 v145, v145, v33
  v_lshrrev_b32 v32, 6, v0
  v_lshlrev_b32 v32, 5, v32
  v_lshlrev_b32 v147, 2, v31
  v_add_u32 v147, 0x20000, v147
  v_add_u32 v146, v32, v147
  ds_write_b32 v146, v144
  ds_write_b32 v146, v145 offset:128
  s_waitcnt lgkmcnt(0)
  s_barrier
  ds_read_b32 v148, v147
  ds_read_b32 v152, v147 offset:128
  ds_read_b32 v149, v147 offset:32
  ds_read_b32 v153, v147 offset:160
  ds_read_b32 v150, v147 offset:64
  ds_read_b32 v154, v147 offset:192
  ds_read_b32 v151, v147 offset:96
  ds_read_b32 v155, v147 offset:224
  s_mov_b32 s96, 0x3ae38e39
  s_mov_b32 s97, 0x3727c5ac
  s_waitcnt lgkmcnt(5)
  v_add_f32 v148, v148, v149
  s_waitcnt lgkmcnt(1)
  v_add_f32 v150, v150, v151
  v_add_f32 v152, v152, v153
  s_waitcnt lgkmcnt(0)
  v_add_f32 v154, v154, v155
  v_add_f32 v148, v148, v150
  v_add_f32 v152, v152, v154
  v_mul_f32 v146, s96, v148
  v_mul_f32 v152, s96, v152
  v_fma_f32 v152, -v146, v146, v152
  v_max_f32 v152, 0, v152
  v_add_f32 v152, s97, v152
  v_rsq_f32 v147, v152
  v_sub_f32 v56, v56, v146
  v_add_f32 v80, 1.0, v80
  v_mul_f32 v56, v56, v147
  v_fma_f32 v56, v56, v80, v200
  v_sub_f32 v57, v57, v146
  v_add_f32 v81, 1.0, v81
  v_mul_f32 v57, v57, v147
  v_fma_f32 v57, v57, v81, v201
  v_sub_f32 v58, v58, v146
  v_add_f32 v82, 1.0, v82
  v_mul_f32 v58, v58, v147
  v_fma_f32 v58, v58, v82, v202
  v_sub_f32 v59, v59, v146
  v_add_f32 v83, 1.0, v83
  v_mul_f32 v59, v59, v147
  v_fma_f32 v59, v59, v83, v203
  v_sub_f32 v60, v60, v146
  v_add_f32 v84, 1.0, v84
  v_mul_f32 v60, v60, v147
  v_fma_f32 v60, v60, v84, v204
  v_sub_f32 v61, v61, v146
  v_add_f32 v85, 1.0, v85
  v_mul_f32 v61, v61, v147
  v_fma_f32 v61, v61, v85, v205
  v_sub_f32 v62, v62, v146
  v_add_f32 v86, 1.0, v86
  v_mul_f32 v62, v62, v147
  v_fma_f32 v62, v62, v86, v206
  v_sub_f32 v63, v63, v146
  v_add_f32 v87, 1.0, v87
  v_mul_f32 v63, v63, v147
  v_fma_f32 v63, v63, v87, v207
  v_cvt_pk_bf16_f32 v160, v56, v57
  v_cvt_pk_bf16_f32 v161, v58, v59
  v_cvt_pk_bf16_f32 v162, v60, v61
  v_cvt_pk_bf16_f32 v163, v62, v63
  v_sub_f32 v120, v120, v146
  v_add_f32 v88, 1.0, v88
  v_mul_f32 v120, v120, v147
  v_fma_f32 v120, v120, v88, v208
  v_sub_f32 v121, v121, v146
  v_add_f32 v89, 1.0, v89
  v_mul_f32 v121, v121, v147
  v_fma_f32 v121, v121, v89, v209
  v_sub_f32 v122, v122, v146
  v_add_f32 v90, 1.0, v90
  v_mul_f32 v122, v122, v147
  v_fma_f32 v122, v122, v90, v210
  v_sub_f32 v123, v123, v146
  v_add_f32 v91, 1.0, v91
  v_mul_f32 v123, v123, v147
  v_fma_f32 v123, v123, v91, v211
  v_sub_f32 v124, v124, v146
  v_add_f32 v92, 1.0, v92
  v_mul_f32 v124, v124, v147
  v_fma_f32 v124, v124, v92, v212
  v_sub_f32 v125, v125, v146
  v_add_f32 v93, 1.0, v93
  v_mul_f32 v125, v125, v147
  v_fma_f32 v125, v125, v93, v213
  v_sub_f32 v126, v126, v146
  v_add_f32 v94, 1.0, v94
  v_mul_f32 v126, v126, v147
  v_fma_f32 v126, v126, v94, v214
  v_sub_f32 v127, v127, v146
  v_add_f32 v95, 1.0, v95
  v_mul_f32 v127, v127, v147
  v_fma_f32 v127, v127, v95, v215
  v_cvt_pk_bf16_f32 v164, v120, v121
  v_cvt_pk_bf16_f32 v165, v122, v123
  v_cvt_pk_bf16_f32 v166, v124, v125
  v_cvt_pk_bf16_f32 v167, v126, v127
  v_sub_f32 v184, v184, v146
  v_add_f32 v96, 1.0, v96
  v_mul_f32 v184, v184, v147
  v_fma_f32 v184, v184, v96, v216
  v_sub_f32 v185, v185, v146
  v_add_f32 v97, 1.0, v97
  v_mul_f32 v185, v185, v147
  v_fma_f32 v185, v185, v97, v217
  v_sub_f32 v186, v186, v146
  v_add_f32 v98, 1.0, v98
  v_mul_f32 v186, v186, v147
  v_fma_f32 v186, v186, v98, v218
  v_sub_f32 v187, v187, v146
  v_add_f32 v99, 1.0, v99
  v_mul_f32 v187, v187, v147
  v_fma_f32 v187, v187, v99, v219
  v_sub_f32 v188, v188, v146
  v_add_f32 v100, 1.0, v100
  v_mul_f32 v188, v188, v147
  v_fma_f32 v188, v188, v100, v220
  v_sub_f32 v189, v189, v146
  v_add_f32 v101, 1.0, v101
  v_mul_f32 v189, v189, v147
  v_fma_f32 v189, v189, v101, v221
  v_sub_f32 v190, v190, v146
  v_add_f32 v102, 1.0, v102
  v_mul_f32 v190, v190, v147
  v_fma_f32 v190, v190, v102, v222
  v_sub_f32 v191, v191, v146
  v_add_f32 v103, 1.0, v103
  v_mul_f32 v191, v191, v147
  v_fma_f32 v191, v191, v103, v223
  v_cvt_pk_bf16_f32 v168, v184, v185
  v_cvt_pk_bf16_f32 v169, v186, v187
  v_cvt_pk_bf16_f32 v170, v188, v189
  v_cvt_pk_bf16_f32 v171, v190, v191
  s_add_u32 s16, s4, 0x800000
  s_addc_u32 s17, s5, 0
  s_mov_b32 s18, 0x240000
  s_mov_b32 s19, 0x20000
  s_lshr_b32 s98, s2, 2
  s_mul_i32 s98, s98, 0x9000
  s_and_b32 s99, s2, 3
  s_lshl_b32 s99, s99, 7
  s_add_u32 s98, s98, s99
  buffer_store_dwordx4 v[160:163], v38, s[16:19], s98 offen sc1
  s_add_u32 s88, s98, 0x4000
  buffer_store_dwordx4 v[164:167], v38, s[16:19], s88 offen sc1
  buffer_store_dwordx4 v[168:171], v39, s[16:19], s98 offen sc1
  s_add_u32 s12, s4, 0x3400000
  s_addc_u32 s13, s5, 0
  s_mov_b32 s14, 0x2400000
  s_mov_b32 s15, 0x20000
  s_waitcnt vmcnt(0)
  s_barrier
  v_mov_b32 v10, 1
  buffer_atomic_add v10, v16, s[8:11], 0 offen sc1
  s_cmp_lg_u32 s53, 0
  s_cbranch_scc1 adaLN_cond__sliding_block_cached__glu_gated_swiglu__prompt_kernel_s3_done
  s_mov_b32 s90, 0x200000
adaLN_cond__sliding_block_cached__glu_gated_swiglu__prompt_kernel_s3_poll:
  buffer_load_dword v9, v17, s[8:11], 0 offen sc1
  s_waitcnt vmcnt(0)
  v_readfirstlane_b32 s89, v9
  s_nop 3
  s_cmp_ge_u32 s89, 48
  s_cbranch_scc1 adaLN_cond__sliding_block_cached__glu_gated_swiglu__prompt_kernel_s3_done
  s_sub_u32 s90, s90, 1
  s_cmp_eq_u32 s90, 0
  s_cbranch_scc1 adaLN_cond__sliding_block_cached__glu_gated_swiglu__prompt_kernel_s3_done
  s_sleep 4
  s_branch adaLN_cond__sliding_block_cached__glu_gated_swiglu__prompt_kernel_s3_poll
adaLN_cond__sliding_block_cached__glu_gated_swiglu__prompt_kernel_s3_done:
  s_barrier
  s_add_u32 s69, s65, 0
  buffer_load_dwordx4 a[0:3], v12, s[16:19], s69 offen sc1
  buffer_load_dwordx4 a[4:7], v12, s[16:19], s69 offen offset:1024 sc1
  buffer_load_dwordx4 a[8:11], v12, s[16:19], s69 offen offset:2048 sc1
  buffer_load_dwordx4 a[12:15], v12, s[16:19], s69 offen offset:3072 sc1
  s_add_u32 s69, s65, 0x1000
  buffer_load_dwordx4 a[16:19], v12, s[16:19], s69 offen sc1
  buffer_load_dwordx4 a[20:23], v12, s[16:19], s69 offen offset:1024 sc1
  buffer_load_dwordx4 a[24:27], v12, s[16:19], s69 offen offset:2048 sc1
  buffer_load_dwordx4 a[28:31], v12, s[16:19], s69 offen offset:3072 sc1
  s_add_u32 s69, s65, 0x2000
  buffer_load_dwordx4 a[32:35], v12, s[16:19], s69 offen sc1
  buffer_load_dwordx4 a[36:39], v12, s[16:19], s69 offen offset:1024 sc1
  buffer_load_dwordx4 a[40:43], v12, s[16:19], s69 offen offset:2048 sc1
  buffer_load_dwordx4 a[44:47], v12, s[16:19], s69 offen offset:3072 sc1
  s_add_u32 s69, s65, 0x3000
  buffer_load_dwordx4 a[48:51], v12, s[16:19], s69 offen sc1
  buffer_load_dwordx4 a[52:55], v12, s[16:19], s69 offen offset:1024 sc1
  buffer_load_dwordx4 a[56:59], v12, s[16:19], s69 offen offset:2048 sc1
  buffer_load_dwordx4 a[60:63], v12, s[16:19], s69 offen offset:3072 sc1
  s_add_u32 s69, s65, 0x4000
  buffer_load_dwordx4 a[64:67], v12, s[16:19], s69 offen sc1
  buffer_load_dwordx4 a[68:71], v12, s[16:19], s69 offen offset:1024 sc1
  buffer_load_dwordx4 a[72:75], v12, s[16:19], s69 offen offset:2048 sc1
  buffer_load_dwordx4 a[76:79], v12, s[16:19], s69 offen offset:3072 sc1
  s_add_u32 s69, s65, 0x5000
  buffer_load_dwordx4 a[80:83], v12, s[16:19], s69 offen sc1
  buffer_load_dwordx4 a[84:87], v12, s[16:19], s69 offen offset:1024 sc1
  buffer_load_dwordx4 a[88:91], v12, s[16:19], s69 offen offset:2048 sc1
  buffer_load_dwordx4 a[92:95], v12, s[16:19], s69 offen offset:3072 sc1
  s_barrier
  ds_read_b64_tr_b16 a[144:145], v15 offset:16384
  s_waitcnt vmcnt(23)
  ds_read_b64_tr_b16 a[146:147], v15 offset:18432
  ds_read_b64_tr_b16 a[148:149], v15 offset:17408
  ds_read_b64_tr_b16 a[150:151], v15 offset:19456
  ds_read_b64_tr_b16 a[152:153], v15 offset:16640
  ds_read_b64_tr_b16 a[154:155], v15 offset:18688
  ds_read_b64_tr_b16 a[156:157], v15 offset:17664
  ds_read_b64_tr_b16 a[158:159], v15 offset:19712
  ds_read_b64_tr_b16 a[160:161], v15 offset:20480
  ds_read_b64_tr_b16 a[162:163], v15 offset:22528
  ds_read_b64_tr_b16 a[164:165], v15 offset:21504
  ds_read_b64_tr_b16 a[166:167], v15 offset:23552
  s_waitcnt lgkmcnt(10)
  v_mfma_f32_32x32x16_bf16 v[56:71], a[144:147], a[0:3], 0
  s_waitcnt lgkmcnt(8)
  ds_read_b64_tr_b16 a[168:169], v15 offset:20736
  s_add_u32 s67, s77, 0x360000
  ds_read_b64_tr_b16 a[170:171], v15 offset:22784
  s_add_u32 m0, s54, 0xc000
  s_nop 0
  buffer_load_dwordx4 v19, s[32:35], s67 offen lds
  v_mfma_f32_32x32x16_bf16 v[72:87], a[148:151], a[0:3], 0
  s_waitcnt lgkmcnt(8)
  ds_read_b64_tr_b16 a[172:173], v15 offset:21760
  ds_read_b64_tr_b16 a[174:175], v15 offset:23808
  v_mfma_f32_32x32x16_bf16 v[88:103], a[152:155], a[0:3], 0
  s_waitcnt lgkmcnt(8)
  ds_read_b64_tr_b16 a[144:145], v15 offset:24576
  s_add_u32 m0, s54, 0xc400
  ds_read_b64_tr_b16 a[146:147], v15 offset:26624
  v_mfma_f32_32x32x16_bf16 v[104:119], a[156:159], a[0:3], 0
  s_waitcnt lgkmcnt(8)
  ds_read_b64_tr_b16 a[148:149], v15 offset:25600
  s_waitcnt vmcnt(23)
  ds_read_b64_tr_b16 a[150:151], v15 offset:27648
  buffer_load_dwordx4 v19, s[44:47], s67 offen lds
  v_mfma_f32_32x32x16_bf16 v[56:71], a[160:163], a[4:7], v[56:71]
  s_waitcnt lgkmcnt(8)
  ds_read_b64_tr_b16 a[152:153], v15 offset:24832
  s_add_u32 s84, s77, 0x80
  ds_read_b64_tr_b16 a[154:155], v15 offset:26880
  buffer_load_dword a253, v21, s[32:35], s84 offen
  v_mfma_f32_32x32x16_bf16 v[72:87], a[164:167], a[4:7], v[72:87]
  s_waitcnt lgkmcnt(8)
  ds_read_b64_tr_b16 a[156:157], v15 offset:25856
  s_add_u32 m0, s54, 0xc800
  ds_read_b64_tr_b16 a[158:159], v15 offset:27904
  v_mfma_f32_32x32x16_bf16 v[88:103], a[168:171], a[4:7], v[88:103]
  s_waitcnt lgkmcnt(8)
  ds_read_b64_tr_b16 a[160:161], v15 offset:28672
  ds_read_b64_tr_b16 a[162:163], v15 offset:30720
  buffer_load_dwordx4 v20, s[32:35], s67 offen lds
  buffer_load_dword a254, v21, s[44:47], s84 offen
  v_mfma_f32_32x32x16_bf16 v[104:119], a[172:175], a[4:7], v[104:119]
  s_waitcnt lgkmcnt(8)
  ds_read_b64_tr_b16 a[164:165], v15 offset:29696
  s_waitcnt vmcnt(26)
  ds_read_b64_tr_b16 a[166:167], v15 offset:31744
  v_mfma_f32_32x32x16_bf16 v[56:71], a[144:147], a[8:11], v[56:71]
  s_waitcnt lgkmcnt(8)
  ds_read_b64_tr_b16 a[168:169], v15 offset:28928
  s_add_u32 m0, s54, 0xcc00
  ds_read_b64_tr_b16 a[170:171], v15 offset:30976
  v_mfma_f32_32x32x16_bf16 v[72:87], a[148:151], a[8:11], v[72:87]
  s_waitcnt lgkmcnt(8)
  ds_read_b64_tr_b16 a[172:173], v15 offset:29952
  ds_read_b64_tr_b16 a[174:175], v15 offset:32000
  s_barrier
  buffer_load_dwordx4 v20, s[44:47], s67 offen lds
  v_mfma_f32_32x32x16_bf16 v[88:103], a[152:155], a[8:11], v[88:103]
  s_waitcnt lgkmcnt(8)
  ds_read_b64_tr_b16 a[144:145], v15 offset:32768
  ds_read_b64_tr_b16 a[146:147], v15 offset:34816
  v_mfma_f32_32x32x16_bf16 v[104:119], a[156:159], a[8:11], v[104:119]
  s_waitcnt lgkmcnt(8)
  ds_read_b64_tr_b16 a[148:149], v15 offset:33792
  s_waitcnt vmcnt(26)
  ds_read_b64_tr_b16 a[150:151], v15 offset:35840
  s_add_u32 s69, s65, 0x6000
  v_mfma_f32_32x32x16_bf16 v[56:71], a[160:163], a[12:15], v[56:71]
  s_waitcnt lgkmcnt(8)
  ds_read_b64_tr_b16 a[152:153], v15 offset:33024
  ds_read_b64_tr_b16 a[154:155], v15 offset:35072
  buffer_load_dwordx4 a[96:99], v12, s[16:19], s69 offen sc1
  v_mfma_f32_32x32x16_bf16 v[72:87], a[164:167], a[12:15], v[72:87]
  s_waitcnt lgkmcnt(8)
  ds_read_b64_tr_b16 a[156:157], v15 offset:34048
  ds_read_b64_tr_b16 a[158:159], v15 offset:36096
  v_mfma_f32_32x32x16_bf16 v[88:103], a[168:171], a[12:15], v[88:103]
  s_waitcnt lgkmcnt(8)
  ds_read_b64_tr_b16 a[160:161], v15 offset:36864
  ds_read_b64_tr_b16 a[162:163], v15 offset:38912
  v_mfma_f32_32x32x16_bf16 v[104:119], a[172:175], a[12:15], v[104:119]
  s_waitcnt lgkmcnt(8)
  ds_read_b64_tr_b16 a[164:165], v15 offset:37888
  s_waitcnt vmcnt(26)
  ds_read_b64_tr_b16 a[166:167], v15 offset:39936
  buffer_load_dwordx4 a[100:103], v12, s[16:19], s69 offen offset:1024 sc1
  v_mfma_f32_32x32x16_bf16 v[56:71], a[144:147], a[16:19], v[56:71]
  s_waitcnt lgkmcnt(8)
  ds_read_b64_tr_b16 a[168:169], v15 offset:37120
  ds_read_b64_tr_b16 a[170:171], v15 offset:39168
  v_mfma_f32_32x32x16_bf16 v[72:87], a[148:151], a[16:19], v[72:87]
  s_waitcnt lgkmcnt(8)
  ds_read_b64_tr_b16 a[172:173], v15 offset:38144
  ds_read_b64_tr_b16 a[174:175], v15 offset:40192
  v_mfma_f32_32x32x16_bf16 v[88:103], a[152:155], a[16:19], v[88:103]
  s_waitcnt lgkmcnt(8)
  ds_read_b64_tr_b16 a[144:145], v15 offset:40960
  ds_read_b64_tr_b16 a[146:147], v15 offset:43008
  buffer_load_dwordx4 a[104:107], v12, s[16:19], s69 offen offset:2048 sc1
  v_mfma_f32_32x32x16_bf16 v[104:119], a[156:159], a[16:19], v[104:119]
  s_waitcnt lgkmcnt(8)
  ds_read_b64_tr_b16 a[148:149], v15 offset:41984
  s_waitcnt vmcnt(27)
  ds_read_b64_tr_b16 a[150:151], v15 offset:44032
  v_mfma_f32_32x32x16_bf16 v[56:71], a[160:163], a[20:23], v[56:71]
  s_waitcnt lgkmcnt(8)
  ds_read_b64_tr_b16 a[152:153], v15 offset:41216
  ds_read_b64_tr_b16 a[154:155], v15 offset:43264
  v_mfma_f32_32x32x16_bf16 v[72:87], a[164:167], a[20:23], v[72:87]
  s_waitcnt lgkmcnt(8)
  ds_read_b64_tr_b16 a[156:157], v15 offset:42240
  ds_read_b64_tr_b16 a[158:159], v15 offset:44288
  buffer_load_dwordx4 a[108:111], v12, s[16:19], s69 offen offset:3072 sc1
  v_mfma_f32_32x32x16_bf16 v[88:103], a[168:171], a[20:23], v[88:103]
  s_waitcnt lgkmcnt(8)
  ds_read_b64_tr_b16 a[160:161], v15 offset:45056
  ds_read_b64_tr_b16 a[162:163], v15 offset:47104
  v_mfma_f32_32x32x16_bf16 v[104:119], a[172:175], a[20:23], v[104:119]
  s_waitcnt lgkmcnt(8)
  ds_read_b64_tr_b16 a[164:165], v15 offset:46080
  s_waitcnt vmcnt(27)
  ds_read_b64_tr_b16 a[166:167], v15 offset:48128
  s_add_u32 s67, s77, 0x3f0000
  s_add_u32 m0, s54, 0x10000
  v_mfma_f32_32x32x16_bf16 v[56:71], a[144:147], a[24:27], v[56:71]
  s_waitcnt lgkmcnt(8)
  ds_read_b64_tr_b16 a[168:169], v15 offset:45312
  ds_read_b64_tr_b16 a[170:171], v15 offset:47360
  buffer_load_dwordx4 v19, s[32:35], s67 offen lds
  s_add_u32 m0, s54, 0x10400
  v_mfma_f32_32x32x16_bf16 v[72:87], a[148:151], a[24:27], v[72:87]
  s_waitcnt lgkmcnt(8)
  ds_read_b64_tr_b16 a[172:173], v15 offset:46336
  ds_read_b64_tr_b16 a[174:175], v15 offset:48384
  s_barrier
  buffer_load_dwordx4 v19, s[44:47], s67 offen lds
  s_add_u32 m0, s54, 0x10800
  v_mfma_f32_32x32x16_bf16 v[88:103], a[152:155], a[24:27], v[88:103]
  s_waitcnt lgkmcnt(8)
  ds_read_b64_tr_b16 a[144:145], v15 offset:49152
  ds_read_b64_tr_b16 a[146:147], v15 offset:51200
  buffer_load_dwordx4 v20, s[32:35], s67 offen lds
  s_add_u32 m0, s54, 0x10c00
  v_mfma_f32_32x32x16_bf16 v[104:119], a[156:159], a[24:27], v[104:119]
  s_waitcnt lgkmcnt(8)
  ds_read_b64_tr_b16 a[148:149], v15 offset:50176
  s_waitcnt vmcnt(29)
  ds_read_b64_tr_b16 a[150:151], v15 offset:52224
  buffer_load_dwordx4 v20, s[44:47], s67 offen lds
  s_add_u32 s69, s65, 0x7000
  v_mfma_f32_32x32x16_bf16 v[56:71], a[160:163], a[28:31], v[56:71]
  s_waitcnt lgkmcnt(8)
  ds_read_b64_tr_b16 a[152:153], v15 offset:49408
  ds_read_b64_tr_b16 a[154:155], v15 offset:51456
  buffer_load_dwordx4 a[112:115], v12, s[16:19], s69 offen sc1
  v_mfma_f32_32x32x16_bf16 v[72:87], a[164:167], a[28:31], v[72:87]
  s_waitcnt lgkmcnt(8)
  ds_read_b64_tr_b16 a[156:157], v15 offset:50432
  ds_read_b64_tr_b16 a[158:159], v15 offset:52480
  buffer_load_dwordx4 a[116:119], v12, s[16:19], s69 offen offset:1024 sc1
  v_mfma_f32_32x32x16_bf16 v[88:103], a[168:171], a[28:31], v[88:103]
  s_waitcnt lgkmcnt(8)
  ds_read_b64_tr_b16 a[160:161], v15 offset:53248
  ds_read_b64_tr_b16 a[162:163], v15 offset:55296
  buffer_load_dwordx4 a[120:123], v12, s[16:19], s69 offen offset:2048 sc1
  v_mfma_f32_32x32x16_bf16 v[104:119], a[172:175], a[28:31], v[104:119]
  s_waitcnt lgkmcnt(8)
  ds_read_b64_tr_b16 a[164:165], v15 offset:54272
  s_waitcnt vmcnt(32)
  ds_read_b64_tr_b16 a[166:167], v15 offset:56320
  buffer_load_dwordx4 a[124:127], v12, s[16:19], s69 offen offset:3072 sc1
  s_add_u32 s67, s77, 0x480000
  s_add_u32 m0, s54, 0x14000
  v_mfma_f32_32x32x16_bf16 v[56:71], a[144:147], a[32:35], v[56:71]
  s_waitcnt lgkmcnt(8)
  ds_read_b64_tr_b16 a[168:169], v15 offset:53504
  ds_read_b64_tr_b16 a[170:171], v15 offset:55552
  buffer_load_dwordx4 v19, s[32:35], s67 offen lds
  s_add_u32 m0, s54, 0x14400
  v_mfma_f32_32x32x16_bf16 v[72:87], a[148:151], a[32:35], v[72:87]
  s_waitcnt lgkmcnt(8)
  ds_read_b64_tr_b16 a[172:173], v15 offset:54528
  ds_read_b64_tr_b16 a[174:175], v15 offset:56576
  buffer_load_dwordx4 v19, s[44:47], s67 offen lds
  s_add_u32 m0, s54, 0x14800
  v_mfma_f32_32x32x16_bf16 v[88:103], a[152:155], a[32:35], v[88:103]
  s_waitcnt lgkmcnt(8)
  ds_read_b64_tr_b16 a[144:145], v15 offset:57344
  ds_read_b64_tr_b16 a[146:147], v15 offset:59392
  buffer_load_dwordx4 v20, s[32:35], s67 offen lds
  s_add_u32 m0, s54, 0x14c00
  v_mfma_f32_32x32x16_bf16 v[104:119], a[156:159], a[32:35], v[104:119]
  s_waitcnt lgkmcnt(8)
  ds_read_b64_tr_b16 a[148:149], v15 offset:58368
  s_waitcnt vmcnt(35)
  ds_read_b64_tr_b16 a[150:151], v15 offset:60416
  buffer_load_dwordx4 v20, s[44:47], s67 offen lds
  s_add_u32 s69, s65, 0x8000
  v_mfma_f32_32x32x16_bf16 v[56:71], a[160:163], a[36:39], v[56:71]
  s_waitcnt lgkmcnt(8)
  ds_read_b64_tr_b16 a[152:153], v15 offset:57600
  ds_read_b64_tr_b16 a[154:155], v15 offset:59648
  buffer_load_dwordx4 a[128:131], v12, s[16:19], s69 offen sc1
  v_mfma_f32_32x32x16_bf16 v[72:87], a[164:167], a[36:39], v[72:87]
  s_waitcnt lgkmcnt(8)
  ds_read_b64_tr_b16 a[156:157], v15 offset:58624
  ds_read_b64_tr_b16 a[158:159], v15 offset:60672
  buffer_load_dwordx4 a[132:135], v12, s[16:19], s69 offen offset:1024 sc1
  v_mfma_f32_32x32x16_bf16 v[88:103], a[168:171], a[36:39], v[88:103]
  s_waitcnt lgkmcnt(8)
  ds_read_b64_tr_b16 a[160:161], v15 offset:61440
  ds_read_b64_tr_b16 a[162:163], v15 offset:63488
  buffer_load_dwordx4 a[136:139], v12, s[16:19], s69 offen offset:2048 sc1
  v_mfma_f32_32x32x16_bf16 v[104:119], a[172:175], a[36:39], v[104:119]
  s_waitcnt lgkmcnt(8)
  ds_read_b64_tr_b16 a[164:165], v15 offset:62464
  s_waitcnt vmcnt(38)
  ds_read_b64_tr_b16 a[166:167], v15 offset:64512
  buffer_load_dwordx4 a[140:143], v12, s[16:19], s69 offen offset:3072 sc1
  v_mfma_f32_32x32x16_bf16 v[56:71], a[144:147], a[40:43], v[56:71]
  s_waitcnt lgkmcnt(8)
  ds_read_b64_tr_b16 a[168:169], v15 offset:61696
  ds_read_b64_tr_b16 a[170:171], v15 offset:63744
  v_mfma_f32_32x32x16_bf16 v[72:87], a[148:151], a[40:43], v[72:87]
  s_waitcnt lgkmcnt(8)
  ds_read_b64_tr_b16 a[172:173], v15 offset:62720
  ds_read_b64_tr_b16 a[174:175], v15 offset:64768
  s_barrier
  v_mfma_f32_32x32x16_bf16 v[88:103], a[152:155], a[40:43], v[88:103]
  s_waitcnt lgkmcnt(8)
  ds_read_b64_tr_b16 a[144:145], v14
  s_add_u32 s67, s77, 0x80
  ds_read_b64_tr_b16 a[146:147], v14 offset:2048
  s_add_u32 m0, s54, 0x18000
  s_nop 0
  buffer_load_dwordx4 v19, s[32:35], s67 offen lds
  v_mfma_f32_32x32x16_bf16 v[104:119], a[156:159], a[40:43], v[104:119]
  s_waitcnt lgkmcnt(8)
  ds_read_b64_tr_b16 a[148:149], v14 offset:1024
  s_waitcnt vmcnt(39)
  ds_read_b64_tr_b16 a[150:151], v14 offset:3072
  v_mfma_f32_32x32x16_bf16 v[56:71], a[160:163], a[44:47], v[56:71]
  s_waitcnt lgkmcnt(8)
  ds_read_b64_tr_b16 a[152:153], v14 offset:256
  s_add_u32 m0, s54, 0x18400
  ds_read_b64_tr_b16 a[154:155], v14 offset:2304
  v_mfma_f32_32x32x16_bf16 v[72:87], a[164:167], a[44:47], v[72:87]
  s_waitcnt lgkmcnt(8)
  ds_read_b64_tr_b16 a[156:157], v14 offset:1280
  ds_read_b64_tr_b16 a[158:159], v14 offset:3328
  buffer_load_dwordx4 v19, s[44:47], s67 offen lds
  v_mfma_f32_32x32x16_bf16 v[88:103], a[168:171], a[44:47], v[88:103]
  s_waitcnt lgkmcnt(8)
  ds_read_b64_tr_b16 a[160:161], v14 offset:4096
  ds_read_b64_tr_b16 a[162:163], v14 offset:6144
  v_mfma_f32_32x32x16_bf16 v[104:119], a[172:175], a[44:47], v[104:119]
  s_waitcnt lgkmcnt(8)
  ds_read_b64_tr_b16 a[164:165], v14 offset:5120
  s_waitcnt vmcnt(39)
  ds_read_b64_tr_b16 a[166:167], v14 offset:7168
  s_add_u32 m0, s54, 0x18800
  v_mfma_f32_32x32x16_bf16 v[56:71], a[144:147], a[48:51], v[56:71]
  s_waitcnt lgkmcnt(8)
  ds_read_b64_tr_b16 a[168:169], v14 offset:4352
  ds_read_b64_tr_b16 a[170:171], v14 offset:6400
  buffer_load_dwordx4 v20, s[32:35], s67 offen lds
  v_mfma_f32_32x32x16_bf16 v[72:87], a[148:151], a[48:51], v[72:87]
  s_waitcnt lgkmcnt(8)
  ds_read_b64_tr_b16 a[172:173], v14 offset:5376
  ds_read_b64_tr_b16 a[174:175], v14 offset:7424
  v_mfma_f32_32x32x16_bf16 v[88:103], a[152:155], a[48:51], v[88:103]
  s_waitcnt lgkmcnt(8)
  ds_read_b64_tr_b16 a[144:145], v14 offset:8192
  s_add_u32 m0, s54, 0x18c00
  ds_read_b64_tr_b16 a[146:147], v14 offset:10240
  v_mfma_f32_32x32x16_bf16 v[104:119], a[156:159], a[48:51], v[104:119]
  s_waitcnt lgkmcnt(8)
  ds_read_b64_tr_b16 a[148:149], v14 offset:9216
  s_waitcnt vmcnt(39)
  ds_read_b64_tr_b16 a[150:151], v14 offset:11264
  buffer_load_dwordx4 v20, s[44:47], s67 offen lds
  v_mfma_f32_32x32x16_bf16 v[56:71], a[160:163], a[52:55], v[56:71]
  s_waitcnt lgkmcnt(8)
  ds_read_b64_tr_b16 a[152:153], v14 offset:8448
  ds_read_b64_tr_b16 a[154:155], v14 offset:10496
  v_mfma_f32_32x32x16_bf16 v[72:87], a[164:167], a[52:55], v[72:87]
  s_waitcnt lgkmcnt(8)
  ds_read_b64_tr_b16 a[156:157], v14 offset:9472
  ds_read_b64_tr_b16 a[158:159], v14 offset:11520
  v_mfma_f32_32x32x16_bf16 v[88:103], a[168:171], a[52:55], v[88:103]
  s_waitcnt lgkmcnt(8)
  ds_read_b64_tr_b16 a[160:161], v14 offset:12288
  ds_read_b64_tr_b16 a[162:163], v14 offset:14336
  v_mfma_f32_32x32x16_bf16 v[104:119], a[172:175], a[52:55], v[104:119]
  s_waitcnt lgkmcnt(8)
  ds_read_b64_tr_b16 a[164:165], v14 offset:13312
  s_waitcnt vmcnt(39)
  ds_read_b64_tr_b16 a[166:167], v14 offset:15360
  v_mfma_f32_32x32x16_bf16 v[56:71], a[144:147], a[56:59], v[56:71]
  s_waitcnt lgkmcnt(8)
  ds_read_b64_tr_b16 a[168:169], v14 offset:12544
  ds_read_b64_tr_b16 a[170:171], v14 offset:14592
  v_mfma_f32_32x32x16_bf16 v[72:87], a[148:151], a[56:59], v[72:87]
  s_waitcnt lgkmcnt(8)
  ds_read_b64_tr_b16 a[172:173], v14 offset:13568
  ds_read_b64_tr_b16 a[174:175], v14 offset:15616
  s_barrier
  v_mfma_f32_32x32x16_bf16 v[88:103], a[152:155], a[56:59], v[88:103]
  s_waitcnt lgkmcnt(8)
  ds_read_b64_tr_b16 a[144:145], v14 offset:16384
  s_add_u32 s67, s77, 0x90080
  ds_read_b64_tr_b16 a[146:147], v14 offset:18432
  s_add_u32 m0, s54, 0x1c000
  s_nop 0
  buffer_load_dwordx4 v19, s[32:35], s67 offen lds
  v_mfma_f32_32x32x16_bf16 v[104:119], a[156:159], a[56:59], v[104:119]
  s_waitcnt lgkmcnt(8)
  ds_read_b64_tr_b16 a[148:149], v14 offset:17408
  s_waitcnt vmcnt(39)
  ds_read_b64_tr_b16 a[150:151], v14 offset:19456
  v_mfma_f32_32x32x16_bf16 v[56:71], a[160:163], a[60:63], v[56:71]
  s_waitcnt lgkmcnt(8)
  ds_read_b64_tr_b16 a[152:153], v14 offset:16640
  s_add_u32 m0, s54, 0x1c400
  ds_read_b64_tr_b16 a[154:155], v14 offset:18688
  v_mfma_f32_32x32x16_bf16 v[72:87], a[164:167], a[60:63], v[72:87]
  s_waitcnt lgkmcnt(8)
  ds_read_b64_tr_b16 a[156:157], v14 offset:17664
  ds_read_b64_tr_b16 a[158:159], v14 offset:19712
  buffer_load_dwordx4 v19, s[44:47], s67 offen lds
  v_mfma_f32_32x32x16_bf16 v[88:103], a[168:171], a[60:63], v[88:103]
  s_waitcnt lgkmcnt(8)
  ds_read_b64_tr_b16 a[160:161], v14 offset:20480
  ds_read_b64_tr_b16 a[162:163], v14 offset:22528
  v_mfma_f32_32x32x16_bf16 v[104:119], a[172:175], a[60:63], v[104:119]
  s_waitcnt lgkmcnt(8)
  ds_read_b64_tr_b16 a[164:165], v14 offset:21504
  s_waitcnt vmcnt(39)
  ds_read_b64_tr_b16 a[166:167], v14 offset:23552
  s_add_u32 m0, s54, 0x1c800
  v_mfma_f32_32x32x16_bf16 v[56:71], a[144:147], a[64:67], v[56:71]
  s_waitcnt lgkmcnt(8)
  ds_read_b64_tr_b16 a[168:169], v14 offset:20736
  ds_read_b64_tr_b16 a[170:171], v14 offset:22784
  buffer_load_dwordx4 v20, s[32:35], s67 offen lds
  v_mfma_f32_32x32x16_bf16 v[72:87], a[148:151], a[64:67], v[72:87]
  s_waitcnt lgkmcnt(8)
  ds_read_b64_tr_b16 a[172:173], v14 offset:21760
  ds_read_b64_tr_b16 a[174:175], v14 offset:23808
  v_mfma_f32_32x32x16_bf16 v[88:103], a[152:155], a[64:67], v[88:103]
  s_waitcnt lgkmcnt(8)
  ds_read_b64_tr_b16 a[144:145], v14 offset:24576
  s_add_u32 m0, s54, 0x1cc00
  ds_read_b64_tr_b16 a[146:147], v14 offset:26624
  v_mfma_f32_32x32x16_bf16 v[104:119], a[156:159], a[64:67], v[104:119]
  s_waitcnt lgkmcnt(8)
  ds_read_b64_tr_b16 a[148:149], v14 offset:25600
  s_waitcnt vmcnt(39)
  ds_read_b64_tr_b16 a[150:151], v14 offset:27648
  buffer_load_dwordx4 v20, s[44:47], s67 offen lds
  v_mfma_f32_32x32x16_bf16 v[56:71], a[160:163], a[68:71], v[56:71]
  s_waitcnt lgkmcnt(8)
  ds_read_b64_tr_b16 a[152:153], v14 offset:24832
  ds_read_b64_tr_b16 a[154:155], v14 offset:26880
  v_mfma_f32_32x32x16_bf16 v[72:87], a[164:167], a[68:71], v[72:87]
  s_waitcnt lgkmcnt(8)
  ds_read_b64_tr_b16 a[156:157], v14 offset:25856
  ds_read_b64_tr_b16 a[158:159], v14 offset:27904
  v_mfma_f32_32x32x16_bf16 v[88:103], a[168:171], a[68:71], v[88:103]
  s_waitcnt lgkmcnt(8)
  ds_read_b64_tr_b16 a[160:161], v14 offset:28672
  ds_read_b64_tr_b16 a[162:163], v14 offset:30720
  v_mfma_f32_32x32x16_bf16 v[104:119], a[172:175], a[68:71], v[104:119]
  s_waitcnt lgkmcnt(8)
  ds_read_b64_tr_b16 a[164:165], v14 offset:29696
  s_waitcnt vmcnt(39)
  ds_read_b64_tr_b16 a[166:167], v14 offset:31744
  v_mfma_f32_32x32x16_bf16 v[56:71], a[144:147], a[72:75], v[56:71]
  s_waitcnt lgkmcnt(8)
  ds_read_b64_tr_b16 a[168:169], v14 offset:28928
  ds_read_b64_tr_b16 a[170:171], v14 offset:30976
  v_mfma_f32_32x32x16_bf16 v[72:87], a[148:151], a[72:75], v[72:87]
  s_waitcnt lgkmcnt(8)
  ds_read_b64_tr_b16 a[172:173], v14 offset:29952
  ds_read_b64_tr_b16 a[174:175], v14 offset:32000
  s_barrier
  v_mfma_f32_32x32x16_bf16 v[88:103], a[152:155], a[72:75], v[88:103]
  s_waitcnt lgkmcnt(8)
  ds_read_b64_tr_b16 a[144:145], v14 offset:32768
  s_add_u32 s67, s77, 0x120080
  ds_read_b64_tr_b16 a[146:147], v14 offset:34816
  s_add_u32 m0, s54, 0
  s_nop 0
  buffer_load_dwordx4 v19, s[32:35], s67 offen lds
  v_mfma_f32_32x32x16_bf16 v[104:119], a[156:159], a[72:75], v[104:119]
  s_waitcnt lgkmcnt(8)
  ds_read_b64_tr_b16 a[148:149], v14 offset:33792
  s_waitcnt vmcnt(39)
  ds_read_b64_tr_b16 a[150:151], v14 offset:35840
  v_mfma_f32_32x32x16_bf16 v[56:71], a[160:163], a[76:79], v[56:71]
  s_waitcnt lgkmcnt(8)
  ds_read_b64_tr_b16 a[152:153], v14 offset:33024
  s_add_u32 m0, s54, 0x400
  ds_read_b64_tr_b16 a[154:155], v14 offset:35072
  v_mfma_f32_32x32x16_bf16 v[72:87], a[164:167], a[76:79], v[72:87]
  s_waitcnt lgkmcnt(8)
  ds_read_b64_tr_b16 a[156:157], v14 offset:34048
  ds_read_b64_tr_b16 a[158:159], v14 offset:36096
  buffer_load_dwordx4 v19, s[44:47], s67 offen lds
  v_mfma_f32_32x32x16_bf16 v[88:103], a[168:171], a[76:79], v[88:103]
  s_waitcnt lgkmcnt(8)
  ds_read_b64_tr_b16 a[160:161], v14 offset:36864
  ds_read_b64_tr_b16 a[162:163], v14 offset:38912
  v_mfma_f32_32x32x16_bf16 v[104:119], a[172:175], a[76:79], v[104:119]
  s_waitcnt lgkmcnt(8)
  ds_read_b64_tr_b16 a[164:165], v14 offset:37888
  s_waitcnt vmcnt(39)
  ds_read_b64_tr_b16 a[166:167], v14 offset:39936
  s_add_u32 m0, s54, 0x800
  v_mfma_f32_32x32x16_bf16 v[56:71], a[144:147], a[80:83], v[56:71]
  s_waitcnt lgkmcnt(8)
  ds_read_b64_tr_b16 a[168:169], v14 offset:37120
  ds_read_b64_tr_b16 a[170:171], v14 offset:39168
  buffer_load_dwordx4 v20, s[32:35], s67 offen lds
  v_mfma_f32_32x32x16_bf16 v[72:87], a[148:151], a[80:83], v[72:87]
  s_waitcnt lgkmcnt(8)
  ds_read_b64_tr_b16 a[172:173], v14 offset:38144
  ds_read_b64_tr_b16 a[174:175], v14 offset:40192
  v_mfma_f32_32x32x16_bf16 v[88:103], a[152:155], a[80:83], v[88:103]
  s_waitcnt lgkmcnt(8)
  ds_read_b64_tr_b16 a[144:145], v14 offset:40960
  s_add_u32 m0, s54, 0xc00
  ds_read_b64_tr_b16 a[146:147], v14 offset:43008
  v_mfma_f32_32x32x16_bf16 v[104:119], a[156:159], a[80:83], v[104:119]
  s_waitcnt lgkmcnt(8)
  ds_read_b64_tr_b16 a[148:149], v14 offset:41984
  s_waitcnt vmcnt(39)
  ds_read_b64_tr_b16 a[150:151], v14 offset:44032
  buffer_load_dwordx4 v20, s[44:47], s67 offen lds
  v_mfma_f32_32x32x16_bf16 v[56:71], a[160:163], a[84:87], v[56:71]
  s_waitcnt lgkmcnt(8)
  ds_read_b64_tr_b16 a[152:153], v14 offset:41216
  ds_read_b64_tr_b16 a[154:155], v14 offset:43264
  v_mfma_f32_32x32x16_bf16 v[72:87], a[164:167], a[84:87], v[72:87]
  s_waitcnt lgkmcnt(8)
  ds_read_b64_tr_b16 a[156:157], v14 offset:42240
  ds_read_b64_tr_b16 a[158:159], v14 offset:44288
  v_mfma_f32_32x32x16_bf16 v[88:103], a[168:171], a[84:87], v[88:103]
  s_waitcnt lgkmcnt(8)
  ds_read_b64_tr_b16 a[160:161], v14 offset:45056
  ds_read_b64_tr_b16 a[162:163], v14 offset:47104
  v_mfma_f32_32x32x16_bf16 v[104:119], a[172:175], a[84:87], v[104:119]
  s_waitcnt lgkmcnt(8)
  ds_read_b64_tr_b16 a[164:165], v14 offset:46080
  s_waitcnt vmcnt(39)
  ds_read_b64_tr_b16 a[166:167], v14 offset:48128
  v_mfma_f32_32x32x16_bf16 v[56:71], a[144:147], a[88:91], v[56:71]
  s_waitcnt lgkmcnt(8)
  ds_read_b64_tr_b16 a[168:169], v14 offset:45312
  ds_read_b64_tr_b16 a[170:171], v14 offset:47360
  v_mfma_f32_32x32x16_bf16 v[72:87], a[148:151], a[88:91], v[72:87]
  s_waitcnt lgkmcnt(8)
  ds_read_b64_tr_b16 a[172:173], v14 offset:46336
  s_waitcnt vmcnt(32)
  ds_read_b64_tr_b16 a[174:175], v14 offset:48384
  s_barrier
  v_mfma_f32_32x32x16_bf16 v[88:103], a[152:155], a[88:91], v[88:103]
  s_waitcnt lgkmcnt(8)
  ds_read_b64_tr_b16 a[144:145], v14 offset:49152
  s_add_u32 s67, s77, 0x1b0080
  ds_read_b64_tr_b16 a[146:147], v14 offset:51200
  s_add_u32 m0, s54, 0x4000
  s_nop 0
  buffer_load_dwordx4 v19, s[32:35], s67 offen lds
  v_mfma_f32_32x32x16_bf16 v[104:119], a[156:159], a[88:91], v[104:119]
  s_waitcnt lgkmcnt(8)
  ds_read_b64_tr_b16 a[148:149], v14 offset:50176
  ds_read_b64_tr_b16 a[150:151], v14 offset:52224
  v_mfma_f32_32x32x16_bf16 v[56:71], a[160:163], a[92:95], v[56:71]
  s_waitcnt lgkmcnt(8)
  ds_read_b64_tr_b16 a[152:153], v14 offset:49408
  s_add_u32 m0, s54, 0x4400
  ds_read_b64_tr_b16 a[154:155], v14 offset:51456
  v_mfma_f32_32x32x16_bf16 v[72:87], a[164:167], a[92:95], v[72:87]
  s_waitcnt lgkmcnt(8)
  ds_read_b64_tr_b16 a[156:157], v14 offset:50432
  ds_read_b64_tr_b16 a[158:159], v14 offset:52480
  buffer_load_dwordx4 v19, s[44:47], s67 offen lds
  v_mfma_f32_32x32x16_bf16 v[88:103], a[168:171], a[92:95], v[88:103]
  s_waitcnt lgkmcnt(8)
  ds_read_b64_tr_b16 a[160:161], v14 offset:53248
  ds_read_b64_tr_b16 a[162:163], v14 offset:55296
  v_mfma_f32_32x32x16_bf16 v[104:119], a[172:175], a[92:95], v[104:119]
  s_waitcnt lgkmcnt(8)
  ds_read_b64_tr_b16 a[164:165], v14 offset:54272
  s_waitcnt vmcnt(33)
  ds_read_b64_tr_b16 a[166:167], v14 offset:56320
  s_add_u32 m0, s54, 0x4800
  v_mfma_f32_32x32x16_bf16 v[56:71], a[144:147], a[96:99], v[56:71]
  s_waitcnt lgkmcnt(8)
  ds_read_b64_tr_b16 a[168:169], v14 offset:53504
  ds_read_b64_tr_b16 a[170:171], v14 offset:55552
  buffer_load_dwordx4 v20, s[32:35], s67 offen lds
  v_mfma_f32_32x32x16_bf16 v[72:87], a[148:151], a[96:99], v[72:87]
  s_waitcnt lgkmcnt(8)
  ds_read_b64_tr_b16 a[172:173], v14 offset:54528
  ds_read_b64_tr_b16 a[174:175], v14 offset:56576
  v_mfma_f32_32x32x16_bf16 v[88:103], a[152:155], a[96:99], v[88:103]
  s_waitcnt lgkmcnt(8)
  ds_read_b64_tr_b16 a[144:145], v14 offset:57344
  s_add_u32 m0, s54, 0x4c00
  ds_read_b64_tr_b16 a[146:147], v14 offset:59392
  v_mfma_f32_32x32x16_bf16 v[104:119], a[156:159], a[96:99], v[104:119]
  s_waitcnt lgkmcnt(8)
  ds_read_b64_tr_b16 a[148:149], v14 offset:58368
  s_waitcnt vmcnt(33)
  ds_read_b64_tr_b16 a[150:151], v14 offset:60416
  buffer_load_dwordx4 v20, s[44:47], s67 offen lds
  v_mfma_f32_32x32x16_bf16 v[56:71], a[160:163], a[100:103], v[56:71]
  s_waitcnt lgkmcnt(8)
  ds_read_b64_tr_b16 a[152:153], v14 offset:57600
  ds_read_b64_tr_b16 a[154:155], v14 offset:59648
  v_mfma_f32_32x32x16_bf16 v[72:87], a[164:167], a[100:103], v[72:87]
  s_waitcnt lgkmcnt(8)
  ds_read_b64_tr_b16 a[156:157], v14 offset:58624
  ds_read_b64_tr_b16 a[158:159], v14 offset:60672
  v_mfma_f32_32x32x16_bf16 v[88:103], a[168:171], a[100:103], v[88:103]
  s_waitcnt lgkmcnt(8)
  ds_read_b64_tr_b16 a[160:161], v14 offset:61440
  ds_read_b64_tr_b16 a[162:163], v14 offset:63488
  v_mfma_f32_32x32x16_bf16 v[104:119], a[172:175], a[100:103], v[104:119]
  s_waitcnt lgkmcnt(8)
  ds_read_b64_tr_b16 a[164:165], v14 offset:62464
  s_waitcnt vmcnt(33)
  ds_read_b64_tr_b16 a[166:167], v14 offset:64512
  v_mfma_f32_32x32x16_bf16 v[56:71], a[144:147], a[104:107], v[56:71]
  s_waitcnt lgkmcnt(8)
  ds_read_b64_tr_b16 a[168:169], v14 offset:61696
  ds_read_b64_tr_b16 a[170:171], v14 offset:63744
  v_mfma_f32_32x32x16_bf16 v[72:87], a[148:151], a[104:107], v[72:87]
  s_waitcnt lgkmcnt(8)
  ds_read_b64_tr_b16 a[172:173], v14 offset:62720
  s_waitcnt vmcnt(28)
  ds_read_b64_tr_b16 a[174:175], v14 offset:64768
  s_barrier
  v_mfma_f32_32x32x16_bf16 v[88:103], a[152:155], a[104:107], v[88:103]
  s_waitcnt lgkmcnt(8)
  ds_read_b64_tr_b16 a[144:145], v15
  s_add_u32 s67, s77, 0x240080
  ds_read_b64_tr_b16 a[146:147], v15 offset:2048
  s_add_u32 m0, s54, 0x8000
  s_nop 0
  buffer_load_dwordx4 v19, s[32:35], s67 offen lds
  v_mfma_f32_32x32x16_bf16 v[104:119], a[156:159], a[104:107], v[104:119]
  s_waitcnt lgkmcnt(8)
  ds_read_b64_tr_b16 a[148:149], v15 offset:1024
  ds_read_b64_tr_b16 a[150:151], v15 offset:3072
  v_mfma_f32_32x32x16_bf16 v[56:71], a[160:163], a[108:111], v[56:71]
  s_waitcnt lgkmcnt(8)
  ds_read_b64_tr_b16 a[152:153], v15 offset:256
  s_add_u32 m0, s54, 0x8400
  ds_read_b64_tr_b16 a[154:155], v15 offset:2304
  v_mfma_f32_32x32x16_bf16 v[72:87], a[164:167], a[108:111], v[72:87]
  s_waitcnt lgkmcnt(8)
  ds_read_b64_tr_b16 a[156:157], v15 offset:1280
  ds_read_b64_tr_b16 a[158:159], v15 offset:3328
  buffer_load_dwordx4 v19, s[44:47], s67 offen lds
  v_mfma_f32_32x32x16_bf16 v[88:103], a[168:171], a[108:111], v[88:103]
  s_waitcnt lgkmcnt(8)
  ds_read_b64_tr_b16 a[160:161], v15 offset:4096
  ds_read_b64_tr_b16 a[162:163], v15 offset:6144
  v_mfma_f32_32x32x16_bf16 v[104:119], a[172:175], a[108:111], v[104:119]
  s_waitcnt lgkmcnt(8)
  ds_read_b64_tr_b16 a[164:165], v15 offset:5120
  s_waitcnt vmcnt(29)
  ds_read_b64_tr_b16 a[166:167], v15 offset:7168
  s_add_u32 m0, s54, 0x8800
  v_mfma_f32_32x32x16_bf16 v[56:71], a[144:147], a[112:115], v[56:71]
  s_waitcnt lgkmcnt(8)
  ds_read_b64_tr_b16 a[168:169], v15 offset:4352
  ds_read_b64_tr_b16 a[170:171], v15 offset:6400
  buffer_load_dwordx4 v20, s[32:35], s67 offen lds
  v_mfma_f32_32x32x16_bf16 v[72:87], a[148:151], a[112:115], v[72:87]
  s_waitcnt lgkmcnt(8)
  ds_read_b64_tr_b16 a[172:173], v15 offset:5376
  ds_read_b64_tr_b16 a[174:175], v15 offset:7424
  v_mfma_f32_32x32x16_bf16 v[88:103], a[152:155], a[112:115], v[88:103]
  s_waitcnt lgkmcnt(8)
  ds_read_b64_tr_b16 a[144:145], v15 offset:8192
  s_add_u32 m0, s54, 0x8c00
  ds_read_b64_tr_b16 a[146:147], v15 offset:10240
  v_mfma_f32_32x32x16_bf16 v[104:119], a[156:159], a[112:115], v[104:119]
  s_waitcnt lgkmcnt(8)
  ds_read_b64_tr_b16 a[148:149], v15 offset:9216
  s_waitcnt vmcnt(29)
  ds_read_b64_tr_b16 a[150:151], v15 offset:11264
  buffer_load_dwordx4 v20, s[44:47], s67 offen lds
  v_mfma_f32_32x32x16_bf16 v[56:71], a[160:163], a[116:119], v[56:71]
  s_waitcnt lgkmcnt(8)
  ds_read_b64_tr_b16 a[152:153], v15 offset:8448
  ds_read_b64_tr_b16 a[154:155], v15 offset:10496
  v_mfma_f32_32x32x16_bf16 v[72:87], a[164:167], a[116:119], v[72:87]
  s_waitcnt lgkmcnt(8)
  ds_read_b64_tr_b16 a[156:157], v15 offset:9472
  ds_read_b64_tr_b16 a[158:159], v15 offset:11520
  v_mfma_f32_32x32x16_bf16 v[88:103], a[168:171], a[116:119], v[88:103]
  s_waitcnt lgkmcnt(8)
  ds_read_b64_tr_b16 a[160:161], v15 offset:12288
  ds_read_b64_tr_b16 a[162:163], v15 offset:14336
  v_mfma_f32_32x32x16_bf16 v[104:119], a[172:175], a[116:119], v[104:119]
  s_waitcnt lgkmcnt(8)
  ds_read_b64_tr_b16 a[164:165], v15 offset:13312
  s_waitcnt vmcnt(29)
  ds_read_b64_tr_b16 a[166:167], v15 offset:15360
  v_mfma_f32_32x32x16_bf16 v[56:71], a[144:147], a[120:123], v[56:71]
  s_waitcnt lgkmcnt(8)
  ds_read_b64_tr_b16 a[168:169], v15 offset:12544
  ds_read_b64_tr_b16 a[170:171], v15 offset:14592
  v_mfma_f32_32x32x16_bf16 v[72:87], a[148:151], a[120:123], v[72:87]
  s_waitcnt lgkmcnt(8)
  ds_read_b64_tr_b16 a[172:173], v15 offset:13568
  s_waitcnt vmcnt(24)
  ds_read_b64_tr_b16 a[174:175], v15 offset:15616
  s_barrier
  v_mfma_f32_32x32x16_bf16 v[88:103], a[152:155], a[120:123], v[88:103]
  s_waitcnt lgkmcnt(8)
  ds_read_b64_tr_b16 a[144:145], v15 offset:16384
  s_add_u32 s67, s77, 0x2d0080
  ds_read_b64_tr_b16 a[146:147], v15 offset:18432
  s_add_u32 m0, s54, 0xc000
  s_nop 0
  buffer_load_dwordx4 v19, s[32:35], s67 offen lds
  v_mfma_f32_32x32x16_bf16 v[104:119], a[156:159], a[120:123], v[104:119]
  s_waitcnt lgkmcnt(8)
  ds_read_b64_tr_b16 a[148:149], v15 offset:17408
  ds_read_b64_tr_b16 a[150:151], v15 offset:19456
  v_mfma_f32_32x32x16_bf16 v[56:71], a[160:163], a[124:127], v[56:71]
  s_waitcnt lgkmcnt(8)
  ds_read_b64_tr_b16 a[152:153], v15 offset:16640
  s_add_u32 m0, s54, 0xc400
  ds_read_b64_tr_b16 a[154:155], v15 offset:18688
  v_mfma_f32_32x32x16_bf16 v[72:87], a[164:167], a[124:127], v[72:87]
  s_waitcnt lgkmcnt(8)
  ds_read_b64_tr_b16 a[156:157], v15 offset:17664
  ds_read_b64_tr_b16 a[158:159], v15 offset:19712
  buffer_load_dwordx4 v19, s[44:47], s67 offen lds
  v_mfma_f32_32x32x16_bf16 v[88:103], a[168:171], a[124:127], v[88:103]
  s_waitcnt lgkmcnt(8)
  ds_read_b64_tr_b16 a[160:161], v15 offset:20480
  ds_read_b64_tr_b16 a[162:163], v15 offset:22528
  v_mfma_f32_32x32x16_bf16 v[104:119], a[172:175], a[124:127], v[104:119]
  s_waitcnt lgkmcnt(8)
  ds_read_b64_tr_b16 a[164:165], v15 offset:21504
  s_waitcnt vmcnt(25)
  ds_read_b64_tr_b16 a[166:167], v15 offset:23552
  s_add_u32 m0, s54, 0xc800
  v_mfma_f32_32x32x16_bf16 v[56:71], a[144:147], a[128:131], v[56:71]
  s_waitcnt lgkmcnt(8)
  ds_read_b64_tr_b16 a[168:169], v15 offset:20736
  ds_read_b64_tr_b16 a[170:171], v15 offset:22784
  buffer_load_dwordx4 v20, s[32:35], s67 offen lds
  v_mfma_f32_32x32x16_bf16 v[72:87], a[148:151], a[128:131], v[72:87]
  s_waitcnt lgkmcnt(8)
  ds_read_b64_tr_b16 a[172:173], v15 offset:21760
  ds_read_b64_tr_b16 a[174:175], v15 offset:23808
  v_mfma_f32_32x32x16_bf16 v[88:103], a[152:155], a[128:131], v[88:103]
  s_waitcnt lgkmcnt(8)
  ds_read_b64_tr_b16 a[144:145], v15 offset:24576
  s_add_u32 m0, s54, 0xcc00
  ds_read_b64_tr_b16 a[146:147], v15 offset:26624
  v_mfma_f32_32x32x16_bf16 v[104:119], a[156:159], a[128:131], v[104:119]
  s_waitcnt lgkmcnt(8)
  ds_read_b64_tr_b16 a[148:149], v15 offset:25600
  s_waitcnt vmcnt(25)
  ds_read_b64_tr_b16 a[150:151], v15 offset:27648
  buffer_load_dwordx4 v20, s[44:47], s67 offen lds
  v_mfma_f32_32x32x16_bf16 v[56:71], a[160:163], a[132:135], v[56:71]
  s_waitcnt lgkmcnt(8)
  ds_read_b64_tr_b16 a[152:153], v15 offset:24832
  ds_read_b64_tr_b16 a[154:155], v15 offset:26880
  v_mfma_f32_32x32x16_bf16 v[72:87], a[164:167], a[132:135], v[72:87]
  s_waitcnt lgkmcnt(8)
  ds_read_b64_tr_b16 a[156:157], v15 offset:25856
  ds_read_b64_tr_b16 a[158:159], v15 offset:27904
  v_mfma_f32_32x32x16_bf16 v[88:103], a[168:171], a[132:135], v[88:103]
  s_waitcnt lgkmcnt(8)
  ds_read_b64_tr_b16 a[160:161], v15 offset:28672
  ds_read_b64_tr_b16 a[162:163], v15 offset:30720
  v_mfma_f32_32x32x16_bf16 v[104:119], a[172:175], a[132:135], v[104:119]
  s_waitcnt lgkmcnt(8)
  ds_read_b64_tr_b16 a[164:165], v15 offset:29696
  s_waitcnt vmcnt(25)
  ds_read_b64_tr_b16 a[166:167], v15 offset:31744
  v_mfma_f32_32x32x16_bf16 v[56:71], a[144:147], a[136:139], v[56:71]
  s_waitcnt lgkmcnt(8)
  ds_read_b64_tr_b16 a[168:169], v15 offset:28928
  ds_read_b64_tr_b16 a[170:171], v15 offset:30976
  v_mfma_f32_32x32x16_bf16 v[72:87], a[148:151], a[136:139], v[72:87]
  s_waitcnt lgkmcnt(8)
  ds_read_b64_tr_b16 a[172:173], v15 offset:29952
  s_waitcnt vmcnt(20)
  ds_read_b64_tr_b16 a[174:175], v15 offset:32000
  s_barrier
  v_mfma_f32_32x32x16_bf16 v[88:103], a[152:155], a[136:139], v[88:103]
  s_waitcnt lgkmcnt(8)
  ds_read_b64_tr_b16 a[144:145], v15 offset:32768
  s_add_u32 s67, s77, 0x360080
  ds_read_b64_tr_b16 a[146:147], v15 offset:34816
  s_add_u32 m0, s54, 0x10000
  s_nop 0
  buffer_load_dwordx4 v19, s[32:35], s67 offen lds
  v_mfma_f32_32x32x16_bf16 v[104:119], a[156:159], a[136:139], v[104:119]
  s_waitcnt lgkmcnt(8)
  ds_read_b64_tr_b16 a[148:149], v15 offset:33792
  ds_read_b64_tr_b16 a[150:151], v15 offset:35840
  v_mfma_f32_32x32x16_bf16 v[56:71], a[160:163], a[140:143], v[56:71]
  s_waitcnt lgkmcnt(8)
  ds_read_b64_tr_b16 a[152:153], v15 offset:33024
  s_add_u32 m0, s54, 0x10400
  ds_read_b64_tr_b16 a[154:155], v15 offset:35072
  v_mfma_f32_32x32x16_bf16 v[72:87], a[164:167], a[140:143], v[72:87]
  s_waitcnt lgkmcnt(8)
  ds_read_b64_tr_b16 a[156:157], v15 offset:34048
  ds_read_b64_tr_b16 a[158:159], v15 offset:36096
  buffer_load_dwordx4 v19, s[44:47], s67 offen lds
  v_mfma_f32_32x32x16_bf16 v[88:103], a[168:171], a[140:143], v[88:103]
  s_waitcnt lgkmcnt(8)
  ds_read_b64_tr_b16 a[160:161], v15 offset:36864
  ds_read_b64_tr_b16 a[162:163], v15 offset:38912
  v_mfma_f32_32x32x16_bf16 v[104:119], a[172:175], a[140:143], v[104:119]
  s_waitcnt lgkmcnt(8)
  ds_read_b64_tr_b16 a[164:165], v15 offset:37888
  s_add_u32 m0, s54, 0x10800
  ds_read_b64_tr_b16 a[166:167], v15 offset:39936
  v_mfma_f32_32x32x16_bf16 v[120:135], a[144:147], a[0:3], 0
  s_waitcnt lgkmcnt(8)
  ds_read_b64_tr_b16 a[168:169], v15 offset:37120
  ds_read_b64_tr_b16 a[170:171], v15 offset:39168
  buffer_load_dwordx4 v20, s[32:35], s67 offen lds
  v_mfma_f32_32x32x16_bf16 v[136:151], a[148:151], a[0:3], 0
  s_waitcnt lgkmcnt(8)
  ds_read_b64_tr_b16 a[172:173], v15 offset:38144
  ds_read_b64_tr_b16 a[174:175], v15 offset:40192
  v_mfma_f32_32x32x16_bf16 v[152:167], a[152:155], a[0:3], 0
  s_waitcnt lgkmcnt(8)
  ds_read_b64_tr_b16 a[144:145], v15 offset:40960
  s_add_u32 m0, s54, 0x10c00
  ds_read_b64_tr_b16 a[146:147], v15 offset:43008
  v_mul_f32 v34, s83, v56
  v_mul_f32 v35, s83, v57
  v_mfma_f32_32x32x16_bf16 v[168:183], a[156:159], a[0:3], 0
  s_waitcnt lgkmcnt(8)
  ds_read_b64_tr_b16 a[148:149], v15 offset:41984
  s_add_u32 s84, s77, 0x100
  ds_read_b64_tr_b16 a[150:151], v15 offset:44032
  buffer_load_dwordx4 v20, s[44:47], s67 offen lds
  buffer_load_dword a253, v21, s[32:35], s84 offen
  v_mfma_f32_32x32x16_bf16 v[120:135], a[160:163], a[4:7], v[120:135]
  s_waitcnt lgkmcnt(8)
  ds_read_b64_tr_b16 a[152:153], v15 offset:41216
  ds_read_b64_tr_b16 a[154:155], v15 offset:43264
  v_exp_f32 v34, v34
  v_mfma_f32_32x32x16_bf16 v[136:151], a[164:167], a[4:7], v[136:151]
  s_waitcnt lgkmcnt(8)
  ds_read_b64_tr_b16 a[156:157], v15 offset:42240
  ds_read_b64_tr_b16 a[158:159], v15 offset:44288
  buffer_load_dword a254, v21, s[44:47], s84 offen
  v_mfma_f32_32x32x16_bf16 v[152:167], a[168:171], a[4:7], v[152:167]
  s_waitcnt lgkmcnt(8)
  ds_read_b64_tr_b16 a[160:161], v15 offset:45056
  ds_read_b64_tr_b16 a[162:163], v15 offset:47104
  v_exp_f32 v35, v35
  v_mul_f32 v72, v56, v72
  v_mfma_f32_32x32x16_bf16 v[168:183], a[172:175], a[4:7], v[168:183]
  s_waitcnt lgkmcnt(8)
  ds_read_b64_tr_b16 a[164:165], v15 offset:46080
  ds_read_b64_tr_b16 a[166:167], v15 offset:48128
  v_mul_f32 v73, v57, v73
  v_add_f32 v34, 1.0, v34
  v_add_f32 v35, 1.0, v35
  v_mfma_f32_32x32x16_bf16 v[120:135], a[144:147], a[8:11], v[120:135]
  s_waitcnt lgkmcnt(8)
  ds_read_b64_tr_b16 a[168:169], v15 offset:45312
  ds_read_b64_tr_b16 a[170:171], v15 offset:47360
  v_rcp_f32 v34, v34
  v_mfma_f32_32x32x16_bf16 v[136:151], a[148:151], a[8:11], v[136:151]
  s_waitcnt lgkmcnt(8)
  ds_read_b64_tr_b16 a[172:173], v15 offset:46336
  s_waitcnt vmcnt(22)
  ds_read_b64_tr_b16 a[174:175], v15 offset:48384
  s_barrier
  v_rcp_f32 v35, v35
  v_mul_f32 v72, v72, v34
  v_mfma_f32_32x32x16_bf16 v[152:167], a[152:155], a[8:11], v[152:167]
  s_waitcnt lgkmcnt(8)
  ds_read_b64_tr_b16 a[144:145], v15 offset:49152
  s_add_u32 s67, s77, 0x3f0080
  ds_read_b64_tr_b16 a[146:147], v15 offset:51200
  s_add_u32 m0, s54, 0x14000
  s_nop 0
  buffer_load_dwordx4 v19, s[32:35], s67 offen lds
  v_mul_f32 v73, v73, v35
  v_mfma_f32_32x32x16_bf16 v[168:183], a[156:159], a[8:11], v[168:183]
  s_waitcnt lgkmcnt(8)
  ds_read_b64_tr_b16 a[148:149], v15 offset:50176
  ds_read_b64_tr_b16 a[150:151], v15 offset:52224
  v_cvt_pk_bf16_f32 v184, v72, v73
  v_mul_f32 v36, s83, v58
  v_mul_f32 v37, s83, v59
  v_mfma_f32_32x32x16_bf16 v[120:135], a[160:163], a[12:15], v[120:135]
  s_waitcnt lgkmcnt(8)
  ds_read_b64_tr_b16 a[152:153], v15 offset:49408
  s_add_u32 m0, s54, 0x14400
  ds_read_b64_tr_b16 a[154:155], v15 offset:51456
  v_exp_f32 v36, v36
  v_mfma_f32_32x32x16_bf16 v[136:151], a[164:167], a[12:15], v[136:151]
  s_waitcnt lgkmcnt(8)
  ds_read_b64_tr_b16 a[156:157], v15 offset:50432
  ds_read_b64_tr_b16 a[158:159], v15 offset:52480
  buffer_load_dwordx4 v19, s[44:47], s67 offen lds
  v_mfma_f32_32x32x16_bf16 v[152:167], a[168:171], a[12:15], v[152:167]
  s_waitcnt lgkmcnt(8)
  ds_read_b64_tr_b16 a[160:161], v15 offset:53248
  ds_read_b64_tr_b16 a[162:163], v15 offset:55296
  v_exp_f32 v37, v37
  v_mul_f32 v74, v58, v74
  v_mfma_f32_32x32x16_bf16 v[168:183], a[172:175], a[12:15], v[168:183]
  s_waitcnt lgkmcnt(8)
  ds_read_b64_tr_b16 a[164:165], v15 offset:54272
  s_add_u32 m0, s54, 0x14800
  ds_read_b64_tr_b16 a[166:167], v15 offset:56320
  v_mul_f32 v75, v59, v75
  v_add_f32 v36, 1.0, v36
  v_add_f32 v37, 1.0, v37
  v_mfma_f32_32x32x16_bf16 v[120:135], a[144:147], a[16:19], v[120:135]
  s_waitcnt lgkmcnt(8)
  ds_read_b64_tr_b16 a[168:169], v15 offset:53504
  ds_read_b64_tr_b16 a[170:171], v15 offset:55552
  buffer_load_dwordx4 v20, s[32:35], s67 offen lds
  v_mfma_f32_32x32x16_bf16 v[136:151], a[148:151], a[16:19], v[136:151]
  s_waitcnt lgkmcnt(8)
  ds_read_b64_tr_b16 a[172:173], v15 offset:54528
  ds_read_b64_tr_b16 a[174:175], v15 offset:56576
  v_rcp_f32 v36, v36
  v_mfma_f32_32x32x16_bf16 v[152:167], a[152:155], a[16:19], v[152:167]
  s_waitcnt lgkmcnt(8)
  ds_read_b64_tr_b16 a[144:145], v15 offset:57344
  s_add_u32 m0, s54, 0x14c00
  ds_read_b64_tr_b16 a[146:147], v15 offset:59392
  v_rcp_f32 v37, v37
  v_mul_f32 v74, v74, v36
  v_mfma_f32_32x32x16_bf16 v[168:183], a[156:159], a[16:19], v[168:183]
  s_waitcnt lgkmcnt(8)
  ds_read_b64_tr_b16 a[148:149], v15 offset:58368
  ds_read_b64_tr_b16 a[150:151], v15 offset:60416
  buffer_load_dwordx4 v20, s[44:47], s67 offen lds
  v_mul_f32 v75, v75, v37
  v_mfma_f32_32x32x16_bf16 v[120:135], a[160:163], a[20:23], v[120:135]
  s_waitcnt lgkmcnt(8)
  ds_read_b64_tr_b16 a[152:153], v15 offset:57600
  ds_read_b64_tr_b16 a[154:155], v15 offset:59648
  v_cvt_pk_bf16_f32 v185, v74, v75
  v_mul_f32 v34, s83, v60
  v_mul_f32 v35, s83, v61
  v_mfma_f32_32x32x16_bf16 v[136:151], a[164:167], a[20:23], v[136:151]
  s_waitcnt lgkmcnt(8)
  ds_read_b64_tr_b16 a[156:157], v15 offset:58624
  ds_read_b64_tr_b16 a[158:159], v15 offset:60672
  v_exp_f32 v34, v34
  v_mfma_f32_32x32x16_bf16 v[152:167], a[168:171], a[20:23], v[152:167]
  s_waitcnt lgkmcnt(8)
  ds_read_b64_tr_b16 a[160:161], v15 offset:61440
  ds_read_b64_tr_b16 a[162:163], v15 offset:63488
  v_exp_f32 v35, v35
  v_mul_f32 v76, v60, v76
  v_mfma_f32_32x32x16_bf16 v[168:183], a[172:175], a[20:23], v[168:183]
  s_waitcnt lgkmcnt(8)
  ds_read_b64_tr_b16 a[164:165], v15 offset:62464
  ds_read_b64_tr_b16 a[166:167], v15 offset:64512
  v_mul_f32 v77, v61, v77
  v_add_f32 v34, 1.0, v34
  v_add_f32 v35, 1.0, v35
  v_mfma_f32_32x32x16_bf16 v[120:135], a[144:147], a[24:27], v[120:135]
  s_waitcnt lgkmcnt(8)
  ds_read_b64_tr_b16 a[168:169], v15 offset:61696
  ds_read_b64_tr_b16 a[170:171], v15 offset:63744
  v_rcp_f32 v34, v34
  v_mfma_f32_32x32x16_bf16 v[136:151], a[148:151], a[24:27], v[136:151]
  s_waitcnt lgkmcnt(8)
  ds_read_b64_tr_b16 a[172:173], v15 offset:62720
  s_waitcnt vmcnt(22)
  ds_read_b64_tr_b16 a[174:175], v15 offset:64768
  s_barrier
  v_rcp_f32 v35, v35
  v_mul_f32 v76, v76, v34
  v_mfma_f32_32x32x16_bf16 v[152:167], a[152:155], a[24:27], v[152:167]
  s_waitcnt lgkmcnt(8)
  ds_read_b64_tr_b16 a[144:145], v14
  s_add_u32 s67, s77, 0x480080
  ds_read_b64_tr_b16 a[146:147], v14 offset:2048
  s_add_u32 m0, s54, 0x18000
  s_nop 0
  buffer_load_dwordx4 v19, s[32:35], s67 offen lds
  v_mul_f32 v77, v77, v35
  v_mfma_f32_32x32x16_bf16 v[168:183], a[156:159], a[24:27], v[168:183]
  s_waitcnt lgkmcnt(8)
  ds_read_b64_tr_b16 a[148:149], v14 offset:1024
  ds_read_b64_tr_b16 a[150:151], v14 offset:3072
  v_cvt_pk_bf16_f32 v186, v76, v77
  v_mul_f32 v36, s83, v62
  v_mul_f32 v37, s83, v63
  v_mfma_f32_32x32x16_bf16 v[120:135], a[160:163], a[28:31], v[120:135]
  s_waitcnt lgkmcnt(8)
  ds_read_b64_tr_b16 a[152:153], v14 offset:256
  s_add_u32 m0, s54, 0x18400
  ds_read_b64_tr_b16 a[154:155], v14 offset:2304
  v_exp_f32 v36, v36
  v_mfma_f32_32x32x16_bf16 v[136:151], a[164:167], a[28:31], v[136:151]
  s_waitcnt lgkmcnt(8)
  ds_read_b64_tr_b16 a[156:157], v14 offset:1280
  ds_read_b64_tr_b16 a[158:159], v14 offset:3328
  buffer_load_dwordx4 v19, s[44:47], s67 offen lds
  v_mfma_f32_32x32x16_bf16 v[152:167], a[168:171], a[28:31], v[152:167]
  s_waitcnt lgkmcnt(8)
  ds_read_b64_tr_b16 a[160:161], v14 offset:4096
  ds_read_b64_tr_b16 a[162:163], v14 offset:6144
  v_exp_f32 v37, v37
  v_mul_f32 v78, v62, v78
  v_mfma_f32_32x32x16_bf16 v[168:183], a[172:175], a[28:31], v[168:183]
  s_waitcnt lgkmcnt(8)
  ds_read_b64_tr_b16 a[164:165], v14 offset:5120
  s_add_u32 m0, s54, 0x18800
  ds_read_b64_tr_b16 a[166:167], v14 offset:7168
  v_mul_f32 v79, v63, v79
  v_add_f32 v36, 1.0, v36
  v_add_f32 v37, 1.0, v37
  v_mfma_f32_32x32x16_bf16 v[120:135], a[144:147], a[32:35], v[120:135]
  s_waitcnt lgkmcnt(8)
  ds_read_b64_tr_b16 a[168:169], v14 offset:4352
  ds_read_b64_tr_b16 a[170:171], v14 offset:6400
  buffer_load_dwordx4 v20, s[32:35], s67 offen lds
  v_mfma_f32_32x32x16_bf16 v[136:151], a[148:151], a[32:35], v[136:151]
  s_waitcnt lgkmcnt(8)
  ds_read_b64_tr_b16 a[172:173], v14 offset:5376
  ds_read_b64_tr_b16 a[174:175], v14 offset:7424
  v_rcp_f32 v36, v36
  v_mfma_f32_32x32x16_bf16 v[152:167], a[152:155], a[32:35], v[152:167]
  s_waitcnt lgkmcnt(8)
  ds_read_b64_tr_b16 a[144:145], v14 offset:8192
  s_add_u32 m0, s54, 0x18c00
  ds_read_b64_tr_b16 a[146:147], v14 offset:10240
  v_rcp_f32 v37, v37
  v_mul_f32 v78, v78, v36
  v_mfma_f32_32x32x16_bf16 v[168:183], a[156:159], a[32:35], v[168:183]
  s_waitcnt lgkmcnt(8)
  ds_read_b64_tr_b16 a[148:149], v14 offset:9216
  ds_read_b64_tr_b16 a[150:151], v14 offset:11264
  buffer_load_dwordx4 v20, s[44:47], s67 offen lds
  v_mul_f32 v79, v79, v37
  v_mfma_f32_32x32x16_bf16 v[120:135], a[160:163], a[36:39], v[120:135]
  s_waitcnt lgkmcnt(8)
  ds_read_b64_tr_b16 a[152:153], v14 offset:8448
  ds_read_b64_tr_b16 a[154:155], v14 offset:10496
  v_cvt_pk_bf16_f32 v187, v78, v79
  v_mul_f32 v34, s83, v64
  v_mul_f32 v35, s83, v65
  v_mfma_f32_32x32x16_bf16 v[136:151], a[164:167], a[36:39], v[136:151]
  s_waitcnt lgkmcnt(8)
  ds_read_b64_tr_b16 a[156:157], v14 offset:9472
  ds_read_b64_tr_b16 a[158:159], v14 offset:11520
  v_exp_f32 v34, v34
  v_mfma_f32_32x32x16_bf16 v[152:167], a[168:171], a[36:39], v[152:167]
  s_waitcnt lgkmcnt(8)
  ds_read_b64_tr_b16 a[160:161], v14 offset:12288
  ds_read_b64_tr_b16 a[162:163], v14 offset:14336
  v_exp_f32 v35, v35
  v_mul_f32 v80, v64, v80
  v_mfma_f32_32x32x16_bf16 v[168:183], a[172:175], a[36:39], v[168:183]
  s_waitcnt lgkmcnt(8)
  ds_read_b64_tr_b16 a[164:165], v14 offset:13312
  ds_read_b64_tr_b16 a[166:167], v14 offset:15360
  v_mul_f32 v81, v65, v81
  v_add_f32 v34, 1.0, v34
  v_add_f32 v35, 1.0, v35
  v_mfma_f32_32x32x16_bf16 v[120:135], a[144:147], a[40:43], v[120:135]
  s_waitcnt lgkmcnt(8)
  ds_read_b64_tr_b16 a[168:169], v14 offset:12544
  ds_read_b64_tr_b16 a[170:171], v14 offset:14592
  v_rcp_f32 v34, v34
  v_mfma_f32_32x32x16_bf16 v[136:151], a[148:151], a[40:43], v[136:151]
  s_waitcnt lgkmcnt(8)
  ds_read_b64_tr_b16 a[172:173], v14 offset:13568
  s_waitcnt vmcnt(22)
  ds_read_b64_tr_b16 a[174:175], v14 offset:15616
  s_barrier
  v_rcp_f32 v35, v35
  v_mul_f32 v80, v80, v34
  v_mfma_f32_32x32x16_bf16 v[152:167], a[152:155], a[40:43], v[152:167]
  s_waitcnt lgkmcnt(8)
  ds_read_b64_tr_b16 a[144:145], v14 offset:16384
  s_add_u32 s67, s77, 0x100
  ds_read_b64_tr_b16 a[146:147], v14 offset:18432
  s_add_u32 m0, s54, 0x1c000
  s_nop 0
  buffer_load_dwordx4 v19, s[32:35], s67 offen lds
  v_mul_f32 v81, v81, v35
  v_mfma_f32_32x32x16_bf16 v[168:183], a[156:159], a[40:43], v[168:183]
  s_waitcnt lgkmcnt(8)
  ds_read_b64_tr_b16 a[148:149], v14 offset:17408
  ds_read_b64_tr_b16 a[150:151], v14 offset:19456
  v_cvt_pk_bf16_f32 v188, v80, v81
  v_mul_f32 v36, s83, v66
  v_mul_f32 v37, s83, v67
  v_mfma_f32_32x32x16_bf16 v[120:135], a[160:163], a[44:47], v[120:135]
  s_waitcnt lgkmcnt(8)
  ds_read_b64_tr_b16 a[152:153], v14 offset:16640
  s_add_u32 m0, s54, 0x1c400
  ds_read_b64_tr_b16 a[154:155], v14 offset:18688
  v_exp_f32 v36, v36
  v_mfma_f32_32x32x16_bf16 v[136:151], a[164:167], a[44:47], v[136:151]
  s_waitcnt lgkmcnt(8)
  ds_read_b64_tr_b16 a[156:157], v14 offset:17664
  ds_read_b64_tr_b16 a[158:159], v14 offset:19712
  buffer_load_dwordx4 v19, s[44:47], s67 offen lds
  v_mfma_f32_32x32x16_bf16 v[152:167], a[168:171], a[44:47], v[152:167]
  s_waitcnt lgkmcnt(8)
  ds_read_b64_tr_b16 a[160:161], v14 offset:20480
  ds_read_b64_tr_b16 a[162:163], v14 offset:22528
  v_exp_f32 v37, v37
  v_mul_f32 v82, v66, v82
  v_mfma_f32_32x32x16_bf16 v[168:183], a[172:175], a[44:47], v[168:183]
  s_waitcnt lgkmcnt(8)
  ds_read_b64_tr_b16 a[164:165], v14 offset:21504
  s_add_u32 m0, s54, 0x1c800
  ds_read_b64_tr_b16 a[166:167], v14 offset:23552
  v_mul_f32 v83, v67, v83
  v_add_f32 v36, 1.0, v36
  v_add_f32 v37, 1.0, v37
  v_mfma_f32_32x32x16_bf16 v[120:135], a[144:147], a[48:51], v[120:135]
  s_waitcnt lgkmcnt(8)
  ds_read_b64_tr_b16 a[168:169], v14 offset:20736
  ds_read_b64_tr_b16 a[170:171], v14 offset:22784
  buffer_load_dwordx4 v20, s[32:35], s67 offen lds
  v_mfma_f32_32x32x16_bf16 v[136:151], a[148:151], a[48:51], v[136:151]
  s_waitcnt lgkmcnt(8)
  ds_read_b64_tr_b16 a[172:173], v14 offset:21760
  ds_read_b64_tr_b16 a[174:175], v14 offset:23808
  v_rcp_f32 v36, v36
  v_mfma_f32_32x32x16_bf16 v[152:167], a[152:155], a[48:51], v[152:167]
  s_waitcnt lgkmcnt(8)
  ds_read_b64_tr_b16 a[144:145], v14 offset:24576
  s_add_u32 m0, s54, 0x1cc00
  ds_read_b64_tr_b16 a[146:147], v14 offset:26624
  v_rcp_f32 v37, v37
  v_mul_f32 v82, v82, v36
  v_mfma_f32_32x32x16_bf16 v[168:183], a[156:159], a[48:51], v[168:183]
  s_waitcnt lgkmcnt(8)
  ds_read_b64_tr_b16 a[148:149], v14 offset:25600
  ds_read_b64_tr_b16 a[150:151], v14 offset:27648
  buffer_load_dwordx4 v20, s[44:47], s67 offen lds
  v_mul_f32 v83, v83, v37
  v_mfma_f32_32x32x16_bf16 v[120:135], a[160:163], a[52:55], v[120:135]
  s_waitcnt lgkmcnt(8)
  ds_read_b64_tr_b16 a[152:153], v14 offset:24832
  ds_read_b64_tr_b16 a[154:155], v14 offset:26880
  v_cvt_pk_bf16_f32 v189, v82, v83
  v_mul_f32 v34, s83, v68
  v_mul_f32 v35, s83, v69
  v_mfma_f32_32x32x16_bf16 v[136:151], a[164:167], a[52:55], v[136:151]
  s_waitcnt lgkmcnt(8)
  ds_read_b64_tr_b16 a[156:157], v14 offset:25856
  ds_read_b64_tr_b16 a[158:159], v14 offset:27904
  v_exp_f32 v34, v34
  v_mfma_f32_32x32x16_bf16 v[152:167], a[168:171], a[52:55], v[152:167]
  s_waitcnt lgkmcnt(8)
  ds_read_b64_tr_b16 a[160:161], v14 offset:28672
  ds_read_b64_tr_b16 a[162:163], v14 offset:30720
  v_exp_f32 v35, v35
  v_mul_f32 v84, v68, v84
  v_mfma_f32_32x32x16_bf16 v[168:183], a[172:175], a[52:55], v[168:183]
  s_waitcnt lgkmcnt(8)
  ds_read_b64_tr_b16 a[164:165], v14 offset:29696
  ds_read_b64_tr_b16 a[166:167], v14 offset:31744
  v_mul_f32 v85, v69, v85
  v_add_f32 v34, 1.0, v34
  v_add_f32 v35, 1.0, v35
  v_mfma_f32_32x32x16_bf16 v[120:135], a[144:147], a[56:59], v[120:135]
  s_waitcnt lgkmcnt(8)
  ds_read_b64_tr_b16 a[168:169], v14 offset:28928
  ds_read_b64_tr_b16 a[170:171], v14 offset:30976
  v_rcp_f32 v34, v34
  v_mfma_f32_32x32x16_bf16 v[136:151], a[148:151], a[56:59], v[136:151]
  s_waitcnt lgkmcnt(8)
  ds_read_b64_tr_b16 a[172:173], v14 offset:29952
  s_waitcnt vmcnt(22)
  ds_read_b64_tr_b16 a[174:175], v14 offset:32000
  s_barrier
  v_rcp_f32 v35, v35
  v_mul_f32 v84, v84, v34
  v_mfma_f32_32x32x16_bf16 v[152:167], a[152:155], a[56:59], v[152:167]
  s_waitcnt lgkmcnt(8)
  ds_read_b64_tr_b16 a[144:145], v14 offset:32768
  s_add_u32 s67, s77, 0x90100
  ds_read_b64_tr_b16 a[146:147], v14 offset:34816
  s_add_u32 m0, s54, 0
  s_nop 0
  buffer_load_dwordx4 v19, s[32:35], s67 offen lds
  v_mul_f32 v85, v85, v35
  v_mfma_f32_32x32x16_bf16 v[168:183], a[156:159], a[56:59], v[168:183]
  s_waitcnt lgkmcnt(8)
  ds_read_b64_tr_b16 a[148:149], v14 offset:33792
  ds_read_b64_tr_b16 a[150:151], v14 offset:35840
  v_cvt_pk_bf16_f32 v190, v84, v85
  v_mul_f32 v36, s83, v70
  v_mul_f32 v37, s83, v71
  v_mfma_f32_32x32x16_bf16 v[120:135], a[160:163], a[60:63], v[120:135]
  s_waitcnt lgkmcnt(8)
  ds_read_b64_tr_b16 a[152:153], v14 offset:33024
  s_add_u32 m0, s54, 0x400
  ds_read_b64_tr_b16 a[154:155], v14 offset:35072
  v_exp_f32 v36, v36
  v_mfma_f32_32x32x16_bf16 v[136:151], a[164:167], a[60:63], v[136:151]
  s_waitcnt lgkmcnt(8)
  ds_read_b64_tr_b16 a[156:157], v14 offset:34048
  ds_read_b64_tr_b16 a[158:159], v14 offset:36096
  buffer_load_dwordx4 v19, s[44:47], s67 offen lds
  v_mfma_f32_32x32x16_bf16 v[152:167], a[168:171], a[60:63], v[152:167]
  s_waitcnt lgkmcnt(8)
  ds_read_b64_tr_b16 a[160:161], v14 offset:36864
  ds_read_b64_tr_b16 a[162:163], v14 offset:38912
  v_exp_f32 v37, v37
  v_mul_f32 v86, v70, v86
  v_mfma_f32_32x32x16_bf16 v[168:183], a[172:175], a[60:63], v[168:183]
  s_waitcnt lgkmcnt(8)
  ds_read_b64_tr_b16 a[164:165], v14 offset:37888
  s_add_u32 m0, s54, 0x800
  ds_read_b64_tr_b16 a[166:167], v14 offset:39936
  v_mul_f32 v87, v71, v87
  v_add_f32 v36, 1.0, v36
  v_add_f32 v37, 1.0, v37
  v_mfma_f32_32x32x16_bf16 v[120:135], a[144:147], a[64:67], v[120:135]
  s_waitcnt lgkmcnt(8)
  ds_read_b64_tr_b16 a[168:169], v14 offset:37120
  ds_read_b64_tr_b16 a[170:171], v14 offset:39168
  buffer_load_dwordx4 v20, s[32:35], s67 offen lds
  v_mfma_f32_32x32x16_bf16 v[136:151], a[148:151], a[64:67], v[136:151]
  s_waitcnt lgkmcnt(8)
  ds_read_b64_tr_b16 a[172:173], v14 offset:38144
  ds_read_b64_tr_b16 a[174:175], v14 offset:40192
  v_rcp_f32 v36, v36
  v_mfma_f32_32x32x16_bf16 v[152:167], a[152:155], a[64:67], v[152:167]
  s_waitcnt lgkmcnt(8)
  ds_read_b64_tr_b16 a[144:145], v14 offset:40960
  s_add_u32 m0, s54, 0xc00
  ds_read_b64_tr_b16 a[146:147], v14 offset:43008
  v_rcp_f32 v37, v37
  v_mul_f32 v86, v86, v36
  v_mfma_f32_32x32x16_bf16 v[168:183], a[156:159], a[64:67], v[168:183]
  s_waitcnt lgkmcnt(8)
  ds_read_b64_tr_b16 a[148:149], v14 offset:41984
  ds_read_b64_tr_b16 a[150:151], v14 offset:44032
  buffer_load_dwordx4 v20, s[44:47], s67 offen lds
  v_mul_f32 v87, v87, v37
  v_mfma_f32_32x32x16_bf16 v[120:135], a[160:163], a[68:71], v[120:135]
  s_waitcnt lgkmcnt(8)
  ds_read_b64_tr_b16 a[152:153], v14 offset:41216
  ds_read_b64_tr_b16 a[154:155], v14 offset:43264
  v_cvt_pk_bf16_f32 v191, v86, v87
  v_mul_f32 v34, s83, v88
  v_mul_f32 v35, s83, v89
  v_mfma_f32_32x32x16_bf16 v[136:151], a[164:167], a[68:71], v[136:151]
  s_waitcnt lgkmcnt(8)
  ds_read_b64_tr_b16 a[156:157], v14 offset:42240
  ds_read_b64_tr_b16 a[158:159], v14 offset:44288
  v_exp_f32 v34, v34
  v_mfma_f32_32x32x16_bf16 v[152:167], a[168:171], a[68:71], v[152:167]
  s_waitcnt lgkmcnt(8)
  ds_read_b64_tr_b16 a[160:161], v14 offset:45056
  ds_read_b64_tr_b16 a[162:163], v14 offset:47104
  v_exp_f32 v35, v35
  v_mul_f32 v104, v88, v104
  v_mfma_f32_32x32x16_bf16 v[168:183], a[172:175], a[68:71], v[168:183]
  s_waitcnt lgkmcnt(8)
  ds_read_b64_tr_b16 a[164:165], v14 offset:46080
  ds_read_b64_tr_b16 a[166:167], v14 offset:48128
  v_mul_f32 v105, v89, v105
  v_add_f32 v34, 1.0, v34
  v_add_f32 v35, 1.0, v35
  v_mfma_f32_32x32x16_bf16 v[120:135], a[144:147], a[72:75], v[120:135]
  s_waitcnt lgkmcnt(8)
  ds_read_b64_tr_b16 a[168:169], v14 offset:45312
  ds_read_b64_tr_b16 a[170:171], v14 offset:47360
  v_rcp_f32 v34, v34
  v_mfma_f32_32x32x16_bf16 v[136:151], a[148:151], a[72:75], v[136:151]
  s_waitcnt lgkmcnt(8)
  ds_read_b64_tr_b16 a[172:173], v14 offset:46336
  s_waitcnt vmcnt(22)
  ds_read_b64_tr_b16 a[174:175], v14 offset:48384
  s_barrier
  v_rcp_f32 v35, v35
  v_mul_f32 v104, v104, v34
  v_mfma_f32_32x32x16_bf16 v[152:167], a[152:155], a[72:75], v[152:167]
  s_waitcnt lgkmcnt(8)
  ds_read_b64_tr_b16 a[144:145], v14 offset:49152
  s_add_u32 s67, s77, 0x120100
  ds_read_b64_tr_b16 a[146:147], v14 offset:51200
  s_add_u32 m0, s54, 0x4000
  s_nop 0
  buffer_load_dwordx4 v19, s[32:35], s67 offen lds
  v_mul_f32 v105, v105, v35
  v_mfma_f32_32x32x16_bf16 v[168:183], a[156:159], a[72:75], v[168:183]
  s_waitcnt lgkmcnt(8)
  ds_read_b64_tr_b16 a[148:149], v14 offset:50176
  ds_read_b64_tr_b16 a[150:151], v14 offset:52224
  v_cvt_pk_bf16_f32 v192, v104, v105
  v_mul_f32 v36, s83, v90
  v_mul_f32 v37, s83, v91
  v_mfma_f32_32x32x16_bf16 v[120:135], a[160:163], a[76:79], v[120:135]
  s_waitcnt lgkmcnt(8)
  ds_read_b64_tr_b16 a[152:153], v14 offset:49408
  s_add_u32 m0, s54, 0x4400
  ds_read_b64_tr_b16 a[154:155], v14 offset:51456
  v_exp_f32 v36, v36
  v_mfma_f32_32x32x16_bf16 v[136:151], a[164:167], a[76:79], v[136:151]
  s_waitcnt lgkmcnt(8)
  ds_read_b64_tr_b16 a[156:157], v14 offset:50432
  ds_read_b64_tr_b16 a[158:159], v14 offset:52480
  buffer_load_dwordx4 v19, s[44:47], s67 offen lds
  v_mfma_f32_32x32x16_bf16 v[152:167], a[168:171], a[76:79], v[152:167]
  s_waitcnt lgkmcnt(8)
  ds_read_b64_tr_b16 a[160:161], v14 offset:53248
  ds_read_b64_tr_b16 a[162:163], v14 offset:55296
  v_exp_f32 v37, v37
  v_mul_f32 v106, v90, v106
  v_mfma_f32_32x32x16_bf16 v[168:183], a[172:175], a[76:79], v[168:183]
  s_waitcnt lgkmcnt(8)
  ds_read_b64_tr_b16 a[164:165], v14 offset:54272
  s_add_u32 m0, s54, 0x4800
  ds_read_b64_tr_b16 a[166:167], v14 offset:56320
  v_mul_f32 v107, v91, v107
  v_add_f32 v36, 1.0, v36
  v_add_f32 v37, 1.0, v37
  v_mfma_f32_32x32x16_bf16 v[120:135], a[144:147], a[80:83], v[120:135]
  s_waitcnt lgkmcnt(8)
  ds_read_b64_tr_b16 a[168:169], v14 offset:53504
  ds_read_b64_tr_b16 a[170:171], v14 offset:55552
  buffer_load_dwordx4 v20, s[32:35], s67 offen lds
  v_mfma_f32_32x32x16_bf16 v[136:151], a[148:151], a[80:83], v[136:151]
  s_waitcnt lgkmcnt(8)
  ds_read_b64_tr_b16 a[172:173], v14 offset:54528
  ds_read_b64_tr_b16 a[174:175], v14 offset:56576
  v_rcp_f32 v36, v36
  v_mfma_f32_32x32x16_bf16 v[152:167], a[152:155], a[80:83], v[152:167]
  s_waitcnt lgkmcnt(8)
  ds_read_b64_tr_b16 a[144:145], v14 offset:57344
  s_add_u32 m0, s54, 0x4c00
  ds_read_b64_tr_b16 a[146:147], v14 offset:59392
  v_rcp_f32 v37, v37
  v_mul_f32 v106, v106, v36
  v_mfma_f32_32x32x16_bf16 v[168:183], a[156:159], a[80:83], v[168:183]
  s_waitcnt lgkmcnt(8)
  ds_read_b64_tr_b16 a[148:149], v14 offset:58368
  ds_read_b64_tr_b16 a[150:151], v14 offset:60416
  buffer_load_dwordx4 v20, s[44:47], s67 offen lds
  v_mul_f32 v107, v107, v37
  v_mfma_f32_32x32x16_bf16 v[120:135], a[160:163], a[84:87], v[120:135]
  s_waitcnt lgkmcnt(8)
  ds_read_b64_tr_b16 a[152:153], v14 offset:57600
  ds_read_b64_tr_b16 a[154:155], v14 offset:59648
  v_cvt_pk_bf16_f32 v193, v106, v107
  v_mul_f32 v34, s83, v92
  v_mul_f32 v35, s83, v93
  v_mfma_f32_32x32x16_bf16 v[136:151], a[164:167], a[84:87], v[136:151]
  s_waitcnt lgkmcnt(8)
  ds_read_b64_tr_b16 a[156:157], v14 offset:58624
  ds_read_b64_tr_b16 a[158:159], v14 offset:60672
  v_exp_f32 v34, v34
  v_mfma_f32_32x32x16_bf16 v[152:167], a[168:171], a[84:87], v[152:167]
  s_waitcnt lgkmcnt(8)
  ds_read_b64_tr_b16 a[160:161], v14 offset:61440
  ds_read_b64_tr_b16 a[162:163], v14 offset:63488
  v_exp_f32 v35, v35
  v_mul_f32 v108, v92, v108
  v_mfma_f32_32x32x16_bf16 v[168:183], a[172:175], a[84:87], v[168:183]
  s_waitcnt lgkmcnt(8)
  ds_read_b64_tr_b16 a[164:165], v14 offset:62464
  ds_read_b64_tr_b16 a[166:167], v14 offset:64512
  v_mul_f32 v109, v93, v109
  v_add_f32 v34, 1.0, v34
  v_add_f32 v35, 1.0, v35
  v_mfma_f32_32x32x16_bf16 v[120:135], a[144:147], a[88:91], v[120:135]
  s_waitcnt lgkmcnt(8)
  ds_read_b64_tr_b16 a[168:169], v14 offset:61696
  ds_read_b64_tr_b16 a[170:171], v14 offset:63744
  v_rcp_f32 v34, v34
  v_mfma_f32_32x32x16_bf16 v[136:151], a[148:151], a[88:91], v[136:151]
  s_waitcnt lgkmcnt(8)
  ds_read_b64_tr_b16 a[172:173], v14 offset:62720
  s_waitcnt vmcnt(22)
  ds_read_b64_tr_b16 a[174:175], v14 offset:64768
  s_barrier
  v_rcp_f32 v35, v35
  v_mul_f32 v108, v108, v34
  v_mfma_f32_32x32x16_bf16 v[152:167], a[152:155], a[88:91], v[152:167]
  s_waitcnt lgkmcnt(8)
  ds_read_b64_tr_b16 a[144:145], v15
  s_add_u32 s67, s77, 0x1b0100
  ds_read_b64_tr_b16 a[146:147], v15 offset:2048
  s_add_u32 m0, s54, 0x8000
  s_nop 0
  buffer_load_dwordx4 v19, s[32:35], s67 offen lds
  v_mul_f32 v109, v109, v35
  v_mfma_f32_32x32x16_bf16 v[168:183], a[156:159], a[88:91], v[168:183]
  s_waitcnt lgkmcnt(8)
  ds_read_b64_tr_b16 a[148:149], v15 offset:1024
  ds_read_b64_tr_b16 a[150:151], v15 offset:3072
  v_cvt_pk_bf16_f32 v194, v108, v109
  v_mul_f32 v36, s83, v94
  v_mul_f32 v37, s83, v95
  v_mfma_f32_32x32x16_bf16 v[120:135], a[160:163], a[92:95], v[120:135]
  s_waitcnt lgkmcnt(8)
  ds_read_b64_tr_b16 a[152:153], v15 offset:256
  s_add_u32 m0, s54, 0x8400
  ds_read_b64_tr_b16 a[154:155], v15 offset:2304
  v_exp_f32 v36, v36
  v_mfma_f32_32x32x16_bf16 v[136:151], a[164:167], a[92:95], v[136:151]
  s_waitcnt lgkmcnt(8)
  ds_read_b64_tr_b16 a[156:157], v15 offset:1280
  ds_read_b64_tr_b16 a[158:159], v15 offset:3328
  buffer_load_dwordx4 v19, s[44:47], s67 offen lds
  v_mfma_f32_32x32x16_bf16 v[152:167], a[168:171], a[92:95], v[152:167]
  s_waitcnt lgkmcnt(8)
  ds_read_b64_tr_b16 a[160:161], v15 offset:4096
  ds_read_b64_tr_b16 a[162:163], v15 offset:6144
  v_exp_f32 v37, v37
  v_mul_f32 v110, v94, v110
  v_mfma_f32_32x32x16_bf16 v[168:183], a[172:175], a[92:95], v[168:183]
  s_waitcnt lgkmcnt(8)
  ds_read_b64_tr_b16 a[164:165], v15 offset:5120
  s_add_u32 m0, s54, 0x8800
  ds_read_b64_tr_b16 a[166:167], v15 offset:7168
  v_mul_f32 v111, v95, v111
  v_add_f32 v36, 1.0, v36
  v_add_f32 v37, 1.0, v37
  v_mfma_f32_32x32x16_bf16 v[120:135], a[144:147], a[96:99], v[120:135]
  s_waitcnt lgkmcnt(8)
  ds_read_b64_tr_b16 a[168:169], v15 offset:4352
  ds_read_b64_tr_b16 a[170:171], v15 offset:6400
  buffer_load_dwordx4 v20, s[32:35], s67 offen lds
  v_mfma_f32_32x32x16_bf16 v[136:151], a[148:151], a[96:99], v[136:151]
  s_waitcnt lgkmcnt(8)
  ds_read_b64_tr_b16 a[172:173], v15 offset:5376
  ds_read_b64_tr_b16 a[174:175], v15 offset:7424
  v_rcp_f32 v36, v36
  v_mfma_f32_32x32x16_bf16 v[152:167], a[152:155], a[96:99], v[152:167]
  s_waitcnt lgkmcnt(8)
  ds_read_b64_tr_b16 a[144:145], v15 offset:8192
  s_add_u32 m0, s54, 0x8c00
  ds_read_b64_tr_b16 a[146:147], v15 offset:10240
  v_rcp_f32 v37, v37
  v_mul_f32 v110, v110, v36
  v_mfma_f32_32x32x16_bf16 v[168:183], a[156:159], a[96:99], v[168:183]
  s_waitcnt lgkmcnt(8)
  ds_read_b64_tr_b16 a[148:149], v15 offset:9216
  ds_read_b64_tr_b16 a[150:151], v15 offset:11264
  buffer_load_dwordx4 v20, s[44:47], s67 offen lds
  v_mul_f32 v111, v111, v37
  v_mfma_f32_32x32x16_bf16 v[120:135], a[160:163], a[100:103], v[120:135]
  s_waitcnt lgkmcnt(8)
  ds_read_b64_tr_b16 a[152:153], v15 offset:8448
  ds_read_b64_tr_b16 a[154:155], v15 offset:10496
  v_cvt_pk_bf16_f32 v195, v110, v111
  v_mul_f32 v34, s83, v96
  v_mul_f32 v35, s83, v97
  v_mfma_f32_32x32x16_bf16 v[136:151], a[164:167], a[100:103], v[136:151]
  s_waitcnt lgkmcnt(8)
  ds_read_b64_tr_b16 a[156:157], v15 offset:9472
  ds_read_b64_tr_b16 a[158:159], v15 offset:11520
  v_exp_f32 v34, v34
  v_mfma_f32_32x32x16_bf16 v[152:167], a[168:171], a[100:103], v[152:167]
  s_waitcnt lgkmcnt(8)
  ds_read_b64_tr_b16 a[160:161], v15 offset:12288
  ds_read_b64_tr_b16 a[162:163], v15 offset:14336
  v_exp_f32 v35, v35
  v_mul_f32 v112, v96, v112
  v_mfma_f32_32x32x16_bf16 v[168:183], a[172:175], a[100:103], v[168:183]
  s_waitcnt lgkmcnt(8)
  ds_read_b64_tr_b16 a[164:165], v15 offset:13312
  ds_read_b64_tr_b16 a[166:167], v15 offset:15360
  v_mul_f32 v113, v97, v113
  v_add_f32 v34, 1.0, v34
  v_add_f32 v35, 1.0, v35
  v_mfma_f32_32x32x16_bf16 v[120:135], a[144:147], a[104:107], v[120:135]
  s_waitcnt lgkmcnt(8)
  ds_read_b64_tr_b16 a[168:169], v15 offset:12544
  ds_read_b64_tr_b16 a[170:171], v15 offset:14592
  v_rcp_f32 v34, v34
  v_mfma_f32_32x32x16_bf16 v[136:151], a[148:151], a[104:107], v[136:151]
  s_waitcnt lgkmcnt(8)
  ds_read_b64_tr_b16 a[172:173], v15 offset:13568
  s_waitcnt vmcnt(20)
  ds_read_b64_tr_b16 a[174:175], v15 offset:15616
  s_barrier
  v_rcp_f32 v35, v35
  v_mul_f32 v112, v112, v34
  v_mfma_f32_32x32x16_bf16 v[152:167], a[152:155], a[104:107], v[152:167]
  s_waitcnt lgkmcnt(8)
  ds_read_b64_tr_b16 a[144:145], v15 offset:16384
  s_add_u32 s67, s77, 0x240100
  ds_read_b64_tr_b16 a[146:147], v15 offset:18432
  s_add_u32 m0, s54, 0xc000
  s_nop 0
  buffer_load_dwordx4 v19, s[32:35], s67 offen lds
  v_mul_f32 v113, v113, v35
  v_mfma_f32_32x32x16_bf16 v[168:183], a[156:159], a[104:107], v[168:183]
  s_waitcnt lgkmcnt(8)
  ds_read_b64_tr_b16 a[148:149], v15 offset:17408
  ds_read_b64_tr_b16 a[150:151], v15 offset:19456
  v_cvt_pk_bf16_f32 v196, v112, v113
  v_mul_f32 v36, s83, v98
  v_mul_f32 v37, s83, v99
  v_mfma_f32_32x32x16_bf16 v[120:135], a[160:163], a[108:111], v[120:135]
  s_waitcnt lgkmcnt(8)
  ds_read_b64_tr_b16 a[152:153], v15 offset:16640
  s_add_u32 m0, s54, 0xc400
  ds_read_b64_tr_b16 a[154:155], v15 offset:18688
  v_exp_f32 v36, v36
  v_mfma_f32_32x32x16_bf16 v[136:151], a[164:167], a[108:111], v[136:151]
  s_waitcnt lgkmcnt(8)
  ds_read_b64_tr_b16 a[156:157], v15 offset:17664
  ds_read_b64_tr_b16 a[158:159], v15 offset:19712
  buffer_load_dwordx4 v19, s[44:47], s67 offen lds
  v_mfma_f32_32x32x16_bf16 v[152:167], a[168:171], a[108:111], v[152:167]
  s_waitcnt lgkmcnt(8)
  ds_read_b64_tr_b16 a[160:161], v15 offset:20480
  ds_read_b64_tr_b16 a[162:163], v15 offset:22528
  v_exp_f32 v37, v37
  v_mul_f32 v114, v98, v114
  v_mfma_f32_32x32x16_bf16 v[168:183], a[172:175], a[108:111], v[168:183]
  s_waitcnt lgkmcnt(8)
  ds_read_b64_tr_b16 a[164:165], v15 offset:21504
  s_add_u32 m0, s54, 0xc800
  ds_read_b64_tr_b16 a[166:167], v15 offset:23552
  v_mul_f32 v115, v99, v115
  v_add_f32 v36, 1.0, v36
  v_add_f32 v37, 1.0, v37
  v_mfma_f32_32x32x16_bf16 v[120:135], a[144:147], a[112:115], v[120:135]
  s_waitcnt lgkmcnt(8)
  ds_read_b64_tr_b16 a[168:169], v15 offset:20736
  ds_read_b64_tr_b16 a[170:171], v15 offset:22784
  buffer_load_dwordx4 v20, s[32:35], s67 offen lds
  v_mfma_f32_32x32x16_bf16 v[136:151], a[148:151], a[112:115], v[136:151]
  s_waitcnt lgkmcnt(8)
  ds_read_b64_tr_b16 a[172:173], v15 offset:21760
  ds_read_b64_tr_b16 a[174:175], v15 offset:23808
  v_rcp_f32 v36, v36
  v_mfma_f32_32x32x16_bf16 v[152:167], a[152:155], a[112:115], v[152:167]
  s_waitcnt lgkmcnt(8)
  ds_read_b64_tr_b16 a[144:145], v15 offset:24576
  s_add_u32 m0, s54, 0xcc00
  ds_read_b64_tr_b16 a[146:147], v15 offset:26624
  v_rcp_f32 v37, v37
  v_mul_f32 v114, v114, v36
  v_mfma_f32_32x32x16_bf16 v[168:183], a[156:159], a[112:115], v[168:183]
  s_waitcnt lgkmcnt(8)
  ds_read_b64_tr_b16 a[148:149], v15 offset:25600
  ds_read_b64_tr_b16 a[150:151], v15 offset:27648
  buffer_load_dwordx4 v20, s[44:47], s67 offen lds
  v_mul_f32 v115, v115, v37
  v_mfma_f32_32x32x16_bf16 v[120:135], a[160:163], a[116:119], v[120:135]
  s_waitcnt lgkmcnt(8)
  ds_read_b64_tr_b16 a[152:153], v15 offset:24832
  ds_read_b64_tr_b16 a[154:155], v15 offset:26880
  v_cvt_pk_bf16_f32 v197, v114, v115
  v_mul_f32 v34, s83, v100
  v_mul_f32 v35, s83, v101
  v_mfma_f32_32x32x16_bf16 v[136:151], a[164:167], a[116:119], v[136:151]
  s_waitcnt lgkmcnt(8)
  ds_read_b64_tr_b16 a[156:157], v15 offset:25856
  ds_read_b64_tr_b16 a[158:159], v15 offset:27904
  v_exp_f32 v34, v34
  v_mfma_f32_32x32x16_bf16 v[152:167], a[168:171], a[116:119], v[152:167]
  s_waitcnt lgkmcnt(8)
  ds_read_b64_tr_b16 a[160:161], v15 offset:28672
  ds_read_b64_tr_b16 a[162:163], v15 offset:30720
  v_exp_f32 v35, v35
  v_mul_f32 v116, v100, v116
  v_mfma_f32_32x32x16_bf16 v[168:183], a[172:175], a[116:119], v[168:183]
  s_waitcnt lgkmcnt(8)
  ds_read_b64_tr_b16 a[164:165], v15 offset:29696
  ds_read_b64_tr_b16 a[166:167], v15 offset:31744
  v_mul_f32 v117, v101, v117
  v_add_f32 v34, 1.0, v34
  v_add_f32 v35, 1.0, v35
  v_mfma_f32_32x32x16_bf16 v[120:135], a[144:147], a[120:123], v[120:135]
  s_waitcnt lgkmcnt(8)
  ds_read_b64_tr_b16 a[168:169], v15 offset:28928
  ds_read_b64_tr_b16 a[170:171], v15 offset:30976
  v_rcp_f32 v34, v34
  v_mfma_f32_32x32x16_bf16 v[136:151], a[148:151], a[120:123], v[136:151]
  s_waitcnt lgkmcnt(8)
  ds_read_b64_tr_b16 a[172:173], v15 offset:29952
  s_waitcnt vmcnt(20)
  ds_read_b64_tr_b16 a[174:175], v15 offset:32000
  s_barrier
  v_rcp_f32 v35, v35
  v_mul_f32 v116, v116, v34
  v_mfma_f32_32x32x16_bf16 v[152:167], a[152:155], a[120:123], v[152:167]
  s_waitcnt lgkmcnt(8)
  ds_read_b64_tr_b16 a[144:145], v15 offset:32768
  s_add_u32 s67, s77, 0x2d0100
  ds_read_b64_tr_b16 a[146:147], v15 offset:34816
  s_add_u32 m0, s54, 0x10000
  s_nop 0
  buffer_load_dwordx4 v19, s[32:35], s67 offen lds
  v_mul_f32 v117, v117, v35
  v_mfma_f32_32x32x16_bf16 v[168:183], a[156:159], a[120:123], v[168:183]
  s_waitcnt lgkmcnt(8)
  ds_read_b64_tr_b16 a[148:149], v15 offset:33792
  ds_read_b64_tr_b16 a[150:151], v15 offset:35840
  v_cvt_pk_bf16_f32 v198, v116, v117
  v_mul_f32 v36, s83, v102
  v_mul_f32 v37, s83, v103
  v_mfma_f32_32x32x16_bf16 v[120:135], a[160:163], a[124:127], v[120:135]
  s_waitcnt lgkmcnt(8)
  ds_read_b64_tr_b16 a[152:153], v15 offset:33024
  s_add_u32 m0, s54, 0x10400
  ds_read_b64_tr_b16 a[154:155], v15 offset:35072
  v_exp_f32 v36, v36
  v_mfma_f32_32x32x16_bf16 v[136:151], a[164:167], a[124:127], v[136:151]
  s_waitcnt lgkmcnt(8)
  ds_read_b64_tr_b16 a[156:157], v15 offset:34048
  ds_read_b64_tr_b16 a[158:159], v15 offset:36096
  buffer_load_dwordx4 v19, s[44:47], s67 offen lds
  v_mfma_f32_32x32x16_bf16 v[152:167], a[168:171], a[124:127], v[152:167]
  s_waitcnt lgkmcnt(8)
  ds_read_b64_tr_b16 a[160:161], v15 offset:36864
  ds_read_b64_tr_b16 a[162:163], v15 offset:38912
  v_exp_f32 v37, v37
  v_mul_f32 v118, v102, v118
  v_mfma_f32_32x32x16_bf16 v[168:183], a[172:175], a[124:127], v[168:183]
  s_waitcnt lgkmcnt(8)
  ds_read_b64_tr_b16 a[164:165], v15 offset:37888
  s_add_u32 m0, s54, 0x10800
  ds_read_b64_tr_b16 a[166:167], v15 offset:39936
  v_mul_f32 v119, v103, v119
  v_add_f32 v36, 1.0, v36
  v_add_f32 v37, 1.0, v37
  v_mfma_f32_32x32x16_bf16 v[120:135], a[144:147], a[128:131], v[120:135]
  s_waitcnt lgkmcnt(8)
  ds_read_b64_tr_b16 a[168:169], v15 offset:37120
  ds_read_b64_tr_b16 a[170:171], v15 offset:39168
  buffer_load_dwordx4 v20, s[32:35], s67 offen lds
  v_mfma_f32_32x32x16_bf16 v[136:151], a[148:151], a[128:131], v[136:151]
  s_waitcnt lgkmcnt(8)
  ds_read_b64_tr_b16 a[172:173], v15 offset:38144
  ds_read_b64_tr_b16 a[174:175], v15 offset:40192
  v_rcp_f32 v36, v36
  v_mfma_f32_32x32x16_bf16 v[152:167], a[152:155], a[128:131], v[152:167]
  s_waitcnt lgkmcnt(8)
  ds_read_b64_tr_b16 a[144:145], v15 offset:40960
  s_add_u32 m0, s54, 0x10c00
  ds_read_b64_tr_b16 a[146:147], v15 offset:43008
  v_rcp_f32 v37, v37
  v_mul_f32 v118, v118, v36
  v_mfma_f32_32x32x16_bf16 v[168:183], a[156:159], a[128:131], v[168:183]
  s_waitcnt lgkmcnt(8)
  ds_read_b64_tr_b16 a[148:149], v15 offset:41984
  ds_read_b64_tr_b16 a[150:151], v15 offset:44032
  buffer_load_dwordx4 v20, s[44:47], s67 offen lds
  v_mul_f32 v119, v119, v37
  v_mfma_f32_32x32x16_bf16 v[120:135], a[160:163], a[132:135], v[120:135]
  s_waitcnt lgkmcnt(8)
  ds_read_b64_tr_b16 a[152:153], v15 offset:41216
  ds_read_b64_tr_b16 a[154:155], v15 offset:43264
  v_cvt_pk_bf16_f32 v199, v118, v119
  v_mfma_f32_32x32x16_bf16 v[136:151], a[164:167], a[132:135], v[136:151]
  s_waitcnt lgkmcnt(8)
  ds_read_b64_tr_b16 a[156:157], v15 offset:42240
  ds_read_b64_tr_b16 a[158:159], v15 offset:44288
  v_mfma_f32_32x32x16_bf16 v[152:167], a[168:171], a[132:135], v[152:167]
  s_waitcnt lgkmcnt(8)
  ds_read_b64_tr_b16 a[160:161], v15 offset:45056
  ds_read_b64_tr_b16 a[162:163], v15 offset:47104
  v_mfma_f32_32x32x16_bf16 v[168:183], a[172:175], a[132:135], v[168:183]
  s_waitcnt lgkmcnt(8)
  ds_read_b64_tr_b16 a[164:165], v15 offset:46080
  ds_read_b64_tr_b16 a[166:167], v15 offset:48128
  v_mfma_f32_32x32x16_bf16 v[120:135], a[144:147], a[136:139], v[120:135]
  s_waitcnt lgkmcnt(8)
  ds_read_b64_tr_b16 a[168:169], v15 offset:45312
  ds_read_b64_tr_b16 a[170:171], v15 offset:47360
  v_mfma_f32_32x32x16_bf16 v[136:151], a[148:151], a[136:139], v[136:151]
  s_waitcnt lgkmcnt(8)
  ds_read_b64_tr_b16 a[172:173], v15 offset:46336
  s_waitcnt vmcnt(20)
  ds_read_b64_tr_b16 a[174:175], v15 offset:48384
  s_barrier
  v_mfma_f32_32x32x16_bf16 v[152:167], a[152:155], a[136:139], v[152:167]
  s_waitcnt lgkmcnt(8)
  ds_read_b64_tr_b16 a[144:145], v15 offset:49152
  s_add_u32 s67, s77, 0x360100
  ds_read_b64_tr_b16 a[146:147], v15 offset:51200
  s_add_u32 m0, s54, 0x14000
  s_nop 0
  buffer_load_dwordx4 v19, s[32:35], s67 offen lds
  v_mfma_f32_32x32x16_bf16 v[168:183], a[156:159], a[136:139], v[168:183]
  s_waitcnt lgkmcnt(8)
  ds_read_b64_tr_b16 a[148:149], v15 offset:50176
  ds_read_b64_tr_b16 a[150:151], v15 offset:52224
  v_mfma_f32_32x32x16_bf16 v[120:135], a[160:163], a[140:143], v[120:135]
  s_waitcnt lgkmcnt(8)
  ds_read_b64_tr_b16 a[152:153], v15 offset:49408
  s_add_u32 m0, s54, 0x14400
  ds_read_b64_tr_b16 a[154:155], v15 offset:51456
  v_mfma_f32_32x32x16_bf16 v[136:151], a[164:167], a[140:143], v[136:151]
  s_waitcnt lgkmcnt(8)
  ds_read_b64_tr_b16 a[156:157], v15 offset:50432
  ds_read_b64_tr_b16 a[158:159], v15 offset:52480
  buffer_load_dwordx4 v19, s[44:47], s67 offen lds
  v_mfma_f32_32x32x16_bf16 v[152:167], a[168:171], a[140:143], v[152:167]
  s_waitcnt lgkmcnt(8)
  ds_read_b64_tr_b16 a[160:161], v15 offset:53248
  ds_read_b64_tr_b16 a[162:163], v15 offset:55296
  v_mfma_f32_32x32x16_bf16 v[168:183], a[172:175], a[140:143], v[168:183]
  s_waitcnt lgkmcnt(8)
  ds_read_b64_tr_b16 a[164:165], v15 offset:54272
  s_add_u32 m0, s54, 0x14800
  ds_read_b64_tr_b16 a[166:167], v15 offset:56320
  v_mfma_f32_32x32x16_bf16 v[56:71], a[144:147], a[0:3], 0
  s_waitcnt lgkmcnt(8)
  ds_read_b64_tr_b16 a[168:169], v15 offset:53504
  ds_read_b64_tr_b16 a[170:171], v15 offset:55552
  buffer_load_dwordx4 v20, s[32:35], s67 offen lds
  v_mfma_f32_32x32x16_bf16 v[72:87], a[148:151], a[0:3], 0
  s_waitcnt lgkmcnt(8)
  ds_read_b64_tr_b16 a[172:173], v15 offset:54528
  ds_read_b64_tr_b16 a[174:175], v15 offset:56576
  v_mfma_f32_32x32x16_bf16 v[88:103], a[152:155], a[0:3], 0
  s_waitcnt lgkmcnt(8)
  ds_read_b64_tr_b16 a[144:145], v15 offset:57344
  s_add_u32 m0, s54, 0x14c00
  ds_read_b64_tr_b16 a[146:147], v15 offset:59392
  v_mul_f32 v34, s83, v120
  v_mul_f32 v35, s83, v121
  v_mfma_f32_32x32x16_bf16 v[104:119], a[156:159], a[0:3], 0
  s_waitcnt lgkmcnt(8)
  ds_read_b64_tr_b16 a[148:149], v15 offset:58368
  s_add_u32 s84, s77, 0x180
  ds_read_b64_tr_b16 a[150:151], v15 offset:60416
  buffer_load_dwordx4 v20, s[44:47], s67 offen lds
  buffer_load_dword a253, v21, s[32:35], s84 offen
  v_mfma_f32_32x32x16_bf16 v[56:71], a[160:163], a[4:7], v[56:71]
  s_waitcnt lgkmcnt(8)
  ds_read_b64_tr_b16 a[152:153], v15 offset:57600
  ds_read_b64_tr_b16 a[154:155], v15 offset:59648
  v_exp_f32 v34, v34
  v_mfma_f32_32x32x16_bf16 v[72:87], a[164:167], a[4:7], v[72:87]
  s_waitcnt lgkmcnt(8)
  ds_read_b64_tr_b16 a[156:157], v15 offset:58624
  ds_read_b64_tr_b16 a[158:159], v15 offset:60672
  buffer_load_dword a254, v21, s[44:47], s84 offen
  v_mfma_f32_32x32x16_bf16 v[88:103], a[168:171], a[4:7], v[88:103]
  s_waitcnt lgkmcnt(8)
  ds_read_b64_tr_b16 a[160:161], v15 offset:61440
  ds_read_b64_tr_b16 a[162:163], v15 offset:63488
  v_exp_f32 v35, v35
  v_mul_f32 v136, v120, v136
  v_mfma_f32_32x32x16_bf16 v[104:119], a[172:175], a[4:7], v[104:119]
  s_waitcnt lgkmcnt(8)
  ds_read_b64_tr_b16 a[164:165], v15 offset:62464
  ds_read_b64_tr_b16 a[166:167], v15 offset:64512
  v_mul_f32 v137, v121, v137
  v_add_f32 v34, 1.0, v34
  v_add_f32 v35, 1.0, v35
  v_mfma_f32_32x32x16_bf16 v[56:71], a[144:147], a[8:11], v[56:71]
  s_waitcnt lgkmcnt(8)
  ds_read_b64_tr_b16 a[168:169], v15 offset:61696
  ds_read_b64_tr_b16 a[170:171], v15 offset:63744
  v_rcp_f32 v34, v34
  v_mfma_f32_32x32x16_bf16 v[72:87], a[148:151], a[8:11], v[72:87]
  s_waitcnt lgkmcnt(8)
  ds_read_b64_tr_b16 a[172:173], v15 offset:62720
  s_waitcnt vmcnt(22)
  ds_read_b64_tr_b16 a[174:175], v15 offset:64768
  s_barrier
  v_rcp_f32 v35, v35
  v_mul_f32 v136, v136, v34
  v_mfma_f32_32x32x16_bf16 v[88:103], a[152:155], a[8:11], v[88:103]
  s_waitcnt lgkmcnt(8)
  ds_read_b64_tr_b16 a[144:145], v14
  s_add_u32 s67, s77, 0x3f0100
  ds_read_b64_tr_b16 a[146:147], v14 offset:2048
  s_add_u32 m0, s54, 0x18000
  s_nop 0
  buffer_load_dwordx4 v19, s[32:35], s67 offen lds
  v_mul_f32 v137, v137, v35
  v_mfma_f32_32x32x16_bf16 v[104:119], a[156:159], a[8:11], v[104:119]
  s_waitcnt lgkmcnt(8)
  ds_read_b64_tr_b16 a[148:149], v14 offset:1024
  ds_read_b64_tr_b16 a[150:151], v14 offset:3072
  v_cvt_pk_bf16_f32 v200, v136, v137
  v_mul_f32 v36, s83, v122
  v_mul_f32 v37, s83, v123
  v_mfma_f32_32x32x16_bf16 v[56:71], a[160:163], a[12:15], v[56:71]
  s_waitcnt lgkmcnt(8)
  ds_read_b64_tr_b16 a[152:153], v14 offset:256
  s_add_u32 m0, s54, 0x18400
  ds_read_b64_tr_b16 a[154:155], v14 offset:2304
  v_exp_f32 v36, v36
  v_mfma_f32_32x32x16_bf16 v[72:87], a[164:167], a[12:15], v[72:87]
  s_waitcnt lgkmcnt(8)
  ds_read_b64_tr_b16 a[156:157], v14 offset:1280
  ds_read_b64_tr_b16 a[158:159], v14 offset:3328
  buffer_load_dwordx4 v19, s[44:47], s67 offen lds
  v_mfma_f32_32x32x16_bf16 v[88:103], a[168:171], a[12:15], v[88:103]
  s_waitcnt lgkmcnt(8)
  ds_read_b64_tr_b16 a[160:161], v14 offset:4096
  ds_read_b64_tr_b16 a[162:163], v14 offset:6144
  v_exp_f32 v37, v37
  v_mul_f32 v138, v122, v138
  v_mfma_f32_32x32x16_bf16 v[104:119], a[172:175], a[12:15], v[104:119]
  s_waitcnt lgkmcnt(8)
  ds_read_b64_tr_b16 a[164:165], v14 offset:5120
  s_add_u32 m0, s54, 0x18800
  ds_read_b64_tr_b16 a[166:167], v14 offset:7168
  v_mul_f32 v139, v123, v139
  v_add_f32 v36, 1.0, v36
  v_add_f32 v37, 1.0, v37
  v_mfma_f32_32x32x16_bf16 v[56:71], a[144:147], a[16:19], v[56:71]
  s_waitcnt lgkmcnt(8)
  ds_read_b64_tr_b16 a[168:169], v14 offset:4352
  ds_read_b64_tr_b16 a[170:171], v14 offset:6400
  buffer_load_dwordx4 v20, s[32:35], s67 offen lds
  v_mfma_f32_32x32x16_bf16 v[72:87], a[148:151], a[16:19], v[72:87]
  s_waitcnt lgkmcnt(8)
  ds_read_b64_tr_b16 a[172:173], v14 offset:5376
  ds_read_b64_tr_b16 a[174:175], v14 offset:7424
  v_rcp_f32 v36, v36
  v_mfma_f32_32x32x16_bf16 v[88:103], a[152:155], a[16:19], v[88:103]
  s_waitcnt lgkmcnt(8)
  ds_read_b64_tr_b16 a[144:145], v14 offset:8192
  s_add_u32 m0, s54, 0x18c00
  ds_read_b64_tr_b16 a[146:147], v14 offset:10240
  v_rcp_f32 v37, v37
  v_mul_f32 v138, v138, v36
  v_mfma_f32_32x32x16_bf16 v[104:119], a[156:159], a[16:19], v[104:119]
  s_waitcnt lgkmcnt(8)
  ds_read_b64_tr_b16 a[148:149], v14 offset:9216
  ds_read_b64_tr_b16 a[150:151], v14 offset:11264
  buffer_load_dwordx4 v20, s[44:47], s67 offen lds
  v_mul_f32 v139, v139, v37
  v_mfma_f32_32x32x16_bf16 v[56:71], a[160:163], a[20:23], v[56:71]
  s_waitcnt lgkmcnt(8)
  ds_read_b64_tr_b16 a[152:153], v14 offset:8448
  ds_read_b64_tr_b16 a[154:155], v14 offset:10496
  v_cvt_pk_bf16_f32 v201, v138, v139
  v_mul_f32 v34, s83, v124
  v_mul_f32 v35, s83, v125
  v_mfma_f32_32x32x16_bf16 v[72:87], a[164:167], a[20:23], v[72:87]
  s_waitcnt lgkmcnt(8)
  ds_read_b64_tr_b16 a[156:157], v14 offset:9472
  ds_read_b64_tr_b16 a[158:159], v14 offset:11520
  v_exp_f32 v34, v34
  v_mfma_f32_32x32x16_bf16 v[88:103], a[168:171], a[20:23], v[88:103]
  s_waitcnt lgkmcnt(8)
  ds_read_b64_tr_b16 a[160:161], v14 offset:12288
  ds_read_b64_tr_b16 a[162:163], v14 offset:14336
  v_exp_f32 v35, v35
  v_mul_f32 v140, v124, v140
  v_mfma_f32_32x32x16_bf16 v[104:119], a[172:175], a[20:23], v[104:119]
  s_waitcnt lgkmcnt(8)
  ds_read_b64_tr_b16 a[164:165], v14 offset:13312
  ds_read_b64_tr_b16 a[166:167], v14 offset:15360
  v_mul_f32 v141, v125, v141
  v_add_f32 v34, 1.0, v34
  v_add_f32 v35, 1.0, v35
  v_mfma_f32_32x32x16_bf16 v[56:71], a[144:147], a[24:27], v[56:71]
  s_waitcnt lgkmcnt(8)
  ds_read_b64_tr_b16 a[168:169], v14 offset:12544
  ds_read_b64_tr_b16 a[170:171], v14 offset:14592
  v_rcp_f32 v34, v34
  v_mfma_f32_32x32x16_bf16 v[72:87], a[148:151], a[24:27], v[72:87]
  s_waitcnt lgkmcnt(8)
  ds_read_b64_tr_b16 a[172:173], v14 offset:13568
  s_waitcnt vmcnt(22)
  ds_read_b64_tr_b16 a[174:175], v14 offset:15616
  s_barrier
  v_rcp_f32 v35, v35
  v_mul_f32 v140, v140, v34
  v_mfma_f32_32x32x16_bf16 v[88:103], a[152:155], a[24:27], v[88:103]
  s_waitcnt lgkmcnt(8)
  ds_read_b64_tr_b16 a[144:145], v14 offset:16384
  s_add_u32 s67, s77, 0x480100
  ds_read_b64_tr_b16 a[146:147], v14 offset:18432
  s_add_u32 m0, s54, 0x1c000
  s_nop 0
  buffer_load_dwordx4 v19, s[32:35], s67 offen lds
  v_mul_f32 v141, v141, v35
  v_mfma_f32_32x32x16_bf16 v[104:119], a[156:159], a[24:27], v[104:119]
  s_waitcnt lgkmcnt(8)
  ds_read_b64_tr_b16 a[148:149], v14 offset:17408
  ds_read_b64_tr_b16 a[150:151], v14 offset:19456
  v_cvt_pk_bf16_f32 v202, v140, v141
  v_mul_f32 v36, s83, v126
  v_mul_f32 v37, s83, v127
  v_mfma_f32_32x32x16_bf16 v[56:71], a[160:163], a[28:31], v[56:71]
  s_waitcnt lgkmcnt(8)
  ds_read_b64_tr_b16 a[152:153], v14 offset:16640
  s_add_u32 m0, s54, 0x1c400
  ds_read_b64_tr_b16 a[154:155], v14 offset:18688
  v_exp_f32 v36, v36
  v_mfma_f32_32x32x16_bf16 v[72:87], a[164:167], a[28:31], v[72:87]
  s_waitcnt lgkmcnt(8)
  ds_read_b64_tr_b16 a[156:157], v14 offset:17664
  ds_read_b64_tr_b16 a[158:159], v14 offset:19712
  buffer_load_dwordx4 v19, s[44:47], s67 offen lds
  v_mfma_f32_32x32x16_bf16 v[88:103], a[168:171], a[28:31], v[88:103]
  s_waitcnt lgkmcnt(8)
  ds_read_b64_tr_b16 a[160:161], v14 offset:20480
  ds_read_b64_tr_b16 a[162:163], v14 offset:22528
  v_exp_f32 v37, v37
  v_mul_f32 v142, v126, v142
  v_mfma_f32_32x32x16_bf16 v[104:119], a[172:175], a[28:31], v[104:119]
  s_waitcnt lgkmcnt(8)
  ds_read_b64_tr_b16 a[164:165], v14 offset:21504
  s_add_u32 m0, s54, 0x1c800
  ds_read_b64_tr_b16 a[166:167], v14 offset:23552
  v_mul_f32 v143, v127, v143
  v_add_f32 v36, 1.0, v36
  v_add_f32 v37, 1.0, v37
  v_mfma_f32_32x32x16_bf16 v[56:71], a[144:147], a[32:35], v[56:71]
  s_waitcnt lgkmcnt(8)
  ds_read_b64_tr_b16 a[168:169], v14 offset:20736
  ds_read_b64_tr_b16 a[170:171], v14 offset:22784
  buffer_load_dwordx4 v20, s[32:35], s67 offen lds
  v_mfma_f32_32x32x16_bf16 v[72:87], a[148:151], a[32:35], v[72:87]
  s_waitcnt lgkmcnt(8)
  ds_read_b64_tr_b16 a[172:173], v14 offset:21760
  ds_read_b64_tr_b16 a[174:175], v14 offset:23808
  v_rcp_f32 v36, v36
  v_mfma_f32_32x32x16_bf16 v[88:103], a[152:155], a[32:35], v[88:103]
  s_waitcnt lgkmcnt(8)
  ds_read_b64_tr_b16 a[144:145], v14 offset:24576
  s_add_u32 m0, s54, 0x1cc00
  ds_read_b64_tr_b16 a[146:147], v14 offset:26624
  v_rcp_f32 v37, v37
  v_mul_f32 v142, v142, v36
  v_mfma_f32_32x32x16_bf16 v[104:119], a[156:159], a[32:35], v[104:119]
  s_waitcnt lgkmcnt(8)
  ds_read_b64_tr_b16 a[148:149], v14 offset:25600
  ds_read_b64_tr_b16 a[150:151], v14 offset:27648
  buffer_load_dwordx4 v20, s[44:47], s67 offen lds
  v_mul_f32 v143, v143, v37
  v_mfma_f32_32x32x16_bf16 v[56:71], a[160:163], a[36:39], v[56:71]
  s_waitcnt lgkmcnt(8)
  ds_read_b64_tr_b16 a[152:153], v14 offset:24832
  ds_read_b64_tr_b16 a[154:155], v14 offset:26880
  v_cvt_pk_bf16_f32 v203, v142, v143
  v_mul_f32 v34, s83, v128
  v_mul_f32 v35, s83, v129
  v_mfma_f32_32x32x16_bf16 v[72:87], a[164:167], a[36:39], v[72:87]
  s_waitcnt lgkmcnt(8)
  ds_read_b64_tr_b16 a[156:157], v14 offset:25856
  ds_read_b64_tr_b16 a[158:159], v14 offset:27904
  v_exp_f32 v34, v34
  v_mfma_f32_32x32x16_bf16 v[88:103], a[168:171], a[36:39], v[88:103]
  s_waitcnt lgkmcnt(8)
  ds_read_b64_tr_b16 a[160:161], v14 offset:28672
  ds_read_b64_tr_b16 a[162:163], v14 offset:30720
  v_exp_f32 v35, v35
  v_mul_f32 v144, v128, v144
  v_mfma_f32_32x32x16_bf16 v[104:119], a[172:175], a[36:39], v[104:119]
  s_waitcnt lgkmcnt(8)
  ds_read_b64_tr_b16 a[164:165], v14 offset:29696
  ds_read_b64_tr_b16 a[166:167], v14 offset:31744
  v_mul_f32 v145, v129, v145
  v_add_f32 v34, 1.0, v34
  v_add_f32 v35, 1.0, v35
  v_mfma_f32_32x32x16_bf16 v[56:71], a[144:147], a[40:43], v[56:71]
  s_waitcnt lgkmcnt(8)
  ds_read_b64_tr_b16 a[168:169], v14 offset:28928
  ds_read_b64_tr_b16 a[170:171], v14 offset:30976
  v_rcp_f32 v34, v34
  v_mfma_f32_32x32x16_bf16 v[72:87], a[148:151], a[40:43], v[72:87]
  s_waitcnt lgkmcnt(8)
  ds_read_b64_tr_b16 a[172:173], v14 offset:29952
  s_waitcnt vmcnt(22)
  ds_read_b64_tr_b16 a[174:175], v14 offset:32000
  s_barrier
  v_rcp_f32 v35, v35
  v_mul_f32 v144, v144, v34
  v_mfma_f32_32x32x16_bf16 v[88:103], a[152:155], a[40:43], v[88:103]
  s_waitcnt lgkmcnt(8)
  ds_read_b64_tr_b16 a[144:145], v14 offset:32768
  s_add_u32 s67, s77, 0x180
  ds_read_b64_tr_b16 a[146:147], v14 offset:34816
  s_add_u32 m0, s54, 0
  s_nop 0
  buffer_load_dwordx4 v19, s[32:35], s67 offen lds
  v_mul_f32 v145, v145, v35
  v_mfma_f32_32x32x16_bf16 v[104:119], a[156:159], a[40:43], v[104:119]
  s_waitcnt lgkmcnt(8)
  ds_read_b64_tr_b16 a[148:149], v14 offset:33792
  ds_read_b64_tr_b16 a[150:151], v14 offset:35840
  buffer_load_dword a255, v30, s[24:27], s81 offen
  v_cvt_pk_bf16_f32 v204, v144, v145
  v_mfma_f32_32x32x16_bf16 v[56:71], a[160:163], a[44:47], v[56:71]
  s_waitcnt lgkmcnt(8)
  ds_read_b64_tr_b16 a[152:153], v14 offset:33024
  s_add_u32 m0, s54, 0x400
  ds_read_b64_tr_b16 a[154:155], v14 offset:35072
  v_mul_f32 v36, s83, v130
  v_mul_f32 v37, s83, v131
  v_mfma_f32_32x32x16_bf16 v[72:87], a[164:167], a[44:47], v[72:87]
  s_waitcnt lgkmcnt(8)
  ds_read_b64_tr_b16 a[156:157], v14 offset:34048
  ds_read_b64_tr_b16 a[158:159], v14 offset:36096
  buffer_load_dwordx4 v19, s[44:47], s67 offen lds
  v_mfma_f32_32x32x16_bf16 v[88:103], a[168:171], a[44:47], v[88:103]
  s_waitcnt lgkmcnt(8)
  ds_read_b64_tr_b16 a[160:161], v14 offset:36864
  ds_read_b64_tr_b16 a[162:163], v14 offset:38912
  v_exp_f32 v36, v36
  v_mfma_f32_32x32x16_bf16 v[104:119], a[172:175], a[44:47], v[104:119]
  s_waitcnt lgkmcnt(8)
  ds_read_b64_tr_b16 a[164:165], v14 offset:37888
  s_add_u32 m0, s54, 0x800
  ds_read_b64_tr_b16 a[166:167], v14 offset:39936
  v_exp_f32 v37, v37
  v_mul_f32 v146, v130, v146
  v_mfma_f32_32x32x16_bf16 v[56:71], a[144:147], a[48:51], v[56:71]
  s_waitcnt lgkmcnt(8)
  ds_read_b64_tr_b16 a[168:169], v14 offset:37120
  ds_read_b64_tr_b16 a[170:171], v14 offset:39168
  buffer_load_dwordx4 v20, s[32:35], s67 offen lds
  v_mul_f32 v147, v131, v147
  v_mfma_f32_32x32x16_bf16 v[72:87], a[148:151], a[48:51], v[72:87]
  s_waitcnt lgkmcnt(8)
  ds_read_b64_tr_b16 a[172:173], v14 offset:38144
  ds_read_b64_tr_b16 a[174:175], v14 offset:40192
  v_add_f32 v36, 1.0, v36
  v_add_f32 v37, 1.0, v37
  v_mfma_f32_32x32x16_bf16 v[88:103], a[152:155], a[48:51], v[88:103]
  s_waitcnt lgkmcnt(8)
  ds_read_b64_tr_b16 a[144:145], v14 offset:40960
  s_add_u32 m0, s54, 0xc00
  ds_read_b64_tr_b16 a[146:147], v14 offset:43008
  v_rcp_f32 v36, v36
  v_mfma_f32_32x32x16_bf16 v[104:119], a[156:159], a[48:51], v[104:119]
  s_waitcnt lgkmcnt(8)
  ds_read_b64_tr_b16 a[148:149], v14 offset:41984
  ds_read_b64_tr_b16 a[150:151], v14 offset:44032
  buffer_load_dwordx4 v20, s[44:47], s67 offen lds
  v_mfma_f32_32x32x16_bf16 v[56:71], a[160:163], a[52:55], v[56:71]
  s_waitcnt lgkmcnt(8)
  ds_read_b64_tr_b16 a[152:153], v14 offset:41216
  ds_read_b64_tr_b16 a[154:155], v14 offset:43264
  v_rcp_f32 v37, v37
  v_mul_f32 v146, v146, v36
  v_mfma_f32_32x32x16_bf16 v[72:87], a[164:167], a[52:55], v[72:87]
  s_waitcnt lgkmcnt(8)
  ds_read_b64_tr_b16 a[156:157], v14 offset:42240
  ds_read_b64_tr_b16 a[158:159], v14 offset:44288
  v_mul_f32 v147, v147, v37
  v_cvt_pk_bf16_f32 v205, v146, v147
  v_mul_f32 v34, s83, v132
  v_mfma_f32_32x32x16_bf16 v[88:103], a[168:171], a[52:55], v[88:103]
  s_waitcnt lgkmcnt(8)
  ds_read_b64_tr_b16 a[160:161], v14 offset:45056
  ds_read_b64_tr_b16 a[162:163], v14 offset:47104
  v_mul_f32 v35, s83, v133
  v_exp_f32 v34, v34
  v_mfma_f32_32x32x16_bf16 v[104:119], a[172:175], a[52:55], v[104:119]
  s_waitcnt lgkmcnt(8)
  ds_read_b64_tr_b16 a[164:165], v14 offset:46080
  ds_read_b64_tr_b16 a[166:167], v14 offset:48128
  v_exp_f32 v35, v35
  v_mul_f32 v148, v132, v148
  v_mfma_f32_32x32x16_bf16 v[56:71], a[144:147], a[56:59], v[56:71]
  s_waitcnt lgkmcnt(8)
  ds_read_b64_tr_b16 a[168:169], v14 offset:45312
  ds_read_b64_tr_b16 a[170:171], v14 offset:47360
  v_mul_f32 v149, v133, v149
  v_add_f32 v34, 1.0, v34
  v_add_f32 v35, 1.0, v35
  v_mfma_f32_32x32x16_bf16 v[72:87], a[148:151], a[56:59], v[72:87]
  s_waitcnt lgkmcnt(8)
  ds_read_b64_tr_b16 a[172:173], v14 offset:46336
  s_waitcnt vmcnt(23)
  ds_read_b64_tr_b16 a[174:175], v14 offset:48384
  s_barrier
  v_rcp_f32 v34, v34
  v_mfma_f32_32x32x16_bf16 v[88:103], a[152:155], a[56:59], v[88:103]
  s_waitcnt lgkmcnt(8)
  ds_read_b64_tr_b16 a[144:145], v14 offset:49152
  s_add_u32 s67, s77, 0x90180
  ds_read_b64_tr_b16 a[146:147], v14 offset:51200
  s_add_u32 m0, s54, 0x4000
  s_nop 0
  buffer_load_dwordx4 v19, s[32:35], s67 offen lds
  v_mfma_f32_32x32x16_bf16 v[104:119], a[156:159], a[56:59], v[104:119]
  s_waitcnt lgkmcnt(8)
  ds_read_b64_tr_b16 a[148:149], v14 offset:50176
  ds_read_b64_tr_b16 a[150:151], v14 offset:52224
  v_rcp_f32 v35, v35
  v_mul_f32 v148, v148, v34
  v_mfma_f32_32x32x16_bf16 v[56:71], a[160:163], a[60:63], v[56:71]
  s_waitcnt lgkmcnt(8)
  ds_read_b64_tr_b16 a[152:153], v14 offset:49408
  s_add_u32 m0, s54, 0x4400
  ds_read_b64_tr_b16 a[154:155], v14 offset:51456
  v_mul_f32 v149, v149, v35
  v_cvt_pk_bf16_f32 v206, v148, v149
  v_mul_f32 v36, s83, v134
  v_mfma_f32_32x32x16_bf16 v[72:87], a[164:167], a[60:63], v[72:87]
  s_waitcnt lgkmcnt(8)
  ds_read_b64_tr_b16 a[156:157], v14 offset:50432
  ds_read_b64_tr_b16 a[158:159], v14 offset:52480
  buffer_load_dwordx4 v19, s[44:47], s67 offen lds
  v_mul_f32 v37, s83, v135
  v_mfma_f32_32x32x16_bf16 v[88:103], a[168:171], a[60:63], v[88:103]
  s_waitcnt lgkmcnt(8)
  ds_read_b64_tr_b16 a[160:161], v14 offset:53248
  ds_read_b64_tr_b16 a[162:163], v14 offset:55296
  v_exp_f32 v36, v36
  v_mfma_f32_32x32x16_bf16 v[104:119], a[172:175], a[60:63], v[104:119]
  s_waitcnt lgkmcnt(8)
  ds_read_b64_tr_b16 a[164:165], v14 offset:54272
  s_add_u32 m0, s54, 0x4800
  ds_read_b64_tr_b16 a[166:167], v14 offset:56320
  v_exp_f32 v37, v37
  v_mul_f32 v150, v134, v150
  v_mfma_f32_32x32x16_bf16 v[56:71], a[144:147], a[64:67], v[56:71]
  s_waitcnt lgkmcnt(8)
  ds_read_b64_tr_b16 a[168:169], v14 offset:53504
  ds_read_b64_tr_b16 a[170:171], v14 offset:55552
  buffer_load_dwordx4 v20, s[32:35], s67 offen lds
  v_mul_f32 v151, v135, v151
  v_mfma_f32_32x32x16_bf16 v[72:87], a[148:151], a[64:67], v[72:87]
  s_waitcnt lgkmcnt(8)
  ds_read_b64_tr_b16 a[172:173], v14 offset:54528
  ds_read_b64_tr_b16 a[174:175], v14 offset:56576
  v_add_f32 v36, 1.0, v36
  v_add_f32 v37, 1.0, v37
  v_mfma_f32_32x32x16_bf16 v[88:103], a[152:155], a[64:67], v[88:103]
  s_waitcnt lgkmcnt(8)
  ds_read_b64_tr_b16 a[144:145], v14 offset:57344
  s_add_u32 m0, s54, 0x4c00
  ds_read_b64_tr_b16 a[146:147], v14 offset:59392
  v_rcp_f32 v36, v36
  v_mfma_f32_32x32x16_bf16 v[104:119], a[156:159], a[64:67], v[104:119]
  s_waitcnt lgkmcnt(8)
  ds_read_b64_tr_b16 a[148:149], v14 offset:58368
  ds_read_b64_tr_b16 a[150:151], v14 offset:60416
  buffer_load_dwordx4 v20, s[44:47], s67 offen lds
  v_mfma_f32_32x32x16_bf16 v[56:71], a[160:163], a[68:71], v[56:71]
  s_waitcnt lgkmcnt(8)
  ds_read_b64_tr_b16 a[152:153], v14 offset:57600
  ds_read_b64_tr_b16 a[154:155], v14 offset:59648
  v_rcp_f32 v37, v37
  v_mul_f32 v150, v150, v36
  v_mfma_f32_32x32x16_bf16 v[72:87], a[164:167], a[68:71], v[72:87]
  s_waitcnt lgkmcnt(8)
  ds_read_b64_tr_b16 a[156:157], v14 offset:58624
  ds_read_b64_tr_b16 a[158:159], v14 offset:60672
  v_mul_f32 v151, v151, v37
  v_cvt_pk_bf16_f32 v207, v150, v151
  v_mul_f32 v34, s83, v152
  v_mfma_f32_32x32x16_bf16 v[88:103], a[168:171], a[68:71], v[88:103]
  s_waitcnt lgkmcnt(8)
  ds_read_b64_tr_b16 a[160:161], v14 offset:61440
  ds_read_b64_tr_b16 a[162:163], v14 offset:63488
  v_mul_f32 v35, s83, v153
  v_exp_f32 v34, v34
  v_mfma_f32_32x32x16_bf16 v[104:119], a[172:175], a[68:71], v[104:119]
  s_waitcnt lgkmcnt(8)
  ds_read_b64_tr_b16 a[164:165], v14 offset:62464
  ds_read_b64_tr_b16 a[166:167], v14 offset:64512
  v_exp_f32 v35, v35
  v_mul_f32 v168, v152, v168
  v_mfma_f32_32x32x16_bf16 v[56:71], a[144:147], a[72:75], v[56:71]
  s_waitcnt lgkmcnt(8)
  ds_read_b64_tr_b16 a[168:169], v14 offset:61696
  ds_read_b64_tr_b16 a[170:171], v14 offset:63744
  v_mul_f32 v169, v153, v169
  v_add_f32 v34, 1.0, v34
  v_add_f32 v35, 1.0, v35
  v_mfma_f32_32x32x16_bf16 v[72:87], a[148:151], a[72:75], v[72:87]
  s_waitcnt lgkmcnt(8)
  ds_read_b64_tr_b16 a[172:173], v14 offset:62720
  s_waitcnt vmcnt(23)
  ds_read_b64_tr_b16 a[174:175], v14 offset:64768
  s_barrier
  v_rcp_f32 v34, v34
  v_mfma_f32_32x32x16_bf16 v[88:103], a[152:155], a[72:75], v[88:103]
  s_waitcnt lgkmcnt(8)
  ds_read_b64_tr_b16 a[144:145], v15
  s_add_u32 s67, s77, 0x120180
  ds_read_b64_tr_b16 a[146:147], v15 offset:2048
  s_add_u32 m0, s54, 0x8000
  s_nop 0
  buffer_load_dwordx4 v19, s[32:35], s67 offen lds
  v_mfma_f32_32x32x16_bf16 v[104:119], a[156:159], a[72:75], v[104:119]
  s_waitcnt lgkmcnt(8)
  ds_read_b64_tr_b16 a[148:149], v15 offset:1024
  ds_read_b64_tr_b16 a[150:151], v15 offset:3072
  v_rcp_f32 v35, v35
  v_mul_f32 v168, v168, v34
  v_mfma_f32_32x32x16_bf16 v[56:71], a[160:163], a[76:79], v[56:71]
  s_waitcnt lgkmcnt(8)
  ds_read_b64_tr_b16 a[152:153], v15 offset:256
  s_add_u32 m0, s54, 0x8400
  ds_read_b64_tr_b16 a[154:155], v15 offset:2304
  v_mul_f32 v169, v169, v35
  v_cvt_pk_bf16_f32 v208, v168, v169
  v_mul_f32 v36, s83, v154
  v_mfma_f32_32x32x16_bf16 v[72:87], a[164:167], a[76:79], v[72:87]
  s_waitcnt lgkmcnt(8)
  ds_read_b64_tr_b16 a[156:157], v15 offset:1280
  ds_read_b64_tr_b16 a[158:159], v15 offset:3328
  buffer_load_dwordx4 v19, s[44:47], s67 offen lds
  v_mul_f32 v37, s83, v155
  v_mfma_f32_32x32x16_bf16 v[88:103], a[168:171], a[76:79], v[88:103]
  s_waitcnt lgkmcnt(8)
  ds_read_b64_tr_b16 a[160:161], v15 offset:4096
  ds_read_b64_tr_b16 a[162:163], v15 offset:6144
  v_exp_f32 v36, v36
  v_mfma_f32_32x32x16_bf16 v[104:119], a[172:175], a[76:79], v[104:119]
  s_waitcnt lgkmcnt(8)
  ds_read_b64_tr_b16 a[164:165], v15 offset:5120
  s_add_u32 m0, s54, 0x8800
  ds_read_b64_tr_b16 a[166:167], v15 offset:7168
  v_exp_f32 v37, v37
  v_mul_f32 v170, v154, v170
  v_mfma_f32_32x32x16_bf16 v[56:71], a[144:147], a[80:83], v[56:71]
  s_waitcnt lgkmcnt(8)
  ds_read_b64_tr_b16 a[168:169], v15 offset:4352
  ds_read_b64_tr_b16 a[170:171], v15 offset:6400
  buffer_load_dwordx4 v20, s[32:35], s67 offen lds
  v_mul_f32 v171, v155, v171
  v_mfma_f32_32x32x16_bf16 v[72:87], a[148:151], a[80:83], v[72:87]
  s_waitcnt lgkmcnt(8)
  ds_read_b64_tr_b16 a[172:173], v15 offset:5376
  ds_read_b64_tr_b16 a[174:175], v15 offset:7424
  v_add_f32 v36, 1.0, v36
  v_add_f32 v37, 1.0, v37
  v_mfma_f32_32x32x16_bf16 v[88:103], a[152:155], a[80:83], v[88:103]
  s_waitcnt lgkmcnt(8)
  ds_read_b64_tr_b16 a[144:145], v15 offset:8192
  s_add_u32 m0, s54, 0x8c00
  ds_read_b64_tr_b16 a[146:147], v15 offset:10240
  v_rcp_f32 v36, v36
  v_mfma_f32_32x32x16_bf16 v[104:119], a[156:159], a[80:83], v[104:119]
  s_waitcnt lgkmcnt(8)
  ds_read_b64_tr_b16 a[148:149], v15 offset:9216
  ds_read_b64_tr_b16 a[150:151], v15 offset:11264
  buffer_load_dwordx4 v20, s[44:47], s67 offen lds
  v_mfma_f32_32x32x16_bf16 v[56:71], a[160:163], a[84:87], v[56:71]
  s_waitcnt lgkmcnt(8)
  ds_read_b64_tr_b16 a[152:153], v15 offset:8448
  ds_read_b64_tr_b16 a[154:155], v15 offset:10496
  v_rcp_f32 v37, v37
  v_mul_f32 v170, v170, v36
  v_mfma_f32_32x32x16_bf16 v[72:87], a[164:167], a[84:87], v[72:87]
  s_waitcnt lgkmcnt(8)
  ds_read_b64_tr_b16 a[156:157], v15 offset:9472
  ds_read_b64_tr_b16 a[158:159], v15 offset:11520
  v_mul_f32 v171, v171, v37
  v_cvt_pk_bf16_f32 v209, v170, v171
  v_mul_f32 v34, s83, v156
  v_mfma_f32_32x32x16_bf16 v[88:103], a[168:171], a[84:87], v[88:103]
  s_waitcnt lgkmcnt(8)
  ds_read_b64_tr_b16 a[160:161], v15 offset:12288
  ds_read_b64_tr_b16 a[162:163], v15 offset:14336
  v_mul_f32 v35, s83, v157
  v_exp_f32 v34, v34
  v_mfma_f32_32x32x16_bf16 v[104:119], a[172:175], a[84:87], v[104:119]
  s_waitcnt lgkmcnt(8)
  ds_read_b64_tr_b16 a[164:165], v15 offset:13312
  ds_read_b64_tr_b16 a[166:167], v15 offset:15360
  v_exp_f32 v35, v35
  v_mul_f32 v172, v156, v172
  v_mfma_f32_32x32x16_bf16 v[56:71], a[144:147], a[88:91], v[56:71]
  s_waitcnt lgkmcnt(8)
  ds_read_b64_tr_b16 a[168:169], v15 offset:12544
  ds_read_b64_tr_b16 a[170:171], v15 offset:14592
  v_mul_f32 v173, v157, v173
  v_add_f32 v34, 1.0, v34
  v_add_f32 v35, 1.0, v35
  v_mfma_f32_32x32x16_bf16 v[72:87], a[148:151], a[88:91], v[72:87]
  s_waitcnt lgkmcnt(8)
  ds_read_b64_tr_b16 a[172:173], v15 offset:13568
  s_waitcnt vmcnt(23)
  ds_read_b64_tr_b16 a[174:175], v15 offset:15616
  s_barrier
  v_rcp_f32 v34, v34
  v_mfma_f32_32x32x16_bf16 v[88:103], a[152:155], a[88:91], v[88:103]
  s_waitcnt lgkmcnt(8)
  ds_read_b64_tr_b16 a[144:145], v15 offset:16384
  s_add_u32 s67, s77, 0x1b0180
  ds_read_b64_tr_b16 a[146:147], v15 offset:18432
  s_add_u32 m0, s54, 0xc000
  s_nop 0
  buffer_load_dwordx4 v19, s[32:35], s67 offen lds
  v_mfma_f32_32x32x16_bf16 v[104:119], a[156:159], a[88:91], v[104:119]
  s_waitcnt lgkmcnt(8)
  ds_read_b64_tr_b16 a[148:149], v15 offset:17408
  ds_read_b64_tr_b16 a[150:151], v15 offset:19456
  v_rcp_f32 v35, v35
  v_mul_f32 v172, v172, v34
  v_mfma_f32_32x32x16_bf16 v[56:71], a[160:163], a[92:95], v[56:71]
  s_waitcnt lgkmcnt(8)
  ds_read_b64_tr_b16 a[152:153], v15 offset:16640
  s_add_u32 m0, s54, 0xc400
  ds_read_b64_tr_b16 a[154:155], v15 offset:18688
  v_mul_f32 v173, v173, v35
  v_cvt_pk_bf16_f32 v210, v172, v173
  v_mul_f32 v36, s83, v158
  v_mfma_f32_32x32x16_bf16 v[72:87], a[164:167], a[92:95], v[72:87]
  s_waitcnt lgkmcnt(8)
  ds_read_b64_tr_b16 a[156:157], v15 offset:17664
  ds_read_b64_tr_b16 a[158:159], v15 offset:19712
  buffer_load_dwordx4 v19, s[44:47], s67 offen lds
  v_mul_f32 v37, s83, v159
  v_mfma_f32_32x32x16_bf16 v[88:103], a[168:171], a[92:95], v[88:103]
  s_waitcnt lgkmcnt(8)
  ds_read_b64_tr_b16 a[160:161], v15 offset:20480
  ds_read_b64_tr_b16 a[162:163], v15 offset:22528
  v_exp_f32 v36, v36
  v_mfma_f32_32x32x16_bf16 v[104:119], a[172:175], a[92:95], v[104:119]
  s_waitcnt lgkmcnt(8)
  ds_read_b64_tr_b16 a[164:165], v15 offset:21504
  s_add_u32 m0, s54, 0xc800
  ds_read_b64_tr_b16 a[166:167], v15 offset:23552
  v_exp_f32 v37, v37
  v_mul_f32 v174, v158, v174
  v_mfma_f32_32x32x16_bf16 v[56:71], a[144:147], a[96:99], v[56:71]
  s_waitcnt lgkmcnt(8)
  ds_read_b64_tr_b16 a[168:169], v15 offset:20736
  ds_read_b64_tr_b16 a[170:171], v15 offset:22784
  buffer_load_dwordx4 v20, s[32:35], s67 offen lds
  v_mul_f32 v175, v159, v175
  v_mfma_f32_32x32x16_bf16 v[72:87], a[148:151], a[96:99], v[72:87]
  s_waitcnt lgkmcnt(8)
  ds_read_b64_tr_b16 a[172:173], v15 offset:21760
  ds_read_b64_tr_b16 a[174:175], v15 offset:23808
  v_add_f32 v36, 1.0, v36
  v_add_f32 v37, 1.0, v37
  v_mfma_f32_32x32x16_bf16 v[88:103], a[152:155], a[96:99], v[88:103]
  s_waitcnt lgkmcnt(8)
  ds_read_b64_tr_b16 a[144:145], v15 offset:24576
  s_add_u32 m0, s54, 0xcc00
  ds_read_b64_tr_b16 a[146:147], v15 offset:26624
  v_rcp_f32 v36, v36
  v_mfma_f32_32x32x16_bf16 v[104:119], a[156:159], a[96:99], v[104:119]
  s_waitcnt lgkmcnt(8)
  ds_read_b64_tr_b16 a[148:149], v15 offset:25600
  ds_read_b64_tr_b16 a[150:151], v15 offset:27648
  buffer_load_dwordx4 v20, s[44:47], s67 offen lds
  v_mfma_f32_32x32x16_bf16 v[56:71], a[160:163], a[100:103], v[56:71]
  s_waitcnt lgkmcnt(8)
  ds_read_b64_tr_b16 a[152:153], v15 offset:24832
  ds_read_b64_tr_b16 a[154:155], v15 offset:26880
  v_rcp_f32 v37, v37
  v_mul_f32 v174, v174, v36
  v_mfma_f32_32x32x16_bf16 v[72:87], a[164:167], a[100:103], v[72:87]
  s_waitcnt lgkmcnt(8)
  ds_read_b64_tr_b16 a[156:157], v15 offset:25856
  ds_read_b64_tr_b16 a[158:159], v15 offset:27904
  v_mul_f32 v175, v175, v37
  v_cvt_pk_bf16_f32 v211, v174, v175
  v_mul_f32 v34, s83, v160
  v_mfma_f32_32x32x16_bf16 v[88:103], a[168:171], a[100:103], v[88:103]
  s_waitcnt lgkmcnt(8)
  ds_read_b64_tr_b16 a[160:161], v15 offset:28672
  ds_read_b64_tr_b16 a[162:163], v15 offset:30720
  v_mul_f32 v35, s83, v161
  v_exp_f32 v34, v34
  v_mfma_f32_32x32x16_bf16 v[104:119], a[172:175], a[100:103], v[104:119]
  s_waitcnt lgkmcnt(8)
  ds_read_b64_tr_b16 a[164:165], v15 offset:29696
  ds_read_b64_tr_b16 a[166:167], v15 offset:31744
  v_exp_f32 v35, v35
  v_mul_f32 v176, v160, v176
  v_mfma_f32_32x32x16_bf16 v[56:71], a[144:147], a[104:107], v[56:71]
  s_waitcnt lgkmcnt(8)
  ds_read_b64_tr_b16 a[168:169], v15 offset:28928
  ds_read_b64_tr_b16 a[170:171], v15 offset:30976
  v_mul_f32 v177, v161, v177
  v_add_f32 v34, 1.0, v34
  v_add_f32 v35, 1.0, v35
  v_mfma_f32_32x32x16_bf16 v[72:87], a[148:151], a[104:107], v[72:87]
  s_waitcnt lgkmcnt(8)
  ds_read_b64_tr_b16 a[172:173], v15 offset:29952
  s_waitcnt vmcnt(21)
  ds_read_b64_tr_b16 a[174:175], v15 offset:32000
  s_barrier
  v_rcp_f32 v34, v34
  v_mfma_f32_32x32x16_bf16 v[88:103], a[152:155], a[104:107], v[88:103]
  s_waitcnt lgkmcnt(8)
  ds_read_b64_tr_b16 a[144:145], v15 offset:32768
  s_add_u32 s67, s77, 0x240180
  ds_read_b64_tr_b16 a[146:147], v15 offset:34816
  s_add_u32 m0, s54, 0x10000
  s_nop 0
  buffer_load_dwordx4 v19, s[32:35], s67 offen lds
  v_mfma_f32_32x32x16_bf16 v[104:119], a[156:159], a[104:107], v[104:119]
  s_waitcnt lgkmcnt(8)
  ds_read_b64_tr_b16 a[148:149], v15 offset:33792
  ds_read_b64_tr_b16 a[150:151], v15 offset:35840
  v_rcp_f32 v35, v35
  v_mul_f32 v176, v176, v34
  v_mfma_f32_32x32x16_bf16 v[56:71], a[160:163], a[108:111], v[56:71]
  s_waitcnt lgkmcnt(8)
  ds_read_b64_tr_b16 a[152:153], v15 offset:33024
  s_add_u32 m0, s54, 0x10400
  ds_read_b64_tr_b16 a[154:155], v15 offset:35072
  v_mul_f32 v177, v177, v35
  v_cvt_pk_bf16_f32 v212, v176, v177
  v_mul_f32 v36, s83, v162
  v_mfma_f32_32x32x16_bf16 v[72:87], a[164:167], a[108:111], v[72:87]
  s_waitcnt lgkmcnt(8)
  ds_read_b64_tr_b16 a[156:157], v15 offset:34048
  ds_read_b64_tr_b16 a[158:159], v15 offset:36096
  buffer_load_dwordx4 v19, s[44:47], s67 offen lds
  v_mul_f32 v37, s83, v163
  v_mfma_f32_32x32x16_bf16 v[88:103], a[168:171], a[108:111], v[88:103]
  s_waitcnt lgkmcnt(8)
  ds_read_b64_tr_b16 a[160:161], v15 offset:36864
  ds_read_b64_tr_b16 a[162:163], v15 offset:38912
  v_exp_f32 v36, v36
  v_mfma_f32_32x32x16_bf16 v[104:119], a[172:175], a[108:111], v[104:119]
  s_waitcnt lgkmcnt(8)
  ds_read_b64_tr_b16 a[164:165], v15 offset:37888
  s_add_u32 m0, s54, 0x10800
  ds_read_b64_tr_b16 a[166:167], v15 offset:39936
  v_exp_f32 v37, v37
  v_mul_f32 v178, v162, v178
  v_mfma_f32_32x32x16_bf16 v[56:71], a[144:147], a[112:115], v[56:71]
  s_waitcnt lgkmcnt(8)
  ds_read_b64_tr_b16 a[168:169], v15 offset:37120
  ds_read_b64_tr_b16 a[170:171], v15 offset:39168
  buffer_load_dwordx4 v20, s[32:35], s67 offen lds
  v_mul_f32 v179, v163, v179
  v_mfma_f32_32x32x16_bf16 v[72:87], a[148:151], a[112:115], v[72:87]
  s_waitcnt lgkmcnt(8)
  ds_read_b64_tr_b16 a[172:173], v15 offset:38144
  ds_read_b64_tr_b16 a[174:175], v15 offset:40192
  v_add_f32 v36, 1.0, v36
  v_add_f32 v37, 1.0, v37
  v_mfma_f32_32x32x16_bf16 v[88:103], a[152:155], a[112:115], v[88:103]
  s_waitcnt lgkmcnt(8)
  ds_read_b64_tr_b16 a[144:145], v15 offset:40960
  s_add_u32 m0, s54, 0x10c00
  ds_read_b64_tr_b16 a[146:147], v15 offset:43008
  v_rcp_f32 v36, v36
  v_mfma_f32_32x32x16_bf16 v[104:119], a[156:159], a[112:115], v[104:119]
  s_waitcnt lgkmcnt(8)
  ds_read_b64_tr_b16 a[148:149], v15 offset:41984
  ds_read_b64_tr_b16 a[150:151], v15 offset:44032
  buffer_load_dwordx4 v20, s[44:47], s67 offen lds
  v_mfma_f32_32x32x16_bf16 v[56:71], a[160:163], a[116:119], v[56:71]
  s_waitcnt lgkmcnt(8)
  ds_read_b64_tr_b16 a[152:153], v15 offset:41216
  ds_read_b64_tr_b16 a[154:155], v15 offset:43264
  v_rcp_f32 v37, v37
  v_mul_f32 v178, v178, v36
  v_mfma_f32_32x32x16_bf16 v[72:87], a[164:167], a[116:119], v[72:87]
  s_waitcnt lgkmcnt(8)
  ds_read_b64_tr_b16 a[156:157], v15 offset:42240
  ds_read_b64_tr_b16 a[158:159], v15 offset:44288
  v_mul_f32 v179, v179, v37
  v_cvt_pk_bf16_f32 v213, v178, v179
  v_mul_f32 v34, s83, v164
  v_mfma_f32_32x32x16_bf16 v[88:103], a[168:171], a[116:119], v[88:103]
  s_waitcnt lgkmcnt(8)
  ds_read_b64_tr_b16 a[160:161], v15 offset:45056
  ds_read_b64_tr_b16 a[162:163], v15 offset:47104
  v_mul_f32 v35, s83, v165
  v_exp_f32 v34, v34
  v_mfma_f32_32x32x16_bf16 v[104:119], a[172:175], a[116:119], v[104:119]
  s_waitcnt lgkmcnt(8)
  ds_read_b64_tr_b16 a[164:165], v15 offset:46080
  ds_read_b64_tr_b16 a[166:167], v15 offset:48128
  v_exp_f32 v35, v35
  v_mul_f32 v180, v164, v180
  v_mfma_f32_32x32x16_bf16 v[56:71], a[144:147], a[120:123], v[56:71]
  s_waitcnt lgkmcnt(8)
  ds_read_b64_tr_b16 a[168:169], v15 offset:45312
  ds_read_b64_tr_b16 a[170:171], v15 offset:47360
  v_mul_f32 v181, v165, v181
  v_add_f32 v34, 1.0, v34
  v_add_f32 v35, 1.0, v35
  v_mfma_f32_32x32x16_bf16 v[72:87], a[148:151], a[120:123], v[72:87]
  s_waitcnt lgkmcnt(8)
  ds_read_b64_tr_b16 a[172:173], v15 offset:46336
  s_waitcnt vmcnt(21)
  ds_read_b64_tr_b16 a[174:175], v15 offset:48384
  s_barrier
  v_rcp_f32 v34, v34
  v_mfma_f32_32x32x16_bf16 v[88:103], a[152:155], a[120:123], v[88:103]
  s_waitcnt lgkmcnt(8)
  ds_read_b64_tr_b16 a[144:145], v15 offset:49152
  s_add_u32 s67, s77, 0x2d0180
  ds_read_b64_tr_b16 a[146:147], v15 offset:51200
  s_add_u32 m0, s54, 0x14000
  s_nop 0
  buffer_load_dwordx4 v19, s[32:35], s67 offen lds
  v_mfma_f32_32x32x16_bf16 v[104:119], a[156:159], a[120:123], v[104:119]
  s_waitcnt lgkmcnt(8)
  ds_read_b64_tr_b16 a[148:149], v15 offset:50176
  ds_read_b64_tr_b16 a[150:151], v15 offset:52224
  v_rcp_f32 v35, v35
  v_mul_f32 v180, v180, v34
  v_mfma_f32_32x32x16_bf16 v[56:71], a[160:163], a[124:127], v[56:71]
  s_waitcnt lgkmcnt(8)
  ds_read_b64_tr_b16 a[152:153], v15 offset:49408
  s_add_u32 m0, s54, 0x14400
  ds_read_b64_tr_b16 a[154:155], v15 offset:51456
  v_mul_f32 v181, v181, v35
  v_cvt_pk_bf16_f32 v214, v180, v181
  v_mul_f32 v36, s83, v166
  v_mfma_f32_32x32x16_bf16 v[72:87], a[164:167], a[124:127], v[72:87]
  s_waitcnt lgkmcnt(8)
  ds_read_b64_tr_b16 a[156:157], v15 offset:50432
  ds_read_b64_tr_b16 a[158:159], v15 offset:52480
  buffer_load_dwordx4 v19, s[44:47], s67 offen lds
  v_mul_f32 v37, s83, v167
  v_mfma_f32_32x32x16_bf16 v[88:103], a[168:171], a[124:127], v[88:103]
  s_waitcnt lgkmcnt(8)
  ds_read_b64_tr_b16 a[160:161], v15 offset:53248
  ds_read_b64_tr_b16 a[162:163], v15 offset:55296
  v_exp_f32 v36, v36
  v_mfma_f32_32x32x16_bf16 v[104:119], a[172:175], a[124:127], v[104:119]
  s_waitcnt lgkmcnt(8)
  ds_read_b64_tr_b16 a[164:165], v15 offset:54272
  s_add_u32 m0, s54, 0x14800
  ds_read_b64_tr_b16 a[166:167], v15 offset:56320
  v_exp_f32 v37, v37
  v_mul_f32 v182, v166, v182
  v_mfma_f32_32x32x16_bf16 v[56:71], a[144:147], a[128:131], v[56:71]
  s_waitcnt lgkmcnt(8)
  ds_read_b64_tr_b16 a[168:169], v15 offset:53504
  ds_read_b64_tr_b16 a[170:171], v15 offset:55552
  buffer_load_dwordx4 v20, s[32:35], s67 offen lds
  v_mul_f32 v183, v167, v183
  v_mfma_f32_32x32x16_bf16 v[72:87], a[148:151], a[128:131], v[72:87]
  s_waitcnt lgkmcnt(8)
  ds_read_b64_tr_b16 a[172:173], v15 offset:54528
  ds_read_b64_tr_b16 a[174:175], v15 offset:56576
  v_add_f32 v36, 1.0, v36
  v_add_f32 v37, 1.0, v37
  v_mfma_f32_32x32x16_bf16 v[88:103], a[152:155], a[128:131], v[88:103]
  s_waitcnt lgkmcnt(8)
  ds_read_b64_tr_b16 a[144:145], v15 offset:57344
  s_add_u32 m0, s54, 0x14c00
  ds_read_b64_tr_b16 a[146:147], v15 offset:59392
  v_rcp_f32 v36, v36
  v_mfma_f32_32x32x16_bf16 v[104:119], a[156:159], a[128:131], v[104:119]
  s_waitcnt lgkmcnt(8)
  ds_read_b64_tr_b16 a[148:149], v15 offset:58368
  ds_read_b64_tr_b16 a[150:151], v15 offset:60416
  buffer_load_dwordx4 v20, s[44:47], s67 offen lds
  v_mfma_f32_32x32x16_bf16 v[56:71], a[160:163], a[132:135], v[56:71]
  s_waitcnt lgkmcnt(8)
  ds_read_b64_tr_b16 a[152:153], v15 offset:57600
  ds_read_b64_tr_b16 a[154:155], v15 offset:59648
  v_rcp_f32 v37, v37
  v_mul_f32 v182, v182, v36
  v_mfma_f32_32x32x16_bf16 v[72:87], a[164:167], a[132:135], v[72:87]
  s_waitcnt lgkmcnt(8)
  ds_read_b64_tr_b16 a[156:157], v15 offset:58624
  ds_read_b64_tr_b16 a[158:159], v15 offset:60672
  v_mul_f32 v183, v183, v37
  v_cvt_pk_bf16_f32 v215, v182, v183
  v_mfma_f32_32x32x16_bf16 v[88:103], a[168:171], a[132:135], v[88:103]
  s_waitcnt lgkmcnt(8)
  ds_read_b64_tr_b16 a[160:161], v15 offset:61440
  ds_read_b64_tr_b16 a[162:163], v15 offset:63488
  v_mfma_f32_32x32x16_bf16 v[104:119], a[172:175], a[132:135], v[104:119]
  s_waitcnt lgkmcnt(8)
  ds_read_b64_tr_b16 a[164:165], v15 offset:62464
  ds_read_b64_tr_b16 a[166:167], v15 offset:64512
  v_mfma_f32_32x32x16_bf16 v[56:71], a[144:147], a[136:139], v[56:71]
  s_waitcnt lgkmcnt(8)
  ds_read_b64_tr_b16 a[168:169], v15 offset:61696
  ds_read_b64_tr_b16 a[170:171], v15 offset:63744
  v_mfma_f32_32x32x16_bf16 v[72:87], a[148:151], a[136:139], v[72:87]
  s_waitcnt lgkmcnt(8)
  ds_read_b64_tr_b16 a[172:173], v15 offset:62720
  s_waitcnt vmcnt(20)
  ds_read_b64_tr_b16 a[174:175], v15 offset:64768
  s_barrier
  v_mfma_f32_32x32x16_bf16 v[88:103], a[152:155], a[136:139], v[88:103]
  s_waitcnt lgkmcnt(8)
  ds_read_b64_tr_b16 a[144:145], v14
  s_add_u32 s67, s77, 0x360180
  ds_read_b64_tr_b16 a[146:147], v14 offset:2048
  s_add_u32 m0, s54, 0x18000
  s_nop 0
  buffer_load_dwordx4 v19, s[32:35], s67 offen lds
  v_mfma_f32_32x32x16_bf16 v[104:119], a[156:159], a[136:139], v[104:119]
  s_waitcnt lgkmcnt(8)
  ds_read_b64_tr_b16 a[148:149], v14 offset:1024
  ds_read_b64_tr_b16 a[150:151], v14 offset:3072
  v_mfma_f32_32x32x16_bf16 v[56:71], a[160:163], a[140:143], v[56:71]
  s_waitcnt lgkmcnt(8)
  ds_read_b64_tr_b16 a[152:153], v14 offset:256
  s_add_u32 m0, s54, 0x18400
  ds_read_b64_tr_b16 a[154:155], v14 offset:2304
  v_mfma_f32_32x32x16_bf16 v[72:87], a[164:167], a[140:143], v[72:87]
  s_waitcnt lgkmcnt(8)
  ds_read_b64_tr_b16 a[156:157], v14 offset:1280
  ds_read_b64_tr_b16 a[158:159], v14 offset:3328
  buffer_load_dwordx4 v19, s[44:47], s67 offen lds
  v_mfma_f32_32x32x16_bf16 v[88:103], a[168:171], a[140:143], v[88:103]
  s_waitcnt lgkmcnt(8)
  ds_read_b64_tr_b16 a[160:161], v14 offset:4096
  ds_read_b64_tr_b16 a[162:163], v14 offset:6144
  v_mfma_f32_32x32x16_bf16 v[104:119], a[172:175], a[140:143], v[104:119]
  s_waitcnt lgkmcnt(8)
  ds_read_b64_tr_b16 a[164:165], v14 offset:5120
  s_add_u32 m0, s54, 0x18800
  ds_read_b64_tr_b16 a[166:167], v14 offset:7168
  v_mfma_f32_32x32x16_bf16 v[120:135], a[144:147], a[0:3], 0
  s_waitcnt lgkmcnt(8)
  ds_read_b64_tr_b16 a[168:169], v14 offset:4352
  ds_read_b64_tr_b16 a[170:171], v14 offset:6400
  buffer_load_dwordx4 v20, s[32:35], s67 offen lds
  v_mfma_f32_32x32x16_bf16 v[136:151], a[148:151], a[0:3], 0
  s_waitcnt lgkmcnt(8)
  ds_read_b64_tr_b16 a[172:173], v14 offset:5376
  ds_read_b64_tr_b16 a[174:175], v14 offset:7424
  v_mfma_f32_32x32x16_bf16 v[152:167], a[152:155], a[0:3], 0
  s_waitcnt lgkmcnt(8)
  ds_read_b64_tr_b16 a[144:145], v14 offset:8192
  s_add_u32 m0, s54, 0x18c00
  ds_read_b64_tr_b16 a[146:147], v14 offset:10240
  v_mul_f32 v34, s83, v56
  v_mul_f32 v35, s83, v57
  v_mfma_f32_32x32x16_bf16 v[168:183], a[156:159], a[0:3], 0
  s_waitcnt lgkmcnt(8)
  ds_read_b64_tr_b16 a[148:149], v14 offset:9216
  s_mov_b32 s84, s78
  ds_read_b64_tr_b16 a[150:151], v14 offset:11264
  buffer_load_dwordx4 v20, s[44:47], s67 offen lds
  buffer_load_dword a253, v21, s[32:35], s84 offen
  v_mfma_f32_32x32x16_bf16 v[120:135], a[160:163], a[4:7], v[120:135]
  s_waitcnt lgkmcnt(8)
  ds_read_b64_tr_b16 a[152:153], v14 offset:8448
  ds_read_b64_tr_b16 a[154:155], v14 offset:10496
  v_exp_f32 v34, v34
  v_mfma_f32_32x32x16_bf16 v[136:151], a[164:167], a[4:7], v[136:151]
  s_waitcnt lgkmcnt(8)
  ds_read_b64_tr_b16 a[156:157], v14 offset:9472
  ds_read_b64_tr_b16 a[158:159], v14 offset:11520
  buffer_load_dword a254, v21, s[44:47], s84 offen
  v_mfma_f32_32x32x16_bf16 v[152:167], a[168:171], a[4:7], v[152:167]
  s_waitcnt lgkmcnt(8)
  ds_read_b64_tr_b16 a[160:161], v14 offset:12288
  ds_read_b64_tr_b16 a[162:163], v14 offset:14336
  v_exp_f32 v35, v35
  v_mul_f32 v72, v56, v72
  v_mfma_f32_32x32x16_bf16 v[168:183], a[172:175], a[4:7], v[168:183]
  s_waitcnt lgkmcnt(8)
  ds_read_b64_tr_b16 a[164:165], v14 offset:13312
  ds_read_b64_tr_b16 a[166:167], v14 offset:15360
  v_mul_f32 v73, v57, v73
  v_add_f32 v34, 1.0, v34
  v_add_f32 v35, 1.0, v35
  v_mfma_f32_32x32x16_bf16 v[120:135], a[144:147], a[8:11], v[120:135]
  s_waitcnt lgkmcnt(8)
  ds_read_b64_tr_b16 a[168:169], v14 offset:12544
  ds_read_b64_tr_b16 a[170:171], v14 offset:14592
  v_rcp_f32 v34, v34
  v_mfma_f32_32x32x16_bf16 v[136:151], a[148:151], a[8:11], v[136:151]
  s_waitcnt lgkmcnt(8)
  ds_read_b64_tr_b16 a[172:173], v14 offset:13568
  s_waitcnt vmcnt(22)
  ds_read_b64_tr_b16 a[174:175], v14 offset:15616
  s_barrier
  v_rcp_f32 v35, v35
  v_mul_f32 v72, v72, v34
  v_mfma_f32_32x32x16_bf16 v[152:167], a[152:155], a[8:11], v[152:167]
  s_waitcnt lgkmcnt(8)
  ds_read_b64_tr_b16 a[144:145], v14 offset:16384
  s_add_u32 s67, s77, 0x3f0180
  ds_read_b64_tr_b16 a[146:147], v14 offset:18432
  s_add_u32 m0, s54, 0x1c000
  s_nop 0
  buffer_load_dwordx4 v19, s[32:35], s67 offen lds
  v_mul_f32 v73, v73, v35
  v_mfma_f32_32x32x16_bf16 v[168:183], a[156:159], a[8:11], v[168:183]
  s_waitcnt lgkmcnt(8)
  ds_read_b64_tr_b16 a[148:149], v14 offset:17408
  ds_read_b64_tr_b16 a[150:151], v14 offset:19456
  v_cvt_pk_bf16_f32 v216, v72, v73
  v_mul_f32 v36, s83, v58
  v_mul_f32 v37, s83, v59
  v_mfma_f32_32x32x16_bf16 v[120:135], a[160:163], a[12:15], v[120:135]
  s_waitcnt lgkmcnt(8)
  ds_read_b64_tr_b16 a[152:153], v14 offset:16640
  s_add_u32 m0, s54, 0x1c400
  ds_read_b64_tr_b16 a[154:155], v14 offset:18688
  v_exp_f32 v36, v36
  v_mfma_f32_32x32x16_bf16 v[136:151], a[164:167], a[12:15], v[136:151]
  s_waitcnt lgkmcnt(8)
  ds_read_b64_tr_b16 a[156:157], v14 offset:17664
  ds_read_b64_tr_b16 a[158:159], v14 offset:19712
  buffer_load_dwordx4 v19, s[44:47], s67 offen lds
  v_mfma_f32_32x32x16_bf16 v[152:167], a[168:171], a[12:15], v[152:167]
  s_waitcnt lgkmcnt(8)
  ds_read_b64_tr_b16 a[160:161], v14 offset:20480
  ds_read_b64_tr_b16 a[162:163], v14 offset:22528
  v_exp_f32 v37, v37
  v_mul_f32 v74, v58, v74
  v_mfma_f32_32x32x16_bf16 v[168:183], a[172:175], a[12:15], v[168:183]
  s_waitcnt lgkmcnt(8)
  ds_read_b64_tr_b16 a[164:165], v14 offset:21504
  s_add_u32 m0, s54, 0x1c800
  ds_read_b64_tr_b16 a[166:167], v14 offset:23552
  v_mul_f32 v75, v59, v75
  v_add_f32 v36, 1.0, v36
  v_add_f32 v37, 1.0, v37
  v_mfma_f32_32x32x16_bf16 v[120:135], a[144:147], a[16:19], v[120:135]
  s_waitcnt lgkmcnt(8)
  ds_read_b64_tr_b16 a[168:169], v14 offset:20736
  ds_read_b64_tr_b16 a[170:171], v14 offset:22784
  buffer_load_dwordx4 v20, s[32:35], s67 offen lds
  v_mfma_f32_32x32x16_bf16 v[136:151], a[148:151], a[16:19], v[136:151]
  s_waitcnt lgkmcnt(8)
  ds_read_b64_tr_b16 a[172:173], v14 offset:21760
  ds_read_b64_tr_b16 a[174:175], v14 offset:23808
  v_rcp_f32 v36, v36
  v_mfma_f32_32x32x16_bf16 v[152:167], a[152:155], a[16:19], v[152:167]
  s_waitcnt lgkmcnt(8)
  ds_read_b64_tr_b16 a[144:145], v14 offset:24576
  s_add_u32 m0, s54, 0x1cc00
  ds_read_b64_tr_b16 a[146:147], v14 offset:26624
  v_rcp_f32 v37, v37
  v_mul_f32 v74, v74, v36
  v_mfma_f32_32x32x16_bf16 v[168:183], a[156:159], a[16:19], v[168:183]
  s_waitcnt lgkmcnt(8)
  ds_read_b64_tr_b16 a[148:149], v14 offset:25600
  ds_read_b64_tr_b16 a[150:151], v14 offset:27648
  buffer_load_dwordx4 v20, s[44:47], s67 offen lds
  v_mul_f32 v75, v75, v37
  v_mfma_f32_32x32x16_bf16 v[120:135], a[160:163], a[20:23], v[120:135]
  s_waitcnt lgkmcnt(8)
  ds_read_b64_tr_b16 a[152:153], v14 offset:24832
  ds_read_b64_tr_b16 a[154:155], v14 offset:26880
  v_cvt_pk_bf16_f32 v217, v74, v75
  v_mul_f32 v34, s83, v60
  v_mul_f32 v35, s83, v61
  v_mfma_f32_32x32x16_bf16 v[136:151], a[164:167], a[20:23], v[136:151]
  s_waitcnt lgkmcnt(8)
  ds_read_b64_tr_b16 a[156:157], v14 offset:25856
  ds_read_b64_tr_b16 a[158:159], v14 offset:27904
  v_exp_f32 v34, v34
  v_mfma_f32_32x32x16_bf16 v[152:167], a[168:171], a[20:23], v[152:167]
  s_waitcnt lgkmcnt(8)
  ds_read_b64_tr_b16 a[160:161], v14 offset:28672
  ds_read_b64_tr_b16 a[162:163], v14 offset:30720
  v_exp_f32 v35, v35
  v_mul_f32 v76, v60, v76
  v_mfma_f32_32x32x16_bf16 v[168:183], a[172:175], a[20:23], v[168:183]
  s_waitcnt lgkmcnt(8)
  ds_read_b64_tr_b16 a[164:165], v14 offset:29696
  ds_read_b64_tr_b16 a[166:167], v14 offset:31744
  v_mul_f32 v77, v61, v77
  v_add_f32 v34, 1.0, v34
  v_add_f32 v35, 1.0, v35
  v_mfma_f32_32x32x16_bf16 v[120:135], a[144:147], a[24:27], v[120:135]
  s_waitcnt lgkmcnt(8)
  ds_read_b64_tr_b16 a[168:169], v14 offset:28928
  ds_read_b64_tr_b16 a[170:171], v14 offset:30976
  v_rcp_f32 v34, v34
  v_mfma_f32_32x32x16_bf16 v[136:151], a[148:151], a[24:27], v[136:151]
  s_waitcnt lgkmcnt(8)
  ds_read_b64_tr_b16 a[172:173], v14 offset:29952
  s_waitcnt vmcnt(22)
  ds_read_b64_tr_b16 a[174:175], v14 offset:32000
  s_barrier
  v_rcp_f32 v35, v35
  v_mul_f32 v76, v76, v34
  v_mfma_f32_32x32x16_bf16 v[152:167], a[152:155], a[24:27], v[152:167]
  s_waitcnt lgkmcnt(8)
  ds_read_b64_tr_b16 a[144:145], v14 offset:32768
  s_add_u32 s67, s77, 0x480180
  ds_read_b64_tr_b16 a[146:147], v14 offset:34816
  s_add_u32 m0, s54, 0
  s_nop 0
  buffer_load_dwordx4 v19, s[32:35], s67 offen lds
  v_mul_f32 v77, v77, v35
  v_mfma_f32_32x32x16_bf16 v[168:183], a[156:159], a[24:27], v[168:183]
  s_waitcnt lgkmcnt(8)
  ds_read_b64_tr_b16 a[148:149], v14 offset:33792
  ds_read_b64_tr_b16 a[150:151], v14 offset:35840
  v_cvt_pk_bf16_f32 v218, v76, v77
  v_mul_f32 v36, s83, v62
  v_mul_f32 v37, s83, v63
  v_mfma_f32_32x32x16_bf16 v[120:135], a[160:163], a[28:31], v[120:135]
  s_waitcnt lgkmcnt(8)
  ds_read_b64_tr_b16 a[152:153], v14 offset:33024
  s_add_u32 m0, s54, 0x400
  ds_read_b64_tr_b16 a[154:155], v14 offset:35072
  v_exp_f32 v36, v36
  v_mfma_f32_32x32x16_bf16 v[136:151], a[164:167], a[28:31], v[136:151]
  s_waitcnt lgkmcnt(8)
  ds_read_b64_tr_b16 a[156:157], v14 offset:34048
  ds_read_b64_tr_b16 a[158:159], v14 offset:36096
  buffer_load_dwordx4 v19, s[44:47], s67 offen lds
  v_mfma_f32_32x32x16_bf16 v[152:167], a[168:171], a[28:31], v[152:167]
  s_waitcnt lgkmcnt(8)
  ds_read_b64_tr_b16 a[160:161], v14 offset:36864
  ds_read_b64_tr_b16 a[162:163], v14 offset:38912
  v_exp_f32 v37, v37
  v_mul_f32 v78, v62, v78
  v_mfma_f32_32x32x16_bf16 v[168:183], a[172:175], a[28:31], v[168:183]
  s_waitcnt lgkmcnt(8)
  ds_read_b64_tr_b16 a[164:165], v14 offset:37888
  s_add_u32 m0, s54, 0x800
  ds_read_b64_tr_b16 a[166:167], v14 offset:39936
  v_mul_f32 v79, v63, v79
  v_add_f32 v36, 1.0, v36
  v_add_f32 v37, 1.0, v37
  v_mfma_f32_32x32x16_bf16 v[120:135], a[144:147], a[32:35], v[120:135]
  s_waitcnt lgkmcnt(8)
  ds_read_b64_tr_b16 a[168:169], v14 offset:37120
  ds_read_b64_tr_b16 a[170:171], v14 offset:39168
  buffer_load_dwordx4 v20, s[32:35], s67 offen lds
  v_mfma_f32_32x32x16_bf16 v[136:151], a[148:151], a[32:35], v[136:151]
  s_waitcnt lgkmcnt(8)
  ds_read_b64_tr_b16 a[172:173], v14 offset:38144
  ds_read_b64_tr_b16 a[174:175], v14 offset:40192
  v_rcp_f32 v36, v36
  v_mfma_f32_32x32x16_bf16 v[152:167], a[152:155], a[32:35], v[152:167]
  s_waitcnt lgkmcnt(8)
  ds_read_b64_tr_b16 a[144:145], v14 offset:40960
  s_add_u32 m0, s54, 0xc00
  ds_read_b64_tr_b16 a[146:147], v14 offset:43008
  v_rcp_f32 v37, v37
  v_mul_f32 v78, v78, v36
  v_mfma_f32_32x32x16_bf16 v[168:183], a[156:159], a[32:35], v[168:183]
  s_waitcnt lgkmcnt(8)
  ds_read_b64_tr_b16 a[148:149], v14 offset:41984
  ds_read_b64_tr_b16 a[150:151], v14 offset:44032
  buffer_load_dwordx4 v20, s[44:47], s67 offen lds
  v_mul_f32 v79, v79, v37
  v_mfma_f32_32x32x16_bf16 v[120:135], a[160:163], a[36:39], v[120:135]
  s_waitcnt lgkmcnt(8)
  ds_read_b64_tr_b16 a[152:153], v14 offset:41216
  ds_read_b64_tr_b16 a[154:155], v14 offset:43264
  v_cvt_pk_bf16_f32 v219, v78, v79
  v_mul_f32 v34, s83, v64
  v_mul_f32 v35, s83, v65
  v_mfma_f32_32x32x16_bf16 v[136:151], a[164:167], a[36:39], v[136:151]
  s_waitcnt lgkmcnt(8)
  ds_read_b64_tr_b16 a[156:157], v14 offset:42240
  ds_read_b64_tr_b16 a[158:159], v14 offset:44288
  v_exp_f32 v34, v34
  v_mfma_f32_32x32x16_bf16 v[152:167], a[168:171], a[36:39], v[152:167]
  s_waitcnt lgkmcnt(8)
  ds_read_b64_tr_b16 a[160:161], v14 offset:45056
  ds_read_b64_tr_b16 a[162:163], v14 offset:47104
  v_exp_f32 v35, v35
  v_mul_f32 v80, v64, v80
  v_mfma_f32_32x32x16_bf16 v[168:183], a[172:175], a[36:39], v[168:183]
  s_waitcnt lgkmcnt(8)
  ds_read_b64_tr_b16 a[164:165], v14 offset:46080
  ds_read_b64_tr_b16 a[166:167], v14 offset:48128
  v_mul_f32 v81, v65, v81
  v_add_f32 v34, 1.0, v34
  v_add_f32 v35, 1.0, v35
  v_mfma_f32_32x32x16_bf16 v[120:135], a[144:147], a[40:43], v[120:135]
  s_waitcnt lgkmcnt(8)
  ds_read_b64_tr_b16 a[168:169], v14 offset:45312
  ds_read_b64_tr_b16 a[170:171], v14 offset:47360
  v_rcp_f32 v34, v34
  v_mfma_f32_32x32x16_bf16 v[136:151], a[148:151], a[40:43], v[136:151]
  s_waitcnt lgkmcnt(8)
  ds_read_b64_tr_b16 a[172:173], v14 offset:46336
  s_waitcnt vmcnt(22)
  ds_read_b64_tr_b16 a[174:175], v14 offset:48384
  s_barrier
  v_rcp_f32 v35, v35
  v_mul_f32 v80, v80, v34
  v_mfma_f32_32x32x16_bf16 v[152:167], a[152:155], a[40:43], v[152:167]
  s_waitcnt lgkmcnt(8)
  ds_read_b64_tr_b16 a[144:145], v14 offset:49152
  s_add_u32 s67, s78, 0
  ds_read_b64_tr_b16 a[146:147], v14 offset:51200
  s_add_u32 m0, s54, 0x4000
  s_nop 0
  buffer_load_dwordx4 v19, s[32:35], s67 offen lds
  v_mul_f32 v81, v81, v35
  v_mfma_f32_32x32x16_bf16 v[168:183], a[156:159], a[40:43], v[168:183]
  s_waitcnt lgkmcnt(8)
  ds_read_b64_tr_b16 a[148:149], v14 offset:50176
  ds_read_b64_tr_b16 a[150:151], v14 offset:52224
  v_cvt_pk_bf16_f32 v220, v80, v81
  v_mul_f32 v36, s83, v66
  v_mul_f32 v37, s83, v67
  v_mfma_f32_32x32x16_bf16 v[120:135], a[160:163], a[44:47], v[120:135]
  s_waitcnt lgkmcnt(8)
  ds_read_b64_tr_b16 a[152:153], v14 offset:49408
  s_add_u32 m0, s54, 0x4400
  ds_read_b64_tr_b16 a[154:155], v14 offset:51456
  v_exp_f32 v36, v36
  v_mfma_f32_32x32x16_bf16 v[136:151], a[164:167], a[44:47], v[136:151]
  s_waitcnt lgkmcnt(8)
  ds_read_b64_tr_b16 a[156:157], v14 offset:50432
  ds_read_b64_tr_b16 a[158:159], v14 offset:52480
  buffer_load_dwordx4 v19, s[44:47], s67 offen lds
  v_mfma_f32_32x32x16_bf16 v[152:167], a[168:171], a[44:47], v[152:167]
  s_waitcnt lgkmcnt(8)
  ds_read_b64_tr_b16 a[160:161], v14 offset:53248
  ds_read_b64_tr_b16 a[162:163], v14 offset:55296
  v_exp_f32 v37, v37
  v_mul_f32 v82, v66, v82
  v_mfma_f32_32x32x16_bf16 v[168:183], a[172:175], a[44:47], v[168:183]
  s_waitcnt lgkmcnt(8)
  ds_read_b64_tr_b16 a[164:165], v14 offset:54272
  s_add_u32 m0, s54, 0x4800
  ds_read_b64_tr_b16 a[166:167], v14 offset:56320
  v_mul_f32 v83, v67, v83
  v_add_f32 v36, 1.0, v36
  v_add_f32 v37, 1.0, v37
  v_mfma_f32_32x32x16_bf16 v[120:135], a[144:147], a[48:51], v[120:135]
  s_waitcnt lgkmcnt(8)
  ds_read_b64_tr_b16 a[168:169], v14 offset:53504
  ds_read_b64_tr_b16 a[170:171], v14 offset:55552
  buffer_load_dwordx4 v20, s[32:35], s67 offen lds
  v_mfma_f32_32x32x16_bf16 v[136:151], a[148:151], a[48:51], v[136:151]
  s_waitcnt lgkmcnt(8)
  ds_read_b64_tr_b16 a[172:173], v14 offset:54528
  ds_read_b64_tr_b16 a[174:175], v14 offset:56576
  v_rcp_f32 v36, v36
  v_mfma_f32_32x32x16_bf16 v[152:167], a[152:155], a[48:51], v[152:167]
  s_waitcnt lgkmcnt(8)
  ds_read_b64_tr_b16 a[144:145], v14 offset:57344
  s_add_u32 m0, s54, 0x4c00
  ds_read_b64_tr_b16 a[146:147], v14 offset:59392
  v_rcp_f32 v37, v37
  v_mul_f32 v82, v82, v36
  v_mfma_f32_32x32x16_bf16 v[168:183], a[156:159], a[48:51], v[168:183]
  s_waitcnt lgkmcnt(8)
  ds_read_b64_tr_b16 a[148:149], v14 offset:58368
  ds_read_b64_tr_b16 a[150:151], v14 offset:60416
  buffer_load_dwordx4 v20, s[44:47], s67 offen lds
  v_mul_f32 v83, v83, v37
  v_mfma_f32_32x32x16_bf16 v[120:135], a[160:163], a[52:55], v[120:135]
  s_waitcnt lgkmcnt(8)
  ds_read_b64_tr_b16 a[152:153], v14 offset:57600
  ds_read_b64_tr_b16 a[154:155], v14 offset:59648
  v_cvt_pk_bf16_f32 v221, v82, v83
  v_mul_f32 v34, s83, v68
  v_mul_f32 v35, s83, v69
  v_mfma_f32_32x32x16_bf16 v[136:151], a[164:167], a[52:55], v[136:151]
  s_waitcnt lgkmcnt(8)
  ds_read_b64_tr_b16 a[156:157], v14 offset:58624
  ds_read_b64_tr_b16 a[158:159], v14 offset:60672
  v_exp_f32 v34, v34
  v_mfma_f32_32x32x16_bf16 v[152:167], a[168:171], a[52:55], v[152:167]
  s_waitcnt lgkmcnt(8)
  ds_read_b64_tr_b16 a[160:161], v14 offset:61440
  ds_read_b64_tr_b16 a[162:163], v14 offset:63488
  v_exp_f32 v35, v35
  v_mul_f32 v84, v68, v84
  v_mfma_f32_32x32x16_bf16 v[168:183], a[172:175], a[52:55], v[168:183]
  s_waitcnt lgkmcnt(8)
  ds_read_b64_tr_b16 a[164:165], v14 offset:62464
  ds_read_b64_tr_b16 a[166:167], v14 offset:64512
  v_mul_f32 v85, v69, v85
  v_add_f32 v34, 1.0, v34
  v_add_f32 v35, 1.0, v35
  v_mfma_f32_32x32x16_bf16 v[120:135], a[144:147], a[56:59], v[120:135]
  s_waitcnt lgkmcnt(8)
  ds_read_b64_tr_b16 a[168:169], v14 offset:61696
  ds_read_b64_tr_b16 a[170:171], v14 offset:63744
  v_rcp_f32 v34, v34
  v_mfma_f32_32x32x16_bf16 v[136:151], a[148:151], a[56:59], v[136:151]
  s_waitcnt lgkmcnt(8)
  ds_read_b64_tr_b16 a[172:173], v14 offset:62720
  s_waitcnt vmcnt(22)
  ds_read_b64_tr_b16 a[174:175], v14 offset:64768
  s_barrier
  v_rcp_f32 v35, v35
  v_mul_f32 v84, v84, v34
  v_mfma_f32_32x32x16_bf16 v[152:167], a[152:155], a[56:59], v[152:167]
  s_waitcnt lgkmcnt(8)
  ds_read_b64_tr_b16 a[144:145], v15
  s_add_u32 s67, s78, 0x90000
  ds_read_b64_tr_b16 a[146:147], v15 offset:2048
  s_add_u32 m0, s54, 0x8000
  s_nop 0
  buffer_load_dwordx4 v19, s[32:35], s67 offen lds
  v_mul_f32 v85, v85, v35
  v_mfma_f32_32x32x16_bf16 v[168:183], a[156:159], a[56:59], v[168:183]
  s_waitcnt lgkmcnt(8)
  ds_read_b64_tr_b16 a[148:149], v15 offset:1024
  ds_read_b64_tr_b16 a[150:151], v15 offset:3072
  v_cvt_pk_bf16_f32 v222, v84, v85
  v_mul_f32 v36, s83, v70
  v_mul_f32 v37, s83, v71
  v_mfma_f32_32x32x16_bf16 v[120:135], a[160:163], a[60:63], v[120:135]
  s_waitcnt lgkmcnt(8)
  ds_read_b64_tr_b16 a[152:153], v15 offset:256
  s_add_u32 m0, s54, 0x8400
  ds_read_b64_tr_b16 a[154:155], v15 offset:2304
  v_exp_f32 v36, v36
  v_mfma_f32_32x32x16_bf16 v[136:151], a[164:167], a[60:63], v[136:151]
  s_waitcnt lgkmcnt(8)
  ds_read_b64_tr_b16 a[156:157], v15 offset:1280
  ds_read_b64_tr_b16 a[158:159], v15 offset:3328
  buffer_load_dwordx4 v19, s[44:47], s67 offen lds
  v_mfma_f32_32x32x16_bf16 v[152:167], a[168:171], a[60:63], v[152:167]
  s_waitcnt lgkmcnt(8)
  ds_read_b64_tr_b16 a[160:161], v15 offset:4096
  ds_read_b64_tr_b16 a[162:163], v15 offset:6144
  v_exp_f32 v37, v37
  v_mul_f32 v86, v70, v86
  v_mfma_f32_32x32x16_bf16 v[168:183], a[172:175], a[60:63], v[168:183]
  s_waitcnt lgkmcnt(8)
  ds_read_b64_tr_b16 a[164:165], v15 offset:5120
  s_add_u32 m0, s54, 0x8800
  ds_read_b64_tr_b16 a[166:167], v15 offset:7168
  v_mul_f32 v87, v71, v87
  v_add_f32 v36, 1.0, v36
  v_add_f32 v37, 1.0, v37
  v_mfma_f32_32x32x16_bf16 v[120:135], a[144:147], a[64:67], v[120:135]
  s_waitcnt lgkmcnt(8)
  ds_read_b64_tr_b16 a[168:169], v15 offset:4352
  ds_read_b64_tr_b16 a[170:171], v15 offset:6400
  buffer_load_dwordx4 v20, s[32:35], s67 offen lds
  v_mfma_f32_32x32x16_bf16 v[136:151], a[148:151], a[64:67], v[136:151]
  s_waitcnt lgkmcnt(8)
  ds_read_b64_tr_b16 a[172:173], v15 offset:5376
  ds_read_b64_tr_b16 a[174:175], v15 offset:7424
  v_rcp_f32 v36, v36
  v_mfma_f32_32x32x16_bf16 v[152:167], a[152:155], a[64:67], v[152:167]
  s_waitcnt lgkmcnt(8)
  ds_read_b64_tr_b16 a[144:145], v15 offset:8192
  s_add_u32 m0, s54, 0x8c00
  ds_read_b64_tr_b16 a[146:147], v15 offset:10240
  v_rcp_f32 v37, v37
  v_mul_f32 v86, v86, v36
  v_mfma_f32_32x32x16_bf16 v[168:183], a[156:159], a[64:67], v[168:183]
  s_waitcnt lgkmcnt(8)
  ds_read_b64_tr_b16 a[148:149], v15 offset:9216
  ds_read_b64_tr_b16 a[150:151], v15 offset:11264
  buffer_load_dwordx4 v20, s[44:47], s67 offen lds
  v_mul_f32 v87, v87, v37
  v_mfma_f32_32x32x16_bf16 v[120:135], a[160:163], a[68:71], v[120:135]
  s_waitcnt lgkmcnt(8)
  ds_read_b64_tr_b16 a[152:153], v15 offset:8448
  ds_read_b64_tr_b16 a[154:155], v15 offset:10496
  v_cvt_pk_bf16_f32 v223, v86, v87
  v_mul_f32 v34, s83, v88
  v_mul_f32 v35, s83, v89
  v_mfma_f32_32x32x16_bf16 v[136:151], a[164:167], a[68:71], v[136:151]
  s_waitcnt lgkmcnt(8)
  ds_read_b64_tr_b16 a[156:157], v15 offset:9472
  ds_read_b64_tr_b16 a[158:159], v15 offset:11520
  v_exp_f32 v34, v34
  v_mfma_f32_32x32x16_bf16 v[152:167], a[168:171], a[68:71], v[152:167]
  s_waitcnt lgkmcnt(8)
  ds_read_b64_tr_b16 a[160:161], v15 offset:12288
  ds_read_b64_tr_b16 a[162:163], v15 offset:14336
  v_exp_f32 v35, v35
  v_mul_f32 v104, v88, v104
  v_mfma_f32_32x32x16_bf16 v[168:183], a[172:175], a[68:71], v[168:183]
  s_waitcnt lgkmcnt(8)
  ds_read_b64_tr_b16 a[164:165], v15 offset:13312
  ds_read_b64_tr_b16 a[166:167], v15 offset:15360
  v_mul_f32 v105, v89, v105
  v_add_f32 v34, 1.0, v34
  v_add_f32 v35, 1.0, v35
  v_mfma_f32_32x32x16_bf16 v[120:135], a[144:147], a[72:75], v[120:135]
  s_waitcnt lgkmcnt(8)
  ds_read_b64_tr_b16 a[168:169], v15 offset:12544
  ds_read_b64_tr_b16 a[170:171], v15 offset:14592
  v_rcp_f32 v34, v34
  v_mfma_f32_32x32x16_bf16 v[136:151], a[148:151], a[72:75], v[136:151]
  s_waitcnt lgkmcnt(8)
  ds_read_b64_tr_b16 a[172:173], v15 offset:13568
  s_waitcnt vmcnt(22)
  ds_read_b64_tr_b16 a[174:175], v15 offset:15616
  s_barrier
  v_rcp_f32 v35, v35
  v_mul_f32 v104, v104, v34
  v_mfma_f32_32x32x16_bf16 v[152:167], a[152:155], a[72:75], v[152:167]
  s_waitcnt lgkmcnt(8)
  ds_read_b64_tr_b16 a[144:145], v15 offset:16384
  s_add_u32 s67, s78, 0x120000
  ds_read_b64_tr_b16 a[146:147], v15 offset:18432
  s_add_u32 m0, s54, 0xc000
  s_nop 0
  buffer_load_dwordx4 v19, s[32:35], s67 offen lds
  v_mul_f32 v105, v105, v35
  v_mfma_f32_32x32x16_bf16 v[168:183], a[156:159], a[72:75], v[168:183]
  s_waitcnt lgkmcnt(8)
  ds_read_b64_tr_b16 a[148:149], v15 offset:17408
  ds_read_b64_tr_b16 a[150:151], v15 offset:19456
  v_cvt_pk_bf16_f32 v224, v104, v105
  v_mul_f32 v36, s83, v90
  v_mul_f32 v37, s83, v91
  v_mfma_f32_32x32x16_bf16 v[120:135], a[160:163], a[76:79], v[120:135]
  s_waitcnt lgkmcnt(8)
  ds_read_b64_tr_b16 a[152:153], v15 offset:16640
  s_add_u32 m0, s54, 0xc400
  ds_read_b64_tr_b16 a[154:155], v15 offset:18688
  v_exp_f32 v36, v36
  v_mfma_f32_32x32x16_bf16 v[136:151], a[164:167], a[76:79], v[136:151]
  s_waitcnt lgkmcnt(8)
  ds_read_b64_tr_b16 a[156:157], v15 offset:17664
  ds_read_b64_tr_b16 a[158:159], v15 offset:19712
  buffer_load_dwordx4 v19, s[44:47], s67 offen lds
  v_mfma_f32_32x32x16_bf16 v[152:167], a[168:171], a[76:79], v[152:167]
  s_waitcnt lgkmcnt(8)
  ds_read_b64_tr_b16 a[160:161], v15 offset:20480
  ds_read_b64_tr_b16 a[162:163], v15 offset:22528
  v_exp_f32 v37, v37
  v_mul_f32 v106, v90, v106
  v_mfma_f32_32x32x16_bf16 v[168:183], a[172:175], a[76:79], v[168:183]
  s_waitcnt lgkmcnt(8)
  ds_read_b64_tr_b16 a[164:165], v15 offset:21504
  s_add_u32 m0, s54, 0xc800
  ds_read_b64_tr_b16 a[166:167], v15 offset:23552
  v_mul_f32 v107, v91, v107
  v_add_f32 v36, 1.0, v36
  v_add_f32 v37, 1.0, v37
  v_mfma_f32_32x32x16_bf16 v[120:135], a[144:147], a[80:83], v[120:135]
  s_waitcnt lgkmcnt(8)
  ds_read_b64_tr_b16 a[168:169], v15 offset:20736
  ds_read_b64_tr_b16 a[170:171], v15 offset:22784
  buffer_load_dwordx4 v20, s[32:35], s67 offen lds
  v_mfma_f32_32x32x16_bf16 v[136:151], a[148:151], a[80:83], v[136:151]
  s_waitcnt lgkmcnt(8)
  ds_read_b64_tr_b16 a[172:173], v15 offset:21760
  ds_read_b64_tr_b16 a[174:175], v15 offset:23808
  v_rcp_f32 v36, v36
  v_mfma_f32_32x32x16_bf16 v[152:167], a[152:155], a[80:83], v[152:167]
  s_waitcnt lgkmcnt(8)
  ds_read_b64_tr_b16 a[144:145], v15 offset:24576
  s_add_u32 m0, s54, 0xcc00
  ds_read_b64_tr_b16 a[146:147], v15 offset:26624
  v_rcp_f32 v37, v37
  v_mul_f32 v106, v106, v36
  v_mfma_f32_32x32x16_bf16 v[168:183], a[156:159], a[80:83], v[168:183]
  s_waitcnt lgkmcnt(8)
  ds_read_b64_tr_b16 a[148:149], v15 offset:25600
  ds_read_b64_tr_b16 a[150:151], v15 offset:27648
  buffer_load_dwordx4 v20, s[44:47], s67 offen lds
  v_mul_f32 v107, v107, v37
  v_mfma_f32_32x32x16_bf16 v[120:135], a[160:163], a[84:87], v[120:135]
  s_waitcnt lgkmcnt(8)
  ds_read_b64_tr_b16 a[152:153], v15 offset:24832
  ds_read_b64_tr_b16 a[154:155], v15 offset:26880
  v_cvt_pk_bf16_f32 v225, v106, v107
  v_mul_f32 v34, s83, v92
  v_mul_f32 v35, s83, v93
  v_mfma_f32_32x32x16_bf16 v[136:151], a[164:167], a[84:87], v[136:151]
  s_waitcnt lgkmcnt(8)
  ds_read_b64_tr_b16 a[156:157], v15 offset:25856
  ds_read_b64_tr_b16 a[158:159], v15 offset:27904
  v_exp_f32 v34, v34
  v_mfma_f32_32x32x16_bf16 v[152:167], a[168:171], a[84:87], v[152:167]
  s_waitcnt lgkmcnt(8)
  ds_read_b64_tr_b16 a[160:161], v15 offset:28672
  ds_read_b64_tr_b16 a[162:163], v15 offset:30720
  v_exp_f32 v35, v35
  v_mul_f32 v108, v92, v108
  v_mfma_f32_32x32x16_bf16 v[168:183], a[172:175], a[84:87], v[168:183]
  s_waitcnt lgkmcnt(8)
  ds_read_b64_tr_b16 a[164:165], v15 offset:29696
  ds_read_b64_tr_b16 a[166:167], v15 offset:31744
  v_mul_f32 v109, v93, v109
  v_add_f32 v34, 1.0, v34
  v_add_f32 v35, 1.0, v35
  v_mfma_f32_32x32x16_bf16 v[120:135], a[144:147], a[88:91], v[120:135]
  s_waitcnt lgkmcnt(8)
  ds_read_b64_tr_b16 a[168:169], v15 offset:28928
  ds_read_b64_tr_b16 a[170:171], v15 offset:30976
  v_rcp_f32 v34, v34
  v_mfma_f32_32x32x16_bf16 v[136:151], a[148:151], a[88:91], v[136:151]
  s_waitcnt lgkmcnt(8)
  ds_read_b64_tr_b16 a[172:173], v15 offset:29952
  s_waitcnt vmcnt(22)
  ds_read_b64_tr_b16 a[174:175], v15 offset:32000
  s_barrier
  v_rcp_f32 v35, v35
  v_mul_f32 v108, v108, v34
  v_mfma_f32_32x32x16_bf16 v[152:167], a[152:155], a[88:91], v[152:167]
  s_waitcnt lgkmcnt(8)
  ds_read_b64_tr_b16 a[144:145], v15 offset:32768
  s_add_u32 s67, s78, 0x1b0000
  ds_read_b64_tr_b16 a[146:147], v15 offset:34816
  s_add_u32 m0, s54, 0x10000
  s_nop 0
  buffer_load_dwordx4 v19, s[32:35], s67 offen lds
  v_mul_f32 v109, v109, v35
  v_mfma_f32_32x32x16_bf16 v[168:183], a[156:159], a[88:91], v[168:183]
  s_waitcnt lgkmcnt(8)
  ds_read_b64_tr_b16 a[148:149], v15 offset:33792
  ds_read_b64_tr_b16 a[150:151], v15 offset:35840
  v_cvt_pk_bf16_f32 v226, v108, v109
  v_mul_f32 v36, s83, v94
  v_mul_f32 v37, s83, v95
  v_mfma_f32_32x32x16_bf16 v[120:135], a[160:163], a[92:95], v[120:135]
  s_waitcnt lgkmcnt(8)
  ds_read_b64_tr_b16 a[152:153], v15 offset:33024
  s_add_u32 m0, s54, 0x10400
  ds_read_b64_tr_b16 a[154:155], v15 offset:35072
  v_exp_f32 v36, v36
  v_mfma_f32_32x32x16_bf16 v[136:151], a[164:167], a[92:95], v[136:151]
  s_waitcnt lgkmcnt(8)
  ds_read_b64_tr_b16 a[156:157], v15 offset:34048
  ds_read_b64_tr_b16 a[158:159], v15 offset:36096
  buffer_load_dwordx4 v19, s[44:47], s67 offen lds
  v_mfma_f32_32x32x16_bf16 v[152:167], a[168:171], a[92:95], v[152:167]
  s_waitcnt lgkmcnt(8)
  ds_read_b64_tr_b16 a[160:161], v15 offset:36864
  ds_read_b64_tr_b16 a[162:163], v15 offset:38912
  v_exp_f32 v37, v37
  v_mul_f32 v110, v94, v110
  v_mfma_f32_32x32x16_bf16 v[168:183], a[172:175], a[92:95], v[168:183]
  s_waitcnt lgkmcnt(8)
  ds_read_b64_tr_b16 a[164:165], v15 offset:37888
  s_add_u32 m0, s54, 0x10800
  ds_read_b64_tr_b16 a[166:167], v15 offset:39936
  v_mul_f32 v111, v95, v111
  v_add_f32 v36, 1.0, v36
  v_add_f32 v37, 1.0, v37
  v_mfma_f32_32x32x16_bf16 v[120:135], a[144:147], a[96:99], v[120:135]
  s_waitcnt lgkmcnt(8)
  ds_read_b64_tr_b16 a[168:169], v15 offset:37120
  ds_read_b64_tr_b16 a[170:171], v15 offset:39168
  buffer_load_dwordx4 v20, s[32:35], s67 offen lds
  v_mfma_f32_32x32x16_bf16 v[136:151], a[148:151], a[96:99], v[136:151]
  s_waitcnt lgkmcnt(8)
  ds_read_b64_tr_b16 a[172:173], v15 offset:38144
  ds_read_b64_tr_b16 a[174:175], v15 offset:40192
  v_rcp_f32 v36, v36
  v_mfma_f32_32x32x16_bf16 v[152:167], a[152:155], a[96:99], v[152:167]
  s_waitcnt lgkmcnt(8)
  ds_read_b64_tr_b16 a[144:145], v15 offset:40960
  s_add_u32 m0, s54, 0x10c00
  ds_read_b64_tr_b16 a[146:147], v15 offset:43008
  v_rcp_f32 v37, v37
  v_mul_f32 v110, v110, v36
  v_mfma_f32_32x32x16_bf16 v[168:183], a[156:159], a[96:99], v[168:183]
  s_waitcnt lgkmcnt(8)
  ds_read_b64_tr_b16 a[148:149], v15 offset:41984
  ds_read_b64_tr_b16 a[150:151], v15 offset:44032
  buffer_load_dwordx4 v20, s[44:47], s67 offen lds
  v_mul_f32 v111, v111, v37
  v_mfma_f32_32x32x16_bf16 v[120:135], a[160:163], a[100:103], v[120:135]
  s_waitcnt lgkmcnt(8)
  ds_read_b64_tr_b16 a[152:153], v15 offset:41216
  ds_read_b64_tr_b16 a[154:155], v15 offset:43264
  v_cvt_pk_bf16_f32 v227, v110, v111
  v_mul_f32 v34, s83, v96
  v_mul_f32 v35, s83, v97
  v_mfma_f32_32x32x16_bf16 v[136:151], a[164:167], a[100:103], v[136:151]
  s_waitcnt lgkmcnt(8)
  ds_read_b64_tr_b16 a[156:157], v15 offset:42240
  ds_read_b64_tr_b16 a[158:159], v15 offset:44288
  v_exp_f32 v34, v34
  v_mfma_f32_32x32x16_bf16 v[152:167], a[168:171], a[100:103], v[152:167]
  s_waitcnt lgkmcnt(8)
  ds_read_b64_tr_b16 a[160:161], v15 offset:45056
  ds_read_b64_tr_b16 a[162:163], v15 offset:47104
  v_exp_f32 v35, v35
  v_mul_f32 v112, v96, v112
  v_mfma_f32_32x32x16_bf16 v[168:183], a[172:175], a[100:103], v[168:183]
  s_waitcnt lgkmcnt(8)
  ds_read_b64_tr_b16 a[164:165], v15 offset:46080
  ds_read_b64_tr_b16 a[166:167], v15 offset:48128
  v_mul_f32 v113, v97, v113
  v_add_f32 v34, 1.0, v34
  v_add_f32 v35, 1.0, v35
  v_mfma_f32_32x32x16_bf16 v[120:135], a[144:147], a[104:107], v[120:135]
  s_waitcnt lgkmcnt(8)
  ds_read_b64_tr_b16 a[168:169], v15 offset:45312
  ds_read_b64_tr_b16 a[170:171], v15 offset:47360
  v_rcp_f32 v34, v34
  v_mfma_f32_32x32x16_bf16 v[136:151], a[148:151], a[104:107], v[136:151]
  s_waitcnt lgkmcnt(8)
  ds_read_b64_tr_b16 a[172:173], v15 offset:46336
  s_waitcnt vmcnt(20)
  ds_read_b64_tr_b16 a[174:175], v15 offset:48384
  s_barrier
  v_rcp_f32 v35, v35
  v_mul_f32 v112, v112, v34
  v_mfma_f32_32x32x16_bf16 v[152:167], a[152:155], a[104:107], v[152:167]
  s_waitcnt lgkmcnt(8)
  ds_read_b64_tr_b16 a[144:145], v15 offset:49152
  s_add_u32 s67, s78, 0x240000
  ds_read_b64_tr_b16 a[146:147], v15 offset:51200
  s_add_u32 m0, s54, 0x14000
  s_nop 0
  buffer_load_dwordx4 v19, s[32:35], s67 offen lds
  v_mul_f32 v113, v113, v35
  v_mfma_f32_32x32x16_bf16 v[168:183], a[156:159], a[104:107], v[168:183]
  s_waitcnt lgkmcnt(8)
  ds_read_b64_tr_b16 a[148:149], v15 offset:50176
  ds_read_b64_tr_b16 a[150:151], v15 offset:52224
  v_cvt_pk_bf16_f32 v228, v112, v113
  v_mul_f32 v36, s83, v98
  v_mul_f32 v37, s83, v99
  v_mfma_f32_32x32x16_bf16 v[120:135], a[160:163], a[108:111], v[120:135]
  s_waitcnt lgkmcnt(8)
  ds_read_b64_tr_b16 a[152:153], v15 offset:49408
  s_add_u32 m0, s54, 0x14400
  ds_read_b64_tr_b16 a[154:155], v15 offset:51456
  v_exp_f32 v36, v36
  v_mfma_f32_32x32x16_bf16 v[136:151], a[164:167], a[108:111], v[136:151]
  s_waitcnt lgkmcnt(8)
  ds_read_b64_tr_b16 a[156:157], v15 offset:50432
  ds_read_b64_tr_b16 a[158:159], v15 offset:52480
  buffer_load_dwordx4 v19, s[44:47], s67 offen lds
  v_mfma_f32_32x32x16_bf16 v[152:167], a[168:171], a[108:111], v[152:167]
  s_waitcnt lgkmcnt(8)
  ds_read_b64_tr_b16 a[160:161], v15 offset:53248
  ds_read_b64_tr_b16 a[162:163], v15 offset:55296
  v_exp_f32 v37, v37
  v_mul_f32 v114, v98, v114
  v_mfma_f32_32x32x16_bf16 v[168:183], a[172:175], a[108:111], v[168:183]
  s_waitcnt lgkmcnt(8)
  ds_read_b64_tr_b16 a[164:165], v15 offset:54272
  s_add_u32 m0, s54, 0x14800
  ds_read_b64_tr_b16 a[166:167], v15 offset:56320
  v_mul_f32 v115, v99, v115
  v_add_f32 v36, 1.0, v36
  v_add_f32 v37, 1.0, v37
  v_mfma_f32_32x32x16_bf16 v[120:135], a[144:147], a[112:115], v[120:135]
  s_waitcnt lgkmcnt(8)
  ds_read_b64_tr_b16 a[168:169], v15 offset:53504
  ds_read_b64_tr_b16 a[170:171], v15 offset:55552
  buffer_load_dwordx4 v20, s[32:35], s67 offen lds
  v_mfma_f32_32x32x16_bf16 v[136:151], a[148:151], a[112:115], v[136:151]
  s_waitcnt lgkmcnt(8)
  ds_read_b64_tr_b16 a[172:173], v15 offset:54528
  ds_read_b64_tr_b16 a[174:175], v15 offset:56576
  v_rcp_f32 v36, v36
  v_mfma_f32_32x32x16_bf16 v[152:167], a[152:155], a[112:115], v[152:167]
  s_waitcnt lgkmcnt(8)
  ds_read_b64_tr_b16 a[144:145], v15 offset:57344
  s_add_u32 m0, s54, 0x14c00
  ds_read_b64_tr_b16 a[146:147], v15 offset:59392
  v_rcp_f32 v37, v37
  v_mul_f32 v114, v114, v36
  v_mfma_f32_32x32x16_bf16 v[168:183], a[156:159], a[112:115], v[168:183]
  s_waitcnt lgkmcnt(8)
  ds_read_b64_tr_b16 a[148:149], v15 offset:58368
  ds_read_b64_tr_b16 a[150:151], v15 offset:60416
  buffer_load_dwordx4 v20, s[44:47], s67 offen lds
  v_mul_f32 v115, v115, v37
  v_mfma_f32_32x32x16_bf16 v[120:135], a[160:163], a[116:119], v[120:135]
  s_waitcnt lgkmcnt(8)
  ds_read_b64_tr_b16 a[152:153], v15 offset:57600
  ds_read_b64_tr_b16 a[154:155], v15 offset:59648
  v_cvt_pk_bf16_f32 v229, v114, v115
  v_mul_f32 v34, s83, v100
  v_mul_f32 v35, s83, v101
  v_mfma_f32_32x32x16_bf16 v[136:151], a[164:167], a[116:119], v[136:151]
  s_waitcnt lgkmcnt(8)
  ds_read_b64_tr_b16 a[156:157], v15 offset:58624
  ds_read_b64_tr_b16 a[158:159], v15 offset:60672
  v_exp_f32 v34, v34
  v_mfma_f32_32x32x16_bf16 v[152:167], a[168:171], a[116:119], v[152:167]
  s_waitcnt lgkmcnt(8)
  ds_read_b64_tr_b16 a[160:161], v15 offset:61440
  ds_read_b64_tr_b16 a[162:163], v15 offset:63488
  v_exp_f32 v35, v35
  v_mul_f32 v116, v100, v116
  v_mfma_f32_32x32x16_bf16 v[168:183], a[172:175], a[116:119], v[168:183]
  s_waitcnt lgkmcnt(8)
  ds_read_b64_tr_b16 a[164:165], v15 offset:62464
  ds_read_b64_tr_b16 a[166:167], v15 offset:64512
  v_mul_f32 v117, v101, v117
  v_add_f32 v34, 1.0, v34
  v_add_f32 v35, 1.0, v35
  v_mfma_f32_32x32x16_bf16 v[120:135], a[144:147], a[120:123], v[120:135]
  s_waitcnt lgkmcnt(8)
  ds_read_b64_tr_b16 a[168:169], v15 offset:61696
  ds_read_b64_tr_b16 a[170:171], v15 offset:63744
  v_rcp_f32 v34, v34
  v_mfma_f32_32x32x16_bf16 v[136:151], a[148:151], a[120:123], v[136:151]
  s_waitcnt lgkmcnt(8)
  ds_read_b64_tr_b16 a[172:173], v15 offset:62720
  s_waitcnt vmcnt(20)
  ds_read_b64_tr_b16 a[174:175], v15 offset:64768
  s_barrier
  v_rcp_f32 v35, v35
  v_mul_f32 v116, v116, v34
  v_mfma_f32_32x32x16_bf16 v[152:167], a[152:155], a[120:123], v[152:167]
  s_waitcnt lgkmcnt(8)
  ds_read_b64_tr_b16 a[144:145], v14
  s_add_u32 s67, s78, 0x2d0000
  ds_read_b64_tr_b16 a[146:147], v14 offset:2048
  s_add_u32 m0, s54, 0x18000
  s_nop 0
  buffer_load_dwordx4 v19, s[32:35], s67 offen lds
  v_mul_f32 v117, v117, v35
  v_mfma_f32_32x32x16_bf16 v[168:183], a[156:159], a[120:123], v[168:183]
  s_waitcnt lgkmcnt(8)
  ds_read_b64_tr_b16 a[148:149], v14 offset:1024
  ds_read_b64_tr_b16 a[150:151], v14 offset:3072
  v_cvt_pk_bf16_f32 v230, v116, v117
  v_mul_f32 v36, s83, v102
  v_mul_f32 v37, s83, v103
  v_mfma_f32_32x32x16_bf16 v[120:135], a[160:163], a[124:127], v[120:135]
  s_waitcnt lgkmcnt(8)
  ds_read_b64_tr_b16 a[152:153], v14 offset:256
  s_add_u32 m0, s54, 0x18400
  ds_read_b64_tr_b16 a[154:155], v14 offset:2304
  v_exp_f32 v36, v36
  v_mfma_f32_32x32x16_bf16 v[136:151], a[164:167], a[124:127], v[136:151]
  s_waitcnt lgkmcnt(8)
  ds_read_b64_tr_b16 a[156:157], v14 offset:1280
  ds_read_b64_tr_b16 a[158:159], v14 offset:3328
  buffer_load_dwordx4 v19, s[44:47], s67 offen lds
  v_mfma_f32_32x32x16_bf16 v[152:167], a[168:171], a[124:127], v[152:167]
  s_waitcnt lgkmcnt(8)
  ds_read_b64_tr_b16 a[160:161], v14 offset:4096
  ds_read_b64_tr_b16 a[162:163], v14 offset:6144
  v_exp_f32 v37, v37
  v_mul_f32 v118, v102, v118
  v_mfma_f32_32x32x16_bf16 v[168:183], a[172:175], a[124:127], v[168:183]
  s_waitcnt lgkmcnt(8)
  ds_read_b64_tr_b16 a[164:165], v14 offset:5120
  s_add_u32 m0, s54, 0x18800
  ds_read_b64_tr_b16 a[166:167], v14 offset:7168
  v_mul_f32 v119, v103, v119
  v_add_f32 v36, 1.0, v36
  v_add_f32 v37, 1.0, v37
  v_mfma_f32_32x32x16_bf16 v[120:135], a[144:147], a[128:131], v[120:135]
  s_waitcnt lgkmcnt(8)
  ds_read_b64_tr_b16 a[168:169], v14 offset:4352
  ds_read_b64_tr_b16 a[170:171], v14 offset:6400
  buffer_load_dwordx4 v20, s[32:35], s67 offen lds
  v_mfma_f32_32x32x16_bf16 v[136:151], a[148:151], a[128:131], v[136:151]
  s_waitcnt lgkmcnt(8)
  ds_read_b64_tr_b16 a[172:173], v14 offset:5376
  ds_read_b64_tr_b16 a[174:175], v14 offset:7424
  v_rcp_f32 v36, v36
  v_mfma_f32_32x32x16_bf16 v[152:167], a[152:155], a[128:131], v[152:167]
  s_waitcnt lgkmcnt(8)
  ds_read_b64_tr_b16 a[144:145], v14 offset:8192
  s_add_u32 m0, s54, 0x18c00
  ds_read_b64_tr_b16 a[146:147], v14 offset:10240
  v_rcp_f32 v37, v37
  v_mul_f32 v118, v118, v36
  v_mfma_f32_32x32x16_bf16 v[168:183], a[156:159], a[128:131], v[168:183]
  s_waitcnt lgkmcnt(8)
  ds_read_b64_tr_b16 a[148:149], v14 offset:9216
  ds_read_b64_tr_b16 a[150:151], v14 offset:11264
  buffer_load_dwordx4 v20, s[44:47], s67 offen lds
  v_mul_f32 v119, v119, v37
  v_mfma_f32_32x32x16_bf16 v[120:135], a[160:163], a[132:135], v[120:135]
  s_waitcnt lgkmcnt(8)
  ds_read_b64_tr_b16 a[152:153], v14 offset:8448
  ds_read_b64_tr_b16 a[154:155], v14 offset:10496
  v_cvt_pk_bf16_f32 v231, v118, v119
  v_mfma_f32_32x32x16_bf16 v[136:151], a[164:167], a[132:135], v[136:151]
  s_waitcnt lgkmcnt(8)
  ds_read_b64_tr_b16 a[156:157], v14 offset:9472
  ds_read_b64_tr_b16 a[158:159], v14 offset:11520
  v_mfma_f32_32x32x16_bf16 v[152:167], a[168:171], a[132:135], v[152:167]
  s_waitcnt lgkmcnt(8)
  ds_read_b64_tr_b16 a[160:161], v14 offset:12288
  ds_read_b64_tr_b16 a[162:163], v14 offset:14336
  v_mfma_f32_32x32x16_bf16 v[168:183], a[172:175], a[132:135], v[168:183]
  s_waitcnt lgkmcnt(8)
  ds_read_b64_tr_b16 a[164:165], v14 offset:13312
  ds_read_b64_tr_b16 a[166:167], v14 offset:15360
  v_mfma_f32_32x32x16_bf16 v[120:135], a[144:147], a[136:139], v[120:135]
  s_waitcnt lgkmcnt(8)
  ds_read_b64_tr_b16 a[168:169], v14 offset:12544
  ds_read_b64_tr_b16 a[170:171], v14 offset:14592
  v_mfma_f32_32x32x16_bf16 v[136:151], a[148:151], a[136:139], v[136:151]
  s_waitcnt lgkmcnt(8)
  ds_read_b64_tr_b16 a[172:173], v14 offset:13568
  s_waitcnt vmcnt(20)
  ds_read_b64_tr_b16 a[174:175], v14 offset:15616
  s_barrier
  v_mfma_f32_32x32x16_bf16 v[152:167], a[152:155], a[136:139], v[152:167]
  s_waitcnt lgkmcnt(8)
  ds_read_b64_tr_b16 a[144:145], v28 offset:16384
  s_add_u32 s67, s78, 0x360000
  ds_read_b64_tr_b16 a[146:147], v28 offset:18432
  s_add_u32 m0, s54, 0x1c000
  s_nop 0
  buffer_load_dwordx4 v19, s[32:35], s67 offen lds
  v_mfma_f32_32x32x16_bf16 v[168:183], a[156:159], a[136:139], v[168:183]
  s_waitcnt lgkmcnt(8)
  ds_read_b64_tr_b16 a[148:149], v28 offset:17408
  ds_read_b64_tr_b16 a[150:151], v28 offset:19456
  v_mfma_f32_32x32x16_bf16 v[120:135], a[160:163], a[140:143], v[120:135]
  s_waitcnt lgkmcnt(8)
  ds_read_b64_tr_b16 a[152:153], v28 offset:20480
  s_add_u32 m0, s54, 0x1c400
  ds_read_b64_tr_b16 a[154:155], v28 offset:22528
  v_mfma_f32_32x32x16_bf16 v[136:151], a[164:167], a[140:143], v[136:151]
  s_waitcnt lgkmcnt(8)
  ds_read_b64_tr_b16 a[156:157], v28 offset:21504
  ds_read_b64_tr_b16 a[158:159], v28 offset:23552
  buffer_load_dwordx4 v19, s[44:47], s67 offen lds
  v_mfma_f32_32x32x16_bf16 v[152:167], a[168:171], a[140:143], v[152:167]
  s_waitcnt lgkmcnt(8)
  ds_read_b64_tr_b16 a[160:161], v28 offset:24576
  ds_read_b64_tr_b16 a[162:163], v28 offset:26624
  v_mfma_f32_32x32x16_bf16 v[168:183], a[172:175], a[140:143], v[168:183]
  s_waitcnt lgkmcnt(8)
  ds_read_b64_tr_b16 a[164:165], v28 offset:25600
  s_add_u32 m0, s54, 0x1c800
  ds_read_b64_tr_b16 a[166:167], v28 offset:27648
  v_mfma_f32_32x32x16_bf16 v[56:71], a[144:147], a[0:3], 0
  s_waitcnt lgkmcnt(8)
  ds_read_b64_tr_b16 a[168:169], v28 offset:28672
  ds_read_b64_tr_b16 a[170:171], v28 offset:30720
  buffer_load_dwordx4 v20, s[32:35], s67 offen lds
  v_mfma_f32_32x32x16_bf16 v[72:87], a[148:151], a[0:3], 0
  s_waitcnt lgkmcnt(8)
  ds_read_b64_tr_b16 a[172:173], v28 offset:29696
  s_waitcnt vmcnt(19)
  ds_read_b64_tr_b16 a[174:175], v28 offset:31744
  s_barrier
  v_mfma_f32_32x32x16_bf16 v[56:71], a[152:155], a[4:7], v[56:71]
  s_waitcnt lgkmcnt(8)
  ds_read_b64_tr_b16 a[144:145], v28 offset:32768
  s_add_u32 m0, s54, 0x1cc00
  ds_read_b64_tr_b16 a[146:147], v28 offset:34816
  v_mul_f32 v34, s83, v120
  v_mul_f32 v35, s83, v121
  v_mfma_f32_32x32x16_bf16 v[72:87], a[156:159], a[4:7], v[72:87]
  s_waitcnt lgkmcnt(8)
  ds_read_b64_tr_b16 a[148:149], v28 offset:33792
  ds_read_b64_tr_b16 a[150:151], v28 offset:35840
  buffer_load_dwordx4 v20, s[44:47], s67 offen lds
  v_mfma_f32_32x32x16_bf16 v[56:71], a[160:163], a[8:11], v[56:71]
  s_waitcnt lgkmcnt(8)
  ds_read_b64_tr_b16 a[152:153], v28 offset:36864
  ds_read_b64_tr_b16 a[154:155], v28 offset:38912
  v_exp_f32 v34, v34
  v_mfma_f32_32x32x16_bf16 v[72:87], a[164:167], a[8:11], v[72:87]
  s_waitcnt lgkmcnt(8)
  ds_read_b64_tr_b16 a[156:157], v28 offset:37888
  s_add_u32 s67, s78, 0x3f0000
  ds_read_b64_tr_b16 a[158:159], v28 offset:39936
  s_add_u32 m0, s54, 0
  v_exp_f32 v35, v35
  v_mul_f32 v136, v120, v136
  v_mfma_f32_32x32x16_bf16 v[56:71], a[168:171], a[12:15], v[56:71]
  s_waitcnt lgkmcnt(8)
  ds_read_b64_tr_b16 a[160:161], v28 offset:40960
  ds_read_b64_tr_b16 a[162:163], v28 offset:43008
  buffer_load_dwordx4 v19, s[32:35], s67 offen lds
  s_add_u32 m0, s54, 0x400
  v_mul_f32 v137, v121, v137
  v_mfma_f32_32x32x16_bf16 v[72:87], a[172:175], a[12:15], v[72:87]
  s_waitcnt lgkmcnt(8)
  ds_read_b64_tr_b16 a[164:165], v28 offset:41984
  ds_read_b64_tr_b16 a[166:167], v28 offset:44032
  buffer_load_dwordx4 v19, s[44:47], s67 offen lds
  s_add_u32 m0, s54, 0x800
  v_add_f32 v34, 1.0, v34
  v_mfma_f32_32x32x16_bf16 v[56:71], a[144:147], a[16:19], v[56:71]
  s_waitcnt lgkmcnt(8)
  ds_read_b64_tr_b16 a[168:169], v28 offset:45056
  ds_read_b64_tr_b16 a[170:171], v28 offset:47104
  buffer_load_dwordx4 v20, s[32:35], s67 offen lds
  s_add_u32 m0, s54, 0xc00
  v_add_f32 v35, 1.0, v35
  v_mfma_f32_32x32x16_bf16 v[72:87], a[148:151], a[16:19], v[72:87]
  s_waitcnt lgkmcnt(8)
  ds_read_b64_tr_b16 a[172:173], v28 offset:46080
  s_waitcnt vmcnt(19)
  ds_read_b64_tr_b16 a[174:175], v28 offset:48128
  s_barrier
  buffer_load_dwordx4 v20, s[44:47], s67 offen lds
  v_mfma_f32_32x32x16_bf16 v[56:71], a[152:155], a[20:23], v[56:71]
  s_waitcnt lgkmcnt(8)
  ds_read_b64_tr_b16 a[144:145], v28 offset:49152
  s_add_u32 s67, s78, 0x480000
  ds_read_b64_tr_b16 a[146:147], v28 offset:51200
  s_add_u32 m0, s54, 0x4000
  s_nop 0
  buffer_load_dwordx4 v19, s[32:35], s67 offen lds
  v_mfma_f32_32x32x16_bf16 v[72:87], a[156:159], a[20:23], v[72:87]
  s_waitcnt lgkmcnt(8)
  ds_read_b64_tr_b16 a[148:149], v28 offset:50176
  ds_read_b64_tr_b16 a[150:151], v28 offset:52224
  v_rcp_f32 v34, v34
  v_mfma_f32_32x32x16_bf16 v[56:71], a[160:163], a[24:27], v[56:71]
  s_waitcnt lgkmcnt(8)
  ds_read_b64_tr_b16 a[152:153], v28 offset:53248
  s_add_u32 m0, s54, 0x4400
  ds_read_b64_tr_b16 a[154:155], v28 offset:55296
  v_rcp_f32 v35, v35
  v_mul_f32 v136, v136, v34
  v_mfma_f32_32x32x16_bf16 v[72:87], a[164:167], a[24:27], v[72:87]
  s_waitcnt lgkmcnt(8)
  ds_read_b64_tr_b16 a[156:157], v28 offset:54272
  ds_read_b64_tr_b16 a[158:159], v28 offset:56320
  buffer_load_dwordx4 v19, s[44:47], s67 offen lds
  v_mul_f32 v137, v137, v35
  v_mfma_f32_32x32x16_bf16 v[56:71], a[168:171], a[28:31], v[56:71]
  s_waitcnt lgkmcnt(8)
  ds_read_b64_tr_b16 a[160:161], v28 offset:57344
  ds_read_b64_tr_b16 a[162:163], v28 offset:59392
  v_cvt_pk_bf16_f32 v232, v136, v137
  v_mul_f32 v36, s83, v122
  v_mul_f32 v37, s83, v123
  v_mfma_f32_32x32x16_bf16 v[72:87], a[172:175], a[28:31], v[72:87]
  s_waitcnt lgkmcnt(8)
  ds_read_b64_tr_b16 a[164:165], v28 offset:58368
  s_add_u32 m0, s54, 0x4800
  ds_read_b64_tr_b16 a[166:167], v28 offset:60416
  v_exp_f32 v36, v36
  v_mfma_f32_32x32x16_bf16 v[56:71], a[144:147], a[32:35], v[56:71]
  s_waitcnt lgkmcnt(8)
  ds_read_b64_tr_b16 a[168:169], v28 offset:61440
  ds_read_b64_tr_b16 a[170:171], v28 offset:63488
  buffer_load_dwordx4 v20, s[32:35], s67 offen lds
  v_mfma_f32_32x32x16_bf16 v[72:87], a[148:151], a[32:35], v[72:87]
  s_waitcnt lgkmcnt(8)
  ds_read_b64_tr_b16 a[172:173], v28 offset:62464
  s_waitcnt vmcnt(19)
  ds_read_b64_tr_b16 a[174:175], v28 offset:64512
  s_barrier
  v_exp_f32 v37, v37
  v_mul_f32 v138, v122, v138
  v_mfma_f32_32x32x16_bf16 v[56:71], a[152:155], a[36:39], v[56:71]
  s_waitcnt lgkmcnt(8)
  ds_read_b64_tr_b16 a[144:145], v29
  s_add_u32 m0, s54, 0x4c00
  ds_read_b64_tr_b16 a[146:147], v29 offset:2048
  v_mul_f32 v139, v123, v139
  v_add_f32 v36, 1.0, v36
  v_add_f32 v37, 1.0, v37
  v_mfma_f32_32x32x16_bf16 v[72:87], a[156:159], a[36:39], v[72:87]
  s_waitcnt lgkmcnt(8)
  ds_read_b64_tr_b16 a[148:149], v29 offset:1024
  ds_read_b64_tr_b16 a[150:151], v29 offset:3072
  buffer_load_dwordx4 v20, s[44:47], s67 offen lds
  v_mfma_f32_32x32x16_bf16 v[56:71], a[160:163], a[40:43], v[56:71]
  s_waitcnt lgkmcnt(8)
  ds_read_b64_tr_b16 a[152:153], v29 offset:4096
  ds_read_b64_tr_b16 a[154:155], v29 offset:6144
  v_rcp_f32 v36, v36
  v_mfma_f32_32x32x16_bf16 v[72:87], a[164:167], a[40:43], v[72:87]
  s_waitcnt lgkmcnt(8)
  ds_read_b64_tr_b16 a[156:157], v29 offset:5120
  s_add_u32 s67, s79, 0
  ds_read_b64_tr_b16 a[158:159], v29 offset:7168
  s_add_u32 m0, s55, 0x8000
  v_rcp_f32 v37, v37
  v_mul_f32 v138, v138, v36
  v_mfma_f32_32x32x16_bf16 v[56:71], a[168:171], a[44:47], v[56:71]
  s_waitcnt lgkmcnt(8)
  ds_read_b64_tr_b16 a[160:161], v29 offset:8192
  ds_read_b64_tr_b16 a[162:163], v29 offset:10240
  buffer_load_dwordx4 v22, s[24:27], s67 offen lds
  s_add_u32 m0, s55, 0x8400
  v_mul_f32 v139, v139, v37
  v_mfma_f32_32x32x16_bf16 v[72:87], a[172:175], a[44:47], v[72:87]
  s_waitcnt lgkmcnt(8)
  ds_read_b64_tr_b16 a[164:165], v29 offset:9216
  ds_read_b64_tr_b16 a[166:167], v29 offset:11264
  buffer_load_dwordx4 v23, s[24:27], s67 offen lds
  s_add_u32 m0, s55, 0x8800
  v_cvt_pk_bf16_f32 v233, v138, v139
  v_mfma_f32_32x32x16_bf16 v[56:71], a[144:147], a[48:51], v[56:71]
  s_waitcnt lgkmcnt(8)
  ds_read_b64_tr_b16 a[168:169], v29 offset:12288
  ds_read_b64_tr_b16 a[170:171], v29 offset:14336
  buffer_load_dwordx4 v24, s[24:27], s67 offen lds
  v_mul_f32 v34, s83, v124
  v_mfma_f32_32x32x16_bf16 v[72:87], a[148:151], a[48:51], v[72:87]
  s_waitcnt lgkmcnt(8)
  ds_read_b64_tr_b16 a[172:173], v29 offset:13312
  s_waitcnt vmcnt(19)
  ds_read_b64_tr_b16 a[174:175], v29 offset:15360
  s_barrier
  v_mul_f32 v35, s83, v125
  v_exp_f32 v34, v34
  v_mfma_f32_32x32x16_bf16 v[56:71], a[152:155], a[52:55], v[56:71]
  s_waitcnt lgkmcnt(8)
  ds_read_b64_tr_b16 a[144:145], v29 offset:16384
  s_add_u32 s67, s79, 0x1b000
  ds_read_b64_tr_b16 a[146:147], v29 offset:18432
  s_add_u32 m0, s55, 0xc000
  s_nop 0
  buffer_load_dwordx4 v22, s[24:27], s67 offen lds
  v_mfma_f32_32x32x16_bf16 v[72:87], a[156:159], a[52:55], v[72:87]
  s_waitcnt lgkmcnt(8)
  ds_read_b64_tr_b16 a[148:149], v29 offset:17408
  ds_read_b64_tr_b16 a[150:151], v29 offset:19456
  v_exp_f32 v35, v35
  v_mul_f32 v140, v124, v140
  v_mfma_f32_32x32x16_bf16 v[56:71], a[160:163], a[56:59], v[56:71]
  s_waitcnt lgkmcnt(8)
  ds_read_b64_tr_b16 a[152:153], v29 offset:20480
  s_add_u32 m0, s55, 0xc400
  ds_read_b64_tr_b16 a[154:155], v29 offset:22528
  v_mul_f32 v141, v125, v141
  v_add_f32 v34, 1.0, v34
  v_add_f32 v35, 1.0, v35
  v_mfma_f32_32x32x16_bf16 v[72:87], a[164:167], a[56:59], v[72:87]
  s_waitcnt lgkmcnt(8)
  ds_read_b64_tr_b16 a[156:157], v29 offset:21504
  ds_read_b64_tr_b16 a[158:159], v29 offset:23552
  buffer_load_dwordx4 v23, s[24:27], s67 offen lds
  v_mfma_f32_32x32x16_bf16 v[56:71], a[168:171], a[60:63], v[56:71]
  s_waitcnt lgkmcnt(8)
  ds_read_b64_tr_b16 a[160:161], v29 offset:24576
  ds_read_b64_tr_b16 a[162:163], v29 offset:26624
  v_rcp_f32 v34, v34
  v_mfma_f32_32x32x16_bf16 v[72:87], a[172:175], a[60:63], v[72:87]
  s_waitcnt lgkmcnt(8)
  ds_read_b64_tr_b16 a[164:165], v29 offset:25600
  s_add_u32 m0, s55, 0xc800
  ds_read_b64_tr_b16 a[166:167], v29 offset:27648
  v_rcp_f32 v35, v35
  v_mul_f32 v140, v140, v34
  v_mfma_f32_32x32x16_bf16 v[56:71], a[144:147], a[64:67], v[56:71]
  s_waitcnt lgkmcnt(8)
  ds_read_b64_tr_b16 a[168:169], v29 offset:28672
  ds_read_b64_tr_b16 a[170:171], v29 offset:30720
  buffer_load_dwordx4 v24, s[24:27], s67 offen lds
  v_mul_f32 v141, v141, v35
  v_mfma_f32_32x32x16_bf16 v[72:87], a[148:151], a[64:67], v[72:87]
  s_waitcnt lgkmcnt(8)
  ds_read_b64_tr_b16 a[172:173], v29 offset:29696
  s_waitcnt vmcnt(18)
  ds_read_b64_tr_b16 a[174:175], v29 offset:31744
  s_barrier
  v_cvt_pk_bf16_f32 v234, v140, v141
  v_mul_f32 v36, s83, v126
  v_mul_f32 v37, s83, v127
  v_mfma_f32_32x32x16_bf16 v[56:71], a[152:155], a[68:71], v[56:71]
  s_waitcnt lgkmcnt(8)
  ds_read_b64_tr_b16 a[144:145], v29 offset:32768
  s_add_u32 s67, s80, 0
  ds_read_b64_tr_b16 a[146:147], v29 offset:34816
  s_add_u32 m0, s55, 0x10000
  v_exp_f32 v36, v36
  v_mfma_f32_32x32x16_bf16 v[72:87], a[156:159], a[68:71], v[72:87]
  s_waitcnt lgkmcnt(8)
  ds_read_b64_tr_b16 a[148:149], v29 offset:33792
  ds_read_b64_tr_b16 a[150:151], v29 offset:35840
  buffer_load_dwordx4 v25, s[24:27], s67 offen lds
  s_add_u32 m0, s55, 0x10400
  v_mfma_f32_32x32x16_bf16 v[56:71], a[160:163], a[72:75], v[56:71]
  s_waitcnt lgkmcnt(8)
  ds_read_b64_tr_b16 a[152:153], v29 offset:36864
  ds_read_b64_tr_b16 a[154:155], v29 offset:38912
  buffer_load_dwordx4 v26, s[24:27], s67 offen lds
  s_add_u32 m0, s55, 0x10800
  v_mfma_f32_32x32x16_bf16 v[72:87], a[164:167], a[72:75], v[72:87]
  s_waitcnt lgkmcnt(8)
  ds_read_b64_tr_b16 a[156:157], v29 offset:37888
  ds_read_b64_tr_b16 a[158:159], v29 offset:39936
  buffer_load_dwordx4 v27, s[24:27], s67 offen lds
  v_mfma_f32_32x32x16_bf16 v[56:71], a[168:171], a[76:79], v[56:71]
  s_waitcnt lgkmcnt(8)
  ds_read_b64_tr_b16 a[160:161], v29 offset:40960
  ds_read_b64_tr_b16 a[162:163], v29 offset:43008
  v_exp_f32 v37, v37
  v_mul_f32 v142, v126, v142
  v_mfma_f32_32x32x16_bf16 v[72:87], a[172:175], a[76:79], v[72:87]
  s_waitcnt lgkmcnt(8)
  ds_read_b64_tr_b16 a[164:165], v29 offset:41984
  ds_read_b64_tr_b16 a[166:167], v29 offset:44032
  v_mul_f32 v143, v127, v143
  v_add_f32 v36, 1.0, v36
  v_add_f32 v37, 1.0, v37
  v_mfma_f32_32x32x16_bf16 v[56:71], a[144:147], a[80:83], v[56:71]
  s_waitcnt lgkmcnt(8)
  ds_read_b64_tr_b16 a[168:169], v29 offset:45056
  ds_read_b64_tr_b16 a[170:171], v29 offset:47104
  v_rcp_f32 v36, v36
  v_mfma_f32_32x32x16_bf16 v[72:87], a[148:151], a[80:83], v[72:87]
  s_waitcnt lgkmcnt(8)
  ds_read_b64_tr_b16 a[172:173], v29 offset:46080
  s_waitcnt vmcnt(17)
  ds_read_b64_tr_b16 a[174:175], v29 offset:48128
  s_barrier
  v_rcp_f32 v37, v37
  v_mul_f32 v142, v142, v36
  v_mfma_f32_32x32x16_bf16 v[56:71], a[152:155], a[84:87], v[56:71]
  s_waitcnt lgkmcnt(8)
  ds_read_b64_tr_b16 a[144:145], v29 offset:49152
  s_add_u32 s67, s79, 0x80
  ds_read_b64_tr_b16 a[146:147], v29 offset:51200
  s_add_u32 m0, s55, 0x14000
  s_nop 0
  buffer_load_dwordx4 v22, s[24:27], s67 offen lds
  v_mul_f32 v143, v143, v37
  v_mfma_f32_32x32x16_bf16 v[72:87], a[156:159], a[84:87], v[72:87]
  s_waitcnt lgkmcnt(8)
  ds_read_b64_tr_b16 a[148:149], v29 offset:50176
  ds_read_b64_tr_b16 a[150:151], v29 offset:52224
  v_cvt_pk_bf16_f32 v235, v142, v143
  v_mul_f32 v34, s83, v128
  v_mul_f32 v35, s83, v129
  v_mfma_f32_32x32x16_bf16 v[56:71], a[160:163], a[88:91], v[56:71]
  s_waitcnt lgkmcnt(8)
  ds_read_b64_tr_b16 a[152:153], v29 offset:53248
  s_add_u32 m0, s55, 0x14400
  ds_read_b64_tr_b16 a[154:155], v29 offset:55296
  v_exp_f32 v34, v34
  v_mfma_f32_32x32x16_bf16 v[72:87], a[164:167], a[88:91], v[72:87]
  s_waitcnt lgkmcnt(8)
  ds_read_b64_tr_b16 a[156:157], v29 offset:54272
  ds_read_b64_tr_b16 a[158:159], v29 offset:56320
  buffer_load_dwordx4 v23, s[24:27], s67 offen lds
  v_mfma_f32_32x32x16_bf16 v[56:71], a[168:171], a[92:95], v[56:71]
  s_waitcnt lgkmcnt(8)
  ds_read_b64_tr_b16 a[160:161], v29 offset:57344
  ds_read_b64_tr_b16 a[162:163], v29 offset:59392
  v_exp_f32 v35, v35
  v_mul_f32 v144, v128, v144
  v_mfma_f32_32x32x16_bf16 v[72:87], a[172:175], a[92:95], v[72:87]
  s_waitcnt lgkmcnt(8)
  ds_read_b64_tr_b16 a[164:165], v29 offset:58368
  s_add_u32 m0, s55, 0x14800
  ds_read_b64_tr_b16 a[166:167], v29 offset:60416
  v_mul_f32 v145, v129, v145
  v_add_f32 v34, 1.0, v34
  v_add_f32 v35, 1.0, v35
  v_mfma_f32_32x32x16_bf16 v[56:71], a[144:147], a[96:99], v[56:71]
  s_waitcnt lgkmcnt(8)
  ds_read_b64_tr_b16 a[168:169], v29 offset:61440
  ds_read_b64_tr_b16 a[170:171], v29 offset:63488
  buffer_load_dwordx4 v24, s[24:27], s67 offen lds
  v_mfma_f32_32x32x16_bf16 v[72:87], a[148:151], a[96:99], v[72:87]
  s_waitcnt lgkmcnt(8)
  ds_read_b64_tr_b16 a[172:173], v29 offset:62464
  s_waitcnt vmcnt(16)
  ds_read_b64_tr_b16 a[174:175], v29 offset:64512
  s_barrier
  v_rcp_f32 v34, v34
  v_mfma_f32_32x32x16_bf16 v[56:71], a[152:155], a[100:103], v[56:71]
  s_waitcnt lgkmcnt(8)
  ds_read_b64_tr_b16 a[144:145], v28
  s_add_u32 s67, s79, 0x1b080
  ds_read_b64_tr_b16 a[146:147], v28 offset:2048
  s_add_u32 m0, s55, 0x18000
  v_rcp_f32 v35, v35
  v_mul_f32 v144, v144, v34
  v_mfma_f32_32x32x16_bf16 v[72:87], a[156:159], a[100:103], v[72:87]
  s_waitcnt lgkmcnt(8)
  ds_read_b64_tr_b16 a[148:149], v28 offset:1024
  ds_read_b64_tr_b16 a[150:151], v28 offset:3072
  buffer_load_dwordx4 v22, s[24:27], s67 offen lds
  s_add_u32 m0, s55, 0x18400
  v_mul_f32 v145, v145, v35
  v_mfma_f32_32x32x16_bf16 v[56:71], a[160:163], a[104:107], v[56:71]
  s_waitcnt lgkmcnt(8)
  ds_read_b64_tr_b16 a[152:153], v28 offset:4096
  ds_read_b64_tr_b16 a[154:155], v28 offset:6144
  buffer_load_dwordx4 v23, s[24:27], s67 offen lds
  s_add_u32 m0, s55, 0x18800
  v_cvt_pk_bf16_f32 v236, v144, v145
  v_mfma_f32_32x32x16_bf16 v[72:87], a[164:167], a[104:107], v[72:87]
  s_waitcnt lgkmcnt(8)
  ds_read_b64_tr_b16 a[156:157], v28 offset:5120
  ds_read_b64_tr_b16 a[158:159], v28 offset:7168
  buffer_load_dwordx4 v24, s[24:27], s67 offen lds
  v_mul_f32 v36, s83, v130
  v_mfma_f32_32x32x16_bf16 v[56:71], a[168:171], a[108:111], v[56:71]
  s_waitcnt lgkmcnt(8)
  ds_read_b64_tr_b16 a[160:161], v28 offset:8192
  ds_read_b64_tr_b16 a[162:163], v28 offset:10240
  v_mul_f32 v37, s83, v131
  v_exp_f32 v36, v36
  v_mfma_f32_32x32x16_bf16 v[72:87], a[172:175], a[108:111], v[72:87]
  s_waitcnt lgkmcnt(8)
  ds_read_b64_tr_b16 a[164:165], v28 offset:9216
  ds_read_b64_tr_b16 a[166:167], v28 offset:11264
  v_exp_f32 v37, v37
  v_mul_f32 v146, v130, v146
  v_mfma_f32_32x32x16_bf16 v[56:71], a[144:147], a[112:115], v[56:71]
  s_waitcnt lgkmcnt(8)
  ds_read_b64_tr_b16 a[168:169], v28 offset:12288
  ds_read_b64_tr_b16 a[170:171], v28 offset:14336
  v_mul_f32 v147, v131, v147
  v_add_f32 v36, 1.0, v36
  v_add_f32 v37, 1.0, v37
  v_mfma_f32_32x32x16_bf16 v[72:87], a[148:151], a[112:115], v[72:87]
  s_waitcnt lgkmcnt(8)
  ds_read_b64_tr_b16 a[172:173], v28 offset:13312
  s_waitcnt vmcnt(15)
  ds_read_b64_tr_b16 a[174:175], v28 offset:15360
  s_barrier
  v_rcp_f32 v36, v36
  v_mfma_f32_32x32x16_bf16 v[56:71], a[152:155], a[116:119], v[56:71]
  s_waitcnt lgkmcnt(8)
  ds_read_b64_tr_b16 a[144:145], v28 offset:16384
  s_add_u32 s67, s80, 0x80
  ds_read_b64_tr_b16 a[146:147], v28 offset:18432
  s_add_u32 m0, s55, 0x1c000
  s_nop 0
  buffer_load_dwordx4 v25, s[24:27], s67 offen lds
  v_mfma_f32_32x32x16_bf16 v[72:87], a[156:159], a[116:119], v[72:87]
  s_waitcnt lgkmcnt(8)
  ds_read_b64_tr_b16 a[148:149], v28 offset:17408
  ds_read_b64_tr_b16 a[150:151], v28 offset:19456
  v_rcp_f32 v37, v37
  v_mul_f32 v146, v146, v36
  v_mfma_f32_32x32x16_bf16 v[56:71], a[160:163], a[120:123], v[56:71]
  s_waitcnt lgkmcnt(8)
  ds_read_b64_tr_b16 a[152:153], v28 offset:20480
  s_add_u32 m0, s55, 0x1c400
  ds_read_b64_tr_b16 a[154:155], v28 offset:22528
  v_mul_f32 v147, v147, v37
  v_cvt_pk_bf16_f32 v237, v146, v147
  v_mul_f32 v34, s83, v132
  v_mfma_f32_32x32x16_bf16 v[72:87], a[164:167], a[120:123], v[72:87]
  s_waitcnt lgkmcnt(8)
  ds_read_b64_tr_b16 a[156:157], v28 offset:21504
  ds_read_b64_tr_b16 a[158:159], v28 offset:23552
  buffer_load_dwordx4 v26, s[24:27], s67 offen lds
  v_mul_f32 v35, s83, v133
  v_mfma_f32_32x32x16_bf16 v[56:71], a[168:171], a[124:127], v[56:71]
  s_waitcnt lgkmcnt(8)
  ds_read_b64_tr_b16 a[160:161], v28 offset:24576
  ds_read_b64_tr_b16 a[162:163], v28 offset:26624
  v_exp_f32 v34, v34
  v_mfma_f32_32x32x16_bf16 v[72:87], a[172:175], a[124:127], v[72:87]
  s_waitcnt lgkmcnt(8)
  ds_read_b64_tr_b16 a[164:165], v28 offset:25600
  s_add_u32 m0, s55, 0x1c800
  ds_read_b64_tr_b16 a[166:167], v28 offset:27648
  v_exp_f32 v35, v35
  v_mul_f32 v148, v132, v148
  v_mfma_f32_32x32x16_bf16 v[56:71], a[144:147], a[128:131], v[56:71]
  s_waitcnt lgkmcnt(8)
  ds_read_b64_tr_b16 a[168:169], v28 offset:28672
  ds_read_b64_tr_b16 a[170:171], v28 offset:30720
  buffer_load_dwordx4 v27, s[24:27], s67 offen lds
  v_mul_f32 v149, v133, v149
  v_mfma_f32_32x32x16_bf16 v[72:87], a[148:151], a[128:131], v[72:87]
  s_waitcnt lgkmcnt(8)
  ds_read_b64_tr_b16 a[172:173], v28 offset:29696
  s_waitcnt vmcnt(15)
  ds_read_b64_tr_b16 a[174:175], v28 offset:31744
  s_barrier
  v_add_f32 v34, 1.0, v34
  v_add_f32 v35, 1.0, v35
  v_mfma_f32_32x32x16_bf16 v[56:71], a[152:155], a[132:135], v[56:71]
  s_waitcnt lgkmcnt(8)
  ds_read_b64_tr_b16 a[144:145], v14 offset:32768
  s_add_u32 s67, s79, 0x100
  ds_read_b64_tr_b16 a[146:147], v14 offset:33792
  s_add_u32 m0, s55, 0
  v_rcp_f32 v34, v34
  v_mfma_f32_32x32x16_bf16 v[72:87], a[156:159], a[132:135], v[72:87]
  s_waitcnt lgkmcnt(8)
  ds_read_b64_tr_b16 a[148:149], v14 offset:33024
  ds_read_b64_tr_b16 a[150:151], v14 offset:34048
  buffer_load_dwordx4 v22, s[24:27], s67 offen lds
  s_add_u32 m0, s55, 0x400
  v_mfma_f32_32x32x16_bf16 v[56:71], a[160:163], a[136:139], v[56:71]
  s_waitcnt lgkmcnt(8)
  ds_read_b64_tr_b16 a[152:153], v14 offset:34816
  ds_read_b64_tr_b16 a[154:155], v14 offset:35840
  buffer_load_dwordx4 v23, s[24:27], s67 offen lds
  s_add_u32 m0, s55, 0x800
  v_mfma_f32_32x32x16_bf16 v[72:87], a[164:167], a[136:139], v[72:87]
  s_waitcnt lgkmcnt(8)
  ds_read_b64_tr_b16 a[156:157], v14 offset:35072
  ds_read_b64_tr_b16 a[158:159], v14 offset:36096
  buffer_load_dwordx4 v24, s[24:27], s67 offen lds
  v_mfma_f32_32x32x16_bf16 v[56:71], a[168:171], a[140:143], v[56:71]
  s_waitcnt lgkmcnt(8)
  ds_read_b64_tr_b16 a[160:161], v14 offset:36864
  ds_read_b64_tr_b16 a[162:163], v14 offset:37888
  v_rcp_f32 v35, v35
  v_mul_f32 v148, v148, v34
  v_mfma_f32_32x32x16_bf16 v[72:87], a[172:175], a[140:143], v[72:87]
  s_waitcnt lgkmcnt(8)
  ds_read_b64_tr_b16 a[164:165], v14 offset:37120
  ds_read_b64_tr_b16 a[166:167], v14 offset:38144
  v_mul_f32 v149, v149, v35
  v_cvt_pk_bf16_f32 v238, v148, v149
  v_mul_f32 v36, s83, v134
  v_mfma_f32_32x32x16_bf16 v[88:103], a[144:147], v[184:187], 0
  s_waitcnt lgkmcnt(8)
  ds_read_b64_tr_b16 a[168:169], v14 offset:38912
  ds_read_b64_tr_b16 a[170:171], v14 offset:39936
  v_mul_f32 v37, s83, v135
  v_exp_f32 v36, v36
  v_mfma_f32_32x32x16_bf16 v[104:119], a[148:151], v[184:187], 0
  s_waitcnt lgkmcnt(8)
  ds_read_b64_tr_b16 a[172:173], v14 offset:39168
  ds_read_b64_tr_b16 a[174:175], v14 offset:40192
  v_exp_f32 v37, v37
  v_mul_f32 v150, v134, v150
  v_mfma_f32_32x32x16_bf16 v[88:103], a[152:155], v[188:191], v[88:103]
  s_waitcnt lgkmcnt(8)
  ds_read_b64_tr_b16 a[144:145], v14 offset:40960
  ds_read_b64_tr_b16 a[146:147], v14 offset:41984
  v_mul_f32 v151, v135, v151
  v_add_f32 v36, 1.0, v36
  v_add_f32 v37, 1.0, v37
  v_mfma_f32_32x32x16_bf16 v[104:119], a[156:159], v[188:191], v[104:119]
  s_waitcnt lgkmcnt(8)
  ds_read_b64_tr_b16 a[148:149], v14 offset:41216
  ds_read_b64_tr_b16 a[150:151], v14 offset:42240
  v_rcp_f32 v36, v36
  v_mfma_f32_32x32x16_bf16 v[88:103], a[160:163], v[192:195], v[88:103]
  s_waitcnt lgkmcnt(8)
  ds_read_b64_tr_b16 a[152:153], v14 offset:43008
  ds_read_b64_tr_b16 a[154:155], v14 offset:44032
  v_rcp_f32 v37, v37
  v_mul_f32 v150, v150, v36
  v_mfma_f32_32x32x16_bf16 v[104:119], a[164:167], v[192:195], v[104:119]
  s_waitcnt lgkmcnt(8)
  ds_read_b64_tr_b16 a[156:157], v14 offset:43264
  s_waitcnt vmcnt(15)
  ds_read_b64_tr_b16 a[158:159], v14 offset:44288
  s_barrier
  v_mul_f32 v151, v151, v37
  v_cvt_pk_bf16_f32 v239, v150, v151
  v_mul_f32 v34, s83, v152
  v_mfma_f32_32x32x16_bf16 v[88:103], a[168:171], v[196:199], v[88:103]
  s_waitcnt lgkmcnt(8)
  ds_read_b64_tr_b16 a[160:161], v14 offset:49152
  s_add_u32 s67, s79, 0x1b100
  ds_read_b64_tr_b16 a[162:163], v14 offset:50176
  s_add_u32 m0, s55, 0x4000
  s_nop 0
  buffer_load_dwordx4 v22, s[24:27], s67 offen lds
  v_mul_f32 v35, s83, v153
  v_mfma_f32_32x32x16_bf16 v[104:119], a[172:175], v[196:199], v[104:119]
  s_waitcnt lgkmcnt(8)
  ds_read_b64_tr_b16 a[164:165], v14 offset:49408
  ds_read_b64_tr_b16 a[166:167], v14 offset:50432
  v_exp_f32 v34, v34
  v_mfma_f32_32x32x16_bf16 v[88:103], a[144:147], v[200:203], v[88:103]
  s_waitcnt lgkmcnt(8)
  ds_read_b64_tr_b16 a[168:169], v14 offset:51200
  s_add_u32 m0, s55, 0x4400
  ds_read_b64_tr_b16 a[170:171], v14 offset:52224
  v_exp_f32 v35, v35
  v_mul_f32 v168, v152, v168
  v_mfma_f32_32x32x16_bf16 v[104:119], a[148:151], v[200:203], v[104:119]
  s_waitcnt lgkmcnt(8)
  ds_read_b64_tr_b16 a[172:173], v14 offset:51456
  ds_read_b64_tr_b16 a[174:175], v14 offset:52480
  buffer_load_dwordx4 v23, s[24:27], s67 offen lds
  v_mul_f32 v169, v153, v169
  v_mfma_f32_32x32x16_bf16 v[88:103], a[152:155], v[204:207], v[88:103]
  s_waitcnt lgkmcnt(8)
  ds_read_b64_tr_b16 a[144:145], v14 offset:53248
  ds_read_b64_tr_b16 a[146:147], v14 offset:54272
  v_add_f32 v34, 1.0, v34
  v_add_f32 v35, 1.0, v35
  v_mfma_f32_32x32x16_bf16 v[104:119], a[156:159], v[204:207], v[104:119]
  s_waitcnt lgkmcnt(8)
  ds_read_b64_tr_b16 a[148:149], v14 offset:53504
  s_add_u32 m0, s55, 0x4800
  ds_read_b64_tr_b16 a[150:151], v14 offset:54528
  v_rcp_f32 v34, v34
  v_mfma_f32_32x32x16_bf16 v[88:103], a[160:163], v[208:211], v[88:103]
  s_waitcnt lgkmcnt(8)
  ds_read_b64_tr_b16 a[152:153], v14 offset:55296
  ds_read_b64_tr_b16 a[154:155], v14 offset:56320
  buffer_load_dwordx4 v24, s[24:27], s67 offen lds
  v_mfma_f32_32x32x16_bf16 v[104:119], a[164:167], v[208:211], v[104:119]
  s_waitcnt lgkmcnt(8)
  ds_read_b64_tr_b16 a[156:157], v14 offset:55552
  ds_read_b64_tr_b16 a[158:159], v14 offset:56576
  v_rcp_f32 v35, v35
  v_mul_f32 v168, v168, v34
  v_mfma_f32_32x32x16_bf16 v[88:103], a[168:171], v[212:215], v[88:103]
  s_waitcnt lgkmcnt(8)
  ds_read_b64_tr_b16 a[160:161], v14 offset:57344
  ds_read_b64_tr_b16 a[162:163], v14 offset:58368
  v_mul_f32 v169, v169, v35
  v_cvt_pk_bf16_f32 v240, v168, v169
  v_mul_f32 v36, s83, v154
  v_mfma_f32_32x32x16_bf16 v[104:119], a[172:175], v[212:215], v[104:119]
  s_waitcnt lgkmcnt(8)
  ds_read_b64_tr_b16 a[164:165], v14 offset:57600
  ds_read_b64_tr_b16 a[166:167], v14 offset:58624
  v_mul_f32 v37, s83, v155
  v_exp_f32 v36, v36
  v_mfma_f32_32x32x16_bf16 v[88:103], a[144:147], v[216:219], v[88:103]
  s_waitcnt lgkmcnt(8)
  ds_read_b64_tr_b16 a[168:169], v14 offset:59392
  ds_read_b64_tr_b16 a[170:171], v14 offset:60416
  v_exp_f32 v37, v37
  v_mul_f32 v170, v154, v170
  v_mfma_f32_32x32x16_bf16 v[104:119], a[148:151], v[216:219], v[104:119]
  s_waitcnt lgkmcnt(8)
  ds_read_b64_tr_b16 a[172:173], v14 offset:59648
  s_waitcnt vmcnt(15)
  ds_read_b64_tr_b16 a[174:175], v14 offset:60672
  s_barrier
  v_mul_f32 v171, v155, v171
  v_add_f32 v36, 1.0, v36
  v_add_f32 v37, 1.0, v37
  v_mfma_f32_32x32x16_bf16 v[88:103], a[152:155], v[220:223], v[88:103]
  s_waitcnt lgkmcnt(8)
  ds_read_b64_tr_b16 a[144:145], v15
  s_add_u32 s67, s80, 0x100
  ds_read_b64_tr_b16 a[146:147], v15 offset:1024
  s_add_u32 m0, s55, 0x8000
  s_nop 0
  buffer_load_dwordx4 v25, s[24:27], s67 offen lds
  v_mfma_f32_32x32x16_bf16 v[104:119], a[156:159], v[220:223], v[104:119]
  s_waitcnt lgkmcnt(8)
  ds_read_b64_tr_b16 a[148:149], v15 offset:256
  ds_read_b64_tr_b16 a[150:151], v15 offset:1280
  v_rcp_f32 v36, v36
  v_mfma_f32_32x32x16_bf16 v[88:103], a[160:163], v[224:227], v[88:103]
  s_waitcnt lgkmcnt(8)
  ds_read_b64_tr_b16 a[152:153], v15 offset:2048
  s_add_u32 m0, s55, 0x8400
  ds_read_b64_tr_b16 a[154:155], v15 offset:3072
  v_rcp_f32 v37, v37
  v_mul_f32 v170, v170, v36
  v_mfma_f32_32x32x16_bf16 v[104:119], a[164:167], v[224:227], v[104:119]
  s_waitcnt lgkmcnt(8)
  ds_read_b64_tr_b16 a[156:157], v15 offset:2304
  ds_read_b64_tr_b16 a[158:159], v15 offset:3328
  buffer_load_dwordx4 v26, s[24:27], s67 offen lds
  v_mul_f32 v171, v171, v37
  v_mfma_f32_32x32x16_bf16 v[88:103], a[168:171], v[228:231], v[88:103]
  s_waitcnt lgkmcnt(8)
  ds_read_b64_tr_b16 a[160:161], v15 offset:4096
  ds_read_b64_tr_b16 a[162:163], v15 offset:5120
  v_cvt_pk_bf16_f32 v241, v170, v171
  v_mul_f32 v34, s83, v156
  v_mul_f32 v35, s83, v157
  v_mfma_f32_32x32x16_bf16 v[104:119], a[172:175], v[228:231], v[104:119]
  s_waitcnt lgkmcnt(8)
  ds_read_b64_tr_b16 a[164:165], v15 offset:4352
  s_add_u32 m0, s55, 0x8800
  ds_read_b64_tr_b16 a[166:167], v15 offset:5376
  v_exp_f32 v34, v34
  v_mfma_f32_32x32x16_bf16 v[88:103], a[144:147], v[232:235], v[88:103]
  s_waitcnt lgkmcnt(8)
  ds_read_b64_tr_b16 a[168:169], v15 offset:6144
  ds_read_b64_tr_b16 a[170:171], v15 offset:7168
  buffer_load_dwordx4 v27, s[24:27], s67 offen lds
  v_mfma_f32_32x32x16_bf16 v[104:119], a[148:151], v[232:235], v[104:119]
  s_waitcnt lgkmcnt(8)
  ds_read_b64_tr_b16 a[172:173], v15 offset:6400
  ds_read_b64_tr_b16 a[174:175], v15 offset:7424
  v_exp_f32 v35, v35
  v_mul_f32 v172, v156, v172
  v_mfma_f32_32x32x16_bf16 v[88:103], a[152:155], v[236:239], v[88:103]
  s_waitcnt lgkmcnt(8)
  ds_read_b64_tr_b16 a[144:145], v15 offset:8192
  ds_read_b64_tr_b16 a[146:147], v15 offset:9216
  v_mul_f32 v173, v157, v173
  v_add_f32 v34, 1.0, v34
  v_add_f32 v35, 1.0, v35
  v_rcp_f32 v34, v34
  v_rcp_f32 v35, v35
  v_mul_f32 v172, v172, v34
  v_mul_f32 v173, v173, v35
  v_cvt_pk_bf16_f32 v242, v172, v173
  v_mul_f32 v36, s83, v158
  v_mul_f32 v37, s83, v159
  v_exp_f32 v36, v36
  v_exp_f32 v37, v37
  v_mul_f32 v174, v158, v174
  v_mul_f32 v175, v159, v175
  v_add_f32 v36, 1.0, v36
  v_add_f32 v37, 1.0, v37
  v_rcp_f32 v36, v36
  v_rcp_f32 v37, v37
  v_mul_f32 v174, v174, v36
  v_mul_f32 v175, v175, v37
  v_cvt_pk_bf16_f32 v243, v174, v175
  v_mul_f32 v34, s83, v160
  v_mul_f32 v35, s83, v161
  v_exp_f32 v34, v34
  v_exp_f32 v35, v35
  v_mul_f32 v176, v160, v176
  v_mul_f32 v177, v161, v177
  v_add_f32 v34, 1.0, v34
  v_add_f32 v35, 1.0, v35
  v_rcp_f32 v34, v34
  v_rcp_f32 v35, v35
  v_mul_f32 v176, v176, v34
  v_mul_f32 v177, v177, v35
  v_cvt_pk_bf16_f32 v244, v176, v177
  v_mul_f32 v36, s83, v162
  v_mul_f32 v37, s83, v163
  v_exp_f32 v36, v36
  v_exp_f32 v37, v37
  v_mul_f32 v178, v162, v178
  v_mul_f32 v179, v163, v179
  v_add_f32 v36, 1.0, v36
  v_add_f32 v37, 1.0, v37
  v_rcp_f32 v36, v36
  v_rcp_f32 v37, v37
  v_mul_f32 v178, v178, v36
  v_mul_f32 v179, v179, v37
  v_cvt_pk_bf16_f32 v245, v178, v179
  v_mul_f32 v34, s83, v164
  v_mul_f32 v35, s83, v165
  v_exp_f32 v34, v34
  v_exp_f32 v35, v35
  v_mul_f32 v180, v164, v180
  v_mul_f32 v181, v165, v181
  v_add_f32 v34, 1.0, v34
  v_add_f32 v35, 1.0, v35
  v_rcp_f32 v34, v34
  v_rcp_f32 v35, v35
  v_mul_f32 v180, v180, v34
  v_mul_f32 v181, v181, v35
  v_cvt_pk_bf16_f32 v246, v180, v181
  v_mul_f32 v36, s83, v166
  v_mul_f32 v37, s83, v167
  v_exp_f32 v36, v36
  v_exp_f32 v37, v37
  v_mul_f32 v182, v166, v182
  v_mul_f32 v183, v167, v183
  v_add_f32 v36, 1.0, v36
  v_add_f32 v37, 1.0, v37
  v_rcp_f32 v36, v36
  v_rcp_f32 v37, v37
  v_mul_f32 v182, v182, v36
  v_mul_f32 v183, v183, v37
  v_cvt_pk_bf16_f32 v247, v182, v183
  v_mfma_f32_32x32x16_bf16 v[104:119], a[156:159], v[236:239], v[104:119]
  s_waitcnt lgkmcnt(8)
  ds_read_b64_tr_b16 a[148:149], v15 offset:8448
  ds_read_b64_tr_b16 a[150:151], v15 offset:9472
  v_mul_f32 v34, s83, v56
  v_mul_f32 v35, s83, v57
  v_mfma_f32_32x32x16_bf16 v[88:103], a[160:163], v[240:243], v[88:103]
  s_waitcnt lgkmcnt(8)
  ds_read_b64_tr_b16 a[152:153], v15 offset:10240
  ds_read_b64_tr_b16 a[154:155], v15 offset:11264
  v_exp_f32 v34, v34
  v_mfma_f32_32x32x16_bf16 v[104:119], a[164:167], v[240:243], v[104:119]
  s_waitcnt lgkmcnt(8)
  ds_read_b64_tr_b16 a[156:157], v15 offset:10496
  s_waitcnt vmcnt(15)
  ds_read_b64_tr_b16 a[158:159], v15 offset:11520
  s_barrier
  v_exp_f32 v35, v35
  v_mul_f32 v72, v56, v72
  v_mfma_f32_32x32x16_bf16 v[88:103], a[168:171], v[244:247], v[88:103]
  s_waitcnt lgkmcnt(8)
  ds_read_b64_tr_b16 a[160:161], v15 offset:16384
  s_add_u32 s67, s79, 0x180
  ds_read_b64_tr_b16 a[162:163], v15 offset:17408
  s_add_u32 m0, s55, 0xc000
  s_nop 0
  buffer_load_dwordx4 v22, s[24:27], s67 offen lds
  v_mul_f32 v73, v57, v73
  v_add_f32 v34, 1.0, v34
  v_add_f32 v35, 1.0, v35
  v_rcp_f32 v34, v34
  v_rcp_f32 v35, v35
  v_mul_f32 v72, v72, v34
  v_mul_f32 v73, v73, v35
  v_cvt_pk_bf16_f32 v248, v72, v73
  v_mul_f32 v36, s83, v58
  v_mul_f32 v37, s83, v59
  v_exp_f32 v36, v36
  v_exp_f32 v37, v37
  v_mul_f32 v74, v58, v74
  v_mul_f32 v75, v59, v75
  v_add_f32 v36, 1.0, v36
  v_add_f32 v37, 1.0, v37
  v_rcp_f32 v36, v36
  v_rcp_f32 v37, v37
  v_mul_f32 v74, v74, v36
  v_mul_f32 v75, v75, v37
  v_cvt_pk_bf16_f32 v249, v74, v75
  v_mul_f32 v34, s83, v60
  v_mul_f32 v35, s83, v61
  v_exp_f32 v34, v34
  v_exp_f32 v35, v35
  v_mul_f32 v76, v60, v76
  v_mul_f32 v77, v61, v77
  v_add_f32 v34, 1.0, v34
  v_add_f32 v35, 1.0, v35
  v_rcp_f32 v34, v34
  v_rcp_f32 v35, v35
  v_mul_f32 v76, v76, v34
  v_mul_f32 v77, v77, v35
  v_cvt_pk_bf16_f32 v250, v76, v77
  v_mul_f32 v36, s83, v62
  v_mul_f32 v37, s83, v63
  v_exp_f32 v36, v36
  v_exp_f32 v37, v37
  v_mul_f32 v78, v62, v78
  v_mul_f32 v79, v63, v79
  v_add_f32 v36, 1.0, v36
  v_add_f32 v37, 1.0, v37
  v_rcp_f32 v36, v36
  v_rcp_f32 v37, v37
  v_mul_f32 v78, v78, v36
  v_mul_f32 v79, v79, v37
  v_cvt_pk_bf16_f32 v251, v78, v79
  v_mul_f32 v34, s83, v64
  v_mul_f32 v35, s83, v65
  v_exp_f32 v34, v34
  v_exp_f32 v35, v35
  v_mul_f32 v80, v64, v80
  v_mul_f32 v81, v65, v81
  v_add_f32 v34, 1.0, v34
  v_add_f32 v35, 1.0, v35
  v_rcp_f32 v34, v34
  v_rcp_f32 v35, v35
  v_mul_f32 v80, v80, v34
  v_mul_f32 v81, v81, v35
  v_cvt_pk_bf16_f32 v252, v80, v81
  v_mul_f32 v36, s83, v66
  v_mul_f32 v37, s83, v67
  v_exp_f32 v36, v36
  v_exp_f32 v37, v37
  v_mul_f32 v82, v66, v82
  v_mul_f32 v83, v67, v83
  v_add_f32 v36, 1.0, v36
  v_add_f32 v37, 1.0, v37
  v_rcp_f32 v36, v36
  v_rcp_f32 v37, v37
  v_mul_f32 v82, v82, v36
  v_mul_f32 v83, v83, v37
  v_cvt_pk_bf16_f32 v253, v82, v83
  v_mul_f32 v34, s83, v68
  v_mul_f32 v35, s83, v69
  v_exp_f32 v34, v34
  v_exp_f32 v35, v35
  v_mul_f32 v84, v68, v84
  v_mul_f32 v85, v69, v85
  v_add_f32 v34, 1.0, v34
  v_add_f32 v35, 1.0, v35
  v_rcp_f32 v34, v34
  v_rcp_f32 v35, v35
  v_mul_f32 v84, v84, v34
  v_mul_f32 v85, v85, v35
  v_cvt_pk_bf16_f32 v254, v84, v85
  v_mul_f32 v36, s83, v70
  v_mul_f32 v37, s83, v71
  v_exp_f32 v36, v36
  v_exp_f32 v37, v37
  v_mul_f32 v86, v70, v86
  v_mul_f32 v87, v71, v87
  v_add_f32 v36, 1.0, v36
  v_add_f32 v37, 1.0, v37
  v_rcp_f32 v36, v36
  v_rcp_f32 v37, v37
  v_mul_f32 v86, v86, v36
  v_mul_f32 v87, v87, v37
  v_cvt_pk_bf16_f32 v255, v86, v87
  v_mfma_f32_32x32x16_bf16 v[104:119], a[172:175], v[244:247], v[104:119]
  s_waitcnt lgkmcnt(8)
  ds_read_b64_tr_b16 a[164:165], v15 offset:16640
  ds_read_b64_tr_b16 a[166:167], v15 offset:17664
  v_mfma_f32_32x32x16_bf16 v[88:103], a[144:147], v[248:251], v[88:103]
  s_waitcnt lgkmcnt(8)
  ds_read_b64_tr_b16 a[168:169], v15 offset:18432
  s_add_u32 m0, s55, 0xc400
  ds_read_b64_tr_b16 a[170:171], v15 offset:19456
  v_mfma_f32_32x32x16_bf16 v[104:119], a[148:151], v[248:251], v[104:119]
  s_waitcnt lgkmcnt(8)
  ds_read_b64_tr_b16 a[172:173], v15 offset:18688
  ds_read_b64_tr_b16 a[174:175], v15 offset:19712
  buffer_load_dwordx4 v23, s[24:27], s67 offen lds
  v_mfma_f32_32x32x16_bf16 v[88:103], a[152:155], v[252:255], v[88:103]
  s_waitcnt lgkmcnt(8)
  ds_read_b64_tr_b16 a[144:145], v15 offset:20480
  ds_read_b64_tr_b16 a[146:147], v15 offset:21504
  v_mfma_f32_32x32x16_bf16 v[104:119], a[156:159], v[252:255], v[104:119]
  s_waitcnt lgkmcnt(8)
  ds_read_b64_tr_b16 a[148:149], v15 offset:20736
  s_add_u32 m0, s55, 0xc800
  ds_read_b64_tr_b16 a[150:151], v15 offset:21760
  v_mfma_f32_32x32x16_bf16 v[120:135], a[160:163], v[184:187], 0
  s_waitcnt lgkmcnt(8)
  ds_read_b64_tr_b16 a[152:153], v15 offset:22528
  ds_read_b64_tr_b16 a[154:155], v15 offset:23552
  buffer_load_dwordx4 v24, s[24:27], s67 offen lds
  v_mfma_f32_32x32x16_bf16 v[136:151], a[164:167], v[184:187], 0
  s_waitcnt lgkmcnt(8)
  ds_read_b64_tr_b16 a[156:157], v15 offset:22784
  ds_read_b64_tr_b16 a[158:159], v15 offset:23808
  v_mfma_f32_32x32x16_bf16 v[120:135], a[168:171], v[188:191], v[120:135]
  s_waitcnt lgkmcnt(8)
  ds_read_b64_tr_b16 a[160:161], v15 offset:24576
  ds_read_b64_tr_b16 a[162:163], v15 offset:25600
  v_cvt_pk_bf16_f32 v152, v88, v89
  v_cvt_pk_bf16_f32 v153, v90, v91
  v_cvt_pk_bf16_f32 v154, v92, v93
  v_mfma_f32_32x32x16_bf16 v[136:151], a[172:175], v[188:191], v[136:151]
  s_waitcnt lgkmcnt(8)
  ds_read_b64_tr_b16 a[164:165], v15 offset:24832
  ds_read_b64_tr_b16 a[166:167], v15 offset:25856
  v_cvt_pk_bf16_f32 v155, v94, v95
  s_add_u32 s57, s66, 0
  v_mfma_f32_32x32x16_bf16 v[120:135], a[144:147], v[192:195], v[120:135]
  s_waitcnt lgkmcnt(8)
  ds_read_b64_tr_b16 a[168:169], v15 offset:26624
  ds_read_b64_tr_b16 a[170:171], v15 offset:27648
  buffer_store_dwordx4 v[152:155], v13, s[12:15], s57 offen sc1
  v_mfma_f32_32x32x16_bf16 v[136:151], a[148:151], v[192:195], v[136:151]
  s_waitcnt lgkmcnt(8)
  ds_read_b64_tr_b16 a[172:173], v15 offset:26880
  s_waitcnt vmcnt(16)
  ds_read_b64_tr_b16 a[174:175], v15 offset:27904
  s_barrier
  v_mfma_f32_32x32x16_bf16 v[120:135], a[152:155], v[196:199], v[120:135]
  s_waitcnt lgkmcnt(8)
  ds_read_b64_tr_b16 a[144:145], v15 offset:32768
  s_add_u32 s67, s79, 0x1b180
  ds_read_b64_tr_b16 a[146:147], v15 offset:33792
  s_add_u32 m0, s55, 0x10000
  s_nop 0
  buffer_load_dwordx4 v22, s[24:27], s67 offen lds
  v_mfma_f32_32x32x16_bf16 v[136:151], a[156:159], v[196:199], v[136:151]
  s_waitcnt lgkmcnt(8)
  ds_read_b64_tr_b16 a[148:149], v15 offset:33024
  ds_read_b64_tr_b16 a[150:151], v15 offset:34048
  v_mfma_f32_32x32x16_bf16 v[120:135], a[160:163], v[200:203], v[120:135]
  s_waitcnt lgkmcnt(8)
  ds_read_b64_tr_b16 a[152:153], v15 offset:34816
  s_add_u32 m0, s55, 0x10400
  ds_read_b64_tr_b16 a[154:155], v15 offset:35840
  v_mfma_f32_32x32x16_bf16 v[136:151], a[164:167], v[200:203], v[136:151]
  s_waitcnt lgkmcnt(8)
  ds_read_b64_tr_b16 a[156:157], v15 offset:35072
  ds_read_b64_tr_b16 a[158:159], v15 offset:36096
  buffer_load_dwordx4 v23, s[24:27], s67 offen lds
  v_cvt_pk_bf16_f32 v156, v96, v97
  v_mfma_f32_32x32x16_bf16 v[120:135], a[168:171], v[204:207], v[120:135]
  s_waitcnt lgkmcnt(8)
  ds_read_b64_tr_b16 a[160:161], v15 offset:36864
  ds_read_b64_tr_b16 a[162:163], v15 offset:37888
  v_cvt_pk_bf16_f32 v157, v98, v99
  v_cvt_pk_bf16_f32 v158, v100, v101
  v_cvt_pk_bf16_f32 v159, v102, v103
  v_mfma_f32_32x32x16_bf16 v[136:151], a[172:175], v[204:207], v[136:151]
  s_waitcnt lgkmcnt(8)
  ds_read_b64_tr_b16 a[164:165], v15 offset:37120
  s_add_u32 m0, s55, 0x10800
  ds_read_b64_tr_b16 a[166:167], v15 offset:38144
  s_add_u32 s57, s66, 0x100
  buffer_store_dwordx4 v[156:159], v13, s[12:15], s57 offen sc1
  v_mfma_f32_32x32x16_bf16 v[120:135], a[144:147], v[208:211], v[120:135]
  s_waitcnt lgkmcnt(8)
  ds_read_b64_tr_b16 a[168:169], v15 offset:38912
  ds_read_b64_tr_b16 a[170:171], v15 offset:39936
  buffer_load_dwordx4 v24, s[24:27], s67 offen lds
  v_mfma_f32_32x32x16_bf16 v[136:151], a[148:151], v[208:211], v[136:151]
  s_waitcnt lgkmcnt(8)
  ds_read_b64_tr_b16 a[172:173], v15 offset:39168
  ds_read_b64_tr_b16 a[174:175], v15 offset:40192
  v_mfma_f32_32x32x16_bf16 v[120:135], a[152:155], v[212:215], v[120:135]
  s_waitcnt lgkmcnt(8)
  ds_read_b64_tr_b16 a[144:145], v15 offset:40960
  ds_read_b64_tr_b16 a[146:147], v15 offset:41984
  v_mfma_f32_32x32x16_bf16 v[136:151], a[156:159], v[212:215], v[136:151]
  s_waitcnt lgkmcnt(8)
  ds_read_b64_tr_b16 a[148:149], v15 offset:41216
  ds_read_b64_tr_b16 a[150:151], v15 offset:42240
  v_mfma_f32_32x32x16_bf16 v[120:135], a[160:163], v[216:219], v[120:135]
  s_waitcnt lgkmcnt(8)
  ds_read_b64_tr_b16 a[152:153], v15 offset:43008
  ds_read_b64_tr_b16 a[154:155], v15 offset:44032
  v_cvt_pk_bf16_f32 v160, v104, v105
  v_cvt_pk_bf16_f32 v161, v106, v107
  v_cvt_pk_bf16_f32 v162, v108, v109
  v_mfma_f32_32x32x16_bf16 v[136:151], a[164:167], v[216:219], v[136:151]
  s_waitcnt lgkmcnt(8)
  ds_read_b64_tr_b16 a[156:157], v15 offset:43264
  s_waitcnt vmcnt(17)
  ds_read_b64_tr_b16 a[158:159], v15 offset:44288
  s_barrier
  v_cvt_pk_bf16_f32 v163, v110, v111
  s_add_u32 s57, s66, 0x200
  v_mfma_f32_32x32x16_bf16 v[120:135], a[168:171], v[220:223], v[120:135]
  s_waitcnt lgkmcnt(8)
  ds_read_b64_tr_b16 a[160:161], v15 offset:49152
  s_add_u32 s67, s80, 0x180
  ds_read_b64_tr_b16 a[162:163], v15 offset:50176
  s_add_u32 m0, s55, 0x14000
  s_nop 0
  buffer_load_dwordx4 v25, s[24:27], s67 offen lds
  v_mfma_f32_32x32x16_bf16 v[136:151], a[172:175], v[220:223], v[136:151]
  s_waitcnt lgkmcnt(8)
  ds_read_b64_tr_b16 a[164:165], v15 offset:49408
  ds_read_b64_tr_b16 a[166:167], v15 offset:50432
  buffer_store_dwordx4 v[160:163], v13, s[12:15], s57 offen sc1
  v_mfma_f32_32x32x16_bf16 v[120:135], a[144:147], v[224:227], v[120:135]
  s_waitcnt lgkmcnt(8)
  ds_read_b64_tr_b16 a[168:169], v15 offset:51200
  s_add_u32 m0, s55, 0x14400
  ds_read_b64_tr_b16 a[170:171], v15 offset:52224
  v_mfma_f32_32x32x16_bf16 v[136:151], a[148:151], v[224:227], v[136:151]
  s_waitcnt lgkmcnt(8)
  ds_read_b64_tr_b16 a[172:173], v15 offset:51456
  ds_read_b64_tr_b16 a[174:175], v15 offset:52480
  buffer_load_dwordx4 v26, s[24:27], s67 offen lds
  v_mfma_f32_32x32x16_bf16 v[120:135], a[152:155], v[228:231], v[120:135]
  s_waitcnt lgkmcnt(8)
  ds_read_b64_tr_b16 a[144:145], v15 offset:53248
  ds_read_b64_tr_b16 a[146:147], v15 offset:54272
  v_mfma_f32_32x32x16_bf16 v[136:151], a[156:159], v[228:231], v[136:151]
  s_waitcnt lgkmcnt(8)
  ds_read_b64_tr_b16 a[148:149], v15 offset:53504
  s_add_u32 m0, s55, 0x14800
  ds_read_b64_tr_b16 a[150:151], v15 offset:54528
  v_cvt_pk_bf16_f32 v164, v112, v113
  v_cvt_pk_bf16_f32 v165, v114, v115
  v_cvt_pk_bf16_f32 v166, v116, v117
  v_mfma_f32_32x32x16_bf16 v[120:135], a[160:163], v[232:235], v[120:135]
  s_waitcnt lgkmcnt(8)
  ds_read_b64_tr_b16 a[152:153], v15 offset:55296
  ds_read_b64_tr_b16 a[154:155], v15 offset:56320
  buffer_load_dwordx4 v27, s[24:27], s67 offen lds
  v_cvt_pk_bf16_f32 v167, v118, v119
  v_mfma_f32_32x32x16_bf16 v[136:151], a[164:167], v[232:235], v[136:151]
  s_waitcnt lgkmcnt(8)
  ds_read_b64_tr_b16 a[156:157], v15 offset:55552
  s_add_u32 s57, s66, 0x300
  ds_read_b64_tr_b16 a[158:159], v15 offset:56576
  buffer_store_dwordx4 v[164:167], v13, s[12:15], s57 offen sc1
  v_mfma_f32_32x32x16_bf16 v[120:135], a[168:171], v[236:239], v[120:135]
  s_waitcnt lgkmcnt(8)
  ds_read_b64_tr_b16 a[160:161], v15 offset:57344
  ds_read_b64_tr_b16 a[162:163], v15 offset:58368
  v_mfma_f32_32x32x16_bf16 v[136:151], a[172:175], v[236:239], v[136:151]
  s_waitcnt lgkmcnt(8)
  ds_read_b64_tr_b16 a[164:165], v15 offset:57600
  ds_read_b64_tr_b16 a[166:167], v15 offset:58624
  v_mfma_f32_32x32x16_bf16 v[120:135], a[144:147], v[240:243], v[120:135]
  s_waitcnt lgkmcnt(8)
  ds_read_b64_tr_b16 a[168:169], v15 offset:59392
  ds_read_b64_tr_b16 a[170:171], v15 offset:60416
  v_mfma_f32_32x32x16_bf16 v[136:151], a[148:151], v[240:243], v[136:151]
  s_waitcnt lgkmcnt(8)
  ds_read_b64_tr_b16 a[172:173], v15 offset:59648
  s_waitcnt vmcnt(19)
  ds_read_b64_tr_b16 a[174:175], v15 offset:60672
  s_barrier
  v_mfma_f32_32x32x16_bf16 v[120:135], a[152:155], v[244:247], v[120:135]
  s_waitcnt lgkmcnt(8)
  ds_read_b64_tr_b16 a[144:145], v14
  s_add_u32 s67, s79, 0x200
  ds_read_b64_tr_b16 a[146:147], v14 offset:1024
  s_add_u32 m0, s55, 0x18000
  s_nop 0
  buffer_load_dwordx4 v22, s[24:27], s67 offen lds
  v_mfma_f32_32x32x16_bf16 v[136:151], a[156:159], v[244:247], v[136:151]
  s_waitcnt lgkmcnt(8)
  ds_read_b64_tr_b16 a[148:149], v14 offset:256
  ds_read_b64_tr_b16 a[150:151], v14 offset:1280
  v_mfma_f32_32x32x16_bf16 v[120:135], a[160:163], v[248:251], v[120:135]
  s_waitcnt lgkmcnt(8)
  ds_read_b64_tr_b16 a[152:153], v14 offset:2048
  s_add_u32 m0, s55, 0x18400
  ds_read_b64_tr_b16 a[154:155], v14 offset:3072
  v_mfma_f32_32x32x16_bf16 v[136:151], a[164:167], v[248:251], v[136:151]
  s_waitcnt lgkmcnt(8)
  ds_read_b64_tr_b16 a[156:157], v14 offset:2304
  ds_read_b64_tr_b16 a[158:159], v14 offset:3328
  buffer_load_dwordx4 v23, s[24:27], s67 offen lds
  v_mfma_f32_32x32x16_bf16 v[120:135], a[168:171], v[252:255], v[120:135]
  s_waitcnt lgkmcnt(8)
  ds_read_b64_tr_b16 a[160:161], v14 offset:4096
  ds_read_b64_tr_b16 a[162:163], v14 offset:5120
  v_mfma_f32_32x32x16_bf16 v[136:151], a[172:175], v[252:255], v[136:151]
  s_waitcnt lgkmcnt(8)
  ds_read_b64_tr_b16 a[164:165], v14 offset:4352
  s_add_u32 m0, s55, 0x18800
  ds_read_b64_tr_b16 a[166:167], v14 offset:5376
  v_mfma_f32_32x32x16_bf16 v[88:103], a[144:147], v[184:187], 0
  s_waitcnt lgkmcnt(8)
  ds_read_b64_tr_b16 a[168:169], v14 offset:6144
  ds_read_b64_tr_b16 a[170:171], v14 offset:7168
  buffer_load_dwordx4 v24, s[24:27], s67 offen lds
  v_mfma_f32_32x32x16_bf16 v[104:119], a[148:151], v[184:187], 0
  s_waitcnt lgkmcnt(8)
  ds_read_b64_tr_b16 a[172:173], v14 offset:6400
  ds_read_b64_tr_b16 a[174:175], v14 offset:7424
  v_mfma_f32_32x32x16_bf16 v[88:103], a[152:155], v[188:191], v[88:103]
  s_waitcnt lgkmcnt(8)
  ds_read_b64_tr_b16 a[144:145], v14 offset:8192
  ds_read_b64_tr_b16 a[146:147], v14 offset:9216
  v_cvt_pk_bf16_f32 v152, v120, v121
  v_cvt_pk_bf16_f32 v153, v122, v123
  v_cvt_pk_bf16_f32 v154, v124, v125
  v_mfma_f32_32x32x16_bf16 v[104:119], a[156:159], v[188:191], v[104:119]
  s_waitcnt lgkmcnt(8)
  ds_read_b64_tr_b16 a[148:149], v14 offset:8448
  ds_read_b64_tr_b16 a[150:151], v14 offset:9472
  v_cvt_pk_bf16_f32 v155, v126, v127
  s_add_u32 s57, s66, 0x400
  v_mfma_f32_32x32x16_bf16 v[88:103], a[160:163], v[192:195], v[88:103]
  s_waitcnt lgkmcnt(8)
  ds_read_b64_tr_b16 a[152:153], v14 offset:10240
  ds_read_b64_tr_b16 a[154:155], v14 offset:11264
  buffer_store_dwordx4 v[152:155], v13, s[12:15], s57 offen sc1
  v_mfma_f32_32x32x16_bf16 v[104:119], a[164:167], v[192:195], v[104:119]
  s_waitcnt lgkmcnt(8)
  ds_read_b64_tr_b16 a[156:157], v14 offset:10496
  s_waitcnt vmcnt(20)
  ds_read_b64_tr_b16 a[158:159], v14 offset:11520
  s_barrier
  v_mfma_f32_32x32x16_bf16 v[88:103], a[168:171], v[196:199], v[88:103]
  s_waitcnt lgkmcnt(8)
  ds_read_b64_tr_b16 a[160:161], v14 offset:16384
  s_add_u32 s67, s79, 0x1b200
  ds_read_b64_tr_b16 a[162:163], v14 offset:17408
  s_add_u32 m0, s55, 0x1c000
  s_nop 0
  buffer_load_dwordx4 v22, s[24:27], s67 offen lds
  v_mfma_f32_32x32x16_bf16 v[104:119], a[172:175], v[196:199], v[104:119]
  s_waitcnt lgkmcnt(8)
  ds_read_b64_tr_b16 a[164:165], v14 offset:16640
  ds_read_b64_tr_b16 a[166:167], v14 offset:17664
  v_mfma_f32_32x32x16_bf16 v[88:103], a[144:147], v[200:203], v[88:103]
  s_waitcnt lgkmcnt(8)
  ds_read_b64_tr_b16 a[168:169], v14 offset:18432
  s_add_u32 m0, s55, 0x1c400
  ds_read_b64_tr_b16 a[170:171], v14 offset:19456
  v_mfma_f32_32x32x16_bf16 v[104:119], a[148:151], v[200:203], v[104:119]
  s_waitcnt lgkmcnt(8)
  ds_read_b64_tr_b16 a[172:173], v14 offset:18688
  ds_read_b64_tr_b16 a[174:175], v14 offset:19712
  buffer_load_dwordx4 v23, s[24:27], s67 offen lds
  v_cvt_pk_bf16_f32 v156, v128, v129
  v_mfma_f32_32x32x16_bf16 v[88:103], a[152:155], v[204:207], v[88:103]
  s_waitcnt lgkmcnt(8)
  ds_read_b64_tr_b16 a[144:145], v14 offset:20480
  ds_read_b64_tr_b16 a[146:147], v14 offset:21504
  v_cvt_pk_bf16_f32 v157, v130, v131
  v_cvt_pk_bf16_f32 v158, v132, v133
  v_cvt_pk_bf16_f32 v159, v134, v135
  v_mfma_f32_32x32x16_bf16 v[104:119], a[156:159], v[204:207], v[104:119]
  s_waitcnt lgkmcnt(8)
  ds_read_b64_tr_b16 a[148:149], v14 offset:20736
  s_add_u32 m0, s55, 0x1c800
  ds_read_b64_tr_b16 a[150:151], v14 offset:21760
  s_add_u32 s57, s66, 0x500
  buffer_store_dwordx4 v[156:159], v13, s[12:15], s57 offen sc1
  v_mfma_f32_32x32x16_bf16 v[88:103], a[160:163], v[208:211], v[88:103]
  s_waitcnt lgkmcnt(8)
  ds_read_b64_tr_b16 a[152:153], v14 offset:22528
  ds_read_b64_tr_b16 a[154:155], v14 offset:23552
  buffer_load_dwordx4 v24, s[24:27], s67 offen lds
  v_mfma_f32_32x32x16_bf16 v[104:119], a[164:167], v[208:211], v[104:119]
  s_waitcnt lgkmcnt(8)
  ds_read_b64_tr_b16 a[156:157], v14 offset:22784
  ds_read_b64_tr_b16 a[158:159], v14 offset:23808
  v_mfma_f32_32x32x16_bf16 v[88:103], a[168:171], v[212:215], v[88:103]
  s_waitcnt lgkmcnt(8)
  ds_read_b64_tr_b16 a[160:161], v14 offset:24576
  ds_read_b64_tr_b16 a[162:163], v14 offset:25600
  v_mfma_f32_32x32x16_bf16 v[104:119], a[172:175], v[212:215], v[104:119]
  s_waitcnt lgkmcnt(8)
  ds_read_b64_tr_b16 a[164:165], v14 offset:24832
  ds_read_b64_tr_b16 a[166:167], v14 offset:25856
  v_mfma_f32_32x32x16_bf16 v[88:103], a[144:147], v[216:219], v[88:103]
  s_waitcnt lgkmcnt(8)
  ds_read_b64_tr_b16 a[168:169], v14 offset:26624
  ds_read_b64_tr_b16 a[170:171], v14 offset:27648
  v_cvt_pk_bf16_f32 v160, v136, v137
  v_cvt_pk_bf16_f32 v161, v138, v139
  v_cvt_pk_bf16_f32 v162, v140, v141
  v_mfma_f32_32x32x16_bf16 v[104:119], a[148:151], v[216:219], v[104:119]
  s_waitcnt lgkmcnt(8)
  ds_read_b64_tr_b16 a[172:173], v14 offset:26880
  s_waitcnt vmcnt(21)
  ds_read_b64_tr_b16 a[174:175], v14 offset:27904
  s_barrier
  v_cvt_pk_bf16_f32 v163, v142, v143
  s_add_u32 s57, s66, 0x600
  v_mfma_f32_32x32x16_bf16 v[88:103], a[152:155], v[220:223], v[88:103]
  s_waitcnt lgkmcnt(8)
  ds_read_b64_tr_b16 a[144:145], v14 offset:32768
  s_add_u32 s67, s80, 0x200
  ds_read_b64_tr_b16 a[146:147], v14 offset:33792
  s_add_u32 m0, s55, 0
  s_nop 0
  buffer_load_dwordx4 v25, s[24:27], s67 offen lds
  v_mfma_f32_32x32x16_bf16 v[104:119], a[156:159], v[220:223], v[104:119]
  s_waitcnt lgkmcnt(8)
  ds_read_b64_tr_b16 a[148:149], v14 offset:33024
  ds_read_b64_tr_b16 a[150:151], v14 offset:34048
  buffer_store_dwordx4 v[160:163], v13, s[12:15], s57 offen sc1
  v_mfma_f32_32x32x16_bf16 v[88:103], a[160:163], v[224:227], v[88:103]
  s_waitcnt lgkmcnt(8)
  ds_read_b64_tr_b16 a[152:153], v14 offset:34816
  s_add_u32 m0, s55, 0x400
  ds_read_b64_tr_b16 a[154:155], v14 offset:35840
  v_mfma_f32_32x32x16_bf16 v[104:119], a[164:167], v[224:227], v[104:119]
  s_waitcnt lgkmcnt(8)
  ds_read_b64_tr_b16 a[156:157], v14 offset:35072
  ds_read_b64_tr_b16 a[158:159], v14 offset:36096
  buffer_load_dwordx4 v26, s[24:27], s67 offen lds
  v_mfma_f32_32x32x16_bf16 v[88:103], a[168:171], v[228:231], v[88:103]
  s_waitcnt lgkmcnt(8)
  ds_read_b64_tr_b16 a[160:161], v14 offset:36864
  ds_read_b64_tr_b16 a[162:163], v14 offset:37888
  v_mfma_f32_32x32x16_bf16 v[104:119], a[172:175], v[228:231], v[104:119]
  s_waitcnt lgkmcnt(8)
  ds_read_b64_tr_b16 a[164:165], v14 offset:37120
  s_add_u32 m0, s55, 0x800
  ds_read_b64_tr_b16 a[166:167], v14 offset:38144
  v_cvt_pk_bf16_f32 v164, v144, v145
  v_cvt_pk_bf16_f32 v165, v146, v147
  v_cvt_pk_bf16_f32 v166, v148, v149
  v_mfma_f32_32x32x16_bf16 v[88:103], a[144:147], v[232:235], v[88:103]
  s_waitcnt lgkmcnt(8)
  ds_read_b64_tr_b16 a[168:169], v14 offset:38912
  ds_read_b64_tr_b16 a[170:171], v14 offset:39936
  buffer_load_dwordx4 v27, s[24:27], s67 offen lds
  v_cvt_pk_bf16_f32 v167, v150, v151
  v_mfma_f32_32x32x16_bf16 v[104:119], a[148:151], v[232:235], v[104:119]
  s_waitcnt lgkmcnt(8)
  ds_read_b64_tr_b16 a[172:173], v14 offset:39168
  s_add_u32 s57, s66, 0x700
  ds_read_b64_tr_b16 a[174:175], v14 offset:40192
  buffer_store_dwordx4 v[164:167], v13, s[12:15], s57 offen sc1
  v_mfma_f32_32x32x16_bf16 v[88:103], a[152:155], v[236:239], v[88:103]
  s_waitcnt lgkmcnt(8)
  ds_read_b64_tr_b16 a[144:145], v14 offset:40960
  ds_read_b64_tr_b16 a[146:147], v14 offset:41984
  v_mfma_f32_32x32x16_bf16 v[104:119], a[156:159], v[236:239], v[104:119]
  s_waitcnt lgkmcnt(8)
  ds_read_b64_tr_b16 a[148:149], v14 offset:41216
  ds_read_b64_tr_b16 a[150:151], v14 offset:42240
  v_mfma_f32_32x32x16_bf16 v[88:103], a[160:163], v[240:243], v[88:103]
  s_waitcnt lgkmcnt(8)
  ds_read_b64_tr_b16 a[152:153], v14 offset:43008
  ds_read_b64_tr_b16 a[154:155], v14 offset:44032
  v_mfma_f32_32x32x16_bf16 v[104:119], a[164:167], v[240:243], v[104:119]
  s_waitcnt lgkmcnt(8)
  ds_read_b64_tr_b16 a[156:157], v14 offset:43264
  s_waitcnt vmcnt(23)
  ds_read_b64_tr_b16 a[158:159], v14 offset:44288
  s_barrier
  v_mfma_f32_32x32x16_bf16 v[88:103], a[168:171], v[244:247], v[88:103]
  s_waitcnt lgkmcnt(8)
  ds_read_b64_tr_b16 a[160:161], v14 offset:49152
  s_add_u32 s67, s79, 0x280
  ds_read_b64_tr_b16 a[162:163], v14 offset:50176
  s_add_u32 m0, s55, 0x4000
  s_nop 0
  buffer_load_dwordx4 v22, s[24:27], s67 offen lds
  v_mfma_f32_32x32x16_bf16 v[104:119], a[172:175], v[244:247], v[104:119]
  s_waitcnt lgkmcnt(8)
  ds_read_b64_tr_b16 a[164:165], v14 offset:49408
  ds_read_b64_tr_b16 a[166:167], v14 offset:50432
  v_mfma_f32_32x32x16_bf16 v[88:103], a[144:147], v[248:251], v[88:103]
  s_waitcnt lgkmcnt(8)
  ds_read_b64_tr_b16 a[168:169], v14 offset:51200
  s_add_u32 m0, s55, 0x4400
  ds_read_b64_tr_b16 a[170:171], v14 offset:52224
  v_mfma_f32_32x32x16_bf16 v[104:119], a[148:151], v[248:251], v[104:119]
  s_waitcnt lgkmcnt(8)
  ds_read_b64_tr_b16 a[172:173], v14 offset:51456
  ds_read_b64_tr_b16 a[174:175], v14 offset:52480
  buffer_load_dwordx4 v23, s[24:27], s67 offen lds
  v_mfma_f32_32x32x16_bf16 v[88:103], a[152:155], v[252:255], v[88:103]
  s_waitcnt lgkmcnt(8)
  ds_read_b64_tr_b16 a[144:145], v14 offset:53248
  ds_read_b64_tr_b16 a[146:147], v14 offset:54272
  v_mfma_f32_32x32x16_bf16 v[104:119], a[156:159], v[252:255], v[104:119]
  s_waitcnt lgkmcnt(8)
  ds_read_b64_tr_b16 a[148:149], v14 offset:53504
  s_add_u32 m0, s55, 0x4800
  ds_read_b64_tr_b16 a[150:151], v14 offset:54528
  v_mfma_f32_32x32x16_bf16 v[120:135], a[160:163], v[184:187], 0
  s_waitcnt lgkmcnt(8)
  ds_read_b64_tr_b16 a[152:153], v14 offset:55296
  ds_read_b64_tr_b16 a[154:155], v14 offset:56320
  buffer_load_dwordx4 v24, s[24:27], s67 offen lds
  v_mfma_f32_32x32x16_bf16 v[136:151], a[164:167], v[184:187], 0
  s_waitcnt lgkmcnt(8)
  ds_read_b64_tr_b16 a[156:157], v14 offset:55552
  ds_read_b64_tr_b16 a[158:159], v14 offset:56576
  v_mfma_f32_32x32x16_bf16 v[120:135], a[168:171], v[188:191], v[120:135]
  s_waitcnt lgkmcnt(8)
  ds_read_b64_tr_b16 a[160:161], v14 offset:57344
  ds_read_b64_tr_b16 a[162:163], v14 offset:58368
  v_cvt_pk_bf16_f32 v152, v88, v89
  v_cvt_pk_bf16_f32 v153, v90, v91
  v_cvt_pk_bf16_f32 v154, v92, v93
  v_mfma_f32_32x32x16_bf16 v[136:151], a[172:175], v[188:191], v[136:151]
  s_waitcnt lgkmcnt(8)
  ds_read_b64_tr_b16 a[164:165], v14 offset:57600
  ds_read_b64_tr_b16 a[166:167], v14 offset:58624
  v_cvt_pk_bf16_f32 v155, v94, v95
  s_add_u32 s57, s66, 0x800
  v_mfma_f32_32x32x16_bf16 v[120:135], a[144:147], v[192:195], v[120:135]
  s_waitcnt lgkmcnt(8)
  ds_read_b64_tr_b16 a[168:169], v14 offset:59392
  ds_read_b64_tr_b16 a[170:171], v14 offset:60416
  buffer_store_dwordx4 v[152:155], v13, s[12:15], s57 offen sc1
  v_mfma_f32_32x32x16_bf16 v[136:151], a[148:151], v[192:195], v[136:151]
  s_waitcnt lgkmcnt(8)
  ds_read_b64_tr_b16 a[172:173], v14 offset:59648
  s_waitcnt vmcnt(22)
  ds_read_b64_tr_b16 a[174:175], v14 offset:60672
  s_barrier
  v_mfma_f32_32x32x16_bf16 v[120:135], a[152:155], v[196:199], v[120:135]
  s_waitcnt lgkmcnt(8)
  ds_read_b64_tr_b16 a[144:145], v15
  s_add_u32 s67, s79, 0x1b280
  ds_read_b64_tr_b16 a[146:147], v15 offset:1024
  s_add_u32 m0, s55, 0x8000
  s_nop 0
  buffer_load_dwordx4 v22, s[24:27], s67 offen lds
  v_mfma_f32_32x32x16_bf16 v[136:151], a[156:159], v[196:199], v[136:151]
  s_waitcnt lgkmcnt(8)
  ds_read_b64_tr_b16 a[148:149], v15 offset:256
  ds_read_b64_tr_b16 a[150:151], v15 offset:1280
  v_mfma_f32_32x32x16_bf16 v[120:135], a[160:163], v[200:203], v[120:135]
  s_waitcnt lgkmcnt(8)
  ds_read_b64_tr_b16 a[152:153], v15 offset:2048
  s_add_u32 m0, s55, 0x8400
  ds_read_b64_tr_b16 a[154:155], v15 offset:3072
  v_mfma_f32_32x32x16_bf16 v[136:151], a[164:167], v[200:203], v[136:151]
  s_waitcnt lgkmcnt(8)
  ds_read_b64_tr_b16 a[156:157], v15 offset:2304
  ds_read_b64_tr_b16 a[158:159], v15 offset:3328
  buffer_load_dwordx4 v23, s[24:27], s67 offen lds
  v_cvt_pk_bf16_f32 v156, v96, v97
  v_mfma_f32_32x32x16_bf16 v[120:135], a[168:171], v[204:207], v[120:135]
  s_waitcnt lgkmcnt(8)
  ds_read_b64_tr_b16 a[160:161], v15 offset:4096
  ds_read_b64_tr_b16 a[162:163], v15 offset:5120
  v_cvt_pk_bf16_f32 v157, v98, v99
  v_cvt_pk_bf16_f32 v158, v100, v101
  v_cvt_pk_bf16_f32 v159, v102, v103
  v_mfma_f32_32x32x16_bf16 v[136:151], a[172:175], v[204:207], v[136:151]
  s_waitcnt lgkmcnt(8)
  ds_read_b64_tr_b16 a[164:165], v15 offset:4352
  s_add_u32 m0, s55, 0x8800
  ds_read_b64_tr_b16 a[166:167], v15 offset:5376
  s_add_u32 s57, s66, 0x900
  buffer_store_dwordx4 v[156:159], v13, s[12:15], s57 offen sc1
  v_mfma_f32_32x32x16_bf16 v[120:135], a[144:147], v[208:211], v[120:135]
  s_waitcnt lgkmcnt(8)
  ds_read_b64_tr_b16 a[168:169], v15 offset:6144
  ds_read_b64_tr_b16 a[170:171], v15 offset:7168
  buffer_load_dwordx4 v24, s[24:27], s67 offen lds
  v_mfma_f32_32x32x16_bf16 v[136:151], a[148:151], v[208:211], v[136:151]
  s_waitcnt lgkmcnt(8)
  ds_read_b64_tr_b16 a[172:173], v15 offset:6400
  ds_read_b64_tr_b16 a[174:175], v15 offset:7424
  v_mfma_f32_32x32x16_bf16 v[120:135], a[152:155], v[212:215], v[120:135]
  s_waitcnt lgkmcnt(8)
  ds_read_b64_tr_b16 a[144:145], v15 offset:8192
  ds_read_b64_tr_b16 a[146:147], v15 offset:9216
  v_mfma_f32_32x32x16_bf16 v[136:151], a[156:159], v[212:215], v[136:151]
  s_waitcnt lgkmcnt(8)
  ds_read_b64_tr_b16 a[148:149], v15 offset:8448
  ds_read_b64_tr_b16 a[150:151], v15 offset:9472
  v_mfma_f32_32x32x16_bf16 v[120:135], a[160:163], v[216:219], v[120:135]
  s_waitcnt lgkmcnt(8)
  ds_read_b64_tr_b16 a[152:153], v15 offset:10240
  ds_read_b64_tr_b16 a[154:155], v15 offset:11264
  v_cvt_pk_bf16_f32 v160, v104, v105
  v_cvt_pk_bf16_f32 v161, v106, v107
  v_cvt_pk_bf16_f32 v162, v108, v109
  v_mfma_f32_32x32x16_bf16 v[136:151], a[164:167], v[216:219], v[136:151]
  s_waitcnt lgkmcnt(8)
  ds_read_b64_tr_b16 a[156:157], v15 offset:10496
  s_waitcnt vmcnt(22)
  ds_read_b64_tr_b16 a[158:159], v15 offset:11520
  s_barrier
  v_cvt_pk_bf16_f32 v163, v110, v111
  s_add_u32 s57, s66, 0xa00
  v_mfma_f32_32x32x16_bf16 v[120:135], a[168:171], v[220:223], v[120:135]
  s_waitcnt lgkmcnt(8)
  ds_read_b64_tr_b16 a[160:161], v15 offset:16384
  s_add_u32 s67, s80, 0x280
  ds_read_b64_tr_b16 a[162:163], v15 offset:17408
  s_add_u32 m0, s55, 0xc000
  s_nop 0
  buffer_load_dwordx4 v25, s[24:27], s67 offen lds
  v_mfma_f32_32x32x16_bf16 v[136:151], a[172:175], v[220:223], v[136:151]
  s_waitcnt lgkmcnt(8)
  ds_read_b64_tr_b16 a[164:165], v15 offset:16640
  ds_read_b64_tr_b16 a[166:167], v15 offset:17664
  buffer_store_dwordx4 v[160:163], v13, s[12:15], s57 offen sc1
  v_mfma_f32_32x32x16_bf16 v[120:135], a[144:147], v[224:227], v[120:135]
  s_waitcnt lgkmcnt(8)
  ds_read_b64_tr_b16 a[168:169], v15 offset:18432
  s_add_u32 m0, s55, 0xc400
  ds_read_b64_tr_b16 a[170:171], v15 offset:19456
  v_mfma_f32_32x32x16_bf16 v[136:151], a[148:151], v[224:227], v[136:151]
  s_waitcnt lgkmcnt(8)
  ds_read_b64_tr_b16 a[172:173], v15 offset:18688
  ds_read_b64_tr_b16 a[174:175], v15 offset:19712
  buffer_load_dwordx4 v26, s[24:27], s67 offen lds
  v_mfma_f32_32x32x16_bf16 v[120:135], a[152:155], v[228:231], v[120:135]
  s_waitcnt lgkmcnt(8)
  ds_read_b64_tr_b16 a[144:145], v15 offset:20480
  ds_read_b64_tr_b16 a[146:147], v15 offset:21504
  v_mfma_f32_32x32x16_bf16 v[136:151], a[156:159], v[228:231], v[136:151]
  s_waitcnt lgkmcnt(8)
  ds_read_b64_tr_b16 a[148:149], v15 offset:20736
  s_add_u32 m0, s55, 0xc800
  ds_read_b64_tr_b16 a[150:151], v15 offset:21760
  v_cvt_pk_bf16_f32 v164, v112, v113
  v_cvt_pk_bf16_f32 v165, v114, v115
  v_cvt_pk_bf16_f32 v166, v116, v117
  v_mfma_f32_32x32x16_bf16 v[120:135], a[160:163], v[232:235], v[120:135]
  s_waitcnt lgkmcnt(8)
  ds_read_b64_tr_b16 a[152:153], v15 offset:22528
  ds_read_b64_tr_b16 a[154:155], v15 offset:23552
  buffer_load_dwordx4 v27, s[24:27], s67 offen lds
  v_cvt_pk_bf16_f32 v167, v118, v119
  v_mfma_f32_32x32x16_bf16 v[136:151], a[164:167], v[232:235], v[136:151]
  s_waitcnt lgkmcnt(8)
  ds_read_b64_tr_b16 a[156:157], v15 offset:22784
  s_add_u32 s57, s66, 0xb00
  ds_read_b64_tr_b16 a[158:159], v15 offset:23808
  buffer_store_dwordx4 v[164:167], v13, s[12:15], s57 offen sc1
  v_mfma_f32_32x32x16_bf16 v[120:135], a[168:171], v[236:239], v[120:135]
  s_waitcnt lgkmcnt(8)
  ds_read_b64_tr_b16 a[160:161], v15 offset:24576
  ds_read_b64_tr_b16 a[162:163], v15 offset:25600
  v_mfma_f32_32x32x16_bf16 v[136:151], a[172:175], v[236:239], v[136:151]
  s_waitcnt lgkmcnt(8)
  ds_read_b64_tr_b16 a[164:165], v15 offset:24832
  ds_read_b64_tr_b16 a[166:167], v15 offset:25856
  v_mfma_f32_32x32x16_bf16 v[120:135], a[144:147], v[240:243], v[120:135]
  s_waitcnt lgkmcnt(8)
  ds_read_b64_tr_b16 a[168:169], v15 offset:26624
  ds_read_b64_tr_b16 a[170:171], v15 offset:27648
  v_mfma_f32_32x32x16_bf16 v[136:151], a[148:151], v[240:243], v[136:151]
  s_waitcnt lgkmcnt(8)
  ds_read_b64_tr_b16 a[172:173], v15 offset:26880
  s_waitcnt vmcnt(23)
  ds_read_b64_tr_b16 a[174:175], v15 offset:27904
  s_barrier
  v_mfma_f32_32x32x16_bf16 v[120:135], a[152:155], v[244:247], v[120:135]
  s_waitcnt lgkmcnt(8)
  ds_read_b64_tr_b16 a[144:145], v15 offset:32768
  s_add_u32 s67, s79, 0x300
  ds_read_b64_tr_b16 a[146:147], v15 offset:33792
  s_add_u32 m0, s55, 0x10000
  s_nop 0
  buffer_load_dwordx4 v22, s[24:27], s67 offen lds
  v_mfma_f32_32x32x16_bf16 v[136:151], a[156:159], v[244:247], v[136:151]
  s_waitcnt lgkmcnt(8)
  ds_read_b64_tr_b16 a[148:149], v15 offset:33024
  ds_read_b64_tr_b16 a[150:151], v15 offset:34048
  v_mfma_f32_32x32x16_bf16 v[120:135], a[160:163], v[248:251], v[120:135]
  s_waitcnt lgkmcnt(8)
  ds_read_b64_tr_b16 a[152:153], v15 offset:34816
  s_add_u32 m0, s55, 0x10400
  ds_read_b64_tr_b16 a[154:155], v15 offset:35840
  v_mfma_f32_32x32x16_bf16 v[136:151], a[164:167], v[248:251], v[136:151]
  s_waitcnt lgkmcnt(8)
  ds_read_b64_tr_b16 a[156:157], v15 offset:35072
  ds_read_b64_tr_b16 a[158:159], v15 offset:36096
  buffer_load_dwordx4 v23, s[24:27], s67 offen lds
  v_mfma_f32_32x32x16_bf16 v[120:135], a[168:171], v[252:255], v[120:135]
  s_waitcnt lgkmcnt(8)
  ds_read_b64_tr_b16 a[160:161], v15 offset:36864
  ds_read_b64_tr_b16 a[162:163], v15 offset:37888
  v_mfma_f32_32x32x16_bf16 v[136:151], a[172:175], v[252:255], v[136:151]
  s_waitcnt lgkmcnt(8)
  ds_read_b64_tr_b16 a[164:165], v15 offset:37120
  s_add_u32 m0, s55, 0x10800
  ds_read_b64_tr_b16 a[166:167], v15 offset:38144
  v_mfma_f32_32x32x16_bf16 v[88:103], a[144:147], v[184:187], 0
  s_waitcnt lgkmcnt(8)
  ds_read_b64_tr_b16 a[168:169], v15 offset:38912
  ds_read_b64_tr_b16 a[170:171], v15 offset:39936
  buffer_load_dwordx4 v24, s[24:27], s67 offen lds
  v_mfma_f32_32x32x16_bf16 v[104:119], a[148:151], v[184:187], 0
  s_waitcnt lgkmcnt(8)
  ds_read_b64_tr_b16 a[172:173], v15 offset:39168
  ds_read_b64_tr_b16 a[174:175], v15 offset:40192
  v_mfma_f32_32x32x16_bf16 v[88:103], a[152:155], v[188:191], v[88:103]
  s_waitcnt lgkmcnt(8)
  ds_read_b64_tr_b16 a[144:145], v15 offset:40960
  ds_read_b64_tr_b16 a[146:147], v15 offset:41984
  v_cvt_pk_bf16_f32 v152, v120, v121
  v_cvt_pk_bf16_f32 v153, v122, v123
  v_cvt_pk_bf16_f32 v154, v124, v125
  v_mfma_f32_32x32x16_bf16 v[104:119], a[156:159], v[188:191], v[104:119]
  s_waitcnt lgkmcnt(8)
  ds_read_b64_tr_b16 a[148:149], v15 offset:41216
  ds_read_b64_tr_b16 a[150:151], v15 offset:42240
  v_cvt_pk_bf16_f32 v155, v126, v127
  s_add_u32 s57, s66, 0xc00
  v_mfma_f32_32x32x16_bf16 v[88:103], a[160:163], v[192:195], v[88:103]
  s_waitcnt lgkmcnt(8)
  ds_read_b64_tr_b16 a[152:153], v15 offset:43008
  ds_read_b64_tr_b16 a[154:155], v15 offset:44032
  buffer_store_dwordx4 v[152:155], v13, s[12:15], s57 offen sc1
  v_mfma_f32_32x32x16_bf16 v[104:119], a[164:167], v[192:195], v[104:119]
  s_waitcnt lgkmcnt(8)
  ds_read_b64_tr_b16 a[156:157], v15 offset:43264
  s_waitcnt vmcnt(22)
  ds_read_b64_tr_b16 a[158:159], v15 offset:44288
  s_barrier
  v_mfma_f32_32x32x16_bf16 v[88:103], a[168:171], v[196:199], v[88:103]
  s_waitcnt lgkmcnt(8)
  ds_read_b64_tr_b16 a[160:161], v15 offset:49152
  s_add_u32 s67, s79, 0x1b300
  ds_read_b64_tr_b16 a[162:163], v15 offset:50176
  s_add_u32 m0, s55, 0x14000
  s_nop 0
  buffer_load_dwordx4 v22, s[24:27], s67 offen lds
  v_mfma_f32_32x32x16_bf16 v[104:119], a[172:175], v[196:199], v[104:119]
  s_waitcnt lgkmcnt(8)
  ds_read_b64_tr_b16 a[164:165], v15 offset:49408
  ds_read_b64_tr_b16 a[166:167], v15 offset:50432
  v_mfma_f32_32x32x16_bf16 v[88:103], a[144:147], v[200:203], v[88:103]
  s_waitcnt lgkmcnt(8)
  ds_read_b64_tr_b16 a[168:169], v15 offset:51200
  s_add_u32 m0, s55, 0x14400
  ds_read_b64_tr_b16 a[170:171], v15 offset:52224
  v_mfma_f32_32x32x16_bf16 v[104:119], a[148:151], v[200:203], v[104:119]
  s_waitcnt lgkmcnt(8)
  ds_read_b64_tr_b16 a[172:173], v15 offset:51456
  ds_read_b64_tr_b16 a[174:175], v15 offset:52480
  buffer_load_dwordx4 v23, s[24:27], s67 offen lds
  v_cvt_pk_bf16_f32 v156, v128, v129
  v_mfma_f32_32x32x16_bf16 v[88:103], a[152:155], v[204:207], v[88:103]
  s_waitcnt lgkmcnt(8)
  ds_read_b64_tr_b16 a[144:145], v15 offset:53248
  ds_read_b64_tr_b16 a[146:147], v15 offset:54272
  v_cvt_pk_bf16_f32 v157, v130, v131
  v_cvt_pk_bf16_f32 v158, v132, v133
  v_cvt_pk_bf16_f32 v159, v134, v135
  v_mfma_f32_32x32x16_bf16 v[104:119], a[156:159], v[204:207], v[104:119]
  s_waitcnt lgkmcnt(8)
  ds_read_b64_tr_b16 a[148:149], v15 offset:53504
  s_add_u32 m0, s55, 0x14800
  ds_read_b64_tr_b16 a[150:151], v15 offset:54528
  s_add_u32 s57, s66, 0xd00
  buffer_store_dwordx4 v[156:159], v13, s[12:15], s57 offen sc1
  v_mfma_f32_32x32x16_bf16 v[88:103], a[160:163], v[208:211], v[88:103]
  s_waitcnt lgkmcnt(8)
  ds_read_b64_tr_b16 a[152:153], v15 offset:55296
  ds_read_b64_tr_b16 a[154:155], v15 offset:56320
  buffer_load_dwordx4 v24, s[24:27], s67 offen lds
  v_mfma_f32_32x32x16_bf16 v[104:119], a[164:167], v[208:211], v[104:119]
  s_waitcnt lgkmcnt(8)
  ds_read_b64_tr_b16 a[156:157], v15 offset:55552
  ds_read_b64_tr_b16 a[158:159], v15 offset:56576
  v_mfma_f32_32x32x16_bf16 v[88:103], a[168:171], v[212:215], v[88:103]
  s_waitcnt lgkmcnt(8)
  ds_read_b64_tr_b16 a[160:161], v15 offset:57344
  ds_read_b64_tr_b16 a[162:163], v15 offset:58368
  v_mfma_f32_32x32x16_bf16 v[104:119], a[172:175], v[212:215], v[104:119]
  s_waitcnt lgkmcnt(8)
  ds_read_b64_tr_b16 a[164:165], v15 offset:57600
  ds_read_b64_tr_b16 a[166:167], v15 offset:58624
  v_mfma_f32_32x32x16_bf16 v[88:103], a[144:147], v[216:219], v[88:103]
  s_waitcnt lgkmcnt(8)
  ds_read_b64_tr_b16 a[168:169], v15 offset:59392
  ds_read_b64_tr_b16 a[170:171], v15 offset:60416
  v_cvt_pk_bf16_f32 v160, v136, v137
  v_cvt_pk_bf16_f32 v161, v138, v139
  v_cvt_pk_bf16_f32 v162, v140, v141
  v_mfma_f32_32x32x16_bf16 v[104:119], a[148:151], v[216:219], v[104:119]
  s_waitcnt lgkmcnt(8)
  ds_read_b64_tr_b16 a[172:173], v15 offset:59648
  s_waitcnt vmcnt(22)
  ds_read_b64_tr_b16 a[174:175], v15 offset:60672
  s_barrier
  v_cvt_pk_bf16_f32 v163, v142, v143
  s_add_u32 s57, s66, 0xe00
  v_mfma_f32_32x32x16_bf16 v[88:103], a[152:155], v[220:223], v[88:103]
  s_waitcnt lgkmcnt(8)
  ds_read_b64_tr_b16 a[144:145], v14
  s_add_u32 s67, s80, 0x300
  ds_read_b64_tr_b16 a[146:147], v14 offset:1024
  s_add_u32 m0, s55, 0x18000
  s_nop 0
  buffer_load_dwordx4 v25, s[24:27], s67 offen lds
  v_mfma_f32_32x32x16_bf16 v[104:119], a[156:159], v[220:223], v[104:119]
  s_waitcnt lgkmcnt(8)
  ds_read_b64_tr_b16 a[148:149], v14 offset:256
  ds_read_b64_tr_b16 a[150:151], v14 offset:1280
  buffer_store_dwordx4 v[160:163], v13, s[12:15], s57 offen sc1
  v_mfma_f32_32x32x16_bf16 v[88:103], a[160:163], v[224:227], v[88:103]
  s_waitcnt lgkmcnt(8)
  ds_read_b64_tr_b16 a[152:153], v14 offset:2048
  s_add_u32 m0, s55, 0x18400
  ds_read_b64_tr_b16 a[154:155], v14 offset:3072
  v_mfma_f32_32x32x16_bf16 v[104:119], a[164:167], v[224:227], v[104:119]
  s_waitcnt lgkmcnt(8)
  ds_read_b64_tr_b16 a[156:157], v14 offset:2304
  ds_read_b64_tr_b16 a[158:159], v14 offset:3328
  buffer_load_dwordx4 v26, s[24:27], s67 offen lds
  v_mfma_f32_32x32x16_bf16 v[88:103], a[168:171], v[228:231], v[88:103]
  s_waitcnt lgkmcnt(8)
  ds_read_b64_tr_b16 a[160:161], v14 offset:4096
  ds_read_b64_tr_b16 a[162:163], v14 offset:5120
  v_mfma_f32_32x32x16_bf16 v[104:119], a[172:175], v[228:231], v[104:119]
  s_waitcnt lgkmcnt(8)
  ds_read_b64_tr_b16 a[164:165], v14 offset:4352
  s_add_u32 m0, s55, 0x18800
  ds_read_b64_tr_b16 a[166:167], v14 offset:5376
  v_cvt_pk_bf16_f32 v164, v144, v145
  v_cvt_pk_bf16_f32 v165, v146, v147
  v_cvt_pk_bf16_f32 v166, v148, v149
  v_mfma_f32_32x32x16_bf16 v[88:103], a[144:147], v[232:235], v[88:103]
  s_waitcnt lgkmcnt(8)
  ds_read_b64_tr_b16 a[168:169], v14 offset:6144
  ds_read_b64_tr_b16 a[170:171], v14 offset:7168
  buffer_load_dwordx4 v27, s[24:27], s67 offen lds
  v_cvt_pk_bf16_f32 v167, v150, v151
  v_mfma_f32_32x32x16_bf16 v[104:119], a[148:151], v[232:235], v[104:119]
  s_waitcnt lgkmcnt(8)
  ds_read_b64_tr_b16 a[172:173], v14 offset:6400
  s_add_u32 s57, s66, 0xf00
  ds_read_b64_tr_b16 a[174:175], v14 offset:7424
  buffer_store_dwordx4 v[164:167], v13, s[12:15], s57 offen sc1
  v_mfma_f32_32x32x16_bf16 v[88:103], a[152:155], v[236:239], v[88:103]
  s_waitcnt lgkmcnt(8)
  ds_read_b64_tr_b16 a[144:145], v14 offset:8192
  ds_read_b64_tr_b16 a[146:147], v14 offset:9216
  v_mfma_f32_32x32x16_bf16 v[104:119], a[156:159], v[236:239], v[104:119]
  s_waitcnt lgkmcnt(8)
  ds_read_b64_tr_b16 a[148:149], v14 offset:8448
  ds_read_b64_tr_b16 a[150:151], v14 offset:9472
  v_mfma_f32_32x32x16_bf16 v[88:103], a[160:163], v[240:243], v[88:103]
  s_waitcnt lgkmcnt(8)
  ds_read_b64_tr_b16 a[152:153], v14 offset:10240
  ds_read_b64_tr_b16 a[154:155], v14 offset:11264
  v_mfma_f32_32x32x16_bf16 v[104:119], a[164:167], v[240:243], v[104:119]
  s_waitcnt lgkmcnt(8)
  ds_read_b64_tr_b16 a[156:157], v14 offset:10496
  s_waitcnt vmcnt(23)
  ds_read_b64_tr_b16 a[158:159], v14 offset:11520
  s_barrier
  v_mfma_f32_32x32x16_bf16 v[88:103], a[168:171], v[244:247], v[88:103]
  s_waitcnt lgkmcnt(8)
  ds_read_b64_tr_b16 a[160:161], v14 offset:16384
  s_add_u32 s67, s79, 0x380
  ds_read_b64_tr_b16 a[162:163], v14 offset:17408
  s_add_u32 m0, s55, 0x1c000
  s_nop 0
  buffer_load_dwordx4 v22, s[24:27], s67 offen lds
  v_mfma_f32_32x32x16_bf16 v[104:119], a[172:175], v[244:247], v[104:119]
  s_waitcnt lgkmcnt(8)
  ds_read_b64_tr_b16 a[164:165], v14 offset:16640
  ds_read_b64_tr_b16 a[166:167], v14 offset:17664
  v_mfma_f32_32x32x16_bf16 v[88:103], a[144:147], v[248:251], v[88:103]
  s_waitcnt lgkmcnt(8)
  ds_read_b64_tr_b16 a[168:169], v14 offset:18432
  s_add_u32 m0, s55, 0x1c400
  ds_read_b64_tr_b16 a[170:171], v14 offset:19456
  v_mfma_f32_32x32x16_bf16 v[104:119], a[148:151], v[248:251], v[104:119]
  s_waitcnt lgkmcnt(8)
  ds_read_b64_tr_b16 a[172:173], v14 offset:18688
  ds_read_b64_tr_b16 a[174:175], v14 offset:19712
  buffer_load_dwordx4 v23, s[24:27], s67 offen lds
  v_mfma_f32_32x32x16_bf16 v[88:103], a[152:155], v[252:255], v[88:103]
  s_waitcnt lgkmcnt(8)
  ds_read_b64_tr_b16 a[144:145], v14 offset:20480
  ds_read_b64_tr_b16 a[146:147], v14 offset:21504
  v_mfma_f32_32x32x16_bf16 v[104:119], a[156:159], v[252:255], v[104:119]
  s_waitcnt lgkmcnt(8)
  ds_read_b64_tr_b16 a[148:149], v14 offset:20736
  s_add_u32 m0, s55, 0x1c800
  ds_read_b64_tr_b16 a[150:151], v14 offset:21760
  v_mfma_f32_32x32x16_bf16 v[120:135], a[160:163], v[184:187], 0
  s_waitcnt lgkmcnt(8)
  ds_read_b64_tr_b16 a[152:153], v14 offset:22528
  ds_read_b64_tr_b16 a[154:155], v14 offset:23552
  buffer_load_dwordx4 v24, s[24:27], s67 offen lds
  v_mfma_f32_32x32x16_bf16 v[136:151], a[164:167], v[184:187], 0
  s_waitcnt lgkmcnt(8)
  ds_read_b64_tr_b16 a[156:157], v14 offset:22784
  ds_read_b64_tr_b16 a[158:159], v14 offset:23808
  v_mfma_f32_32x32x16_bf16 v[120:135], a[168:171], v[188:191], v[120:135]
  s_waitcnt lgkmcnt(8)
  ds_read_b64_tr_b16 a[160:161], v14 offset:24576
  ds_read_b64_tr_b16 a[162:163], v14 offset:25600
  v_cvt_pk_bf16_f32 v152, v88, v89
  v_cvt_pk_bf16_f32 v153, v90, v91
  v_cvt_pk_bf16_f32 v154, v92, v93
  v_mfma_f32_32x32x16_bf16 v[136:151], a[172:175], v[188:191], v[136:151]
  s_waitcnt lgkmcnt(8)
  ds_read_b64_tr_b16 a[164:165], v14 offset:24832
  ds_read_b64_tr_b16 a[166:167], v14 offset:25856
  v_cvt_pk_bf16_f32 v155, v94, v95
  s_add_u32 s57, s66, 0x1000
  v_mfma_f32_32x32x16_bf16 v[120:135], a[144:147], v[192:195], v[120:135]
  s_waitcnt lgkmcnt(8)
  ds_read_b64_tr_b16 a[168:169], v14 offset:26624
  ds_read_b64_tr_b16 a[170:171], v14 offset:27648
  buffer_store_dwordx4 v[152:155], v13, s[12:15], s57 offen sc1
  v_mfma_f32_32x32x16_bf16 v[136:151], a[148:151], v[192:195], v[136:151]
  s_waitcnt lgkmcnt(8)
  ds_read_b64_tr_b16 a[172:173], v14 offset:26880
  s_waitcnt vmcnt(22)
  ds_read_b64_tr_b16 a[174:175], v14 offset:27904
  s_barrier
  v_mfma_f32_32x32x16_bf16 v[120:135], a[152:155], v[196:199], v[120:135]
  s_waitcnt lgkmcnt(8)
  ds_read_b64_tr_b16 a[144:145], v14 offset:32768
  s_add_u32 s67, s79, 0x1b380
  ds_read_b64_tr_b16 a[146:147], v14 offset:33792
  s_add_u32 m0, s55, 0
  s_nop 0
  buffer_load_dwordx4 v22, s[24:27], s67 offen lds
  v_mfma_f32_32x32x16_bf16 v[136:151], a[156:159], v[196:199], v[136:151]
  s_waitcnt lgkmcnt(8)
  ds_read_b64_tr_b16 a[148:149], v14 offset:33024
  ds_read_b64_tr_b16 a[150:151], v14 offset:34048
  v_mfma_f32_32x32x16_bf16 v[120:135], a[160:163], v[200:203], v[120:135]
  s_waitcnt lgkmcnt(8)
  ds_read_b64_tr_b16 a[152:153], v14 offset:34816
  s_add_u32 m0, s55, 0x400
  ds_read_b64_tr_b16 a[154:155], v14 offset:35840
  v_mfma_f32_32x32x16_bf16 v[136:151], a[164:167], v[200:203], v[136:151]
  s_waitcnt lgkmcnt(8)
  ds_read_b64_tr_b16 a[156:157], v14 offset:35072
  ds_read_b64_tr_b16 a[158:159], v14 offset:36096
  buffer_load_dwordx4 v23, s[24:27], s67 offen lds
  v_cvt_pk_bf16_f32 v156, v96, v97
  v_mfma_f32_32x32x16_bf16 v[120:135], a[168:171], v[204:207], v[120:135]
  s_waitcnt lgkmcnt(8)
  ds_read_b64_tr_b16 a[160:161], v14 offset:36864
  ds_read_b64_tr_b16 a[162:163], v14 offset:37888
  v_cvt_pk_bf16_f32 v157, v98, v99
  v_cvt_pk_bf16_f32 v158, v100, v101
  v_cvt_pk_bf16_f32 v159, v102, v103
  v_mfma_f32_32x32x16_bf16 v[136:151], a[172:175], v[204:207], v[136:151]
  s_waitcnt lgkmcnt(8)
  ds_read_b64_tr_b16 a[164:165], v14 offset:37120
  s_add_u32 m0, s55, 0x800
  ds_read_b64_tr_b16 a[166:167], v14 offset:38144
  s_add_u32 s57, s66, 0x1100
  buffer_store_dwordx4 v[156:159], v13, s[12:15], s57 offen sc1
  v_mfma_f32_32x32x16_bf16 v[120:135], a[144:147], v[208:211], v[120:135]
  s_waitcnt lgkmcnt(8)
  ds_read_b64_tr_b16 a[168:169], v14 offset:38912
  ds_read_b64_tr_b16 a[170:171], v14 offset:39936
  buffer_load_dwordx4 v24, s[24:27], s67 offen lds
  v_mfma_f32_32x32x16_bf16 v[136:151], a[148:151], v[208:211], v[136:151]
  s_waitcnt lgkmcnt(8)
  ds_read_b64_tr_b16 a[172:173], v14 offset:39168
  ds_read_b64_tr_b16 a[174:175], v14 offset:40192
  v_mfma_f32_32x32x16_bf16 v[120:135], a[152:155], v[212:215], v[120:135]
  s_waitcnt lgkmcnt(8)
  ds_read_b64_tr_b16 a[144:145], v14 offset:40960
  ds_read_b64_tr_b16 a[146:147], v14 offset:41984
  v_mfma_f32_32x32x16_bf16 v[136:151], a[156:159], v[212:215], v[136:151]
  s_waitcnt lgkmcnt(8)
  ds_read_b64_tr_b16 a[148:149], v14 offset:41216
  ds_read_b64_tr_b16 a[150:151], v14 offset:42240
  v_mfma_f32_32x32x16_bf16 v[120:135], a[160:163], v[216:219], v[120:135]
  s_waitcnt lgkmcnt(8)
  ds_read_b64_tr_b16 a[152:153], v14 offset:43008
  ds_read_b64_tr_b16 a[154:155], v14 offset:44032
  v_cvt_pk_bf16_f32 v160, v104, v105
  v_cvt_pk_bf16_f32 v161, v106, v107
  v_cvt_pk_bf16_f32 v162, v108, v109
  v_mfma_f32_32x32x16_bf16 v[136:151], a[164:167], v[216:219], v[136:151]
  s_waitcnt lgkmcnt(8)
  ds_read_b64_tr_b16 a[156:157], v14 offset:43264
  s_waitcnt vmcnt(22)
  ds_read_b64_tr_b16 a[158:159], v14 offset:44288
  s_barrier
  v_cvt_pk_bf16_f32 v163, v110, v111
  s_add_u32 s57, s66, 0x1200
  v_mfma_f32_32x32x16_bf16 v[120:135], a[168:171], v[220:223], v[120:135]
  s_waitcnt lgkmcnt(8)
  ds_read_b64_tr_b16 a[160:161], v14 offset:49152
  s_add_u32 s67, s80, 0x380
  ds_read_b64_tr_b16 a[162:163], v14 offset:50176
  s_add_u32 m0, s55, 0x4000
  s_nop 0
  buffer_load_dwordx4 v25, s[24:27], s67 offen lds
  v_mfma_f32_32x32x16_bf16 v[136:151], a[172:175], v[220:223], v[136:151]
  s_waitcnt lgkmcnt(8)
  ds_read_b64_tr_b16 a[164:165], v14 offset:49408
  ds_read_b64_tr_b16 a[166:167], v14 offset:50432
  buffer_store_dwordx4 v[160:163], v13, s[12:15], s57 offen sc1
  v_mfma_f32_32x32x16_bf16 v[120:135], a[144:147], v[224:227], v[120:135]
  s_waitcnt lgkmcnt(8)
  ds_read_b64_tr_b16 a[168:169], v14 offset:51200
  s_add_u32 m0, s55, 0x4400
  ds_read_b64_tr_b16 a[170:171], v14 offset:52224
  v_mfma_f32_32x32x16_bf16 v[136:151], a[148:151], v[224:227], v[136:151]
  s_waitcnt lgkmcnt(8)
  ds_read_b64_tr_b16 a[172:173], v14 offset:51456
  ds_read_b64_tr_b16 a[174:175], v14 offset:52480
  buffer_load_dwordx4 v26, s[24:27], s67 offen lds
  v_mfma_f32_32x32x16_bf16 v[120:135], a[152:155], v[228:231], v[120:135]
  s_waitcnt lgkmcnt(8)
  ds_read_b64_tr_b16 a[144:145], v14 offset:53248
  ds_read_b64_tr_b16 a[146:147], v14 offset:54272
  v_mfma_f32_32x32x16_bf16 v[136:151], a[156:159], v[228:231], v[136:151]
  s_waitcnt lgkmcnt(8)
  ds_read_b64_tr_b16 a[148:149], v14 offset:53504
  s_add_u32 m0, s55, 0x4800
  ds_read_b64_tr_b16 a[150:151], v14 offset:54528
  v_cvt_pk_bf16_f32 v164, v112, v113
  v_cvt_pk_bf16_f32 v165, v114, v115
  v_cvt_pk_bf16_f32 v166, v116, v117
  v_mfma_f32_32x32x16_bf16 v[120:135], a[160:163], v[232:235], v[120:135]
  s_waitcnt lgkmcnt(8)
  ds_read_b64_tr_b16 a[152:153], v14 offset:55296
  ds_read_b64_tr_b16 a[154:155], v14 offset:56320
  buffer_load_dwordx4 v27, s[24:27], s67 offen lds
  v_cvt_pk_bf16_f32 v167, v118, v119
  v_mfma_f32_32x32x16_bf16 v[136:151], a[164:167], v[232:235], v[136:151]
  s_waitcnt lgkmcnt(8)
  ds_read_b64_tr_b16 a[156:157], v14 offset:55552
  s_add_u32 s57, s66, 0x1300
  ds_read_b64_tr_b16 a[158:159], v14 offset:56576
  buffer_store_dwordx4 v[164:167], v13, s[12:15], s57 offen sc1
  v_mfma_f32_32x32x16_bf16 v[120:135], a[168:171], v[236:239], v[120:135]
  s_waitcnt lgkmcnt(8)
  ds_read_b64_tr_b16 a[160:161], v14 offset:57344
  ds_read_b64_tr_b16 a[162:163], v14 offset:58368
  v_mfma_f32_32x32x16_bf16 v[136:151], a[172:175], v[236:239], v[136:151]
  s_waitcnt lgkmcnt(8)
  ds_read_b64_tr_b16 a[164:165], v14 offset:57600
  ds_read_b64_tr_b16 a[166:167], v14 offset:58624
  v_mfma_f32_32x32x16_bf16 v[120:135], a[144:147], v[240:243], v[120:135]
  s_waitcnt lgkmcnt(8)
  ds_read_b64_tr_b16 a[168:169], v14 offset:59392
  ds_read_b64_tr_b16 a[170:171], v14 offset:60416
  v_mfma_f32_32x32x16_bf16 v[136:151], a[148:151], v[240:243], v[136:151]
  s_waitcnt lgkmcnt(8)
  ds_read_b64_tr_b16 a[172:173], v14 offset:59648
  s_waitcnt vmcnt(23)
  ds_read_b64_tr_b16 a[174:175], v14 offset:60672
  s_barrier
  v_mfma_f32_32x32x16_bf16 v[120:135], a[152:155], v[244:247], v[120:135]
  s_waitcnt lgkmcnt(8)
  ds_read_b64_tr_b16 a[144:145], v15
  s_add_u32 s67, s79, 0x400
  ds_read_b64_tr_b16 a[146:147], v15 offset:1024
  s_add_u32 m0, s55, 0x8000
  s_nop 0
  buffer_load_dwordx4 v22, s[24:27], s67 offen lds
  v_mfma_f32_32x32x16_bf16 v[136:151], a[156:159], v[244:247], v[136:151]
  s_waitcnt lgkmcnt(8)
  ds_read_b64_tr_b16 a[148:149], v15 offset:256
  ds_read_b64_tr_b16 a[150:151], v15 offset:1280
  v_mfma_f32_32x32x16_bf16 v[120:135], a[160:163], v[248:251], v[120:135]
  s_waitcnt lgkmcnt(8)
  ds_read_b64_tr_b16 a[152:153], v15 offset:2048
  s_add_u32 m0, s55, 0x8400
  ds_read_b64_tr_b16 a[154:155], v15 offset:3072
  v_mfma_f32_32x32x16_bf16 v[136:151], a[164:167], v[248:251], v[136:151]
  s_waitcnt lgkmcnt(8)
  ds_read_b64_tr_b16 a[156:157], v15 offset:2304
  ds_read_b64_tr_b16 a[158:159], v15 offset:3328
  buffer_load_dwordx4 v23, s[24:27], s67 offen lds
  v_mfma_f32_32x32x16_bf16 v[120:135], a[168:171], v[252:255], v[120:135]
  s_waitcnt lgkmcnt(8)
  ds_read_b64_tr_b16 a[160:161], v15 offset:4096
  ds_read_b64_tr_b16 a[162:163], v15 offset:5120
  v_mfma_f32_32x32x16_bf16 v[136:151], a[172:175], v[252:255], v[136:151]
  s_waitcnt lgkmcnt(8)
  ds_read_b64_tr_b16 a[164:165], v15 offset:4352
  s_add_u32 m0, s55, 0x8800
  ds_read_b64_tr_b16 a[166:167], v15 offset:5376
  v_mfma_f32_32x32x16_bf16 v[88:103], a[144:147], v[184:187], 0
  s_waitcnt lgkmcnt(8)
  ds_read_b64_tr_b16 a[168:169], v15 offset:6144
  ds_read_b64_tr_b16 a[170:171], v15 offset:7168
  buffer_load_dwordx4 v24, s[24:27], s67 offen lds
  v_mfma_f32_32x32x16_bf16 v[104:119], a[148:151], v[184:187], 0
  s_waitcnt lgkmcnt(8)
  ds_read_b64_tr_b16 a[172:173], v15 offset:6400
  ds_read_b64_tr_b16 a[174:175], v15 offset:7424
  v_mfma_f32_32x32x16_bf16 v[88:103], a[152:155], v[188:191], v[88:103]
  s_waitcnt lgkmcnt(8)
  ds_read_b64_tr_b16 a[144:145], v15 offset:8192
  ds_read_b64_tr_b16 a[146:147], v15 offset:9216
  v_cvt_pk_bf16_f32 v152, v120, v121
  v_cvt_pk_bf16_f32 v153, v122, v123
  v_cvt_pk_bf16_f32 v154, v124, v125
  v_mfma_f32_32x32x16_bf16 v[104:119], a[156:159], v[188:191], v[104:119]
  s_waitcnt lgkmcnt(8)
  ds_read_b64_tr_b16 a[148:149], v15 offset:8448
  ds_read_b64_tr_b16 a[150:151], v15 offset:9472
  v_cvt_pk_bf16_f32 v155, v126, v127
  s_add_u32 s57, s66, 0x1400
  v_mfma_f32_32x32x16_bf16 v[88:103], a[160:163], v[192:195], v[88:103]
  s_waitcnt lgkmcnt(8)
  ds_read_b64_tr_b16 a[152:153], v15 offset:10240
  ds_read_b64_tr_b16 a[154:155], v15 offset:11264
  buffer_store_dwordx4 v[152:155], v13, s[12:15], s57 offen sc1
  v_mfma_f32_32x32x16_bf16 v[104:119], a[164:167], v[192:195], v[104:119]
  s_waitcnt lgkmcnt(8)
  ds_read_b64_tr_b16 a[156:157], v15 offset:10496
  s_waitcnt vmcnt(22)
  ds_read_b64_tr_b16 a[158:159], v15 offset:11520
  s_barrier
  v_mfma_f32_32x32x16_bf16 v[88:103], a[168:171], v[196:199], v[88:103]
  s_waitcnt lgkmcnt(8)
  ds_read_b64_tr_b16 a[160:161], v15 offset:16384
  s_add_u32 s67, s79, 0x1b400
  ds_read_b64_tr_b16 a[162:163], v15 offset:17408
  s_add_u32 m0, s55, 0xc000
  s_nop 0
  buffer_load_dwordx4 v22, s[24:27], s67 offen lds
  v_mfma_f32_32x32x16_bf16 v[104:119], a[172:175], v[196:199], v[104:119]
  s_waitcnt lgkmcnt(8)
  ds_read_b64_tr_b16 a[164:165], v15 offset:16640
  s_waitcnt vmcnt(18)
  ds_read_b64_tr_b16 a[166:167], v15 offset:17664
  s_barrier
  v_mov_b32 v57, 1
  buffer_atomic_add v57, v16, s[8:11], 0 offen offset:128 sc1
  v_mfma_f32_32x32x16_bf16 v[88:103], a[144:147], v[200:203], v[88:103]
  s_waitcnt lgkmcnt(8)
  ds_read_b64_tr_b16 a[168:169], v15 offset:18432
  s_add_u32 m0, s55, 0xc400
  ds_read_b64_tr_b16 a[170:171], v15 offset:19456
  v_mfma_f32_32x32x16_bf16 v[104:119], a[148:151], v[200:203], v[104:119]
  s_waitcnt lgkmcnt(8)
  ds_read_b64_tr_b16 a[172:173], v15 offset:18688
  ds_read_b64_tr_b16 a[174:175], v15 offset:19712
  buffer_load_dwordx4 v23, s[24:27], s67 offen lds
  v_cvt_pk_bf16_f32 v156, v128, v129
  v_mfma_f32_32x32x16_bf16 v[88:103], a[152:155], v[204:207], v[88:103]
  s_waitcnt lgkmcnt(8)
  ds_read_b64_tr_b16 a[144:145], v15 offset:20480
  ds_read_b64_tr_b16 a[146:147], v15 offset:21504
  v_cvt_pk_bf16_f32 v157, v130, v131
  v_cvt_pk_bf16_f32 v158, v132, v133
  v_cvt_pk_bf16_f32 v159, v134, v135
  v_mfma_f32_32x32x16_bf16 v[104:119], a[156:159], v[204:207], v[104:119]
  s_waitcnt lgkmcnt(8)
  ds_read_b64_tr_b16 a[148:149], v15 offset:20736
  s_add_u32 m0, s55, 0xc800
  ds_read_b64_tr_b16 a[150:151], v15 offset:21760
  s_add_u32 s57, s66, 0x1500
  buffer_store_dwordx4 v[156:159], v13, s[12:15], s57 offen sc1
  v_mfma_f32_32x32x16_bf16 v[88:103], a[160:163], v[208:211], v[88:103]
  s_waitcnt lgkmcnt(8)
  ds_read_b64_tr_b16 a[152:153], v15 offset:22528
  ds_read_b64_tr_b16 a[154:155], v15 offset:23552
  buffer_load_dwordx4 v24, s[24:27], s67 offen lds
  v_mfma_f32_32x32x16_bf16 v[104:119], a[164:167], v[208:211], v[104:119]
  s_waitcnt lgkmcnt(8)
  ds_read_b64_tr_b16 a[156:157], v15 offset:22784
  ds_read_b64_tr_b16 a[158:159], v15 offset:23808
  v_mfma_f32_32x32x16_bf16 v[88:103], a[168:171], v[212:215], v[88:103]
  s_waitcnt lgkmcnt(8)
  ds_read_b64_tr_b16 a[160:161], v15 offset:24576
  ds_read_b64_tr_b16 a[162:163], v15 offset:25600
  v_mfma_f32_32x32x16_bf16 v[104:119], a[172:175], v[212:215], v[104:119]
  s_waitcnt lgkmcnt(8)
  ds_read_b64_tr_b16 a[164:165], v15 offset:24832
  ds_read_b64_tr_b16 a[166:167], v15 offset:25856
  v_mfma_f32_32x32x16_bf16 v[88:103], a[144:147], v[216:219], v[88:103]
  s_waitcnt lgkmcnt(8)
  ds_read_b64_tr_b16 a[168:169], v15 offset:26624
  ds_read_b64_tr_b16 a[170:171], v15 offset:27648
  v_cvt_pk_bf16_f32 v160, v136, v137
  v_cvt_pk_bf16_f32 v161, v138, v139
  v_cvt_pk_bf16_f32 v162, v140, v141
  v_mfma_f32_32x32x16_bf16 v[104:119], a[148:151], v[216:219], v[104:119]
  s_waitcnt lgkmcnt(8)
  ds_read_b64_tr_b16 a[172:173], v15 offset:26880
  ds_read_b64_tr_b16 a[174:175], v15 offset:27904
  s_barrier
  v_cvt_pk_bf16_f32 v163, v142, v143
  s_add_u32 s57, s66, 0x1600
  v_mfma_f32_32x32x16_bf16 v[88:103], a[152:155], v[220:223], v[88:103]
  s_waitcnt lgkmcnt(8)
  ds_read_b64_tr_b16 a[144:145], v15 offset:32768
  s_add_u32 s67, s80, 0x400
  ds_read_b64_tr_b16 a[146:147], v15 offset:33792
  s_add_u32 m0, s55, 0x10000
  s_nop 0
  buffer_load_dwordx4 v25, s[24:27], s67 offen lds
  v_mfma_f32_32x32x16_bf16 v[104:119], a[156:159], v[220:223], v[104:119]
  s_waitcnt lgkmcnt(8)
  ds_read_b64_tr_b16 a[148:149], v15 offset:33024
  ds_read_b64_tr_b16 a[150:151], v15 offset:34048
  buffer_store_dwordx4 v[160:163], v13, s[12:15], s57 offen sc1
  v_mfma_f32_32x32x16_bf16 v[88:103], a[160:163], v[224:227], v[88:103]
  s_waitcnt lgkmcnt(8)
  ds_read_b64_tr_b16 a[152:153], v15 offset:34816
  s_add_u32 m0, s55, 0x10400
  ds_read_b64_tr_b16 a[154:155], v15 offset:35840
  v_mfma_f32_32x32x16_bf16 v[104:119], a[164:167], v[224:227], v[104:119]
  s_waitcnt lgkmcnt(8)
  ds_read_b64_tr_b16 a[156:157], v15 offset:35072
  ds_read_b64_tr_b16 a[158:159], v15 offset:36096
  buffer_load_dwordx4 v26, s[24:27], s67 offen lds
  v_mfma_f32_32x32x16_bf16 v[88:103], a[168:171], v[228:231], v[88:103]
  s_waitcnt lgkmcnt(8)
  ds_read_b64_tr_b16 a[160:161], v15 offset:36864
  ds_read_b64_tr_b16 a[162:163], v15 offset:37888
  v_mfma_f32_32x32x16_bf16 v[104:119], a[172:175], v[228:231], v[104:119]
  s_waitcnt lgkmcnt(8)
  ds_read_b64_tr_b16 a[164:165], v15 offset:37120
  s_add_u32 m0, s55, 0x10800
  ds_read_b64_tr_b16 a[166:167], v15 offset:38144
  v_cvt_pk_bf16_f32 v164, v144, v145
  v_cvt_pk_bf16_f32 v165, v146, v147
  v_cvt_pk_bf16_f32 v166, v148, v149
  v_mfma_f32_32x32x16_bf16 v[88:103], a[144:147], v[232:235], v[88:103]
  s_waitcnt lgkmcnt(8)
  ds_read_b64_tr_b16 a[168:169], v15 offset:38912
  ds_read_b64_tr_b16 a[170:171], v15 offset:39936
  buffer_load_dwordx4 v27, s[24:27], s67 offen lds
  v_cvt_pk_bf16_f32 v167, v150, v151
  v_mfma_f32_32x32x16_bf16 v[104:119], a[148:151], v[232:235], v[104:119]
  s_waitcnt lgkmcnt(8)
  ds_read_b64_tr_b16 a[172:173], v15 offset:39168
  s_add_u32 s57, s66, 0x1700
  ds_read_b64_tr_b16 a[174:175], v15 offset:40192
  buffer_store_dwordx4 v[164:167], v13, s[12:15], s57 offen sc1
  v_mfma_f32_32x32x16_bf16 v[88:103], a[152:155], v[236:239], v[88:103]
  s_waitcnt lgkmcnt(8)
  ds_read_b64_tr_b16 a[144:145], v15 offset:40960
  ds_read_b64_tr_b16 a[146:147], v15 offset:41984
  v_mfma_f32_32x32x16_bf16 v[104:119], a[156:159], v[236:239], v[104:119]
  s_waitcnt lgkmcnt(8)
  ds_read_b64_tr_b16 a[148:149], v15 offset:41216
  ds_read_b64_tr_b16 a[150:151], v15 offset:42240
  v_mfma_f32_32x32x16_bf16 v[88:103], a[160:163], v[240:243], v[88:103]
  s_waitcnt lgkmcnt(8)
  ds_read_b64_tr_b16 a[152:153], v15 offset:43008
  ds_read_b64_tr_b16 a[154:155], v15 offset:44032
  v_mfma_f32_32x32x16_bf16 v[104:119], a[164:167], v[240:243], v[104:119]
  s_waitcnt lgkmcnt(8)
  ds_read_b64_tr_b16 a[156:157], v15 offset:43264
  s_waitcnt vmcnt(24)
  ds_read_b64_tr_b16 a[158:159], v15 offset:44288
  s_barrier
  v_mfma_f32_32x32x16_bf16 v[88:103], a[168:171], v[244:247], v[88:103]
  s_waitcnt lgkmcnt(8)
  ds_read_b64_tr_b16 a[160:161], v15 offset:49152
  ds_read_b64_tr_b16 a[162:163], v15 offset:50176
  v_mfma_f32_32x32x16_bf16 v[104:119], a[172:175], v[244:247], v[104:119]
  s_waitcnt lgkmcnt(8)
  ds_read_b64_tr_b16 a[164:165], v15 offset:49408
  ds_read_b64_tr_b16 a[166:167], v15 offset:50432
  v_mfma_f32_32x32x16_bf16 v[88:103], a[144:147], v[248:251], v[88:103]
  s_waitcnt lgkmcnt(8)
  ds_read_b64_tr_b16 a[168:169], v15 offset:51200
  ds_read_b64_tr_b16 a[170:171], v15 offset:52224
  v_mfma_f32_32x32x16_bf16 v[104:119], a[148:151], v[248:251], v[104:119]
  s_waitcnt lgkmcnt(8)
  ds_read_b64_tr_b16 a[172:173], v15 offset:51456
  ds_read_b64_tr_b16 a[174:175], v15 offset:52480
  v_mfma_f32_32x32x16_bf16 v[88:103], a[152:155], v[252:255], v[88:103]
  s_waitcnt lgkmcnt(8)
  ds_read_b64_tr_b16 a[144:145], v15 offset:53248
  ds_read_b64_tr_b16 a[146:147], v15 offset:54272
  v_mfma_f32_32x32x16_bf16 v[104:119], a[156:159], v[252:255], v[104:119]
  s_waitcnt lgkmcnt(8)
  ds_read_b64_tr_b16 a[148:149], v15 offset:53504
  ds_read_b64_tr_b16 a[150:151], v15 offset:54528
  v_mfma_f32_32x32x16_bf16 v[120:135], a[160:163], v[184:187], 0
  s_waitcnt lgkmcnt(8)
  ds_read_b64_tr_b16 a[152:153], v15 offset:55296
  ds_read_b64_tr_b16 a[154:155], v15 offset:56320
  v_mfma_f32_32x32x16_bf16 v[136:151], a[164:167], v[184:187], 0
  s_waitcnt lgkmcnt(8)
  ds_read_b64_tr_b16 a[156:157], v15 offset:55552
  ds_read_b64_tr_b16 a[158:159], v15 offset:56576
  v_mfma_f32_32x32x16_bf16 v[120:135], a[168:171], v[188:191], v[120:135]
  s_waitcnt lgkmcnt(8)
  ds_read_b64_tr_b16 a[160:161], v15 offset:57344
  ds_read_b64_tr_b16 a[162:163], v15 offset:58368
  v_cvt_pk_bf16_f32 v152, v88, v89
  v_cvt_pk_bf16_f32 v153, v90, v91
  v_cvt_pk_bf16_f32 v154, v92, v93
  v_mfma_f32_32x32x16_bf16 v[136:151], a[172:175], v[188:191], v[136:151]
  s_waitcnt lgkmcnt(8)
  ds_read_b64_tr_b16 a[164:165], v15 offset:57600
  ds_read_b64_tr_b16 a[166:167], v15 offset:58624
  v_cvt_pk_bf16_f32 v155, v94, v95
  s_add_u32 s57, s66, 0x1800
  v_mfma_f32_32x32x16_bf16 v[120:135], a[144:147], v[192:195], v[120:135]
  s_waitcnt lgkmcnt(8)
  ds_read_b64_tr_b16 a[168:169], v15 offset:59392
  ds_read_b64_tr_b16 a[170:171], v15 offset:60416
  buffer_store_dwordx4 v[152:155], v13, s[12:15], s57 offen sc1
  v_mfma_f32_32x32x16_bf16 v[136:151], a[148:151], v[192:195], v[136:151]
  s_waitcnt lgkmcnt(8)
  ds_read_b64_tr_b16 a[172:173], v15 offset:59648
  s_waitcnt vmcnt(20)
  ds_read_b64_tr_b16 a[174:175], v15 offset:60672
  s_barrier
  v_mfma_f32_32x32x16_bf16 v[120:135], a[152:155], v[196:199], v[120:135]
  s_waitcnt lgkmcnt(8)
  ds_read_b64_tr_b16 a[144:145], v14
  ds_read_b64_tr_b16 a[146:147], v14 offset:1024
  v_mfma_f32_32x32x16_bf16 v[136:151], a[156:159], v[196:199], v[136:151]
  s_waitcnt lgkmcnt(8)
  ds_read_b64_tr_b16 a[148:149], v14 offset:256
  ds_read_b64_tr_b16 a[150:151], v14 offset:1280
  v_mfma_f32_32x32x16_bf16 v[120:135], a[160:163], v[200:203], v[120:135]
  s_waitcnt lgkmcnt(8)
  ds_read_b64_tr_b16 a[152:153], v14 offset:2048
  ds_read_b64_tr_b16 a[154:155], v14 offset:3072
  v_mfma_f32_32x32x16_bf16 v[136:151], a[164:167], v[200:203], v[136:151]
  s_waitcnt lgkmcnt(8)
  ds_read_b64_tr_b16 a[156:157], v14 offset:2304
  ds_read_b64_tr_b16 a[158:159], v14 offset:3328
  v_cvt_pk_bf16_f32 v156, v96, v97
  v_cvt_pk_bf16_f32 v157, v98, v99
  v_cvt_pk_bf16_f32 v158, v100, v101
  v_mfma_f32_32x32x16_bf16 v[120:135], a[168:171], v[204:207], v[120:135]
  s_waitcnt lgkmcnt(8)
  ds_read_b64_tr_b16 a[160:161], v14 offset:4096
  ds_read_b64_tr_b16 a[162:163], v14 offset:5120
  v_cvt_pk_bf16_f32 v159, v102, v103
  s_add_u32 s57, s66, 0x1900
  v_mfma_f32_32x32x16_bf16 v[136:151], a[172:175], v[204:207], v[136:151]
  s_waitcnt lgkmcnt(8)
  ds_read_b64_tr_b16 a[164:165], v14 offset:4352
  ds_read_b64_tr_b16 a[166:167], v14 offset:5376
  buffer_store_dwordx4 v[156:159], v13, s[12:15], s57 offen sc1
  v_mfma_f32_32x32x16_bf16 v[120:135], a[144:147], v[208:211], v[120:135]
  s_waitcnt lgkmcnt(8)
  ds_read_b64_tr_b16 a[168:169], v14 offset:6144
  ds_read_b64_tr_b16 a[170:171], v14 offset:7168
  v_mfma_f32_32x32x16_bf16 v[136:151], a[148:151], v[208:211], v[136:151]
  s_waitcnt lgkmcnt(8)
  ds_read_b64_tr_b16 a[172:173], v14 offset:6400
  ds_read_b64_tr_b16 a[174:175], v14 offset:7424
  v_mfma_f32_32x32x16_bf16 v[120:135], a[152:155], v[212:215], v[120:135]
  s_waitcnt lgkmcnt(8)
  ds_read_b64_tr_b16 a[144:145], v14 offset:8192
  ds_read_b64_tr_b16 a[146:147], v14 offset:9216
  v_mfma_f32_32x32x16_bf16 v[136:151], a[156:159], v[212:215], v[136:151]
  s_waitcnt lgkmcnt(8)
  ds_read_b64_tr_b16 a[148:149], v14 offset:8448
  ds_read_b64_tr_b16 a[150:151], v14 offset:9472
  v_mfma_f32_32x32x16_bf16 v[120:135], a[160:163], v[216:219], v[120:135]
  s_waitcnt lgkmcnt(8)
  ds_read_b64_tr_b16 a[152:153], v14 offset:10240
  ds_read_b64_tr_b16 a[154:155], v14 offset:11264
  v_cvt_pk_bf16_f32 v160, v104, v105
  v_cvt_pk_bf16_f32 v161, v106, v107
  v_cvt_pk_bf16_f32 v162, v108, v109
  v_mfma_f32_32x32x16_bf16 v[136:151], a[164:167], v[216:219], v[136:151]
  s_waitcnt lgkmcnt(8)
  ds_read_b64_tr_b16 a[156:157], v14 offset:10496
  s_waitcnt vmcnt(17)
  ds_read_b64_tr_b16 a[158:159], v14 offset:11520
  s_barrier
  v_cvt_pk_bf16_f32 v163, v110, v111
  s_add_u32 s57, s66, 0x1a00
  v_mfma_f32_32x32x16_bf16 v[120:135], a[168:171], v[220:223], v[120:135]
  s_waitcnt lgkmcnt(8)
  ds_read_b64_tr_b16 a[160:161], v14 offset:16384
  ds_read_b64_tr_b16 a[162:163], v14 offset:17408
  buffer_store_dwordx4 v[160:163], v13, s[12:15], s57 offen sc1
  v_mfma_f32_32x32x16_bf16 v[136:151], a[172:175], v[220:223], v[136:151]
  s_waitcnt lgkmcnt(8)
  ds_read_b64_tr_b16 a[164:165], v14 offset:16640
  ds_read_b64_tr_b16 a[166:167], v14 offset:17664
  v_mfma_f32_32x32x16_bf16 v[120:135], a[144:147], v[224:227], v[120:135]
  s_waitcnt lgkmcnt(8)
  ds_read_b64_tr_b16 a[168:169], v14 offset:18432
  ds_read_b64_tr_b16 a[170:171], v14 offset:19456
  v_mfma_f32_32x32x16_bf16 v[136:151], a[148:151], v[224:227], v[136:151]
  s_waitcnt lgkmcnt(8)
  ds_read_b64_tr_b16 a[172:173], v14 offset:18688
  ds_read_b64_tr_b16 a[174:175], v14 offset:19712
  v_mfma_f32_32x32x16_bf16 v[120:135], a[152:155], v[228:231], v[120:135]
  s_waitcnt lgkmcnt(8)
  ds_read_b64_tr_b16 a[144:145], v14 offset:20480
  ds_read_b64_tr_b16 a[146:147], v14 offset:21504
  v_mfma_f32_32x32x16_bf16 v[136:151], a[156:159], v[228:231], v[136:151]
  s_waitcnt lgkmcnt(8)
  ds_read_b64_tr_b16 a[148:149], v14 offset:20736
  ds_read_b64_tr_b16 a[150:151], v14 offset:21760
  v_cvt_pk_bf16_f32 v164, v112, v113
  v_cvt_pk_bf16_f32 v165, v114, v115
  v_cvt_pk_bf16_f32 v166, v116, v117
  v_mfma_f32_32x32x16_bf16 v[120:135], a[160:163], v[232:235], v[120:135]
  s_waitcnt lgkmcnt(8)
  ds_read_b64_tr_b16 a[152:153], v14 offset:22528
  ds_read_b64_tr_b16 a[154:155], v14 offset:23552
  v_cvt_pk_bf16_f32 v167, v118, v119
  s_add_u32 s57, s66, 0x1b00
  v_mfma_f32_32x32x16_bf16 v[136:151], a[164:167], v[232:235], v[136:151]
  s_waitcnt lgkmcnt(8)
  ds_read_b64_tr_b16 a[156:157], v14 offset:22784
  ds_read_b64_tr_b16 a[158:159], v14 offset:23808
  buffer_store_dwordx4 v[164:167], v13, s[12:15], s57 offen sc1
  v_mfma_f32_32x32x16_bf16 v[120:135], a[168:171], v[236:239], v[120:135]
  s_waitcnt lgkmcnt(8)
  ds_read_b64_tr_b16 a[160:161], v14 offset:24576
  ds_read_b64_tr_b16 a[162:163], v14 offset:25600
  v_mfma_f32_32x32x16_bf16 v[136:151], a[172:175], v[236:239], v[136:151]
  s_waitcnt lgkmcnt(8)
  ds_read_b64_tr_b16 a[164:165], v14 offset:24832
  ds_read_b64_tr_b16 a[166:167], v14 offset:25856
  v_mfma_f32_32x32x16_bf16 v[120:135], a[144:147], v[240:243], v[120:135]
  s_waitcnt lgkmcnt(8)
  ds_read_b64_tr_b16 a[168:169], v14 offset:26624
  ds_read_b64_tr_b16 a[170:171], v14 offset:27648
  v_mfma_f32_32x32x16_bf16 v[136:151], a[148:151], v[240:243], v[136:151]
  s_waitcnt lgkmcnt(8)
  ds_read_b64_tr_b16 a[172:173], v14 offset:26880
  s_waitcnt vmcnt(15)
  ds_read_b64_tr_b16 a[174:175], v14 offset:27904
  s_barrier
  v_mfma_f32_32x32x16_bf16 v[120:135], a[152:155], v[244:247], v[120:135]
  s_waitcnt lgkmcnt(8)
  ds_read_b64_tr_b16 a[144:145], v14 offset:32768
  ds_read_b64_tr_b16 a[146:147], v14 offset:33792
  v_mfma_f32_32x32x16_bf16 v[136:151], a[156:159], v[244:247], v[136:151]
  s_waitcnt lgkmcnt(8)
  ds_read_b64_tr_b16 a[148:149], v14 offset:33024
  ds_read_b64_tr_b16 a[150:151], v14 offset:34048
  v_mfma_f32_32x32x16_bf16 v[120:135], a[160:163], v[248:251], v[120:135]
  s_waitcnt lgkmcnt(8)
  ds_read_b64_tr_b16 a[152:153], v14 offset:34816
  ds_read_b64_tr_b16 a[154:155], v14 offset:35840
  v_mfma_f32_32x32x16_bf16 v[136:151], a[164:167], v[248:251], v[136:151]
  s_waitcnt lgkmcnt(8)
  ds_read_b64_tr_b16 a[156:157], v14 offset:35072
  ds_read_b64_tr_b16 a[158:159], v14 offset:36096
  v_mfma_f32_32x32x16_bf16 v[120:135], a[168:171], v[252:255], v[120:135]
  s_waitcnt lgkmcnt(8)
  ds_read_b64_tr_b16 a[160:161], v14 offset:36864
  ds_read_b64_tr_b16 a[162:163], v14 offset:37888
  v_mfma_f32_32x32x16_bf16 v[136:151], a[172:175], v[252:255], v[136:151]
  s_waitcnt lgkmcnt(8)
  ds_read_b64_tr_b16 a[164:165], v14 offset:37120
  ds_read_b64_tr_b16 a[166:167], v14 offset:38144
  v_mfma_f32_32x32x16_bf16 v[88:103], a[144:147], v[184:187], 0
  s_waitcnt lgkmcnt(8)
  ds_read_b64_tr_b16 a[168:169], v14 offset:38912
  ds_read_b64_tr_b16 a[170:171], v14 offset:39936
  v_mfma_f32_32x32x16_bf16 v[104:119], a[148:151], v[184:187], 0
  s_waitcnt lgkmcnt(8)
  ds_read_b64_tr_b16 a[172:173], v14 offset:39168
  ds_read_b64_tr_b16 a[174:175], v14 offset:40192
  v_mfma_f32_32x32x16_bf16 v[88:103], a[152:155], v[188:191], v[88:103]
  s_waitcnt lgkmcnt(8)
  ds_read_b64_tr_b16 a[144:145], v14 offset:40960
  ds_read_b64_tr_b16 a[146:147], v14 offset:41984
  v_cvt_pk_bf16_f32 v152, v120, v121
  v_cvt_pk_bf16_f32 v153, v122, v123
  v_cvt_pk_bf16_f32 v154, v124, v125
  v_mfma_f32_32x32x16_bf16 v[104:119], a[156:159], v[188:191], v[104:119]
  s_waitcnt lgkmcnt(8)
  ds_read_b64_tr_b16 a[148:149], v14 offset:41216
  ds_read_b64_tr_b16 a[150:151], v14 offset:42240
  v_cvt_pk_bf16_f32 v155, v126, v127
  s_add_u32 s57, s66, 0x1c00
  v_mfma_f32_32x32x16_bf16 v[88:103], a[160:163], v[192:195], v[88:103]
  s_waitcnt lgkmcnt(8)
  ds_read_b64_tr_b16 a[152:153], v14 offset:43008
  ds_read_b64_tr_b16 a[154:155], v14 offset:44032
  buffer_store_dwordx4 v[152:155], v13, s[12:15], s57 offen sc1
  v_mfma_f32_32x32x16_bf16 v[104:119], a[164:167], v[192:195], v[104:119]
  s_waitcnt lgkmcnt(8)
  ds_read_b64_tr_b16 a[156:157], v14 offset:43264
  s_waitcnt vmcnt(10)
  ds_read_b64_tr_b16 a[158:159], v14 offset:44288
  s_barrier
  buffer_load_dword v57, v17, s[8:11], 0 offen offset:128 sc1
  v_mfma_f32_32x32x16_bf16 v[88:103], a[168:171], v[196:199], v[88:103]
  s_waitcnt lgkmcnt(8)
  ds_read_b64_tr_b16 a[160:161], v14 offset:49152
  ds_read_b64_tr_b16 a[162:163], v14 offset:50176
  v_mfma_f32_32x32x16_bf16 v[104:119], a[172:175], v[196:199], v[104:119]
  s_waitcnt lgkmcnt(8)
  ds_read_b64_tr_b16 a[164:165], v14 offset:49408
  ds_read_b64_tr_b16 a[166:167], v14 offset:50432
  v_mfma_f32_32x32x16_bf16 v[88:103], a[144:147], v[200:203], v[88:103]
  s_waitcnt lgkmcnt(8)
  ds_read_b64_tr_b16 a[168:169], v14 offset:51200
  ds_read_b64_tr_b16 a[170:171], v14 offset:52224
  v_mfma_f32_32x32x16_bf16 v[104:119], a[148:151], v[200:203], v[104:119]
  s_waitcnt lgkmcnt(8)
  ds_read_b64_tr_b16 a[172:173], v14 offset:51456
  ds_read_b64_tr_b16 a[174:175], v14 offset:52480
  v_cvt_pk_bf16_f32 v156, v128, v129
  v_cvt_pk_bf16_f32 v157, v130, v131
  v_cvt_pk_bf16_f32 v158, v132, v133
  v_mfma_f32_32x32x16_bf16 v[88:103], a[152:155], v[204:207], v[88:103]
  s_waitcnt lgkmcnt(8)
  ds_read_b64_tr_b16 a[144:145], v14 offset:53248
  ds_read_b64_tr_b16 a[146:147], v14 offset:54272
  v_cvt_pk_bf16_f32 v159, v134, v135
  s_add_u32 s57, s66, 0x1d00
  v_mfma_f32_32x32x16_bf16 v[104:119], a[156:159], v[204:207], v[104:119]
  s_waitcnt lgkmcnt(8)
  ds_read_b64_tr_b16 a[148:149], v14 offset:53504
  ds_read_b64_tr_b16 a[150:151], v14 offset:54528
  buffer_store_dwordx4 v[156:159], v13, s[12:15], s57 offen sc1
  v_mfma_f32_32x32x16_bf16 v[88:103], a[160:163], v[208:211], v[88:103]
  s_waitcnt lgkmcnt(8)
  ds_read_b64_tr_b16 a[152:153], v14 offset:55296
  ds_read_b64_tr_b16 a[154:155], v14 offset:56320
  v_mfma_f32_32x32x16_bf16 v[104:119], a[164:167], v[208:211], v[104:119]
  s_waitcnt lgkmcnt(8)
  ds_read_b64_tr_b16 a[156:157], v14 offset:55552
  ds_read_b64_tr_b16 a[158:159], v14 offset:56576
  v_mfma_f32_32x32x16_bf16 v[88:103], a[168:171], v[212:215], v[88:103]
  s_waitcnt lgkmcnt(8)
  ds_read_b64_tr_b16 a[160:161], v14 offset:57344
  ds_read_b64_tr_b16 a[162:163], v14 offset:58368
  v_mfma_f32_32x32x16_bf16 v[104:119], a[172:175], v[212:215], v[104:119]
  s_waitcnt lgkmcnt(8)
  ds_read_b64_tr_b16 a[164:165], v14 offset:57600
  ds_read_b64_tr_b16 a[166:167], v14 offset:58624
  v_mfma_f32_32x32x16_bf16 v[88:103], a[144:147], v[216:219], v[88:103]
  s_waitcnt lgkmcnt(8)
  ds_read_b64_tr_b16 a[168:169], v14 offset:59392
  ds_read_b64_tr_b16 a[170:171], v14 offset:60416
  v_cvt_pk_bf16_f32 v160, v136, v137
  v_cvt_pk_bf16_f32 v161, v138, v139
  v_cvt_pk_bf16_f32 v162, v140, v141
  v_mfma_f32_32x32x16_bf16 v[104:119], a[148:151], v[216:219], v[104:119]
  s_waitcnt lgkmcnt(8)
  ds_read_b64_tr_b16 a[172:173], v14 offset:59648
  s_waitcnt vmcnt(8)
  ds_read_b64_tr_b16 a[174:175], v14 offset:60672
  s_barrier
  v_cvt_pk_bf16_f32 v163, v142, v143
  s_add_u32 s57, s66, 0x1e00
  v_mfma_f32_32x32x16_bf16 v[88:103], a[152:155], v[220:223], v[88:103]
  s_waitcnt lgkmcnt(8)
  ds_read_b64_tr_b16 a[144:145], v15
  ds_read_b64_tr_b16 a[146:147], v15 offset:1024
  buffer_store_dwordx4 v[160:163], v13, s[12:15], s57 offen sc1
  v_mfma_f32_32x32x16_bf16 v[104:119], a[156:159], v[220:223], v[104:119]
  s_waitcnt lgkmcnt(8)
  ds_read_b64_tr_b16 a[148:149], v15 offset:256
  ds_read_b64_tr_b16 a[150:151], v15 offset:1280
  v_mfma_f32_32x32x16_bf16 v[88:103], a[160:163], v[224:227], v[88:103]
  s_waitcnt lgkmcnt(8)
  ds_read_b64_tr_b16 a[152:153], v15 offset:2048
  ds_read_b64_tr_b16 a[154:155], v15 offset:3072
  v_mfma_f32_32x32x16_bf16 v[104:119], a[164:167], v[224:227], v[104:119]
  s_waitcnt lgkmcnt(8)
  ds_read_b64_tr_b16 a[156:157], v15 offset:2304
  ds_read_b64_tr_b16 a[158:159], v15 offset:3328
  v_mfma_f32_32x32x16_bf16 v[88:103], a[168:171], v[228:231], v[88:103]
  s_waitcnt lgkmcnt(8)
  ds_read_b64_tr_b16 a[160:161], v15 offset:4096
  ds_read_b64_tr_b16 a[162:163], v15 offset:5120
  v_mfma_f32_32x32x16_bf16 v[104:119], a[172:175], v[228:231], v[104:119]
  s_waitcnt lgkmcnt(8)
  ds_read_b64_tr_b16 a[164:165], v15 offset:4352
  ds_read_b64_tr_b16 a[166:167], v15 offset:5376
  v_cvt_pk_bf16_f32 v164, v144, v145
  v_cvt_pk_bf16_f32 v165, v146, v147
  v_cvt_pk_bf16_f32 v166, v148, v149
  v_mfma_f32_32x32x16_bf16 v[88:103], a[144:147], v[232:235], v[88:103]
  s_waitcnt lgkmcnt(8)
  ds_read_b64_tr_b16 a[168:169], v15 offset:6144
  ds_read_b64_tr_b16 a[170:171], v15 offset:7168
  v_cvt_pk_bf16_f32 v167, v150, v151
  s_add_u32 s57, s66, 0x1f00
  v_mfma_f32_32x32x16_bf16 v[104:119], a[148:151], v[232:235], v[104:119]
  s_waitcnt lgkmcnt(8)
  ds_read_b64_tr_b16 a[172:173], v15 offset:6400
  ds_read_b64_tr_b16 a[174:175], v15 offset:7424
  buffer_store_dwordx4 v[164:167], v13, s[12:15], s57 offen sc1
  v_mfma_f32_32x32x16_bf16 v[88:103], a[152:155], v[236:239], v[88:103]
  s_waitcnt lgkmcnt(8)
  ds_read_b64_tr_b16 a[144:145], v15 offset:8192
  ds_read_b64_tr_b16 a[146:147], v15 offset:9216
  v_mfma_f32_32x32x16_bf16 v[104:119], a[156:159], v[236:239], v[104:119]
  s_waitcnt lgkmcnt(8)
  ds_read_b64_tr_b16 a[148:149], v15 offset:8448
  ds_read_b64_tr_b16 a[150:151], v15 offset:9472
  v_mfma_f32_32x32x16_bf16 v[88:103], a[160:163], v[240:243], v[88:103]
  s_waitcnt lgkmcnt(8)
  ds_read_b64_tr_b16 a[152:153], v15 offset:10240
  ds_read_b64_tr_b16 a[154:155], v15 offset:11264
  v_mfma_f32_32x32x16_bf16 v[104:119], a[164:167], v[240:243], v[104:119]
  s_waitcnt lgkmcnt(8)
  ds_read_b64_tr_b16 a[156:157], v15 offset:10496
  ds_read_b64_tr_b16 a[158:159], v15 offset:11520
  v_mfma_f32_32x32x16_bf16 v[88:103], a[168:171], v[244:247], v[88:103]
  s_waitcnt lgkmcnt(8)
  v_mfma_f32_32x32x16_bf16 v[104:119], a[172:175], v[244:247], v[104:119]
  s_waitcnt lgkmcnt(6)
  v_mfma_f32_32x32x16_bf16 v[88:103], a[144:147], v[248:251], v[88:103]
  s_waitcnt lgkmcnt(4)
  v_mfma_f32_32x32x16_bf16 v[104:119], a[148:151], v[248:251], v[104:119]
  s_waitcnt lgkmcnt(2)
  v_mfma_f32_32x32x16_bf16 v[88:103], a[152:155], v[252:255], v[88:103]
  s_waitcnt lgkmcnt(0)
  v_mfma_f32_32x32x16_bf16 v[104:119], a[156:159], v[252:255], v[104:119]
  s_waitcnt vmcnt(3)
  v_readfirstlane_b32 s85, v57
  s_nop 3
  s_cmp_ge_u32 s85, 32
  s_cbranch_scc1 adaLN_cond__sliding_block_cached__glu_gated_swiglu__prompt_kernel_e2_ok
  s_mov_b32 s72, 0x200000
adaLN_cond__sliding_block_cached__glu_gated_swiglu__prompt_kernel_e2_spin:
  buffer_load_dword v57, v17, s[8:11], 0 offen offset:128 sc1
  s_waitcnt vmcnt(0)
  v_readfirstlane_b32 s85, v57
  s_nop 3
  s_cmp_ge_u32 s85, 32
  s_cbranch_scc1 adaLN_cond__sliding_block_cached__glu_gated_swiglu__prompt_kernel_e2_ok
  s_sub_u32 s72, s72, 1
  s_cmp_eq_u32 s72, 0
  s_cbranch_scc1 adaLN_cond__sliding_block_cached__glu_gated_swiglu__prompt_kernel_e2_ok
  s_sleep 4
  s_branch adaLN_cond__sliding_block_cached__glu_gated_swiglu__prompt_kernel_e2_spin
adaLN_cond__sliding_block_cached__glu_gated_swiglu__prompt_kernel_e2_ok:
  s_nop 7
  v_cvt_pk_bf16_f32 v152, v88, v89
  v_cvt_pk_bf16_f32 v153, v90, v91
  v_cvt_pk_bf16_f32 v154, v92, v93
  v_cvt_pk_bf16_f32 v155, v94, v95
  s_add_u32 s57, s66, 0x2000
  buffer_store_dwordx4 v[152:155], v13, s[12:15], s57 offen sc1
  v_cvt_pk_bf16_f32 v156, v96, v97
  v_cvt_pk_bf16_f32 v157, v98, v99
  v_cvt_pk_bf16_f32 v158, v100, v101
  v_cvt_pk_bf16_f32 v159, v102, v103
  s_add_u32 s57, s66, 0x2100
  buffer_store_dwordx4 v[156:159], v13, s[12:15], s57 offen sc1
  v_cvt_pk_bf16_f32 v160, v104, v105
  v_cvt_pk_bf16_f32 v161, v106, v107
  v_cvt_pk_bf16_f32 v162, v108, v109
  v_cvt_pk_bf16_f32 v163, v110, v111
  s_add_u32 s57, s66, 0x2200
  buffer_store_dwordx4 v[160:163], v13, s[12:15], s57 offen sc1
  v_cvt_pk_bf16_f32 v164, v112, v113
  v_cvt_pk_bf16_f32 v165, v114, v115
  v_cvt_pk_bf16_f32 v166, v116, v117
  v_cvt_pk_bf16_f32 v167, v118, v119
  s_add_u32 s57, s66, 0x2300
  buffer_store_dwordx4 v[164:167], v13, s[12:15], s57 offen sc1
  s_load_dwordx2 s[28:29], s[0:1], 0x58
  v_and_b32 v22, 7, v0
  v_cmp_gt_u32 s[86:87], 64, v0
  v_lshrrev_b32 v23, 4, v0
  v_lshlrev_b32 v27, 4, v23
  v_bfe_u32 v24, v0, 3, 1
  v_lshlrev_b32 v24, 2, v24
  v_add_u32 v27, v27, v24
  s_lshl_b32 s88, s2, 3
  v_add_u32 v23, s88, v22
  v_mul_u32_u24 v23, 0x240, v23
  v_add_u32 v23, v23, v27
  v_lshlrev_b32 v25, 1, v23
  v_lshlrev_b32 v27, 2, v27
  v_lshrrev_b32 v23, 4, v0
  v_lshlrev_b32 v23, 10, v23
  v_bfe_u32 v24, v0, 3, 1
  v_lshlrev_b32 v24, 9, v24
  v_add_u32 v23, v23, v24
  v_lshlrev_b32 v24, 4, v22
  v_add_u32 v29, v23, v24
  v_lshlrev_b32 v31, 4, v0
  v_lshlrev_b32 v33, 5, v0
  v_mov_b32 v23, 0x40000000
  v_add_u32 v24, 0x400, v25
  v_cndmask_b32 v26, v23, v24, s[86:87]
  v_add_u32 v24, 0x800, v27
  v_cndmask_b32 v28, v23, v24, s[86:87]
  v_add_u32 v24, 0x8000, v29
  v_cndmask_b32 v30, v23, v24, s[86:87]
  v_add_u32 v24, 0x2000, v31
  v_cndmask_b32 v32, v23, v24, s[86:87]
  v_add_u32 v24, 0x4000, v33
  v_cndmask_b32 v34, v23, v24, s[86:87]
  s_mov_b32 s30, 0x240000
  s_mov_b32 s31, 0x20000
  s_waitcnt lgkmcnt(0)
  s_mul_i32 s91, s2, 0x24000
  s_lshl_b32 s93, s53, 10
  s_add_u32 s93, s93, s91
  s_mov_b32 s92, 0x2d00
  buffer_load_dwordx4 a[12:15], v27, s[20:23], s92 offen sc1
  buffer_load_dwordx4 a[16:19], v27, s[20:23], s92 offen offset:32 sc1
  buffer_load_dwordx4 a[20:23], v27, s[20:23], s92 offen offset:1024 sc1
  buffer_load_dwordx4 a[24:27], v27, s[20:23], s92 offen offset:1056 sc1
  buffer_load_dwordx4 a[28:31], v28, s[20:23], s92 offen sc1
  buffer_load_dwordx4 a[32:35], v28, s[20:23], s92 offen offset:32 sc1
  s_waitcnt vmcnt(6)
  s_barrier
  v_mov_b32 v10, 1
  buffer_atomic_add v10, v16, s[8:11], 0 offen sc1
  s_cmp_lg_u32 s53, 0
  s_cbranch_scc0 adaLN_cond__sliding_block_cached__glu_gated_swiglu__prompt_kernel_l2
  s_add_u32 s69, s93, 0
  buffer_load_dwordx4 v[56:59], v12, s[12:15], s69 offen sc1
  s_add_u32 s69, s93, 9216
  buffer_load_dwordx4 v[60:63], v12, s[12:15], s69 offen sc1
  s_add_u32 s69, s93, 18432
  buffer_load_dwordx4 v[64:67], v12, s[12:15], s69 offen sc1
  s_add_u32 s69, s93, 27648
  buffer_load_dwordx4 v[68:71], v12, s[12:15], s69 offen sc1
  s_add_u32 s69, s93, 36864
  buffer_load_dwordx4 v[72:75], v12, s[12:15], s69 offen sc1
  s_add_u32 s69, s93, 46080
  buffer_load_dwordx4 v[76:79], v12, s[12:15], s69 offen sc1
  s_add_u32 s69, s93, 55296
  buffer_load_dwordx4 v[80:83], v12, s[12:15], s69 offen sc1
  s_add_u32 s69, s93, 64512
  buffer_load_dwordx4 v[84:87], v12, s[12:15], s69 offen sc1
  s_add_u32 s69, s93, 73728
  buffer_load_dwordx4 v[88:91], v12, s[12:15], s69 offen sc1
  s_add_u32 s69, s93, 82944
  buffer_load_dwordx4 v[92:95], v12, s[12:15], s69 offen sc1
  s_add_u32 s69, s93, 92160
  buffer_load_dwordx4 v[96:99], v12, s[12:15], s69 offen sc1
  s_add_u32 s69, s93, 101376
  buffer_load_dwordx4 v[100:103], v12, s[12:15], s69 offen sc1
  s_add_u32 s69, s93, 110592
  buffer_load_dwordx4 v[104:107], v12, s[12:15], s69 offen sc1
  s_add_u32 s69, s93, 119808
  buffer_load_dwordx4 v[108:111], v12, s[12:15], s69 offen sc1
  s_add_u32 s69, s93, 129024
  buffer_load_dwordx4 v[112:115], v12, s[12:15], s69 offen sc1
  s_add_u32 s69, s93, 138240
  buffer_load_dwordx4 v[116:119], v12, s[12:15], s69 offen sc1
adaLN_cond__sliding_block_cached__glu_gated_swiglu__prompt_kernel_l2:
  s_cmp_lg_u32 s53, 0
  s_cbranch_scc1 adaLN_cond__sliding_block_cached__glu_gated_swiglu__prompt_kernel_s4_done
  s_mov_b32 s90, 0x200000
adaLN_cond__sliding_block_cached__glu_gated_swiglu__prompt_kernel_s4_poll:
  buffer_load_dword v9, v17, s[8:11], 0 offen sc1
  s_waitcnt vmcnt(0)
  v_readfirstlane_b32 s89, v9
  s_nop 3
  s_cmp_ge_u32 s89, 64
  s_cbranch_scc1 adaLN_cond__sliding_block_cached__glu_gated_swiglu__prompt_kernel_s4_done
  s_sub_u32 s90, s90, 1
  s_cmp_eq_u32 s90, 0
  s_cbranch_scc1 adaLN_cond__sliding_block_cached__glu_gated_swiglu__prompt_kernel_s4_done
  s_sleep 4
  s_branch adaLN_cond__sliding_block_cached__glu_gated_swiglu__prompt_kernel_s4_poll
adaLN_cond__sliding_block_cached__glu_gated_swiglu__prompt_kernel_s4_done:
  s_barrier
  s_cmp_eq_u32 s53, 0
  s_cbranch_scc0 adaLN_cond__sliding_block_cached__glu_gated_swiglu__prompt_kernel_l2b
  s_add_u32 s69, s93, 0
  buffer_load_dwordx4 v[56:59], v12, s[12:15], s69 offen sc1
  s_add_u32 s69, s93, 9216
  buffer_load_dwordx4 v[60:63], v12, s[12:15], s69 offen sc1
  s_add_u32 s69, s93, 18432
  buffer_load_dwordx4 v[64:67], v12, s[12:15], s69 offen sc1
  s_add_u32 s69, s93, 27648
  buffer_load_dwordx4 v[68:71], v12, s[12:15], s69 offen sc1
  s_add_u32 s69, s93, 36864
  buffer_load_dwordx4 v[72:75], v12, s[12:15], s69 offen sc1
  s_add_u32 s69, s93, 46080
  buffer_load_dwordx4 v[76:79], v12, s[12:15], s69 offen sc1
  s_add_u32 s69, s93, 55296
  buffer_load_dwordx4 v[80:83], v12, s[12:15], s69 offen sc1
  s_add_u32 s69, s93, 64512
  buffer_load_dwordx4 v[84:87], v12, s[12:15], s69 offen sc1
  s_add_u32 s69, s93, 73728
  buffer_load_dwordx4 v[88:91], v12, s[12:15], s69 offen sc1
  s_add_u32 s69, s93, 82944
  buffer_load_dwordx4 v[92:95], v12, s[12:15], s69 offen sc1
  s_add_u32 s69, s93, 92160
  buffer_load_dwordx4 v[96:99], v12, s[12:15], s69 offen sc1
  s_add_u32 s69, s93, 101376
  buffer_load_dwordx4 v[100:103], v12, s[12:15], s69 offen sc1
  s_add_u32 s69, s93, 110592
  buffer_load_dwordx4 v[104:107], v12, s[12:15], s69 offen sc1
  s_add_u32 s69, s93, 119808
  buffer_load_dwordx4 v[108:111], v12, s[12:15], s69 offen sc1
  s_add_u32 s69, s93, 129024
  buffer_load_dwordx4 v[112:115], v12, s[12:15], s69 offen sc1
  s_add_u32 s69, s93, 138240
  buffer_load_dwordx4 v[116:119], v12, s[12:15], s69 offen sc1
adaLN_cond__sliding_block_cached__glu_gated_swiglu__prompt_kernel_l2b:
  s_add_u32 s94, s91, 0
  buffer_load_dwordx4 v[184:187], v32, s[12:15], s94 offen sc1
  s_add_u32 s94, s91, 0x2400
  buffer_load_dwordx4 v[188:191], v32, s[12:15], s94 offen sc1
  s_add_u32 s94, s91, 0x4800
  buffer_load_dwordx4 v[192:195], v32, s[12:15], s94 offen sc1
  s_add_u32 s94, s91, 0x6c00
  buffer_load_dwordx4 v[196:199], v32, s[12:15], s94 offen sc1
  s_add_u32 s94, s91, 0x9000
  buffer_load_dwordx4 v[200:203], v32, s[12:15], s94 offen sc1
  s_add_u32 s94, s91, 0xb400
  buffer_load_dwordx4 v[204:207], v32, s[12:15], s94 offen sc1
  s_add_u32 s94, s91, 0xd800
  buffer_load_dwordx4 v[208:211], v32, s[12:15], s94 offen sc1
  s_add_u32 s94, s91, 0xfc00
  buffer_load_dwordx4 v[212:215], v32, s[12:15], s94 offen sc1
  s_add_u32 s94, s91, 0x12000
  buffer_load_dwordx4 v[216:219], v32, s[12:15], s94 offen sc1
  s_add_u32 s94, s91, 0x14400
  buffer_load_dwordx4 v[220:223], v32, s[12:15], s94 offen sc1
  s_add_u32 s94, s91, 0x16800
  buffer_load_dwordx4 v[224:227], v32, s[12:15], s94 offen sc1
  s_add_u32 s94, s91, 0x18c00
  buffer_load_dwordx4 v[228:231], v32, s[12:15], s94 offen sc1
  s_add_u32 s94, s91, 0x1b000
  buffer_load_dwordx4 v[232:235], v32, s[12:15], s94 offen sc1
  s_add_u32 s94, s91, 0x1d400
  buffer_load_dwordx4 v[236:239], v32, s[12:15], s94 offen sc1
  s_add_u32 s94, s91, 0x1f800
  buffer_load_dwordx4 v[240:243], v32, s[12:15], s94 offen sc1
  s_add_u32 s94, s91, 0x21c00
  buffer_load_dwordx4 v[244:247], v32, s[12:15], s94 offen sc1
  s_add_u32 s95, s91, 0x1000
  buffer_load_dwordx4 v[120:123], v31, s[12:15], s95 offen sc1
  s_add_u32 s95, s91, 0x3400
  buffer_load_dwordx4 v[124:127], v31, s[12:15], s95 offen sc1
  s_add_u32 s95, s91, 0x5800
  buffer_load_dwordx4 v[128:131], v31, s[12:15], s95 offen sc1
  s_add_u32 s95, s91, 0x7c00
  buffer_load_dwordx4 v[132:135], v31, s[12:15], s95 offen sc1
  s_add_u32 s95, s91, 0xa000
  buffer_load_dwordx4 v[136:139], v31, s[12:15], s95 offen sc1
  s_add_u32 s95, s91, 0xc400
  buffer_load_dwordx4 v[140:143], v31, s[12:15], s95 offen sc1
  s_add_u32 s95, s91, 0xe800
  buffer_load_dwordx4 v[144:147], v31, s[12:15], s95 offen sc1
  s_add_u32 s95, s91, 0x10c00
  buffer_load_dwordx4 v[148:151], v31, s[12:15], s95 offen sc1
  s_add_u32 s95, s91, 0x13000
  buffer_load_dwordx4 v[152:155], v31, s[12:15], s95 offen sc1
  s_add_u32 s95, s91, 0x15400
  buffer_load_dwordx4 v[156:159], v31, s[12:15], s95 offen sc1
  s_add_u32 s95, s91, 0x17800
  buffer_load_dwordx4 v[160:163], v31, s[12:15], s95 offen sc1
  s_add_u32 s95, s91, 0x19c00
  buffer_load_dwordx4 v[164:167], v31, s[12:15], s95 offen sc1
  s_add_u32 s95, s91, 0x1c000
  buffer_load_dwordx4 v[168:171], v31, s[12:15], s95 offen sc1
  s_add_u32 s95, s91, 0x1e400
  buffer_load_dwordx4 v[172:175], v31, s[12:15], s95 offen sc1
  s_add_u32 s95, s91, 0x20800
  buffer_load_dwordx4 v[176:179], v31, s[12:15], s95 offen sc1
  s_add_u32 s95, s91, 0x22c00
  buffer_load_dwordx4 v[180:183], v31, s[12:15], s95 offen sc1
  v_bfe_u32 v9, v0, 3, 1
  v_lshlrev_b32 v10, 3, v9
  v_add_u32 v252, v25, v10
  v_add_u32 v253, v26, v10
  v_cmp_eq_u32 vcc, 1, v9
  s_waitcnt vmcnt(47)
  v_mfma_f32_32x32x16_bf16 a[96:111], a[176:179], v[56:59], 0
  s_waitcnt vmcnt(46)
  v_mfma_f32_32x32x16_bf16 a[96:111], a[176:179], v[60:63], a[96:111]
  s_waitcnt vmcnt(45)
  v_mfma_f32_32x32x16_bf16 a[96:111], a[176:179], v[64:67], a[96:111]
  s_waitcnt vmcnt(44)
  v_mfma_f32_32x32x16_bf16 a[96:111], a[176:179], v[68:71], a[96:111]
  s_waitcnt vmcnt(43)
  v_mfma_f32_32x32x16_bf16 a[96:111], a[176:179], v[72:75], a[96:111]
  s_waitcnt vmcnt(42)
  v_mfma_f32_32x32x16_bf16 a[96:111], a[176:179], v[76:79], a[96:111]
  s_waitcnt vmcnt(41)
  v_mfma_f32_32x32x16_bf16 a[96:111], a[176:179], v[80:83], a[96:111]
  s_waitcnt vmcnt(40)
  v_mfma_f32_32x32x16_bf16 a[96:111], a[176:179], v[84:87], a[96:111]
  s_waitcnt vmcnt(39)
  v_mfma_f32_32x32x16_bf16 a[96:111], a[176:179], v[88:91], a[96:111]
  s_waitcnt vmcnt(38)
  v_mfma_f32_32x32x16_bf16 a[96:111], a[176:179], v[92:95], a[96:111]
  s_waitcnt vmcnt(37)
  v_mfma_f32_32x32x16_bf16 a[96:111], a[176:179], v[96:99], a[96:111]
  s_waitcnt vmcnt(36)
  v_mfma_f32_32x32x16_bf16 a[96:111], a[176:179], v[100:103], a[96:111]
  s_waitcnt vmcnt(35)
  v_mfma_f32_32x32x16_bf16 a[96:111], a[176:179], v[104:107], a[96:111]
  s_waitcnt vmcnt(34)
  v_mfma_f32_32x32x16_bf16 a[96:111], a[176:179], v[108:111], a[96:111]
  s_waitcnt vmcnt(33)
  v_mfma_f32_32x32x16_bf16 a[96:111], a[176:179], v[112:115], a[96:111]
  s_waitcnt vmcnt(32)
  v_mfma_f32_32x32x16_bf16 a[96:111], a[176:179], v[116:119], a[96:111]
  s_waitcnt vmcnt(31)
  v_mfma_f32_32x32x16_bf16 a[128:143], a[176:179], v[184:187], 0
  s_waitcnt vmcnt(30)
  v_mfma_f32_32x32x16_bf16 a[128:143], a[176:179], v[188:191], a[128:143]
  s_waitcnt vmcnt(29)
  v_mfma_f32_32x32x16_bf16 a[128:143], a[176:179], v[192:195], a[128:143]
  s_waitcnt vmcnt(28)
  v_mfma_f32_32x32x16_bf16 a[128:143], a[176:179], v[196:199], a[128:143]
  s_waitcnt vmcnt(27)
  v_mfma_f32_32x32x16_bf16 a[128:143], a[176:179], v[200:203], a[128:143]
  s_waitcnt vmcnt(26)
  v_mfma_f32_32x32x16_bf16 a[128:143], a[176:179], v[204:207], a[128:143]
  s_waitcnt vmcnt(25)
  v_mfma_f32_32x32x16_bf16 a[128:143], a[176:179], v[208:211], a[128:143]
  s_waitcnt vmcnt(24)
  v_mfma_f32_32x32x16_bf16 a[128:143], a[176:179], v[212:215], a[128:143]
  s_waitcnt vmcnt(23)
  v_mfma_f32_32x32x16_bf16 a[128:143], a[176:179], v[216:219], a[128:143]
  s_waitcnt vmcnt(22)
  v_mfma_f32_32x32x16_bf16 a[128:143], a[176:179], v[220:223], a[128:143]
  s_waitcnt vmcnt(21)
  v_mfma_f32_32x32x16_bf16 a[128:143], a[176:179], v[224:227], a[128:143]
  s_waitcnt vmcnt(20)
  v_mfma_f32_32x32x16_bf16 a[128:143], a[176:179], v[228:231], a[128:143]
  s_waitcnt vmcnt(19)
  v_mfma_f32_32x32x16_bf16 a[128:143], a[176:179], v[232:235], a[128:143]
  s_waitcnt vmcnt(18)
  v_mfma_f32_32x32x16_bf16 a[128:143], a[176:179], v[236:239], a[128:143]
  s_waitcnt vmcnt(17)
  v_mfma_f32_32x32x16_bf16 a[128:143], a[176:179], v[240:243], a[128:143]
  s_waitcnt vmcnt(16)
  v_mfma_f32_32x32x16_bf16 a[128:143], a[176:179], v[244:247], a[128:143]
  v_accvgpr_read_b32 v56, a208
  v_accvgpr_read_b32 v57, a209
  v_accvgpr_read_b32 v58, a210
  v_accvgpr_read_b32 v59, a211
  v_accvgpr_read_b32 v60, a212
  v_accvgpr_read_b32 v61, a213
  v_accvgpr_read_b32 v62, a214
  v_accvgpr_read_b32 v63, a215
  v_accvgpr_read_b32 v64, a12
  v_accvgpr_read_b32 v65, a13
  v_accvgpr_read_b32 v66, a14
  v_accvgpr_read_b32 v67, a15
  v_accvgpr_read_b32 v68, a16
  v_accvgpr_read_b32 v69, a17
  v_accvgpr_read_b32 v70, a18
  v_accvgpr_read_b32 v71, a19
  v_accvgpr_read_b32 v72, a96
  v_accvgpr_read_b32 v73, a97
  v_accvgpr_read_b32 v74, a98
  v_accvgpr_read_b32 v75, a99
  v_accvgpr_read_b32 v76, a100
  v_accvgpr_read_b32 v77, a101
  v_accvgpr_read_b32 v78, a102
  v_accvgpr_read_b32 v79, a103
  v_fmac_f32 v56, v64, v72
  v_fmac_f32 v57, v65, v73
  v_fmac_f32 v58, v66, v74
  v_fmac_f32 v59, v67, v75
  v_fmac_f32 v60, v68, v76
  v_fmac_f32 v61, v69, v77
  v_fmac_f32 v62, v70, v78
  v_fmac_f32 v63, v71, v79
  v_cvt_pk_bf16_f32 v80, v56, v57
  v_cvt_pk_bf16_f32 v81, v58, v59
  v_cvt_pk_bf16_f32 v82, v60, v61
  v_cvt_pk_bf16_f32 v83, v62, v63
  v_cndmask_b32 v84, v82, v80
  v_cndmask_b32 v85, v83, v81
  s_nop 0
  v_mov_b32 v86, v84 row_ror:8 row_mask:0xf bank_mask:0xf
  v_mov_b32 v87, v85 row_ror:8 row_mask:0xf bank_mask:0xf
  v_cndmask_b32 v88, v80, v86
  v_cndmask_b32 v89, v81, v87
  v_cndmask_b32 v90, v86, v82
  v_cndmask_b32 v91, v87, v83
  buffer_store_dwordx4 v[88:91], v252, s[28:31], 0 offen
  v_accvgpr_read_b32 v184, a224
  v_accvgpr_read_b32 v185, a225
  v_accvgpr_read_b32 v186, a226
  v_accvgpr_read_b32 v187, a227
  v_accvgpr_read_b32 v188, a228
  v_accvgpr_read_b32 v189, a229
  v_accvgpr_read_b32 v190, a230
  v_accvgpr_read_b32 v191, a231
  v_accvgpr_read_b32 v192, a28
  v_accvgpr_read_b32 v193, a29
  v_accvgpr_read_b32 v194, a30
  v_accvgpr_read_b32 v195, a31
  v_accvgpr_read_b32 v196, a32
  v_accvgpr_read_b32 v197, a33
  v_accvgpr_read_b32 v198, a34
  v_accvgpr_read_b32 v199, a35
  v_accvgpr_read_b32 v200, a128
  v_accvgpr_read_b32 v201, a129
  v_accvgpr_read_b32 v202, a130
  v_accvgpr_read_b32 v203, a131
  v_accvgpr_read_b32 v204, a132
  v_accvgpr_read_b32 v205, a133
  v_accvgpr_read_b32 v206, a134
  v_accvgpr_read_b32 v207, a135
  v_fmac_f32 v184, v192, v200
  v_fmac_f32 v185, v193, v201
  v_fmac_f32 v186, v194, v202
  v_fmac_f32 v187, v195, v203
  v_fmac_f32 v188, v196, v204
  v_fmac_f32 v189, v197, v205
  v_fmac_f32 v190, v198, v206
  v_fmac_f32 v191, v199, v207
  v_cvt_pk_bf16_f32 v208, v184, v185
  v_cvt_pk_bf16_f32 v209, v186, v187
  v_cvt_pk_bf16_f32 v210, v188, v189
  v_cvt_pk_bf16_f32 v211, v190, v191
  v_cndmask_b32 v212, v210, v208
  v_cndmask_b32 v213, v211, v209
  s_nop 0
  v_mov_b32 v214, v212 row_ror:8 row_mask:0xf bank_mask:0xf
  v_mov_b32 v215, v213 row_ror:8 row_mask:0xf bank_mask:0xf
  v_cndmask_b32 v216, v208, v214
  v_cndmask_b32 v217, v209, v215
  v_cndmask_b32 v218, v214, v210
  v_cndmask_b32 v219, v215, v211
  buffer_store_dwordx4 v[216:219], v253, s[28:31], 0 offen
  s_waitcnt vmcnt(17)
  v_mfma_f32_32x32x16_bf16 a[112:127], a[176:179], v[120:123], 0
  s_waitcnt vmcnt(16)
  v_mfma_f32_32x32x16_bf16 a[112:127], a[176:179], v[124:127], a[112:127]
  s_waitcnt vmcnt(15)
  v_mfma_f32_32x32x16_bf16 a[112:127], a[176:179], v[128:131], a[112:127]
  s_waitcnt vmcnt(14)
  v_mfma_f32_32x32x16_bf16 a[112:127], a[176:179], v[132:135], a[112:127]
  s_waitcnt vmcnt(13)
  v_mfma_f32_32x32x16_bf16 a[112:127], a[176:179], v[136:139], a[112:127]
  s_waitcnt vmcnt(12)
  v_mfma_f32_32x32x16_bf16 a[112:127], a[176:179], v[140:143], a[112:127]
  s_waitcnt vmcnt(11)
  v_mfma_f32_32x32x16_bf16 a[112:127], a[176:179], v[144:147], a[112:127]
  s_waitcnt vmcnt(10)
  v_mfma_f32_32x32x16_bf16 a[112:127], a[176:179], v[148:151], a[112:127]
  s_waitcnt vmcnt(9)
  v_mfma_f32_32x32x16_bf16 a[112:127], a[176:179], v[152:155], a[112:127]
  s_waitcnt vmcnt(8)
  v_mfma_f32_32x32x16_bf16 a[112:127], a[176:179], v[156:159], a[112:127]
  s_waitcnt vmcnt(7)
  v_mfma_f32_32x32x16_bf16 a[112:127], a[176:179], v[160:163], a[112:127]
  s_waitcnt vmcnt(6)
  v_mfma_f32_32x32x16_bf16 a[112:127], a[176:179], v[164:167], a[112:127]
  s_waitcnt vmcnt(5)
  v_mfma_f32_32x32x16_bf16 a[112:127], a[176:179], v[168:171], a[112:127]
  s_waitcnt vmcnt(4)
  v_mfma_f32_32x32x16_bf16 a[112:127], a[176:179], v[172:175], a[112:127]
  s_waitcnt vmcnt(3)
  v_mfma_f32_32x32x16_bf16 a[112:127], a[176:179], v[176:179], a[112:127]
  s_waitcnt vmcnt(2)
  v_mfma_f32_32x32x16_bf16 a[112:127], a[176:179], v[180:183], a[112:127]
  v_accvgpr_read_b32 v120, a216
  v_accvgpr_read_b32 v121, a217
  v_accvgpr_read_b32 v122, a218
  v_accvgpr_read_b32 v123, a219
  v_accvgpr_read_b32 v124, a220
  v_accvgpr_read_b32 v125, a221
  v_accvgpr_read_b32 v126, a222
  v_accvgpr_read_b32 v127, a223
  v_accvgpr_read_b32 v128, a20
  v_accvgpr_read_b32 v129, a21
  v_accvgpr_read_b32 v130, a22
  v_accvgpr_read_b32 v131, a23
  v_accvgpr_read_b32 v132, a24
  v_accvgpr_read_b32 v133, a25
  v_accvgpr_read_b32 v134, a26
  v_accvgpr_read_b32 v135, a27
  v_accvgpr_read_b32 v136, a112
  v_accvgpr_read_b32 v137, a113
  v_accvgpr_read_b32 v138, a114
  v_accvgpr_read_b32 v139, a115
  v_accvgpr_read_b32 v140, a116
  v_accvgpr_read_b32 v141, a117
  v_accvgpr_read_b32 v142, a118
  v_accvgpr_read_b32 v143, a119
  v_fmac_f32 v120, v128, v136
  v_fmac_f32 v121, v129, v137
  v_fmac_f32 v122, v130, v138
  v_fmac_f32 v123, v131, v139
  v_fmac_f32 v124, v132, v140
  v_fmac_f32 v125, v133, v141
  v_fmac_f32 v126, v134, v142
  v_fmac_f32 v127, v135, v143
  v_cvt_pk_bf16_f32 v144, v120, v121
  v_cvt_pk_bf16_f32 v145, v122, v123
  v_cvt_pk_bf16_f32 v146, v124, v125
  v_cvt_pk_bf16_f32 v147, v126, v127
  v_cndmask_b32 v148, v146, v144
  v_cndmask_b32 v149, v147, v145
  s_nop 0
  v_mov_b32 v150, v148 row_ror:8 row_mask:0xf bank_mask:0xf
  v_mov_b32 v151, v149 row_ror:8 row_mask:0xf bank_mask:0xf
  v_cndmask_b32 v152, v144, v150
  v_cndmask_b32 v153, v145, v151
  v_cndmask_b32 v154, v150, v146
  v_cndmask_b32 v155, v151, v147
  buffer_store_dwordx4 v[152:155], v252, s[28:31], 0 offen offset:512
adaLN_cond__sliding_block_cached__glu_gated_swiglu__prompt_kernel_done:
  s_endpgm
adaLN_cond__sliding_block_cached__glu_gated_swiglu__prompt_kernel_slow:
  s_waitcnt vmcnt(0) lgkmcnt(0)
  s_nop 15
  s_nop 15
  s_mov_b32 s70, m0
  s_lshl_b32 s73, s53, 13
  s_add_u32 s73, s73, 0x20000
  v_bfe_u32 v208, v1, 1, 3
  v_lshlrev_b32 v208, 8, v208
  v_lshlrev_b32 v209, 5, v6
  v_add_u32 v208, v208, v209
  v_and_b32 v209, 1, v1
  v_xor_b32 v209, 0, v209
  v_lshlrev_b32 v209, 4, v209
  v_add_u32 v208, v208, v209
  v_add_u32 v192, 0, v208
  v_bfe_u32 v208, v1, 1, 3
  v_lshlrev_b32 v208, 8, v208
  v_lshlrev_b32 v209, 5, v6
  v_add_u32 v208, v208, v209
  v_and_b32 v209, 1, v1
  v_xor_b32 v209, 0, v209
  v_lshlrev_b32 v209, 4, v209
  v_add_u32 v208, v208, v209
  v_add_u32 v193, 0x80, v208
  v_bfe_u32 v208, v1, 1, 3
  v_lshlrev_b32 v208, 8, v208
  v_lshlrev_b32 v209, 5, v6
  v_add_u32 v208, v208, v209
  v_and_b32 v209, 1, v1
  v_xor_b32 v209, 1, v209
  v_lshlrev_b32 v209, 4, v209
  v_add_u32 v208, v208, v209
  v_add_u32 v194, 0, v208
  v_bfe_u32 v208, v1, 1, 3
  v_lshlrev_b32 v208, 8, v208
  v_lshlrev_b32 v209, 5, v6
  v_add_u32 v208, v208, v209
  v_and_b32 v209, 1, v1
  v_xor_b32 v209, 1, v209
  v_lshlrev_b32 v209, 4, v209
  v_add_u32 v208, v208, v209
  v_add_u32 v195, 0x80, v208
  v_lshlrev_b32 v208, 8, v4
  v_lshlrev_b32 v209, 6, v6
  v_add_u32 v208, v208, v209
  v_add_u32 v196, v208, v7
  v_bfe_u32 v208, v1, 3, 2
  v_lshlrev_b32 v209, 11, v208
  v_and_b32 v208, 1, v208
  v_xor_b32 v208, v208, v2
  v_lshlrev_b32 v208, 4, v208
  v_add_u32 v209, v209, v208
  v_and_b32 v208, 7, v1
  v_lshlrev_b32 v208, 5, v208
  v_add_u32 v209, v209, v208
  v_add_u32 v197, s73, v209
  v_lshlrev_b32 v208, 10, v2
  v_add_u32 v208, v208, v8
  v_add_u32 v198, s73, v208
  v_mov_b32 v200, 0xff800000
  v_mov_b32 v224, 0
  v_mov_b32 v201, 0xff800000
  v_mov_b32 v226, 0
  v_accvgpr_write_b32 a0, 0
  v_accvgpr_write_b32 a1, 0
  v_accvgpr_write_b32 a2, 0
  v_accvgpr_write_b32 a3, 0
  v_accvgpr_write_b32 a4, 0
  v_accvgpr_write_b32 a5, 0
  v_accvgpr_write_b32 a6, 0
  v_accvgpr_write_b32 a7, 0
  v_accvgpr_write_b32 a8, 0
  v_accvgpr_write_b32 a9, 0
  v_accvgpr_write_b32 a10, 0
  v_accvgpr_write_b32 a11, 0
  v_accvgpr_write_b32 a12, 0
  v_accvgpr_write_b32 a13, 0
  v_accvgpr_write_b32 a14, 0
  v_accvgpr_write_b32 a15, 0
  v_accvgpr_write_b32 a16, 0
  v_accvgpr_write_b32 a17, 0
  v_accvgpr_write_b32 a18, 0
  v_accvgpr_write_b32 a19, 0
  v_accvgpr_write_b32 a20, 0
  v_accvgpr_write_b32 a21, 0
  v_accvgpr_write_b32 a22, 0
  v_accvgpr_write_b32 a23, 0
  v_accvgpr_write_b32 a24, 0
  v_accvgpr_write_b32 a25, 0
  v_accvgpr_write_b32 a26, 0
  v_accvgpr_write_b32 a27, 0
  v_accvgpr_write_b32 a28, 0
  v_accvgpr_write_b32 a29, 0
  v_accvgpr_write_b32 a30, 0
  v_accvgpr_write_b32 a31, 0
  v_accvgpr_write_b32 a32, 0
  v_accvgpr_write_b32 a33, 0
  v_accvgpr_write_b32 a34, 0
  v_accvgpr_write_b32 a35, 0
  v_accvgpr_write_b32 a36, 0
  v_accvgpr_write_b32 a37, 0
  v_accvgpr_write_b32 a38, 0
  v_accvgpr_write_b32 a39, 0
  v_accvgpr_write_b32 a40, 0
  v_accvgpr_write_b32 a41, 0
  v_accvgpr_write_b32 a42, 0
  v_accvgpr_write_b32 a43, 0
  v_accvgpr_write_b32 a44, 0
  v_accvgpr_write_b32 a45, 0
  v_accvgpr_write_b32 a46, 0
  v_accvgpr_write_b32 a47, 0
  v_accvgpr_write_b32 a48, 0
  v_accvgpr_write_b32 a49, 0
  v_accvgpr_write_b32 a50, 0
  v_accvgpr_write_b32 a51, 0
  v_accvgpr_write_b32 a52, 0
  v_accvgpr_write_b32 a53, 0
  v_accvgpr_write_b32 a54, 0
  v_accvgpr_write_b32 a55, 0
  v_accvgpr_write_b32 a56, 0
  v_accvgpr_write_b32 a57, 0
  v_accvgpr_write_b32 a58, 0
  v_accvgpr_write_b32 a59, 0
  v_accvgpr_write_b32 a60, 0
  v_accvgpr_write_b32 a61, 0
  v_accvgpr_write_b32 a62, 0
  v_accvgpr_write_b32 a63, 0
  v_accvgpr_write_b32 a64, 0
  v_accvgpr_write_b32 a65, 0
  v_accvgpr_write_b32 a66, 0
  v_accvgpr_write_b32 a67, 0
  v_accvgpr_write_b32 a68, 0
  v_accvgpr_write_b32 a69, 0
  v_accvgpr_write_b32 a70, 0
  v_accvgpr_write_b32 a71, 0
  v_accvgpr_write_b32 a72, 0
  v_accvgpr_write_b32 a73, 0
  v_accvgpr_write_b32 a74, 0
  v_accvgpr_write_b32 a75, 0
  v_accvgpr_write_b32 a76, 0
  v_accvgpr_write_b32 a77, 0
  v_accvgpr_write_b32 a78, 0
  v_accvgpr_write_b32 a79, 0
  v_accvgpr_write_b32 a80, 0
  v_accvgpr_write_b32 a81, 0
  v_accvgpr_write_b32 a82, 0
  v_accvgpr_write_b32 a83, 0
  v_accvgpr_write_b32 a84, 0
  v_accvgpr_write_b32 a85, 0
  v_accvgpr_write_b32 a86, 0
  v_accvgpr_write_b32 a87, 0
  v_accvgpr_write_b32 a88, 0
  v_accvgpr_write_b32 a89, 0
  v_accvgpr_write_b32 a90, 0
  v_accvgpr_write_b32 a91, 0
  v_accvgpr_write_b32 a92, 0
  v_accvgpr_write_b32 a93, 0
  v_accvgpr_write_b32 a94, 0
  v_accvgpr_write_b32 a95, 0
  v_accvgpr_write_b32 a96, 0
  v_accvgpr_write_b32 a97, 0
  v_accvgpr_write_b32 a98, 0
  v_accvgpr_write_b32 a99, 0
  v_accvgpr_write_b32 a100, 0
  v_accvgpr_write_b32 a101, 0
  v_accvgpr_write_b32 a102, 0
  v_accvgpr_write_b32 a103, 0
  v_accvgpr_write_b32 a104, 0
  v_accvgpr_write_b32 a105, 0
  v_accvgpr_write_b32 a106, 0
  v_accvgpr_write_b32 a107, 0
  v_accvgpr_write_b32 a108, 0
  v_accvgpr_write_b32 a109, 0
  v_accvgpr_write_b32 a110, 0
  v_accvgpr_write_b32 a111, 0
  v_accvgpr_write_b32 a112, 0
  v_accvgpr_write_b32 a113, 0
  v_accvgpr_write_b32 a114, 0
  v_accvgpr_write_b32 a115, 0
  v_accvgpr_write_b32 a116, 0
  v_accvgpr_write_b32 a117, 0
  v_accvgpr_write_b32 a118, 0
  v_accvgpr_write_b32 a119, 0
  v_accvgpr_write_b32 a120, 0
  v_accvgpr_write_b32 a121, 0
  v_accvgpr_write_b32 a122, 0
  v_accvgpr_write_b32 a123, 0
  v_accvgpr_write_b32 a124, 0
  v_accvgpr_write_b32 a125, 0
  v_accvgpr_write_b32 a126, 0
  v_accvgpr_write_b32 a127, 0
  s_mov_b32 s71, 0
adaLN_cond__sliding_block_cached__glu_gated_swiglu__prompt_kernel_slowloop:
  s_add_u32 s68, s63, s71
  s_add_u32 s68, s68, 0
  s_add_u32 m0, s73, 0
  s_nop 0
  buffer_load_dwordx4 v192, s[24:27], s68 offen lds
  s_add_u32 m0, s73, 0x400
  s_nop 0
  buffer_load_dwordx4 v193, s[24:27], s68 offen lds
  s_add_u32 s68, s63, s71
  s_add_u32 s68, s68, 0x800
  s_add_u32 m0, s73, 0x800
  s_nop 0
  buffer_load_dwordx4 v194, s[24:27], s68 offen lds
  s_add_u32 m0, s73, 0xc00
  s_nop 0
  buffer_load_dwordx4 v195, s[24:27], s68 offen lds
  s_add_u32 s68, s63, s71
  s_add_u32 s68, s68, 0x1000
  s_add_u32 m0, s73, 0x1000
  s_nop 0
  buffer_load_dwordx4 v192, s[24:27], s68 offen lds
  s_add_u32 m0, s73, 0x1400
  s_nop 0
  buffer_load_dwordx4 v193, s[24:27], s68 offen lds
  s_add_u32 s68, s63, s71
  s_add_u32 s68, s68, 0x1800
  s_add_u32 m0, s73, 0x1800
  s_nop 0
  buffer_load_dwordx4 v194, s[24:27], s68 offen lds
  s_add_u32 m0, s73, 0x1c00
  s_nop 0
  buffer_load_dwordx4 v195, s[24:27], s68 offen lds
  s_waitcnt vmcnt(0)
  ds_read_b128 a[176:179], v197
  ds_read_b128 a[180:183], v197 offset:256
  ds_read_b128 a[184:187], v197 offset:512
  ds_read_b128 a[188:191], v197 offset:768
  ds_read_b128 a[192:195], v197 offset:1024
  ds_read_b128 a[196:199], v197 offset:1280
  ds_read_b128 a[200:203], v197 offset:1536
  ds_read_b128 a[204:207], v197 offset:1792
  s_waitcnt lgkmcnt(7)
  v_mfma_f32_32x32x16_bf16 v[128:143], a[176:179], v[64:67], 0
  v_mfma_f32_32x32x16_bf16 v[144:159], a[176:179], v[96:99], 0
  s_waitcnt lgkmcnt(6)
  v_mfma_f32_32x32x16_bf16 v[128:143], a[180:183], v[68:71], v[128:143]
  v_mfma_f32_32x32x16_bf16 v[144:159], a[180:183], v[100:103], v[144:159]
  s_waitcnt lgkmcnt(5)
  v_mfma_f32_32x32x16_bf16 v[128:143], a[184:187], v[72:75], v[128:143]
  v_mfma_f32_32x32x16_bf16 v[144:159], a[184:187], v[104:107], v[144:159]
  s_waitcnt lgkmcnt(4)
  v_mfma_f32_32x32x16_bf16 v[128:143], a[188:191], v[76:79], v[128:143]
  v_mfma_f32_32x32x16_bf16 v[144:159], a[188:191], v[108:111], v[144:159]
  s_waitcnt lgkmcnt(3)
  v_mfma_f32_32x32x16_bf16 v[128:143], a[192:195], v[80:83], v[128:143]
  v_mfma_f32_32x32x16_bf16 v[144:159], a[192:195], v[112:115], v[144:159]
  s_waitcnt lgkmcnt(2)
  v_mfma_f32_32x32x16_bf16 v[128:143], a[196:199], v[84:87], v[128:143]
  v_mfma_f32_32x32x16_bf16 v[144:159], a[196:199], v[116:119], v[144:159]
  s_waitcnt lgkmcnt(1)
  v_mfma_f32_32x32x16_bf16 v[128:143], a[200:203], v[88:91], v[128:143]
  v_mfma_f32_32x32x16_bf16 v[144:159], a[200:203], v[120:123], v[144:159]
  s_waitcnt lgkmcnt(0)
  v_mfma_f32_32x32x16_bf16 v[128:143], a[204:207], v[92:95], v[128:143]
  v_mfma_f32_32x32x16_bf16 v[144:159], a[204:207], v[124:127], v[144:159]
  s_nop 10
  v_max3_f32 v202, v128, v129, v130
  v_max3_f32 v202, v202, v131, v132
  v_max3_f32 v202, v202, v133, v134
  v_max3_f32 v202, v202, v135, v136
  v_max3_f32 v202, v202, v137, v138
  v_max3_f32 v202, v202, v139, v140
  v_max3_f32 v202, v202, v141, v142
  v_max_f32 v202, v202, v143
  v_mov_b32 v208, v202
  s_nop 1
  v_permlane32_swap_b32 v202, v208
  v_max3_f32 v202, v202, v208, v200
  v_sub_f32 v204, v200, v202
  v_exp_f32 v204, v204
  v_mov_b32 v200, v202
  v_sub_f32 v128, v128, v202
  v_exp_f32 v128, v128
  v_sub_f32 v129, v129, v202
  v_exp_f32 v129, v129
  v_sub_f32 v130, v130, v202
  v_exp_f32 v130, v130
  v_sub_f32 v131, v131, v202
  v_exp_f32 v131, v131
  v_sub_f32 v132, v132, v202
  v_exp_f32 v132, v132
  v_sub_f32 v133, v133, v202
  v_exp_f32 v133, v133
  v_sub_f32 v134, v134, v202
  v_exp_f32 v134, v134
  v_sub_f32 v135, v135, v202
  v_exp_f32 v135, v135
  v_sub_f32 v136, v136, v202
  v_exp_f32 v136, v136
  v_sub_f32 v137, v137, v202
  v_exp_f32 v137, v137
  v_sub_f32 v138, v138, v202
  v_exp_f32 v138, v138
  v_sub_f32 v139, v139, v202
  v_exp_f32 v139, v139
  v_sub_f32 v140, v140, v202
  v_exp_f32 v140, v140
  v_sub_f32 v141, v141, v202
  v_exp_f32 v141, v141
  v_sub_f32 v142, v142, v202
  v_exp_f32 v142, v142
  v_sub_f32 v143, v143, v202
  v_exp_f32 v143, v143
  v_add_f32 v206, v128, v129
  v_add_f32 v206, v206, v130
  v_add_f32 v206, v206, v131
  v_add_f32 v206, v206, v132
  v_add_f32 v206, v206, v133
  v_add_f32 v206, v206, v134
  v_add_f32 v206, v206, v135
  v_add_f32 v206, v206, v136
  v_add_f32 v206, v206, v137
  v_add_f32 v206, v206, v138
  v_add_f32 v206, v206, v139
  v_add_f32 v206, v206, v140
  v_add_f32 v206, v206, v141
  v_add_f32 v206, v206, v142
  v_add_f32 v206, v206, v143
  v_fma_f32 v224, v224, v204, v206
  v_cvt_pk_bf16_f32 v128, v128, v129
  v_cvt_pk_bf16_f32 v129, v130, v131
  v_cvt_pk_bf16_f32 v130, v132, v133
  v_cvt_pk_bf16_f32 v131, v134, v135
  v_cvt_pk_bf16_f32 v132, v136, v137
  v_cvt_pk_bf16_f32 v133, v138, v139
  v_cvt_pk_bf16_f32 v134, v140, v141
  v_cvt_pk_bf16_f32 v135, v142, v143
  v_accvgpr_read_b32 v208, a0
  v_mul_f32 v208, v208, v204
  v_accvgpr_write_b32 a0, v208
  v_accvgpr_read_b32 v208, a1
  v_mul_f32 v208, v208, v204
  v_accvgpr_write_b32 a1, v208
  v_accvgpr_read_b32 v208, a2
  v_mul_f32 v208, v208, v204
  v_accvgpr_write_b32 a2, v208
  v_accvgpr_read_b32 v208, a3
  v_mul_f32 v208, v208, v204
  v_accvgpr_write_b32 a3, v208
  v_accvgpr_read_b32 v208, a4
  v_mul_f32 v208, v208, v204
  v_accvgpr_write_b32 a4, v208
  v_accvgpr_read_b32 v208, a5
  v_mul_f32 v208, v208, v204
  v_accvgpr_write_b32 a5, v208
  v_accvgpr_read_b32 v208, a6
  v_mul_f32 v208, v208, v204
  v_accvgpr_write_b32 a6, v208
  v_accvgpr_read_b32 v208, a7
  v_mul_f32 v208, v208, v204
  v_accvgpr_write_b32 a7, v208
  v_accvgpr_read_b32 v208, a8
  v_mul_f32 v208, v208, v204
  v_accvgpr_write_b32 a8, v208
  v_accvgpr_read_b32 v208, a9
  v_mul_f32 v208, v208, v204
  v_accvgpr_write_b32 a9, v208
  v_accvgpr_read_b32 v208, a10
  v_mul_f32 v208, v208, v204
  v_accvgpr_write_b32 a10, v208
  v_accvgpr_read_b32 v208, a11
  v_mul_f32 v208, v208, v204
  v_accvgpr_write_b32 a11, v208
  v_accvgpr_read_b32 v208, a12
  v_mul_f32 v208, v208, v204
  v_accvgpr_write_b32 a12, v208
  v_accvgpr_read_b32 v208, a13
  v_mul_f32 v208, v208, v204
  v_accvgpr_write_b32 a13, v208
  v_accvgpr_read_b32 v208, a14
  v_mul_f32 v208, v208, v204
  v_accvgpr_write_b32 a14, v208
  v_accvgpr_read_b32 v208, a15
  v_mul_f32 v208, v208, v204
  v_accvgpr_write_b32 a15, v208
  v_accvgpr_read_b32 v208, a16
  v_mul_f32 v208, v208, v204
  v_accvgpr_write_b32 a16, v208
  v_accvgpr_read_b32 v208, a17
  v_mul_f32 v208, v208, v204
  v_accvgpr_write_b32 a17, v208
  v_accvgpr_read_b32 v208, a18
  v_mul_f32 v208, v208, v204
  v_accvgpr_write_b32 a18, v208
  v_accvgpr_read_b32 v208, a19
  v_mul_f32 v208, v208, v204
  v_accvgpr_write_b32 a19, v208
  v_accvgpr_read_b32 v208, a20
  v_mul_f32 v208, v208, v204
  v_accvgpr_write_b32 a20, v208
  v_accvgpr_read_b32 v208, a21
  v_mul_f32 v208, v208, v204
  v_accvgpr_write_b32 a21, v208
  v_accvgpr_read_b32 v208, a22
  v_mul_f32 v208, v208, v204
  v_accvgpr_write_b32 a22, v208
  v_accvgpr_read_b32 v208, a23
  v_mul_f32 v208, v208, v204
  v_accvgpr_write_b32 a23, v208
  v_accvgpr_read_b32 v208, a24
  v_mul_f32 v208, v208, v204
  v_accvgpr_write_b32 a24, v208
  v_accvgpr_read_b32 v208, a25
  v_mul_f32 v208, v208, v204
  v_accvgpr_write_b32 a25, v208
  v_accvgpr_read_b32 v208, a26
  v_mul_f32 v208, v208, v204
  v_accvgpr_write_b32 a26, v208
  v_accvgpr_read_b32 v208, a27
  v_mul_f32 v208, v208, v204
  v_accvgpr_write_b32 a27, v208
  v_accvgpr_read_b32 v208, a28
  v_mul_f32 v208, v208, v204
  v_accvgpr_write_b32 a28, v208
  v_accvgpr_read_b32 v208, a29
  v_mul_f32 v208, v208, v204
  v_accvgpr_write_b32 a29, v208
  v_accvgpr_read_b32 v208, a30
  v_mul_f32 v208, v208, v204
  v_accvgpr_write_b32 a30, v208
  v_accvgpr_read_b32 v208, a31
  v_mul_f32 v208, v208, v204
  v_accvgpr_write_b32 a31, v208
  v_accvgpr_read_b32 v208, a32
  v_mul_f32 v208, v208, v204
  v_accvgpr_write_b32 a32, v208
  v_accvgpr_read_b32 v208, a33
  v_mul_f32 v208, v208, v204
  v_accvgpr_write_b32 a33, v208
  v_accvgpr_read_b32 v208, a34
  v_mul_f32 v208, v208, v204
  v_accvgpr_write_b32 a34, v208
  v_accvgpr_read_b32 v208, a35
  v_mul_f32 v208, v208, v204
  v_accvgpr_write_b32 a35, v208
  v_accvgpr_read_b32 v208, a36
  v_mul_f32 v208, v208, v204
  v_accvgpr_write_b32 a36, v208
  v_accvgpr_read_b32 v208, a37
  v_mul_f32 v208, v208, v204
  v_accvgpr_write_b32 a37, v208
  v_accvgpr_read_b32 v208, a38
  v_mul_f32 v208, v208, v204
  v_accvgpr_write_b32 a38, v208
  v_accvgpr_read_b32 v208, a39
  v_mul_f32 v208, v208, v204
  v_accvgpr_write_b32 a39, v208
  v_accvgpr_read_b32 v208, a40
  v_mul_f32 v208, v208, v204
  v_accvgpr_write_b32 a40, v208
  v_accvgpr_read_b32 v208, a41
  v_mul_f32 v208, v208, v204
  v_accvgpr_write_b32 a41, v208
  v_accvgpr_read_b32 v208, a42
  v_mul_f32 v208, v208, v204
  v_accvgpr_write_b32 a42, v208
  v_accvgpr_read_b32 v208, a43
  v_mul_f32 v208, v208, v204
  v_accvgpr_write_b32 a43, v208
  v_accvgpr_read_b32 v208, a44
  v_mul_f32 v208, v208, v204
  v_accvgpr_write_b32 a44, v208
  v_accvgpr_read_b32 v208, a45
  v_mul_f32 v208, v208, v204
  v_accvgpr_write_b32 a45, v208
  v_accvgpr_read_b32 v208, a46
  v_mul_f32 v208, v208, v204
  v_accvgpr_write_b32 a46, v208
  v_accvgpr_read_b32 v208, a47
  v_mul_f32 v208, v208, v204
  v_accvgpr_write_b32 a47, v208
  v_accvgpr_read_b32 v208, a48
  v_mul_f32 v208, v208, v204
  v_accvgpr_write_b32 a48, v208
  v_accvgpr_read_b32 v208, a49
  v_mul_f32 v208, v208, v204
  v_accvgpr_write_b32 a49, v208
  v_accvgpr_read_b32 v208, a50
  v_mul_f32 v208, v208, v204
  v_accvgpr_write_b32 a50, v208
  v_accvgpr_read_b32 v208, a51
  v_mul_f32 v208, v208, v204
  v_accvgpr_write_b32 a51, v208
  v_accvgpr_read_b32 v208, a52
  v_mul_f32 v208, v208, v204
  v_accvgpr_write_b32 a52, v208
  v_accvgpr_read_b32 v208, a53
  v_mul_f32 v208, v208, v204
  v_accvgpr_write_b32 a53, v208
  v_accvgpr_read_b32 v208, a54
  v_mul_f32 v208, v208, v204
  v_accvgpr_write_b32 a54, v208
  v_accvgpr_read_b32 v208, a55
  v_mul_f32 v208, v208, v204
  v_accvgpr_write_b32 a55, v208
  v_accvgpr_read_b32 v208, a56
  v_mul_f32 v208, v208, v204
  v_accvgpr_write_b32 a56, v208
  v_accvgpr_read_b32 v208, a57
  v_mul_f32 v208, v208, v204
  v_accvgpr_write_b32 a57, v208
  v_accvgpr_read_b32 v208, a58
  v_mul_f32 v208, v208, v204
  v_accvgpr_write_b32 a58, v208
  v_accvgpr_read_b32 v208, a59
  v_mul_f32 v208, v208, v204
  v_accvgpr_write_b32 a59, v208
  v_accvgpr_read_b32 v208, a60
  v_mul_f32 v208, v208, v204
  v_accvgpr_write_b32 a60, v208
  v_accvgpr_read_b32 v208, a61
  v_mul_f32 v208, v208, v204
  v_accvgpr_write_b32 a61, v208
  v_accvgpr_read_b32 v208, a62
  v_mul_f32 v208, v208, v204
  v_accvgpr_write_b32 a62, v208
  v_accvgpr_read_b32 v208, a63
  v_mul_f32 v208, v208, v204
  v_accvgpr_write_b32 a63, v208
  v_max3_f32 v203, v144, v145, v146
  v_max3_f32 v203, v203, v147, v148
  v_max3_f32 v203, v203, v149, v150
  v_max3_f32 v203, v203, v151, v152
  v_max3_f32 v203, v203, v153, v154
  v_max3_f32 v203, v203, v155, v156
  v_max3_f32 v203, v203, v157, v158
  v_max_f32 v203, v203, v159
  v_mov_b32 v208, v203
  s_nop 1
  v_permlane32_swap_b32 v203, v208
  v_max3_f32 v203, v203, v208, v201
  v_sub_f32 v205, v201, v203
  v_exp_f32 v205, v205
  v_mov_b32 v201, v203
  v_sub_f32 v144, v144, v203
  v_exp_f32 v144, v144
  v_sub_f32 v145, v145, v203
  v_exp_f32 v145, v145
  v_sub_f32 v146, v146, v203
  v_exp_f32 v146, v146
  v_sub_f32 v147, v147, v203
  v_exp_f32 v147, v147
  v_sub_f32 v148, v148, v203
  v_exp_f32 v148, v148
  v_sub_f32 v149, v149, v203
  v_exp_f32 v149, v149
  v_sub_f32 v150, v150, v203
  v_exp_f32 v150, v150
  v_sub_f32 v151, v151, v203
  v_exp_f32 v151, v151
  v_sub_f32 v152, v152, v203
  v_exp_f32 v152, v152
  v_sub_f32 v153, v153, v203
  v_exp_f32 v153, v153
  v_sub_f32 v154, v154, v203
  v_exp_f32 v154, v154
  v_sub_f32 v155, v155, v203
  v_exp_f32 v155, v155
  v_sub_f32 v156, v156, v203
  v_exp_f32 v156, v156
  v_sub_f32 v157, v157, v203
  v_exp_f32 v157, v157
  v_sub_f32 v158, v158, v203
  v_exp_f32 v158, v158
  v_sub_f32 v159, v159, v203
  v_exp_f32 v159, v159
  v_add_f32 v207, v144, v145
  v_add_f32 v207, v207, v146
  v_add_f32 v207, v207, v147
  v_add_f32 v207, v207, v148
  v_add_f32 v207, v207, v149
  v_add_f32 v207, v207, v150
  v_add_f32 v207, v207, v151
  v_add_f32 v207, v207, v152
  v_add_f32 v207, v207, v153
  v_add_f32 v207, v207, v154
  v_add_f32 v207, v207, v155
  v_add_f32 v207, v207, v156
  v_add_f32 v207, v207, v157
  v_add_f32 v207, v207, v158
  v_add_f32 v207, v207, v159
  v_fma_f32 v226, v226, v205, v207
  v_cvt_pk_bf16_f32 v144, v144, v145
  v_cvt_pk_bf16_f32 v145, v146, v147
  v_cvt_pk_bf16_f32 v146, v148, v149
  v_cvt_pk_bf16_f32 v147, v150, v151
  v_cvt_pk_bf16_f32 v148, v152, v153
  v_cvt_pk_bf16_f32 v149, v154, v155
  v_cvt_pk_bf16_f32 v150, v156, v157
  v_cvt_pk_bf16_f32 v151, v158, v159
  v_accvgpr_read_b32 v208, a64
  v_mul_f32 v208, v208, v205
  v_accvgpr_write_b32 a64, v208
  v_accvgpr_read_b32 v208, a65
  v_mul_f32 v208, v208, v205
  v_accvgpr_write_b32 a65, v208
  v_accvgpr_read_b32 v208, a66
  v_mul_f32 v208, v208, v205
  v_accvgpr_write_b32 a66, v208
  v_accvgpr_read_b32 v208, a67
  v_mul_f32 v208, v208, v205
  v_accvgpr_write_b32 a67, v208
  v_accvgpr_read_b32 v208, a68
  v_mul_f32 v208, v208, v205
  v_accvgpr_write_b32 a68, v208
  v_accvgpr_read_b32 v208, a69
  v_mul_f32 v208, v208, v205
  v_accvgpr_write_b32 a69, v208
  v_accvgpr_read_b32 v208, a70
  v_mul_f32 v208, v208, v205
  v_accvgpr_write_b32 a70, v208
  v_accvgpr_read_b32 v208, a71
  v_mul_f32 v208, v208, v205
  v_accvgpr_write_b32 a71, v208
  v_accvgpr_read_b32 v208, a72
  v_mul_f32 v208, v208, v205
  v_accvgpr_write_b32 a72, v208
  v_accvgpr_read_b32 v208, a73
  v_mul_f32 v208, v208, v205
  v_accvgpr_write_b32 a73, v208
  v_accvgpr_read_b32 v208, a74
  v_mul_f32 v208, v208, v205
  v_accvgpr_write_b32 a74, v208
  v_accvgpr_read_b32 v208, a75
  v_mul_f32 v208, v208, v205
  v_accvgpr_write_b32 a75, v208
  v_accvgpr_read_b32 v208, a76
  v_mul_f32 v208, v208, v205
  v_accvgpr_write_b32 a76, v208
  v_accvgpr_read_b32 v208, a77
  v_mul_f32 v208, v208, v205
  v_accvgpr_write_b32 a77, v208
  v_accvgpr_read_b32 v208, a78
  v_mul_f32 v208, v208, v205
  v_accvgpr_write_b32 a78, v208
  v_accvgpr_read_b32 v208, a79
  v_mul_f32 v208, v208, v205
  v_accvgpr_write_b32 a79, v208
  v_accvgpr_read_b32 v208, a80
  v_mul_f32 v208, v208, v205
  v_accvgpr_write_b32 a80, v208
  v_accvgpr_read_b32 v208, a81
  v_mul_f32 v208, v208, v205
  v_accvgpr_write_b32 a81, v208
  v_accvgpr_read_b32 v208, a82
  v_mul_f32 v208, v208, v205
  v_accvgpr_write_b32 a82, v208
  v_accvgpr_read_b32 v208, a83
  v_mul_f32 v208, v208, v205
  v_accvgpr_write_b32 a83, v208
  v_accvgpr_read_b32 v208, a84
  v_mul_f32 v208, v208, v205
  v_accvgpr_write_b32 a84, v208
  v_accvgpr_read_b32 v208, a85
  v_mul_f32 v208, v208, v205
  v_accvgpr_write_b32 a85, v208
  v_accvgpr_read_b32 v208, a86
  v_mul_f32 v208, v208, v205
  v_accvgpr_write_b32 a86, v208
  v_accvgpr_read_b32 v208, a87
  v_mul_f32 v208, v208, v205
  v_accvgpr_write_b32 a87, v208
  v_accvgpr_read_b32 v208, a88
  v_mul_f32 v208, v208, v205
  v_accvgpr_write_b32 a88, v208
  v_accvgpr_read_b32 v208, a89
  v_mul_f32 v208, v208, v205
  v_accvgpr_write_b32 a89, v208
  v_accvgpr_read_b32 v208, a90
  v_mul_f32 v208, v208, v205
  v_accvgpr_write_b32 a90, v208
  v_accvgpr_read_b32 v208, a91
  v_mul_f32 v208, v208, v205
  v_accvgpr_write_b32 a91, v208
  v_accvgpr_read_b32 v208, a92
  v_mul_f32 v208, v208, v205
  v_accvgpr_write_b32 a92, v208
  v_accvgpr_read_b32 v208, a93
  v_mul_f32 v208, v208, v205
  v_accvgpr_write_b32 a93, v208
  v_accvgpr_read_b32 v208, a94
  v_mul_f32 v208, v208, v205
  v_accvgpr_write_b32 a94, v208
  v_accvgpr_read_b32 v208, a95
  v_mul_f32 v208, v208, v205
  v_accvgpr_write_b32 a95, v208
  v_accvgpr_read_b32 v208, a96
  v_mul_f32 v208, v208, v205
  v_accvgpr_write_b32 a96, v208
  v_accvgpr_read_b32 v208, a97
  v_mul_f32 v208, v208, v205
  v_accvgpr_write_b32 a97, v208
  v_accvgpr_read_b32 v208, a98
  v_mul_f32 v208, v208, v205
  v_accvgpr_write_b32 a98, v208
  v_accvgpr_read_b32 v208, a99
  v_mul_f32 v208, v208, v205
  v_accvgpr_write_b32 a99, v208
  v_accvgpr_read_b32 v208, a100
  v_mul_f32 v208, v208, v205
  v_accvgpr_write_b32 a100, v208
  v_accvgpr_read_b32 v208, a101
  v_mul_f32 v208, v208, v205
  v_accvgpr_write_b32 a101, v208
  v_accvgpr_read_b32 v208, a102
  v_mul_f32 v208, v208, v205
  v_accvgpr_write_b32 a102, v208
  v_accvgpr_read_b32 v208, a103
  v_mul_f32 v208, v208, v205
  v_accvgpr_write_b32 a103, v208
  v_accvgpr_read_b32 v208, a104
  v_mul_f32 v208, v208, v205
  v_accvgpr_write_b32 a104, v208
  v_accvgpr_read_b32 v208, a105
  v_mul_f32 v208, v208, v205
  v_accvgpr_write_b32 a105, v208
  v_accvgpr_read_b32 v208, a106
  v_mul_f32 v208, v208, v205
  v_accvgpr_write_b32 a106, v208
  v_accvgpr_read_b32 v208, a107
  v_mul_f32 v208, v208, v205
  v_accvgpr_write_b32 a107, v208
  v_accvgpr_read_b32 v208, a108
  v_mul_f32 v208, v208, v205
  v_accvgpr_write_b32 a108, v208
  v_accvgpr_read_b32 v208, a109
  v_mul_f32 v208, v208, v205
  v_accvgpr_write_b32 a109, v208
  v_accvgpr_read_b32 v208, a110
  v_mul_f32 v208, v208, v205
  v_accvgpr_write_b32 a110, v208
  v_accvgpr_read_b32 v208, a111
  v_mul_f32 v208, v208, v205
  v_accvgpr_write_b32 a111, v208
  v_accvgpr_read_b32 v208, a112
  v_mul_f32 v208, v208, v205
  v_accvgpr_write_b32 a112, v208
  v_accvgpr_read_b32 v208, a113
  v_mul_f32 v208, v208, v205
  v_accvgpr_write_b32 a113, v208
  v_accvgpr_read_b32 v208, a114
  v_mul_f32 v208, v208, v205
  v_accvgpr_write_b32 a114, v208
  v_accvgpr_read_b32 v208, a115
  v_mul_f32 v208, v208, v205
  v_accvgpr_write_b32 a115, v208
  v_accvgpr_read_b32 v208, a116
  v_mul_f32 v208, v208, v205
  v_accvgpr_write_b32 a116, v208
  v_accvgpr_read_b32 v208, a117
  v_mul_f32 v208, v208, v205
  v_accvgpr_write_b32 a117, v208
  v_accvgpr_read_b32 v208, a118
  v_mul_f32 v208, v208, v205
  v_accvgpr_write_b32 a118, v208
  v_accvgpr_read_b32 v208, a119
  v_mul_f32 v208, v208, v205
  v_accvgpr_write_b32 a119, v208
  v_accvgpr_read_b32 v208, a120
  v_mul_f32 v208, v208, v205
  v_accvgpr_write_b32 a120, v208
  v_accvgpr_read_b32 v208, a121
  v_mul_f32 v208, v208, v205
  v_accvgpr_write_b32 a121, v208
  v_accvgpr_read_b32 v208, a122
  v_mul_f32 v208, v208, v205
  v_accvgpr_write_b32 a122, v208
  v_accvgpr_read_b32 v208, a123
  v_mul_f32 v208, v208, v205
  v_accvgpr_write_b32 a123, v208
  v_accvgpr_read_b32 v208, a124
  v_mul_f32 v208, v208, v205
  v_accvgpr_write_b32 a124, v208
  v_accvgpr_read_b32 v208, a125
  v_mul_f32 v208, v208, v205
  v_accvgpr_write_b32 a125, v208
  v_accvgpr_read_b32 v208, a126
  v_mul_f32 v208, v208, v205
  v_accvgpr_write_b32 a126, v208
  v_accvgpr_read_b32 v208, a127
  v_mul_f32 v208, v208, v205
  v_accvgpr_write_b32 a127, v208
  s_add_u32 s68, s63, s71
  s_add_u32 s68, s68, 0
  s_add_u32 m0, s73, 0
  s_nop 0
  buffer_load_dwordx4 v196, s[28:31], s68 offen lds
  s_add_u32 s68, s63, s71
  s_add_u32 s68, s68, 0x400
  s_add_u32 m0, s73, 0x400
  s_nop 0
  buffer_load_dwordx4 v196, s[28:31], s68 offen lds
  s_add_u32 s68, s63, s71
  s_add_u32 s68, s68, 0x800
  s_add_u32 m0, s73, 0x800
  s_nop 0
  buffer_load_dwordx4 v196, s[28:31], s68 offen lds
  s_add_u32 s68, s63, s71
  s_add_u32 s68, s68, 0xc00
  s_add_u32 m0, s73, 0xc00
  s_nop 0
  buffer_load_dwordx4 v196, s[28:31], s68 offen lds
  s_add_u32 s68, s63, s71
  s_add_u32 s68, s68, 0x1000
  s_add_u32 m0, s73, 0x1000
  s_nop 0
  buffer_load_dwordx4 v196, s[28:31], s68 offen lds
  s_add_u32 s68, s63, s71
  s_add_u32 s68, s68, 0x1400
  s_add_u32 m0, s73, 0x1400
  s_nop 0
  buffer_load_dwordx4 v196, s[28:31], s68 offen lds
  s_add_u32 s68, s63, s71
  s_add_u32 s68, s68, 0x1800
  s_add_u32 m0, s73, 0x1800
  s_nop 0
  buffer_load_dwordx4 v196, s[28:31], s68 offen lds
  s_add_u32 s68, s63, s71
  s_add_u32 s68, s68, 0x1c00
  s_add_u32 m0, s73, 0x1c00
  s_nop 0
  buffer_load_dwordx4 v196, s[28:31], s68 offen lds
  s_waitcnt vmcnt(0)
  ds_read_b64_tr_b16 a[176:177], v198
  ds_read_b64_tr_b16 a[178:179], v198 offset:2048
  ds_read_b64_tr_b16 a[180:181], v198 offset:256
  ds_read_b64_tr_b16 a[182:183], v198 offset:2304
  ds_read_b64_tr_b16 a[184:185], v198 offset:512
  ds_read_b64_tr_b16 a[186:187], v198 offset:2560
  ds_read_b64_tr_b16 a[188:189], v198 offset:768
  ds_read_b64_tr_b16 a[190:191], v198 offset:2816
  ds_read_b64_tr_b16 a[192:193], v198 offset:4096
  ds_read_b64_tr_b16 a[194:195], v198 offset:6144
  ds_read_b64_tr_b16 a[196:197], v198 offset:4352
  ds_read_b64_tr_b16 a[198:199], v198 offset:6400
  ds_read_b64_tr_b16 a[200:201], v198 offset:4608
  ds_read_b64_tr_b16 a[202:203], v198 offset:6656
  ds_read_b64_tr_b16 a[204:205], v198 offset:4864
  ds_read_b64_tr_b16 a[206:207], v198 offset:6912
  s_waitcnt lgkmcnt(14)
  v_mfma_f32_32x32x16_bf16 a[0:15], a[176:179], v[128:131], a[0:15]
  v_mfma_f32_32x32x16_bf16 a[64:79], a[176:179], v[144:147], a[64:79]
  s_waitcnt lgkmcnt(12)
  v_mfma_f32_32x32x16_bf16 a[16:31], a[180:183], v[128:131], a[16:31]
  v_mfma_f32_32x32x16_bf16 a[80:95], a[180:183], v[144:147], a[80:95]
  s_waitcnt lgkmcnt(10)
  v_mfma_f32_32x32x16_bf16 a[32:47], a[184:187], v[128:131], a[32:47]
  v_mfma_f32_32x32x16_bf16 a[96:111], a[184:187], v[144:147], a[96:111]
  s_waitcnt lgkmcnt(8)
  v_mfma_f32_32x32x16_bf16 a[48:63], a[188:191], v[128:131], a[48:63]
  v_mfma_f32_32x32x16_bf16 a[112:127], a[188:191], v[144:147], a[112:127]
  s_waitcnt lgkmcnt(6)
  v_mfma_f32_32x32x16_bf16 a[0:15], a[192:195], v[132:135], a[0:15]
  v_mfma_f32_32x32x16_bf16 a[64:79], a[192:195], v[148:151], a[64:79]
  s_waitcnt lgkmcnt(4)
  v_mfma_f32_32x32x16_bf16 a[16:31], a[196:199], v[132:135], a[16:31]
  v_mfma_f32_32x32x16_bf16 a[80:95], a[196:199], v[148:151], a[80:95]
  s_waitcnt lgkmcnt(2)
  v_mfma_f32_32x32x16_bf16 a[32:47], a[200:203], v[132:135], a[32:47]
  v_mfma_f32_32x32x16_bf16 a[96:111], a[200:203], v[148:151], a[96:111]
  s_waitcnt lgkmcnt(0)
  v_mfma_f32_32x32x16_bf16 a[48:63], a[204:207], v[132:135], a[48:63]
  v_mfma_f32_32x32x16_bf16 a[112:127], a[204:207], v[148:151], a[112:127]
  s_add_u32 s71, s71, 0x2000
  s_cmp_lt_u32 s71, 0x20000
  s_cbranch_scc1 adaLN_cond__sliding_block_cached__glu_gated_swiglu__prompt_kernel_slowloop
  v_mov_b32 v208, v224
  s_nop 1
  v_permlane32_swap_b32 v224, v208
  v_add_f32 v224, v224, v208
  v_mov_b32 v208, v226
  s_nop 1
  v_permlane32_swap_b32 v226, v208
  v_add_f32 v226, v226, v208
  s_mov_b32 m0, s70
  s_waitcnt vmcnt(0) lgkmcnt(0)
  s_nop 15
  s_nop 15
  s_branch adaLN_cond__sliding_block_cached__glu_gated_swiglu__prompt_kernel_back
adaLN_cond__sliding_block_cached__glu_gated_swiglu__prompt_kernel_end:
.section .rodata,"a"
.p2align 6
.amdhsa_kernel adaLN_cond__sliding_block_cached__glu_gated_swiglu__prompt_kernel
  .amdhsa_next_free_vgpr 512
  .amdhsa_next_free_sgpr 102
  .amdhsa_accum_offset 256
  .amdhsa_group_segment_fixed_size 0
  .amdhsa_kernarg_size 112
  .amdhsa_user_sgpr_count 2
  .amdhsa_user_sgpr_kernarg_segment_ptr 1
  .amdhsa_system_sgpr_workgroup_id_x 1
.end_amdhsa_kernel
```
